```python
import torch

def _softmax(x, axis=-1):
    return torch.softmax(x, dim=axis)
def _gelu(x):
    return torch.nn.functional.gelu(x, approximate="tanh")
def _silu(x):
    return torch.nn.functional.silu(x)
def _sigmoid(x):
    return torch.sigmoid(x)
def _layernorm(x, axis=-1, eps=1e-5):
    m = x.mean(dim=axis, keepdim=True)
    v = x.var(dim=axis, keepdim=True, unbiased=False)
    return (x - m) / torch.sqrt(v + eps)
def _scatter_add(tgt, idx, src, axis=0):
    return tgt.clone().index_add_(axis, idx, src)
def _segment_sum(src, seg, n):
    out = torch.zeros((n,) + src.shape[1:], dtype=src.dtype)
    return out.index_add_(0, seg, src)
def _pad(x, pw):
    flat = tuple(v for pair in reversed(pw) for v in pair)
    return torch.nn.functional.pad(x, flat)

kernel_name = 'standalone__seq2seq_rnn_t_joint__speech'

def setup_inputs():

    _w = (lambda a: (lambda t: t.to(torch.bfloat16) if t.is_floating_point() else t)(torch.as_tensor(a)))
    B, T, D, K = 2, 4000, 512, 15
    U = 8
    sc = (1.0 / (K * D)) ** 0.5
    sd = (1.0 / D) ** 0.5
    return {
        "x": _w((lambda *s: torch.randn(*s, dtype=torch.bfloat16) * 0.4)(B, T, D) * 0.5),
        "w1": _w((lambda *s: torch.randn(*s, dtype=torch.bfloat16) * 3.2)(K, D, D) * sc),
        "w2": _w((lambda *s: torch.randn(*s, dtype=torch.bfloat16) * 3.2)(K, D, D) * sc),
        "g": _w((lambda *s: torch.randn(*s, dtype=torch.bfloat16) * 3.2)(B, U, D) * 0.5),
        "w_f": _w((lambda *s: torch.randn(*s, dtype=torch.bfloat16) * 3.2)(D, D) * sd),
        "w_g": _w((lambda *s: torch.randn(*s, dtype=torch.bfloat16) * 3.2)(D, D) * sd),
        "w_o": _w((lambda *s: torch.randn(*s, dtype=torch.bfloat16) * 3.2)(D, D) * sd),
    }

def reference(x, w1, w2, g, w_f, w_g, w_o):
    B, T, D = x.shape
    K = w1.shape[0]
    pad = K // 2
    xp = _pad(x, ((0,0),(pad,pad),(0,0)))
    h = torch.zeros_like(x)
    for i in range(K):
        h = h + torch.einsum("btc,cd->btd", xp[:, i:i+T, :], w1[i])
    h = _gelu(h)[:, ::2, :]
    T1 = h.shape[1]
    hp = _pad(h, ((0,0),(pad,pad),(0,0)))
    f = torch.zeros_like(h)
    for i in range(K):
        f = f + torch.einsum("btc,cd->btd", hp[:, i:i+T1, :], w2[i])
    f = _gelu(f)[:, ::2, :]
    fe = torch.einsum("btd,de->bte", f, w_f)
    ge = torch.einsum("bud,de->bue", g, w_g)
    j = torch.tanh(fe[:, :, None, :] + ge[:, None, :, :])
    return torch.einsum("btud,dv->btuv", j, w_o)
```

```asm
; @launch grid=(256,1,1) block=(256,1,1) lds=151616
.amdgcn_target "amdgcn-amd-amdhsa--gfx950"
.text
.globl standalone__seq2seq_rnn_t_joint__speech_kernel
.p2align 8
.type standalone__seq2seq_rnn_t_joint__speech_kernel,@function
standalone__seq2seq_rnn_t_joint__speech_kernel:
    s_cmp_ge_u32 s2, 256
    s_cbranch_scc1 standalone__seq2seq_rnn_t_joint__speech_kernel_end
    s_load_dwordx2 s[4:5], s[0:1], 0
    s_load_dwordx2 s[8:9], s[0:1], 8
    s_load_dwordx2 s[12:13], s[0:1], 72
    v_lshrrev_b32 v1, 6, v0
    v_and_b32 v0, 63, v0
    s_and_b32 s18, s2, 3
    s_lshl_b32 s18, s18, 1
    s_bfe_u32 s27, s2, 0x10003
    s_add_u32 s18, s18, s27
    s_lshr_b32 s17, s2, 4
    s_bfe_u32 s27, s2, 0x10002
    s_lshl_b32 s27, s27, 4
    s_add_u32 s17, s17, s27
    v_readfirstlane_b32 s16, v1
    s_lshr_b32 s19, s17, 4
    s_and_b32 s20, s17, 15
    s_mul_i32 s20, s20, 126
    v_and_b32 v1, 15, v0
    v_lshrrev_b32 v2, 4, v0
    s_lshl_b32 s27, s16, 2
    s_add_u32 s27, s27, s20
    v_add_u32 v3, s27, v2
    v_lshlrev_b32 v3, 11, v3
    v_subrev_u32 v3, 7168, v3
    s_lshr_b32 s28, s16, 1
    s_lshl_b32 s28, s28, 1
    v_xor_b32 v4, s28, v1
    v_lshlrev_b32 v4, 4, v4
    s_lshl_b32 s24, s16, 10
    s_mov_b32 s26, 0
    s_mul_i32 s27, s19, 4096000
    v_xor_b32 v5, 0, v4
    v_add_u32 v20, v5, v3
    v_xor_b32 v5, 64, v4
    v_add_u32 v21, v5, v3
    v_add_u32 v21, 32768, v21
    v_xor_b32 v5, 128, v4
    v_add_u32 v22, v5, v3
    v_add_u32 v22, 65536, v22
    v_xor_b32 v5, 192, v4
    v_add_u32 v23, v5, v3
    v_add_u32 v23, 98304, v23
    v_add_u32 v24, 131072, v20
    v_add_u32 v25, 131072, v21
    v_add_u32 v26, 131072, v22
    v_add_u32 v27, 131072, v23
    s_and_b32 s25, s16, 1
    s_lshl_b32 s29, s25, 2
    s_add_u32 s29, s29, s20
    s_add_u32 s29, s29, 128
    v_add_u32 v5, s29, v2
    v_lshlrev_b32 v5, 11, v5
    v_subrev_u32 v5, 7168, v5
    v_lshl_add_u32 v28, v1, 4, v5
    s_add_u32 s25, s25, 32
    s_lshl_b32 s25, s25, 10
    v_lshrrev_b32 v3, 3, v0
    v_and_b32 v4, 4, v3
    v_and_b32 v5, 1, v3
    v_lshl_or_b32 v4, v5, 1, v4
    v_bfe_u32 v5, v3, 1, 1
    v_or_b32 v4, v4, v5
    v_lshlrev_b32 v4, 12, v4
    s_lshl_b32 s28, s18, 7
    v_add_u32 v4, s28, v4
    v_and_b32 v5, 7, v0
    v_xor_b32 v6, 0, v5
    v_lshl_add_u32 v16, v6, 4, v4
    v_xor_b32 v6, 2, v5
    v_lshl_add_u32 v17, v6, 4, v4
    v_xor_b32 v6, 4, v5
    v_lshl_add_u32 v18, v6, 4, v4
    v_xor_b32 v6, 6, v5
    v_lshl_add_u32 v19, v6, 4, v4
    s_lshl_b32 s21, s16, 15
    s_mul_i32 s23, s16, 20480
    s_add_u32 s23, s23, 69632
    s_mov_b32 s10, 7864320
    s_mov_b32 s11, 0x00020000
    s_mov_b32 s6, 4096000
    s_mov_b32 s7, 0x00020000
    s_waitcnt lgkmcnt(0)
    s_add_u32 s4, s4, s27
    s_addc_u32 s5, s5, 0
    s_add_u32 s22, s21, 0
    s_add_u32 m0, s23, 0
    s_nop 0
    buffer_load_dwordx4 v16, s[8:11], s22 offen offset:0 lds
    buffer_load_dwordx4 v17, s[8:11], s22 offen offset:1024 lds
    buffer_load_dwordx4 v18, s[8:11], s22 offen offset:2048 lds
    buffer_load_dwordx4 v19, s[8:11], s22 offen offset:3072 lds
    s_add_u32 m0, s24, 0
    s_nop 0
    buffer_load_dwordx4 v20, s[4:7], s26 offen lds
    s_add_u32 m0, s24, 4096
    s_nop 0
    buffer_load_dwordx4 v21, s[4:7], s26 offen lds
    s_add_u32 m0, s24, 8192
    s_nop 0
    buffer_load_dwordx4 v22, s[4:7], s26 offen lds
    s_add_u32 m0, s24, 12288
    s_nop 0
    buffer_load_dwordx4 v23, s[4:7], s26 offen lds
    s_add_u32 m0, s24, 16384
    s_nop 0
    buffer_load_dwordx4 v24, s[4:7], s26 offen lds
    s_add_u32 m0, s24, 20480
    s_nop 0
    buffer_load_dwordx4 v25, s[4:7], s26 offen lds
    s_add_u32 m0, s24, 24576
    s_nop 0
    buffer_load_dwordx4 v26, s[4:7], s26 offen lds
    s_add_u32 m0, s24, 28672
    s_nop 0
    buffer_load_dwordx4 v27, s[4:7], s26 offen lds
    s_add_u32 m0, s25, 0
    s_nop 0
    buffer_load_dwordx4 v28, s[4:7], s26 offen lds
    s_add_u32 s22, s21, 1048576
    s_add_u32 m0, s23, 4096
    s_nop 0
    buffer_load_dwordx4 v16, s[8:11], s22 offen offset:0 lds
    buffer_load_dwordx4 v17, s[8:11], s22 offen offset:1024 lds
    buffer_load_dwordx4 v18, s[8:11], s22 offen offset:2048 lds
    buffer_load_dwordx4 v19, s[8:11], s22 offen offset:3072 lds
    s_add_u32 s22, s21, 2097152
    s_add_u32 m0, s23, 8192
    s_nop 0
    buffer_load_dwordx4 v16, s[8:11], s22 offen offset:0 lds
    buffer_load_dwordx4 v17, s[8:11], s22 offen offset:1024 lds
    buffer_load_dwordx4 v18, s[8:11], s22 offen offset:2048 lds
    buffer_load_dwordx4 v19, s[8:11], s22 offen offset:3072 lds
    s_add_u32 s22, s21, 3145728
    s_add_u32 m0, s23, 12288
    s_nop 0
    buffer_load_dwordx4 v16, s[8:11], s22 offen offset:0 lds
    buffer_load_dwordx4 v17, s[8:11], s22 offen offset:1024 lds
    buffer_load_dwordx4 v18, s[8:11], s22 offen offset:2048 lds
    buffer_load_dwordx4 v19, s[8:11], s22 offen offset:3072 lds
    s_add_u32 s22, s21, 4194304
    s_add_u32 m0, s23, 16384
    s_nop 0
    buffer_load_dwordx4 v16, s[8:11], s22 offen offset:0 lds
    buffer_load_dwordx4 v17, s[8:11], s22 offen offset:1024 lds
    buffer_load_dwordx4 v18, s[8:11], s22 offen offset:2048 lds
    buffer_load_dwordx4 v19, s[8:11], s22 offen offset:3072 lds
    s_add_u32 s92, s12, 11534336
    s_addc_u32 s93, s13, 0
    s_load_dword s100, s[92:93], 0
    v_and_b32 v188, 31, v0
    v_lshlrev_b32 v188, 4, v188
    v_lshrrev_b32 v5, 5, v0
    v_lshl_add_u32 v188, v5, 19, v188
    s_lshl_b32 s28, s2, 9
    v_add_u32 v188, s28, v188
    s_lshl_b32 s28, s16, 17
    buffer_load_dwordx4 v[180:183], v188, s[8:11], s28 offen
    s_add_u32 s28, s28, 1048576
    buffer_load_dwordx4 v[180:183], v188, s[8:11], s28 offen
    s_add_u32 s28, s28, 1048576
    buffer_load_dwordx4 v[180:183], v188, s[8:11], s28 offen
    s_add_u32 s28, s28, 1048576
    buffer_load_dwordx4 v[180:183], v188, s[8:11], s28 offen
    s_add_u32 s28, s28, 1048576
    buffer_load_dwordx4 v[180:183], v188, s[8:11], s28 offen
    s_add_u32 s28, s28, 1048576
    buffer_load_dwordx4 v[180:183], v188, s[8:11], s28 offen
    s_add_u32 s28, s28, 1048576
    buffer_load_dwordx4 v[180:183], v188, s[8:11], s28 offen
    s_add_u32 s28, s28, 1048576
    buffer_load_dwordx4 v[180:183], v188, s[8:11], s28 offen
    v_add_u32 v29, 1024, v20
    v_add_u32 v30, 1024, v21
    v_add_u32 v31, 1024, v22
    v_add_u32 v32, 1024, v23
    v_add_u32 v33, 1024, v24
    v_add_u32 v34, 1024, v25
    v_add_u32 v35, 1024, v26
    v_add_u32 v36, 1024, v27
    v_add_u32 v37, 1024, v28
    s_lshl_b32 s28, s16, 2
    v_add_u32 v3, s28, v2
    v_lshlrev_b32 v6, 11, v1
    v_add_u32 v4, 0, v1
    v_and_b32 v4, 7, v4
    v_lshlrev_b32 v4, 1, v4
    v_xor_b32 v4, v4, v3
    v_lshl_add_u32 v8, v4, 4, v6
    v_add_u32 v4, 1, v1
    v_and_b32 v4, 7, v4
    v_lshlrev_b32 v4, 1, v4
    v_xor_b32 v4, v4, v3
    v_lshl_add_u32 v9, v4, 4, v6
    v_bfe_u32 v3, v0, 2, 2
    v_lshlrev_b32 v4, 3, v3
    v_lshrrev_b32 v5, 1, v2
    v_lshl_add_u32 v4, v5, 2, v4
    v_and_b32 v5, 1, v2
    v_add_u32 v4, v4, v5
    v_lshlrev_b32 v4, 7, v4
    v_and_b32 v5, 3, v0
    v_lshl_add_u32 v4, v5, 3, v4
    v_add_u32 v4, s23, v4
    v_xor_b32 v5, 0, v3
    v_lshl_add_u32 v12, v5, 5, v4
    v_xor_b32 v5, 1, v3
    v_lshl_add_u32 v13, v5, 5, v4
    v_xor_b32 v5, 2, v3
    v_lshl_add_u32 v14, v5, 5, v4
    v_xor_b32 v5, 3, v3
    v_lshl_add_u32 v15, v5, 5, v4
    s_load_dwordx2 s[90:91], s[0:1], 16
    s_load_dwordx2 s[92:93], s[0:1], 32
    s_load_dwordx2 s[94:95], s[0:1], 48
    s_load_dwordx2 s[96:97], s[0:1], 40
    v_lshlrev_b32 v156, 13, v2
    v_lshl_add_u32 v156, v1, 3, v156
    v_lshlrev_b32 v157, 14, v2
    v_lshl_add_u32 v157, v1, 3, v157
    v_lshlrev_b32 v158, 4, v0
    s_mov_b32 s98, 0x05040100
    s_mov_b32 s99, 0x07060302
    s_waitcnt lgkmcnt(0)
    s_add_u32 s100, s100, 1
    s_add_u32 s32, s12, 16777216
    s_addc_u32 s33, s13, 0
    s_mov_b32 s34, 9453568
    s_mov_b32 s35, 0x00020000
    s_lshl_b32 s27, s2, 2
    s_add_u32 s27, s27, s16
    s_mov_b32 s36, s90
    s_mov_b32 s37, s91
    s_mov_b32 s38, 7864320
    s_mov_b32 s39, 0x00020000
    s_lshr_b32 s28, s27, 3
    s_lshl_b32 s28, s28, 15
    s_and_b32 s29, s27, 7
    s_lshl_b32 s29, s29, 7
    s_add_u32 s60, s28, s29
    s_add_u32 s61, s60, 2048
    s_add_u32 s62, s60, 4096
    s_add_u32 s63, s60, 6144
    s_add_u32 s28, s27, 1024
    s_cmp_lt_u32 s28, 1920
    s_cselect_b32 s64, s90, s92
    s_cselect_b32 s65, s91, s93
    s_mov_b32 s66, 524288
    s_cselect_b32 s66, 7864320, s66
    s_mov_b32 s67, 0x00020000
    s_movk_i32 s30, 4096
    s_cselect_b32 s30, 2048, s30
    s_cselect_b64 vcc, -1, 0
    s_movk_i32 s29, 1920
    s_cselect_b32 s29, 0, s29
    s_sub_u32 s28, s28, s29
    v_cndmask_b32 v157, v157, v156, vcc
    s_lshr_b32 s29, s28, 3
    s_lshl_b32 s68, s29, 15
    s_lshr_b32 s69, s29, 1
    s_lshl_b32 s69, s69, 16
    s_and_b32 s29, s29, 1
    s_lshl_b32 s29, s29, 11
    s_add_u32 s69, s69, s29
    s_cmp_eq_u32 s30, 2048
    s_cselect_b32 s68, s68, s69
    s_and_b32 s28, s28, 7
    s_lshl_b32 s28, s28, 7
    s_add_u32 s68, s68, s28
    s_add_u32 s69, s68, s30
    s_add_u32 s86, s69, s30
    s_add_u32 s87, s86, s30
    s_cmp_lt_u32 s2, 128
    s_cselect_b32 s94, s94, s96
    s_cselect_b32 s95, s95, s97
    s_and_b32 s28, s2, 127
    s_lshr_b32 s29, s28, 3
    s_lshl_b32 s29, s29, 15
    s_and_b32 s28, s28, 7
    s_lshl_b32 s28, s28, 7
    s_add_u32 s88, s28, s29
    s_and_b32 s28, s2, 3
    s_cmp_eq_u32 s28, s16
    s_cselect_b32 s88, s88, 0x7ff00000
    s_add_u32 s89, s2, 2048
    s_lshl_b32 s89, s89, 12
    s_add_u32 s89, s2, 2048
    s_lshl_b32 s89, s89, 12
    s_and_b32 s28, s2, 3
    s_cmp_eq_u32 s28, s16
    s_cselect_b32 s89, s89, 0x7ff00000
    s_lshr_b32 s28, s27, 3
    s_lshl_b32 s28, s28, 11
    s_and_b32 s29, s27, 7
    s_mul_i32 s29, s29, 983040
    s_add_u32 s31, s28, s29
    s_add_u32 s30, s31, 491520
    s_mov_b32 s54, s30
    s_add_u32 s55, s31, 262144
    s_add_u32 s28, s27, 1024
    s_lshl_b32 s29, s28, 12
    s_cmp_lt_u32 s28, 1920
    s_cselect_b32 s55, s55, s29
    s_add_u32 s84, s55, 491520
    s_add_u32 s85, s55, 2048
    s_cmp_lt_u32 s28, 1920
    s_cselect_b32 s84, s84, s85
    s_add_u32 s85, s89, 2048
    s_load_dwordx2 s[56:57], s[0:1], 24
    s_mov_b32 s58, 16384
    s_mov_b32 s59, 0x00020000
    s_lshl_b32 s27, s2, 2
    s_add_u32 s27, s27, s16
    s_lshl_b32 s28, s27, 6
    s_lshl_b32 s29, s27, 10
    s_add_u32 s29, s29, 9437184
    s_cmp_lt_u32 s27, 16
    s_cselect_b32 s52, s28, 0x7ff00000
    s_cselect_b32 s53, s29, 0x7ff00000
    v_lshlrev_b32 v159, 10, v1
    v_lshl_add_u32 v159, v2, 4, v159
    s_waitcnt lgkmcnt(0)
    s_waitcnt vmcnt(24)
    s_barrier
    ds_read_b64_tr_b16 v[92:93], v12 offset:0
    ds_read_b64_tr_b16 v[94:95], v12 offset:256
    ds_read_b64_tr_b16 v[96:97], v13 offset:0
    ds_read_b64_tr_b16 v[98:99], v13 offset:256
    ds_read_b64_tr_b16 v[100:101], v14 offset:0
    ds_read_b64_tr_b16 v[102:103], v14 offset:256
    ds_read_b64_tr_b16 v[104:105], v15 offset:0
    ds_read_b64_tr_b16 v[106:107], v15 offset:256
    ds_read_b128 v[40:43], v8 offset:0
    ds_read_b128 v[44:47], v8 offset:256
    ds_read_b128 v[48:51], v8 offset:512
    ds_read_b128 v[52:55], v8 offset:768
    ds_read_b128 v[56:59], v8 offset:1024
    ds_read_b128 v[60:63], v8 offset:1280
    ds_read_b128 v[64:67], v8 offset:1536
    ds_read_b128 v[68:71], v8 offset:1792
    s_waitcnt lgkmcnt(8)
    s_waitcnt lgkmcnt(7)
    v_mfma_f32_16x16x32_bf16 a[0:3], v[92:95], v[40:43], 0
    s_waitcnt vmcnt(20)
    v_mfma_f32_16x16x32_bf16 a[4:7], v[96:99], v[40:43], 0
    ds_read_b64_tr_b16 v[108:109], v12 offset:4096
    v_mfma_f32_16x16x32_bf16 a[8:11], v[100:103], v[40:43], 0
    ds_read_b64_tr_b16 v[110:111], v12 offset:4352
    v_mfma_f32_16x16x32_bf16 a[12:15], v[104:107], v[40:43], 0
    ds_read_b64_tr_b16 v[112:113], v13 offset:4096
    s_waitcnt lgkmcnt(9)
    v_mfma_f32_16x16x32_bf16 a[28:31], v[104:107], v[44:47], 0
    ds_read_b64_tr_b16 v[114:115], v13 offset:4352
    v_mfma_f32_16x16x32_bf16 a[24:27], v[100:103], v[44:47], 0
    ds_read_b64_tr_b16 v[116:117], v14 offset:4096
    v_mfma_f32_16x16x32_bf16 a[20:23], v[96:99], v[44:47], 0
    ds_read_b64_tr_b16 v[118:119], v14 offset:4352
    v_mfma_f32_16x16x32_bf16 a[16:19], v[92:95], v[44:47], 0
    ds_read_b64_tr_b16 v[120:121], v15 offset:4096
    s_waitcnt lgkmcnt(12)
    v_mfma_f32_16x16x32_bf16 a[32:35], v[92:95], v[48:51], 0
    ds_read_b64_tr_b16 v[122:123], v15 offset:4352
    v_mfma_f32_16x16x32_bf16 a[36:39], v[96:99], v[48:51], 0
    v_mfma_f32_16x16x32_bf16 a[40:43], v[100:103], v[48:51], 0
    v_mfma_f32_16x16x32_bf16 a[44:47], v[104:107], v[48:51], 0
    ds_read_b128 v[72:75], v9 offset:2048
    s_waitcnt lgkmcnt(13)
    v_mfma_f32_16x16x32_bf16 a[60:63], v[104:107], v[52:55], 0
    s_add_u32 s22, s21, 5242880
    s_add_u32 m0, s23, 0
    v_mfma_f32_16x16x32_bf16 a[56:59], v[100:103], v[52:55], 0
    buffer_load_dwordx4 v16, s[8:11], s22 offen offset:0 lds
    v_mfma_f32_16x16x32_bf16 a[52:55], v[96:99], v[52:55], 0
    buffer_load_dwordx4 v17, s[8:11], s22 offen offset:1024 lds
    v_mfma_f32_16x16x32_bf16 a[48:51], v[92:95], v[52:55], 0
    buffer_load_dwordx4 v18, s[8:11], s22 offen offset:2048 lds
    s_waitcnt lgkmcnt(12)
    v_mfma_f32_16x16x32_bf16 a[64:67], v[92:95], v[56:59], 0
    buffer_load_dwordx4 v19, s[8:11], s22 offen offset:3072 lds
    v_mfma_f32_16x16x32_bf16 a[68:71], v[96:99], v[56:59], 0
    s_mov_b32 s26, 0
    v_mfma_f32_16x16x32_bf16 a[72:75], v[100:103], v[56:59], 0
    s_add_u32 m0, s24, 34816
    v_mfma_f32_16x16x32_bf16 a[76:79], v[104:107], v[56:59], 0
    buffer_load_dwordx4 v29, s[4:7], s26 offen lds
    s_waitcnt lgkmcnt(11)
    v_mfma_f32_16x16x32_bf16 a[92:95], v[104:107], v[60:63], 0
    s_add_u32 m0, s24, 38912
    v_mfma_f32_16x16x32_bf16 a[88:91], v[100:103], v[60:63], 0
    buffer_load_dwordx4 v30, s[4:7], s26 offen lds
    v_mfma_f32_16x16x32_bf16 a[84:87], v[96:99], v[60:63], 0
    v_mfma_f32_16x16x32_bf16 a[80:83], v[92:95], v[60:63], 0
    s_waitcnt lgkmcnt(10)
    v_mfma_f32_16x16x32_bf16 a[96:99], v[92:95], v[64:67], 0
    v_mfma_f32_16x16x32_bf16 a[100:103], v[96:99], v[64:67], 0
    v_mfma_f32_16x16x32_bf16 a[104:107], v[100:103], v[64:67], 0
    v_mfma_f32_16x16x32_bf16 a[108:111], v[104:107], v[64:67], 0
    s_waitcnt lgkmcnt(9)
    v_mfma_f32_16x16x32_bf16 a[124:127], v[104:107], v[68:71], 0
    v_mfma_f32_16x16x32_bf16 a[120:123], v[100:103], v[68:71], 0
    v_mfma_f32_16x16x32_bf16 a[116:119], v[96:99], v[68:71], 0
    v_mfma_f32_16x16x32_bf16 a[112:115], v[92:95], v[68:71], 0
    s_waitcnt lgkmcnt(1)
    v_mfma_f32_16x16x32_bf16 a[0:3], v[108:111], v[44:47], a[0:3]
    s_waitcnt vmcnt(22)
    v_mfma_f32_16x16x32_bf16 a[4:7], v[112:115], v[44:47], a[4:7]
    ds_read_b64_tr_b16 v[92:93], v12 offset:8192
    v_mfma_f32_16x16x32_bf16 a[8:11], v[116:119], v[44:47], a[8:11]
    ds_read_b64_tr_b16 v[94:95], v12 offset:8448
    v_mfma_f32_16x16x32_bf16 a[12:15], v[120:123], v[44:47], a[12:15]
    ds_read_b64_tr_b16 v[96:97], v13 offset:8192
    v_mfma_f32_16x16x32_bf16 a[28:31], v[120:123], v[48:51], a[28:31]
    ds_read_b64_tr_b16 v[98:99], v13 offset:8448
    v_mfma_f32_16x16x32_bf16 a[24:27], v[116:119], v[48:51], a[24:27]
    ds_read_b64_tr_b16 v[100:101], v14 offset:8192
    v_mfma_f32_16x16x32_bf16 a[20:23], v[112:115], v[48:51], a[20:23]
    ds_read_b64_tr_b16 v[102:103], v14 offset:8448
    v_mfma_f32_16x16x32_bf16 a[16:19], v[108:111], v[48:51], a[16:19]
    ds_read_b64_tr_b16 v[104:105], v15 offset:8192
    v_mfma_f32_16x16x32_bf16 a[32:35], v[108:111], v[52:55], a[32:35]
    ds_read_b64_tr_b16 v[106:107], v15 offset:8448
    v_mfma_f32_16x16x32_bf16 a[36:39], v[112:115], v[52:55], a[36:39]
    v_mfma_f32_16x16x32_bf16 a[40:43], v[116:119], v[52:55], a[40:43]
    v_mfma_f32_16x16x32_bf16 a[44:47], v[120:123], v[52:55], a[44:47]
    ds_read_b128 v[76:79], v9 offset:2304
    v_mfma_f32_16x16x32_bf16 a[60:63], v[120:123], v[56:59], a[60:63]
    s_add_u32 s22, s21, 6291456
    s_add_u32 m0, s23, 4096
    v_mfma_f32_16x16x32_bf16 a[56:59], v[116:119], v[56:59], a[56:59]
    buffer_load_dwordx4 v16, s[8:11], s22 offen offset:0 lds
    v_mfma_f32_16x16x32_bf16 a[52:55], v[112:115], v[56:59], a[52:55]
    buffer_load_dwordx4 v17, s[8:11], s22 offen offset:1024 lds
    v_mfma_f32_16x16x32_bf16 a[48:51], v[108:111], v[56:59], a[48:51]
    buffer_load_dwordx4 v18, s[8:11], s22 offen offset:2048 lds
    v_mfma_f32_16x16x32_bf16 a[64:67], v[108:111], v[60:63], a[64:67]
    buffer_load_dwordx4 v19, s[8:11], s22 offen offset:3072 lds
    v_mfma_f32_16x16x32_bf16 a[68:71], v[112:115], v[60:63], a[68:71]
    s_add_u32 m0, s24, 43008
    v_mfma_f32_16x16x32_bf16 a[72:75], v[116:119], v[60:63], a[72:75]
    buffer_load_dwordx4 v31, s[4:7], s26 offen lds
    v_mfma_f32_16x16x32_bf16 a[76:79], v[120:123], v[60:63], a[76:79]
    s_add_u32 m0, s24, 47104
    v_mfma_f32_16x16x32_bf16 a[92:95], v[120:123], v[64:67], a[92:95]
    buffer_load_dwordx4 v32, s[4:7], s26 offen lds
    v_mfma_f32_16x16x32_bf16 a[88:91], v[116:119], v[64:67], a[88:91]
    v_mfma_f32_16x16x32_bf16 a[84:87], v[112:115], v[64:67], a[84:87]
    v_mfma_f32_16x16x32_bf16 a[80:83], v[108:111], v[64:67], a[80:83]
    v_mfma_f32_16x16x32_bf16 a[96:99], v[108:111], v[68:71], a[96:99]
    v_mfma_f32_16x16x32_bf16 a[100:103], v[112:115], v[68:71], a[100:103]
    v_mfma_f32_16x16x32_bf16 a[104:107], v[116:119], v[68:71], a[104:107]
    v_mfma_f32_16x16x32_bf16 a[108:111], v[120:123], v[68:71], a[108:111]
    s_waitcnt lgkmcnt(9)
    v_mfma_f32_16x16x32_bf16 a[124:127], v[120:123], v[72:75], a[124:127]
    v_mfma_f32_16x16x32_bf16 a[120:123], v[116:119], v[72:75], a[120:123]
    v_mfma_f32_16x16x32_bf16 a[116:119], v[112:115], v[72:75], a[116:119]
    v_mfma_f32_16x16x32_bf16 a[112:115], v[108:111], v[72:75], a[112:115]
    s_waitcnt lgkmcnt(1)
    v_mfma_f32_16x16x32_bf16 a[0:3], v[92:95], v[48:51], a[0:3]
    s_waitcnt vmcnt(24)
    v_mfma_f32_16x16x32_bf16 a[4:7], v[96:99], v[48:51], a[4:7]
    ds_read_b64_tr_b16 v[108:109], v12 offset:12288
    v_mfma_f32_16x16x32_bf16 a[8:11], v[100:103], v[48:51], a[8:11]
    ds_read_b64_tr_b16 v[110:111], v12 offset:12544
    v_mfma_f32_16x16x32_bf16 a[12:15], v[104:107], v[48:51], a[12:15]
    ds_read_b64_tr_b16 v[112:113], v13 offset:12288
    v_mfma_f32_16x16x32_bf16 a[28:31], v[104:107], v[52:55], a[28:31]
    ds_read_b64_tr_b16 v[114:115], v13 offset:12544
    v_mfma_f32_16x16x32_bf16 a[24:27], v[100:103], v[52:55], a[24:27]
    ds_read_b64_tr_b16 v[116:117], v14 offset:12288
    v_mfma_f32_16x16x32_bf16 a[20:23], v[96:99], v[52:55], a[20:23]
    ds_read_b64_tr_b16 v[118:119], v14 offset:12544
    v_mfma_f32_16x16x32_bf16 a[16:19], v[92:95], v[52:55], a[16:19]
    ds_read_b64_tr_b16 v[120:121], v15 offset:12288
    v_mfma_f32_16x16x32_bf16 a[32:35], v[92:95], v[56:59], a[32:35]
    ds_read_b64_tr_b16 v[122:123], v15 offset:12544
    v_mfma_f32_16x16x32_bf16 a[36:39], v[96:99], v[56:59], a[36:39]
    v_mfma_f32_16x16x32_bf16 a[40:43], v[100:103], v[56:59], a[40:43]
    v_mfma_f32_16x16x32_bf16 a[44:47], v[104:107], v[56:59], a[44:47]
    ds_read_b128 v[80:83], v9 offset:2560
    v_mfma_f32_16x16x32_bf16 a[60:63], v[104:107], v[60:63], a[60:63]
    s_add_u32 s22, s21, 7340032
    s_add_u32 m0, s23, 8192
    v_mfma_f32_16x16x32_bf16 a[56:59], v[100:103], v[60:63], a[56:59]
    buffer_load_dwordx4 v16, s[8:11], s22 offen offset:0 lds
    v_mfma_f32_16x16x32_bf16 a[52:55], v[96:99], v[60:63], a[52:55]
    buffer_load_dwordx4 v17, s[8:11], s22 offen offset:1024 lds
    v_mfma_f32_16x16x32_bf16 a[48:51], v[92:95], v[60:63], a[48:51]
    buffer_load_dwordx4 v18, s[8:11], s22 offen offset:2048 lds
    v_mfma_f32_16x16x32_bf16 a[64:67], v[92:95], v[64:67], a[64:67]
    buffer_load_dwordx4 v19, s[8:11], s22 offen offset:3072 lds
    v_mfma_f32_16x16x32_bf16 a[68:71], v[96:99], v[64:67], a[68:71]
    s_add_u32 m0, s24, 51200
    v_mfma_f32_16x16x32_bf16 a[72:75], v[100:103], v[64:67], a[72:75]
    buffer_load_dwordx4 v33, s[4:7], s26 offen lds
    v_mfma_f32_16x16x32_bf16 a[76:79], v[104:107], v[64:67], a[76:79]
    s_add_u32 m0, s24, 55296
    v_mfma_f32_16x16x32_bf16 a[92:95], v[104:107], v[68:71], a[92:95]
    buffer_load_dwordx4 v34, s[4:7], s26 offen lds
    v_mfma_f32_16x16x32_bf16 a[88:91], v[100:103], v[68:71], a[88:91]
    v_mfma_f32_16x16x32_bf16 a[84:87], v[96:99], v[68:71], a[84:87]
    v_mfma_f32_16x16x32_bf16 a[80:83], v[92:95], v[68:71], a[80:83]
    v_mfma_f32_16x16x32_bf16 a[96:99], v[92:95], v[72:75], a[96:99]
    v_mfma_f32_16x16x32_bf16 a[100:103], v[96:99], v[72:75], a[100:103]
    v_mfma_f32_16x16x32_bf16 a[104:107], v[100:103], v[72:75], a[104:107]
    v_mfma_f32_16x16x32_bf16 a[108:111], v[104:107], v[72:75], a[108:111]
    s_waitcnt lgkmcnt(9)
    v_mfma_f32_16x16x32_bf16 a[124:127], v[104:107], v[76:79], a[124:127]
    v_mfma_f32_16x16x32_bf16 a[120:123], v[100:103], v[76:79], a[120:123]
    v_mfma_f32_16x16x32_bf16 a[116:119], v[96:99], v[76:79], a[116:119]
    v_mfma_f32_16x16x32_bf16 a[112:115], v[92:95], v[76:79], a[112:115]
    s_waitcnt lgkmcnt(1)
    v_mfma_f32_16x16x32_bf16 a[0:3], v[108:111], v[52:55], a[0:3]
    s_waitcnt vmcnt(26)
    v_mfma_f32_16x16x32_bf16 a[4:7], v[112:115], v[52:55], a[4:7]
    ds_read_b64_tr_b16 v[92:93], v12 offset:16384
    v_mfma_f32_16x16x32_bf16 a[8:11], v[116:119], v[52:55], a[8:11]
    ds_read_b64_tr_b16 v[94:95], v12 offset:16640
    v_mfma_f32_16x16x32_bf16 a[12:15], v[120:123], v[52:55], a[12:15]
    ds_read_b64_tr_b16 v[96:97], v13 offset:16384
    v_mfma_f32_16x16x32_bf16 a[28:31], v[120:123], v[56:59], a[28:31]
    ds_read_b64_tr_b16 v[98:99], v13 offset:16640
    v_mfma_f32_16x16x32_bf16 a[24:27], v[116:119], v[56:59], a[24:27]
    ds_read_b64_tr_b16 v[100:101], v14 offset:16384
    v_mfma_f32_16x16x32_bf16 a[20:23], v[112:115], v[56:59], a[20:23]
    ds_read_b64_tr_b16 v[102:103], v14 offset:16640
    v_mfma_f32_16x16x32_bf16 a[16:19], v[108:111], v[56:59], a[16:19]
    ds_read_b64_tr_b16 v[104:105], v15 offset:16384
    v_mfma_f32_16x16x32_bf16 a[32:35], v[108:111], v[60:63], a[32:35]
    ds_read_b64_tr_b16 v[106:107], v15 offset:16640
    v_mfma_f32_16x16x32_bf16 a[36:39], v[112:115], v[60:63], a[36:39]
    v_mfma_f32_16x16x32_bf16 a[40:43], v[116:119], v[60:63], a[40:43]
    v_mfma_f32_16x16x32_bf16 a[44:47], v[120:123], v[60:63], a[44:47]
    ds_read_b128 v[84:87], v9 offset:2816
    v_mfma_f32_16x16x32_bf16 a[60:63], v[120:123], v[64:67], a[60:63]
    s_add_u32 s22, s21, 524288
    s_add_u32 m0, s23, 12288
    v_mfma_f32_16x16x32_bf16 a[56:59], v[116:119], v[64:67], a[56:59]
    buffer_load_dwordx4 v16, s[8:11], s22 offen offset:0 lds
    v_mfma_f32_16x16x32_bf16 a[52:55], v[112:115], v[64:67], a[52:55]
    buffer_load_dwordx4 v17, s[8:11], s22 offen offset:1024 lds
    v_mfma_f32_16x16x32_bf16 a[48:51], v[108:111], v[64:67], a[48:51]
    buffer_load_dwordx4 v18, s[8:11], s22 offen offset:2048 lds
    v_mfma_f32_16x16x32_bf16 a[64:67], v[108:111], v[68:71], a[64:67]
    buffer_load_dwordx4 v19, s[8:11], s22 offen offset:3072 lds
    v_mfma_f32_16x16x32_bf16 a[68:71], v[112:115], v[68:71], a[68:71]
    s_add_u32 m0, s24, 59392
    v_mfma_f32_16x16x32_bf16 a[72:75], v[116:119], v[68:71], a[72:75]
    buffer_load_dwordx4 v35, s[4:7], s26 offen lds
    v_mfma_f32_16x16x32_bf16 a[76:79], v[120:123], v[68:71], a[76:79]
    s_add_u32 m0, s24, 63488
    v_mfma_f32_16x16x32_bf16 a[92:95], v[120:123], v[72:75], a[92:95]
    buffer_load_dwordx4 v36, s[4:7], s26 offen lds
    v_mfma_f32_16x16x32_bf16 a[88:91], v[116:119], v[72:75], a[88:91]
    v_mfma_f32_16x16x32_bf16 a[84:87], v[112:115], v[72:75], a[84:87]
    v_mfma_f32_16x16x32_bf16 a[80:83], v[108:111], v[72:75], a[80:83]
    v_mfma_f32_16x16x32_bf16 a[96:99], v[108:111], v[76:79], a[96:99]
    v_mfma_f32_16x16x32_bf16 a[100:103], v[112:115], v[76:79], a[100:103]
    v_mfma_f32_16x16x32_bf16 a[104:107], v[116:119], v[76:79], a[104:107]
    v_mfma_f32_16x16x32_bf16 a[108:111], v[120:123], v[76:79], a[108:111]
    s_waitcnt lgkmcnt(9)
    v_mfma_f32_16x16x32_bf16 a[124:127], v[120:123], v[80:83], a[124:127]
    v_mfma_f32_16x16x32_bf16 a[120:123], v[116:119], v[80:83], a[120:123]
    v_mfma_f32_16x16x32_bf16 a[116:119], v[112:115], v[80:83], a[116:119]
    v_mfma_f32_16x16x32_bf16 a[112:115], v[108:111], v[80:83], a[112:115]
    s_waitcnt lgkmcnt(1)
    v_mfma_f32_16x16x32_bf16 a[0:3], v[92:95], v[56:59], a[0:3]
    s_waitcnt vmcnt(20)
    v_mfma_f32_16x16x32_bf16 a[4:7], v[96:99], v[56:59], a[4:7]
    ds_read_b64_tr_b16 v[108:109], v12 offset:0
    v_mfma_f32_16x16x32_bf16 a[8:11], v[100:103], v[56:59], a[8:11]
    ds_read_b64_tr_b16 v[110:111], v12 offset:256
    v_mfma_f32_16x16x32_bf16 a[12:15], v[104:107], v[56:59], a[12:15]
    ds_read_b64_tr_b16 v[112:113], v13 offset:0
    v_mfma_f32_16x16x32_bf16 a[28:31], v[104:107], v[60:63], a[28:31]
    ds_read_b64_tr_b16 v[114:115], v13 offset:256
    v_mfma_f32_16x16x32_bf16 a[24:27], v[100:103], v[60:63], a[24:27]
    ds_read_b64_tr_b16 v[116:117], v14 offset:0
    v_mfma_f32_16x16x32_bf16 a[20:23], v[96:99], v[60:63], a[20:23]
    ds_read_b64_tr_b16 v[118:119], v14 offset:256
    v_mfma_f32_16x16x32_bf16 a[16:19], v[92:95], v[60:63], a[16:19]
    ds_read_b64_tr_b16 v[120:121], v15 offset:0
    v_mfma_f32_16x16x32_bf16 a[32:35], v[92:95], v[64:67], a[32:35]
    ds_read_b64_tr_b16 v[122:123], v15 offset:256
    v_mfma_f32_16x16x32_bf16 a[36:39], v[96:99], v[64:67], a[36:39]
    v_mfma_f32_16x16x32_bf16 a[40:43], v[100:103], v[64:67], a[40:43]
    v_mfma_f32_16x16x32_bf16 a[44:47], v[104:107], v[64:67], a[44:47]
    ds_read_b128 v[88:91], v9 offset:3072
    v_mfma_f32_16x16x32_bf16 a[60:63], v[104:107], v[68:71], a[60:63]
    s_add_u32 s22, s21, 1572864
    s_add_u32 m0, s23, 16384
    v_mfma_f32_16x16x32_bf16 a[56:59], v[100:103], v[68:71], a[56:59]
    buffer_load_dwordx4 v16, s[8:11], s22 offen offset:0 lds
    v_mfma_f32_16x16x32_bf16 a[52:55], v[96:99], v[68:71], a[52:55]
    buffer_load_dwordx4 v17, s[8:11], s22 offen offset:1024 lds
    v_mfma_f32_16x16x32_bf16 a[48:51], v[92:95], v[68:71], a[48:51]
    buffer_load_dwordx4 v18, s[8:11], s22 offen offset:2048 lds
    v_mfma_f32_16x16x32_bf16 a[64:67], v[92:95], v[72:75], a[64:67]
    buffer_load_dwordx4 v19, s[8:11], s22 offen offset:3072 lds
    v_mfma_f32_16x16x32_bf16 a[68:71], v[96:99], v[72:75], a[68:71]
    s_add_u32 m0, s25, 34816
    v_mfma_f32_16x16x32_bf16 a[72:75], v[100:103], v[72:75], a[72:75]
    buffer_load_dwordx4 v37, s[4:7], s26 offen lds
    v_mfma_f32_16x16x32_bf16 a[76:79], v[104:107], v[72:75], a[76:79]
    v_mfma_f32_16x16x32_bf16 a[92:95], v[104:107], v[76:79], a[92:95]
    v_mfma_f32_16x16x32_bf16 a[88:91], v[100:103], v[76:79], a[88:91]
    v_mfma_f32_16x16x32_bf16 a[84:87], v[96:99], v[76:79], a[84:87]
    v_mfma_f32_16x16x32_bf16 a[80:83], v[92:95], v[76:79], a[80:83]
    v_mfma_f32_16x16x32_bf16 a[96:99], v[92:95], v[80:83], a[96:99]
    v_mfma_f32_16x16x32_bf16 a[100:103], v[96:99], v[80:83], a[100:103]
    v_mfma_f32_16x16x32_bf16 a[104:107], v[100:103], v[80:83], a[104:107]
    v_mfma_f32_16x16x32_bf16 a[108:111], v[104:107], v[80:83], a[108:111]
    s_waitcnt lgkmcnt(9)
    v_mfma_f32_16x16x32_bf16 a[124:127], v[104:107], v[84:87], a[124:127]
    v_mfma_f32_16x16x32_bf16 a[120:123], v[100:103], v[84:87], a[120:123]
    v_mfma_f32_16x16x32_bf16 a[116:119], v[96:99], v[84:87], a[116:119]
    v_mfma_f32_16x16x32_bf16 a[112:115], v[92:95], v[84:87], a[112:115]
    s_waitcnt lgkmcnt(1)
    v_mfma_f32_16x16x32_bf16 a[0:3], v[108:111], v[60:63], a[0:3]
    s_waitcnt vmcnt(19)
    v_mfma_f32_16x16x32_bf16 a[4:7], v[112:115], v[60:63], a[4:7]
    ds_read_b64_tr_b16 v[92:93], v12 offset:4096
    v_mfma_f32_16x16x32_bf16 a[8:11], v[116:119], v[60:63], a[8:11]
    ds_read_b64_tr_b16 v[94:95], v12 offset:4352
    buffer_load_dwordx4 v[124:127], v159, s[56:59], s52 offen
    v_mfma_f32_16x16x32_bf16 a[12:15], v[120:123], v[60:63], a[12:15]
    ds_read_b64_tr_b16 v[96:97], v13 offset:4096
    v_mfma_f32_16x16x32_bf16 a[28:31], v[120:123], v[64:67], a[28:31]
    ds_read_b64_tr_b16 v[98:99], v13 offset:4352
    v_mfma_f32_16x16x32_bf16 a[24:27], v[116:119], v[64:67], a[24:27]
    ds_read_b64_tr_b16 v[100:101], v14 offset:4096
    v_mfma_f32_16x16x32_bf16 a[20:23], v[112:115], v[64:67], a[20:23]
    ds_read_b64_tr_b16 v[102:103], v14 offset:4352
    v_mfma_f32_16x16x32_bf16 a[16:19], v[108:111], v[64:67], a[16:19]
    ds_read_b64_tr_b16 v[104:105], v15 offset:4096
    v_mfma_f32_16x16x32_bf16 a[32:35], v[108:111], v[68:71], a[32:35]
    ds_read_b64_tr_b16 v[106:107], v15 offset:4352
    v_mfma_f32_16x16x32_bf16 a[36:39], v[112:115], v[68:71], a[36:39]
    v_mfma_f32_16x16x32_bf16 a[40:43], v[116:119], v[68:71], a[40:43]
    v_mfma_f32_16x16x32_bf16 a[44:47], v[120:123], v[68:71], a[44:47]
    ds_read_b128 v[40:43], v9 offset:3328
    v_mfma_f32_16x16x32_bf16 a[60:63], v[120:123], v[72:75], a[60:63]
    s_add_u32 s22, s21, 2621440
    s_add_u32 m0, s23, 0
    v_mfma_f32_16x16x32_bf16 a[56:59], v[116:119], v[72:75], a[56:59]
    buffer_load_dwordx4 v16, s[8:11], s22 offen offset:0 lds
    v_mfma_f32_16x16x32_bf16 a[52:55], v[112:115], v[72:75], a[52:55]
    buffer_load_dwordx4 v17, s[8:11], s22 offen offset:1024 lds
    v_mfma_f32_16x16x32_bf16 a[48:51], v[108:111], v[72:75], a[48:51]
    buffer_load_dwordx4 v18, s[8:11], s22 offen offset:2048 lds
    v_mfma_f32_16x16x32_bf16 a[64:67], v[108:111], v[76:79], a[64:67]
    buffer_load_dwordx4 v19, s[8:11], s22 offen offset:3072 lds
    v_mfma_f32_16x16x32_bf16 a[68:71], v[112:115], v[76:79], a[68:71]
    v_mfma_f32_16x16x32_bf16 a[72:75], v[116:119], v[76:79], a[72:75]
    v_mfma_f32_16x16x32_bf16 a[76:79], v[120:123], v[76:79], a[76:79]
    v_mfma_f32_16x16x32_bf16 a[92:95], v[120:123], v[80:83], a[92:95]
    v_mfma_f32_16x16x32_bf16 a[88:91], v[116:119], v[80:83], a[88:91]
    v_mfma_f32_16x16x32_bf16 a[84:87], v[112:115], v[80:83], a[84:87]
    v_mfma_f32_16x16x32_bf16 a[80:83], v[108:111], v[80:83], a[80:83]
    v_mfma_f32_16x16x32_bf16 a[96:99], v[108:111], v[84:87], a[96:99]
    v_mfma_f32_16x16x32_bf16 a[100:103], v[112:115], v[84:87], a[100:103]
    v_mfma_f32_16x16x32_bf16 a[104:107], v[116:119], v[84:87], a[104:107]
    v_mfma_f32_16x16x32_bf16 a[108:111], v[120:123], v[84:87], a[108:111]
    s_waitcnt lgkmcnt(9)
    v_mfma_f32_16x16x32_bf16 a[124:127], v[120:123], v[88:91], a[124:127]
    v_mfma_f32_16x16x32_bf16 a[120:123], v[116:119], v[88:91], a[120:123]
    v_mfma_f32_16x16x32_bf16 a[116:119], v[112:115], v[88:91], a[116:119]
    v_mfma_f32_16x16x32_bf16 a[112:115], v[108:111], v[88:91], a[112:115]
    s_waitcnt lgkmcnt(1)
    v_mfma_f32_16x16x32_bf16 a[0:3], v[92:95], v[64:67], a[0:3]
    s_waitcnt vmcnt(18)
    v_mfma_f32_16x16x32_bf16 a[4:7], v[96:99], v[64:67], a[4:7]
    ds_read_b64_tr_b16 v[108:109], v12 offset:8192
    v_mfma_f32_16x16x32_bf16 a[8:11], v[100:103], v[64:67], a[8:11]
    ds_read_b64_tr_b16 v[110:111], v12 offset:8448
    v_mfma_f32_16x16x32_bf16 a[12:15], v[104:107], v[64:67], a[12:15]
    ds_read_b64_tr_b16 v[112:113], v13 offset:8192
    v_mfma_f32_16x16x32_bf16 a[28:31], v[104:107], v[68:71], a[28:31]
    ds_read_b64_tr_b16 v[114:115], v13 offset:8448
    v_mfma_f32_16x16x32_bf16 a[24:27], v[100:103], v[68:71], a[24:27]
    ds_read_b64_tr_b16 v[116:117], v14 offset:8192
    v_mfma_f32_16x16x32_bf16 a[20:23], v[96:99], v[68:71], a[20:23]
    ds_read_b64_tr_b16 v[118:119], v14 offset:8448
    v_mfma_f32_16x16x32_bf16 a[16:19], v[92:95], v[68:71], a[16:19]
    ds_read_b64_tr_b16 v[120:121], v15 offset:8192
    v_mfma_f32_16x16x32_bf16 a[32:35], v[92:95], v[72:75], a[32:35]
    ds_read_b64_tr_b16 v[122:123], v15 offset:8448
    v_mfma_f32_16x16x32_bf16 a[36:39], v[96:99], v[72:75], a[36:39]
    v_mfma_f32_16x16x32_bf16 a[40:43], v[100:103], v[72:75], a[40:43]
    v_mfma_f32_16x16x32_bf16 a[44:47], v[104:107], v[72:75], a[44:47]
    ds_read_b128 v[44:47], v9 offset:3584
    v_mfma_f32_16x16x32_bf16 a[60:63], v[104:107], v[76:79], a[60:63]
    s_add_u32 s22, s21, 3670016
    s_add_u32 m0, s23, 4096
    v_mfma_f32_16x16x32_bf16 a[56:59], v[100:103], v[76:79], a[56:59]
    buffer_load_dwordx4 v16, s[8:11], s22 offen offset:0 lds
    v_mfma_f32_16x16x32_bf16 a[52:55], v[96:99], v[76:79], a[52:55]
    buffer_load_dwordx4 v17, s[8:11], s22 offen offset:1024 lds
    v_mfma_f32_16x16x32_bf16 a[48:51], v[92:95], v[76:79], a[48:51]
    buffer_load_dwordx4 v18, s[8:11], s22 offen offset:2048 lds
    v_mfma_f32_16x16x32_bf16 a[64:67], v[92:95], v[80:83], a[64:67]
    buffer_load_dwordx4 v19, s[8:11], s22 offen offset:3072 lds
    v_mfma_f32_16x16x32_bf16 a[68:71], v[96:99], v[80:83], a[68:71]
    v_mfma_f32_16x16x32_bf16 a[72:75], v[100:103], v[80:83], a[72:75]
    v_mfma_f32_16x16x32_bf16 a[76:79], v[104:107], v[80:83], a[76:79]
    v_mfma_f32_16x16x32_bf16 a[92:95], v[104:107], v[84:87], a[92:95]
    v_mfma_f32_16x16x32_bf16 a[88:91], v[100:103], v[84:87], a[88:91]
    v_mfma_f32_16x16x32_bf16 a[84:87], v[96:99], v[84:87], a[84:87]
    v_mfma_f32_16x16x32_bf16 a[80:83], v[92:95], v[84:87], a[80:83]
    v_mfma_f32_16x16x32_bf16 a[96:99], v[92:95], v[88:91], a[96:99]
    v_mfma_f32_16x16x32_bf16 a[100:103], v[96:99], v[88:91], a[100:103]
    v_mfma_f32_16x16x32_bf16 a[104:107], v[100:103], v[88:91], a[104:107]
    v_mfma_f32_16x16x32_bf16 a[108:111], v[104:107], v[88:91], a[108:111]
    s_waitcnt lgkmcnt(9)
    v_mfma_f32_16x16x32_bf16 a[124:127], v[104:107], v[40:43], a[124:127]
    v_mfma_f32_16x16x32_bf16 a[120:123], v[100:103], v[40:43], a[120:123]
    v_mfma_f32_16x16x32_bf16 a[116:119], v[96:99], v[40:43], a[116:119]
    v_mfma_f32_16x16x32_bf16 a[112:115], v[92:95], v[40:43], a[112:115]
    s_waitcnt lgkmcnt(1)
    v_mfma_f32_16x16x32_bf16 a[0:3], v[108:111], v[68:71], a[0:3]
    s_waitcnt vmcnt(9) lgkmcnt(0)
    s_barrier
    v_mfma_f32_16x16x32_bf16 a[4:7], v[112:115], v[68:71], a[4:7]
    ds_read_b64_tr_b16 v[92:93], v12 offset:12288
    v_mfma_f32_16x16x32_bf16 a[8:11], v[116:119], v[68:71], a[8:11]
    ds_read_b64_tr_b16 v[94:95], v12 offset:12544
    v_mfma_f32_16x16x32_bf16 a[12:15], v[120:123], v[68:71], a[12:15]
    ds_read_b64_tr_b16 v[96:97], v13 offset:12288
    ds_read_b128 v[68:71], v8 offset:34816
    v_mfma_f32_16x16x32_bf16 a[28:31], v[120:123], v[72:75], a[28:31]
    ds_read_b64_tr_b16 v[98:99], v13 offset:12544
    v_mfma_f32_16x16x32_bf16 a[24:27], v[116:119], v[72:75], a[24:27]
    ds_read_b64_tr_b16 v[100:101], v14 offset:12288
    v_mfma_f32_16x16x32_bf16 a[20:23], v[112:115], v[72:75], a[20:23]
    ds_read_b64_tr_b16 v[102:103], v14 offset:12544
    v_mfma_f32_16x16x32_bf16 a[16:19], v[108:111], v[72:75], a[16:19]
    ds_read_b64_tr_b16 v[104:105], v15 offset:12288
    ds_read_b128 v[72:75], v8 offset:35072
    v_mfma_f32_16x16x32_bf16 a[32:35], v[108:111], v[76:79], a[32:35]
    ds_read_b64_tr_b16 v[106:107], v15 offset:12544
    v_mfma_f32_16x16x32_bf16 a[36:39], v[112:115], v[76:79], a[36:39]
    v_mfma_f32_16x16x32_bf16 a[40:43], v[116:119], v[76:79], a[40:43]
    v_mfma_f32_16x16x32_bf16 a[44:47], v[120:123], v[76:79], a[44:47]
    ds_read_b128 v[76:79], v8 offset:35328
    v_mfma_f32_16x16x32_bf16 a[60:63], v[120:123], v[80:83], a[60:63]
    s_add_u32 s22, s21, 4718592
    s_add_u32 m0, s23, 8192
    v_mfma_f32_16x16x32_bf16 a[56:59], v[116:119], v[80:83], a[56:59]
    buffer_load_dwordx4 v16, s[8:11], s22 offen offset:0 lds
    v_mfma_f32_16x16x32_bf16 a[52:55], v[112:115], v[80:83], a[52:55]
    buffer_load_dwordx4 v17, s[8:11], s22 offen offset:1024 lds
    v_mfma_f32_16x16x32_bf16 a[48:51], v[108:111], v[80:83], a[48:51]
    ds_read_b128 v[80:83], v8 offset:35584
    buffer_load_dwordx4 v18, s[8:11], s22 offen offset:2048 lds
    v_mfma_f32_16x16x32_bf16 a[64:67], v[108:111], v[84:87], a[64:67]
    buffer_load_dwordx4 v19, s[8:11], s22 offen offset:3072 lds
    v_mfma_f32_16x16x32_bf16 a[68:71], v[112:115], v[84:87], a[68:71]
    s_mov_b32 s26, 256
    v_mfma_f32_16x16x32_bf16 a[72:75], v[116:119], v[84:87], a[72:75]
    s_add_u32 m0, s24, 0
    v_mfma_f32_16x16x32_bf16 a[76:79], v[120:123], v[84:87], a[76:79]
    ds_read_b128 v[84:87], v8 offset:35840
    buffer_load_dwordx4 v20, s[4:7], s26 offen lds
    v_mfma_f32_16x16x32_bf16 a[92:95], v[120:123], v[88:91], a[92:95]
    s_add_u32 m0, s24, 4096
    v_mfma_f32_16x16x32_bf16 a[88:91], v[116:119], v[88:91], a[88:91]
    buffer_load_dwordx4 v21, s[4:7], s26 offen lds
    v_mfma_f32_16x16x32_bf16 a[84:87], v[112:115], v[88:91], a[84:87]
    v_mfma_f32_16x16x32_bf16 a[80:83], v[108:111], v[88:91], a[80:83]
    ds_read_b128 v[88:91], v8 offset:36096
    v_mfma_f32_16x16x32_bf16 a[96:99], v[108:111], v[40:43], a[96:99]
    v_mfma_f32_16x16x32_bf16 a[100:103], v[112:115], v[40:43], a[100:103]
    v_mfma_f32_16x16x32_bf16 a[104:107], v[116:119], v[40:43], a[104:107]
    v_mfma_f32_16x16x32_bf16 a[108:111], v[120:123], v[40:43], a[108:111]
    ds_read_b128 v[40:43], v8 offset:36352
    v_mfma_f32_16x16x32_bf16 a[124:127], v[120:123], v[44:47], a[124:127]
    v_mfma_f32_16x16x32_bf16 a[120:123], v[116:119], v[44:47], a[120:123]
    v_mfma_f32_16x16x32_bf16 a[116:119], v[112:115], v[44:47], a[116:119]
    v_mfma_f32_16x16x32_bf16 a[112:115], v[108:111], v[44:47], a[112:115]
    ds_read_b128 v[44:47], v8 offset:36608
    s_waitcnt lgkmcnt(6)
    v_mfma_f32_16x16x32_bf16 a[0:3], v[92:95], v[68:71], a[0:3]
    v_mfma_f32_16x16x32_bf16 a[4:7], v[96:99], v[68:71], a[4:7]
    ds_read_b64_tr_b16 v[108:109], v12 offset:16384
    v_mfma_f32_16x16x32_bf16 a[8:11], v[100:103], v[68:71], a[8:11]
    ds_read_b64_tr_b16 v[110:111], v12 offset:16640
    v_mfma_f32_16x16x32_bf16 a[12:15], v[104:107], v[68:71], a[12:15]
    ds_read_b64_tr_b16 v[112:113], v13 offset:16384
    v_mfma_f32_16x16x32_bf16 a[28:31], v[104:107], v[72:75], a[28:31]
    ds_read_b64_tr_b16 v[114:115], v13 offset:16640
    v_mfma_f32_16x16x32_bf16 a[24:27], v[100:103], v[72:75], a[24:27]
    ds_read_b64_tr_b16 v[116:117], v14 offset:16384
    v_mfma_f32_16x16x32_bf16 a[20:23], v[96:99], v[72:75], a[20:23]
    ds_read_b64_tr_b16 v[118:119], v14 offset:16640
    v_mfma_f32_16x16x32_bf16 a[16:19], v[92:95], v[72:75], a[16:19]
    ds_read_b64_tr_b16 v[120:121], v15 offset:16384
    s_waitcnt lgkmcnt(12)
    v_mfma_f32_16x16x32_bf16 a[32:35], v[92:95], v[76:79], a[32:35]
    ds_read_b64_tr_b16 v[122:123], v15 offset:16640
    v_mfma_f32_16x16x32_bf16 a[36:39], v[96:99], v[76:79], a[36:39]
    v_mfma_f32_16x16x32_bf16 a[40:43], v[100:103], v[76:79], a[40:43]
    v_mfma_f32_16x16x32_bf16 a[44:47], v[104:107], v[76:79], a[44:47]
    ds_read_b128 v[48:51], v9 offset:36864
    s_waitcnt lgkmcnt(13)
    v_mfma_f32_16x16x32_bf16 a[60:63], v[104:107], v[80:83], a[60:63]
    s_add_u32 s22, s21, 5767168
    s_add_u32 m0, s23, 12288
    v_mfma_f32_16x16x32_bf16 a[56:59], v[100:103], v[80:83], a[56:59]
    buffer_load_dwordx4 v16, s[8:11], s22 offen offset:0 lds
    v_mfma_f32_16x16x32_bf16 a[52:55], v[96:99], v[80:83], a[52:55]
    buffer_load_dwordx4 v17, s[8:11], s22 offen offset:1024 lds
    v_mfma_f32_16x16x32_bf16 a[48:51], v[92:95], v[80:83], a[48:51]
    buffer_load_dwordx4 v18, s[8:11], s22 offen offset:2048 lds
    s_waitcnt lgkmcnt(12)
    v_mfma_f32_16x16x32_bf16 a[64:67], v[92:95], v[84:87], a[64:67]
    buffer_load_dwordx4 v19, s[8:11], s22 offen offset:3072 lds
    v_mfma_f32_16x16x32_bf16 a[68:71], v[96:99], v[84:87], a[68:71]
    s_add_u32 m0, s24, 8192
    v_mfma_f32_16x16x32_bf16 a[72:75], v[100:103], v[84:87], a[72:75]
    buffer_load_dwordx4 v22, s[4:7], s26 offen lds
    v_mfma_f32_16x16x32_bf16 a[76:79], v[104:107], v[84:87], a[76:79]
    s_add_u32 m0, s24, 12288
    s_waitcnt lgkmcnt(11)
    v_mfma_f32_16x16x32_bf16 a[92:95], v[104:107], v[88:91], a[92:95]
    buffer_load_dwordx4 v23, s[4:7], s26 offen lds
    v_mfma_f32_16x16x32_bf16 a[88:91], v[100:103], v[88:91], a[88:91]
    v_mfma_f32_16x16x32_bf16 a[84:87], v[96:99], v[88:91], a[84:87]
    v_mfma_f32_16x16x32_bf16 a[80:83], v[92:95], v[88:91], a[80:83]
    s_waitcnt lgkmcnt(10)
    v_mfma_f32_16x16x32_bf16 a[96:99], v[92:95], v[40:43], a[96:99]
    v_mfma_f32_16x16x32_bf16 a[100:103], v[96:99], v[40:43], a[100:103]
    v_mfma_f32_16x16x32_bf16 a[104:107], v[100:103], v[40:43], a[104:107]
    v_mfma_f32_16x16x32_bf16 a[108:111], v[104:107], v[40:43], a[108:111]
    s_waitcnt lgkmcnt(9)
    v_mfma_f32_16x16x32_bf16 a[124:127], v[104:107], v[44:47], a[124:127]
    v_mfma_f32_16x16x32_bf16 a[120:123], v[100:103], v[44:47], a[120:123]
    v_mfma_f32_16x16x32_bf16 a[116:119], v[96:99], v[44:47], a[116:119]
    v_mfma_f32_16x16x32_bf16 a[112:115], v[92:95], v[44:47], a[112:115]
    s_waitcnt lgkmcnt(1)
    v_mfma_f32_16x16x32_bf16 a[0:3], v[108:111], v[72:75], a[0:3]
    s_waitcnt vmcnt(16)
    v_mfma_f32_16x16x32_bf16 a[4:7], v[112:115], v[72:75], a[4:7]
    ds_read_b64_tr_b16 v[92:93], v12 offset:0
    v_mfma_f32_16x16x32_bf16 a[8:11], v[116:119], v[72:75], a[8:11]
    ds_read_b64_tr_b16 v[94:95], v12 offset:256
    v_mfma_f32_16x16x32_bf16 a[12:15], v[120:123], v[72:75], a[12:15]
    ds_read_b64_tr_b16 v[96:97], v13 offset:0
    v_mfma_f32_16x16x32_bf16 a[28:31], v[120:123], v[76:79], a[28:31]
    ds_read_b64_tr_b16 v[98:99], v13 offset:256
    v_mfma_f32_16x16x32_bf16 a[24:27], v[116:119], v[76:79], a[24:27]
    ds_read_b64_tr_b16 v[100:101], v14 offset:0
    v_mfma_f32_16x16x32_bf16 a[20:23], v[112:115], v[76:79], a[20:23]
    ds_read_b64_tr_b16 v[102:103], v14 offset:256
    v_mfma_f32_16x16x32_bf16 a[16:19], v[108:111], v[76:79], a[16:19]
    ds_read_b64_tr_b16 v[104:105], v15 offset:0
    v_mfma_f32_16x16x32_bf16 a[32:35], v[108:111], v[80:83], a[32:35]
    ds_read_b64_tr_b16 v[106:107], v15 offset:256
    v_mfma_f32_16x16x32_bf16 a[36:39], v[112:115], v[80:83], a[36:39]
    v_mfma_f32_16x16x32_bf16 a[40:43], v[116:119], v[80:83], a[40:43]
    v_mfma_f32_16x16x32_bf16 a[44:47], v[120:123], v[80:83], a[44:47]
    ds_read_b128 v[52:55], v9 offset:37120
    v_mfma_f32_16x16x32_bf16 a[60:63], v[120:123], v[84:87], a[60:63]
    s_add_u32 s22, s21, 6815744
    s_add_u32 m0, s23, 16384
    v_mfma_f32_16x16x32_bf16 a[56:59], v[116:119], v[84:87], a[56:59]
    buffer_load_dwordx4 v16, s[8:11], s22 offen offset:0 lds
    v_mfma_f32_16x16x32_bf16 a[52:55], v[112:115], v[84:87], a[52:55]
    buffer_load_dwordx4 v17, s[8:11], s22 offen offset:1024 lds
    v_mfma_f32_16x16x32_bf16 a[48:51], v[108:111], v[84:87], a[48:51]
    buffer_load_dwordx4 v18, s[8:11], s22 offen offset:2048 lds
    v_mfma_f32_16x16x32_bf16 a[64:67], v[108:111], v[88:91], a[64:67]
    buffer_load_dwordx4 v19, s[8:11], s22 offen offset:3072 lds
    v_mfma_f32_16x16x32_bf16 a[68:71], v[112:115], v[88:91], a[68:71]
    s_add_u32 m0, s24, 16384
    v_mfma_f32_16x16x32_bf16 a[72:75], v[116:119], v[88:91], a[72:75]
    buffer_load_dwordx4 v24, s[4:7], s26 offen lds
    v_mfma_f32_16x16x32_bf16 a[76:79], v[120:123], v[88:91], a[76:79]
    s_add_u32 m0, s24, 20480
    v_mfma_f32_16x16x32_bf16 a[92:95], v[120:123], v[40:43], a[92:95]
    buffer_load_dwordx4 v25, s[4:7], s26 offen lds
    v_mfma_f32_16x16x32_bf16 a[88:91], v[116:119], v[40:43], a[88:91]
    v_mfma_f32_16x16x32_bf16 a[84:87], v[112:115], v[40:43], a[84:87]
    v_mfma_f32_16x16x32_bf16 a[80:83], v[108:111], v[40:43], a[80:83]
    v_mfma_f32_16x16x32_bf16 a[96:99], v[108:111], v[44:47], a[96:99]
    v_mfma_f32_16x16x32_bf16 a[100:103], v[112:115], v[44:47], a[100:103]
    v_mfma_f32_16x16x32_bf16 a[104:107], v[116:119], v[44:47], a[104:107]
    v_mfma_f32_16x16x32_bf16 a[108:111], v[120:123], v[44:47], a[108:111]
    s_waitcnt lgkmcnt(9)
    v_mfma_f32_16x16x32_bf16 a[124:127], v[120:123], v[48:51], a[124:127]
    v_mfma_f32_16x16x32_bf16 a[120:123], v[116:119], v[48:51], a[120:123]
    v_mfma_f32_16x16x32_bf16 a[116:119], v[112:115], v[48:51], a[116:119]
    v_mfma_f32_16x16x32_bf16 a[112:115], v[108:111], v[48:51], a[112:115]
    s_waitcnt lgkmcnt(1)
    v_mfma_f32_16x16x32_bf16 a[0:3], v[92:95], v[76:79], a[0:3]
    s_waitcnt vmcnt(18)
    v_mfma_f32_16x16x32_bf16 a[4:7], v[96:99], v[76:79], a[4:7]
    ds_read_b64_tr_b16 v[108:109], v12 offset:4096
    v_mfma_f32_16x16x32_bf16 a[8:11], v[100:103], v[76:79], a[8:11]
    ds_read_b64_tr_b16 v[110:111], v12 offset:4352
    v_mfma_f32_16x16x32_bf16 a[12:15], v[104:107], v[76:79], a[12:15]
    ds_read_b64_tr_b16 v[112:113], v13 offset:4096
    v_mfma_f32_16x16x32_bf16 a[28:31], v[104:107], v[80:83], a[28:31]
    ds_read_b64_tr_b16 v[114:115], v13 offset:4352
    v_mfma_f32_16x16x32_bf16 a[24:27], v[100:103], v[80:83], a[24:27]
    ds_read_b64_tr_b16 v[116:117], v14 offset:4096
    v_mfma_f32_16x16x32_bf16 a[20:23], v[96:99], v[80:83], a[20:23]
    ds_read_b64_tr_b16 v[118:119], v14 offset:4352
    v_mfma_f32_16x16x32_bf16 a[16:19], v[92:95], v[80:83], a[16:19]
    ds_read_b64_tr_b16 v[120:121], v15 offset:4096
    v_mfma_f32_16x16x32_bf16 a[32:35], v[92:95], v[84:87], a[32:35]
    ds_read_b64_tr_b16 v[122:123], v15 offset:4352
    v_mfma_f32_16x16x32_bf16 a[36:39], v[96:99], v[84:87], a[36:39]
    v_mfma_f32_16x16x32_bf16 a[40:43], v[100:103], v[84:87], a[40:43]
    v_mfma_f32_16x16x32_bf16 a[44:47], v[104:107], v[84:87], a[44:47]
    ds_read_b128 v[56:59], v9 offset:37376
    v_mfma_f32_16x16x32_bf16 a[60:63], v[104:107], v[88:91], a[60:63]
    s_add_u32 s22, s21, 131072
    s_add_u32 m0, s23, 0
    v_mfma_f32_16x16x32_bf16 a[56:59], v[100:103], v[88:91], a[56:59]
    buffer_load_dwordx4 v16, s[8:11], s22 offen offset:0 lds
    v_mfma_f32_16x16x32_bf16 a[52:55], v[96:99], v[88:91], a[52:55]
    buffer_load_dwordx4 v17, s[8:11], s22 offen offset:1024 lds
    v_mfma_f32_16x16x32_bf16 a[48:51], v[92:95], v[88:91], a[48:51]
    buffer_load_dwordx4 v18, s[8:11], s22 offen offset:2048 lds
    v_mfma_f32_16x16x32_bf16 a[64:67], v[92:95], v[40:43], a[64:67]
    buffer_load_dwordx4 v19, s[8:11], s22 offen offset:3072 lds
    v_mfma_f32_16x16x32_bf16 a[68:71], v[96:99], v[40:43], a[68:71]
    s_add_u32 m0, s24, 24576
    v_mfma_f32_16x16x32_bf16 a[72:75], v[100:103], v[40:43], a[72:75]
    buffer_load_dwordx4 v26, s[4:7], s26 offen lds
    v_mfma_f32_16x16x32_bf16 a[76:79], v[104:107], v[40:43], a[76:79]
    s_add_u32 m0, s24, 28672
    v_mfma_f32_16x16x32_bf16 a[92:95], v[104:107], v[44:47], a[92:95]
    buffer_load_dwordx4 v27, s[4:7], s26 offen lds
    v_mfma_f32_16x16x32_bf16 a[88:91], v[100:103], v[44:47], a[88:91]
    v_mfma_f32_16x16x32_bf16 a[84:87], v[96:99], v[44:47], a[84:87]
    v_mfma_f32_16x16x32_bf16 a[80:83], v[92:95], v[44:47], a[80:83]
    v_mfma_f32_16x16x32_bf16 a[96:99], v[92:95], v[48:51], a[96:99]
    v_mfma_f32_16x16x32_bf16 a[100:103], v[96:99], v[48:51], a[100:103]
    v_mfma_f32_16x16x32_bf16 a[104:107], v[100:103], v[48:51], a[104:107]
    v_mfma_f32_16x16x32_bf16 a[108:111], v[104:107], v[48:51], a[108:111]
    s_waitcnt lgkmcnt(9)
    v_mfma_f32_16x16x32_bf16 a[124:127], v[104:107], v[52:55], a[124:127]
    v_mfma_f32_16x16x32_bf16 a[120:123], v[100:103], v[52:55], a[120:123]
    v_mfma_f32_16x16x32_bf16 a[116:119], v[96:99], v[52:55], a[116:119]
    v_mfma_f32_16x16x32_bf16 a[112:115], v[92:95], v[52:55], a[112:115]
    s_waitcnt lgkmcnt(1)
    v_mfma_f32_16x16x32_bf16 a[0:3], v[108:111], v[80:83], a[0:3]
    s_waitcnt vmcnt(20)
    v_mfma_f32_16x16x32_bf16 a[4:7], v[112:115], v[80:83], a[4:7]
    ds_read_b64_tr_b16 v[92:93], v12 offset:8192
    v_mfma_f32_16x16x32_bf16 a[8:11], v[116:119], v[80:83], a[8:11]
    ds_read_b64_tr_b16 v[94:95], v12 offset:8448
    buffer_store_dwordx4 v[124:127], v158, s[32:35], s53 offen sc0 sc1
    v_mfma_f32_16x16x32_bf16 a[12:15], v[120:123], v[80:83], a[12:15]
    ds_read_b64_tr_b16 v[96:97], v13 offset:8192
    v_mfma_f32_16x16x32_bf16 a[28:31], v[120:123], v[84:87], a[28:31]
    ds_read_b64_tr_b16 v[98:99], v13 offset:8448
    v_mfma_f32_16x16x32_bf16 a[24:27], v[116:119], v[84:87], a[24:27]
    ds_read_b64_tr_b16 v[100:101], v14 offset:8192
    v_mfma_f32_16x16x32_bf16 a[20:23], v[112:115], v[84:87], a[20:23]
    ds_read_b64_tr_b16 v[102:103], v14 offset:8448
    v_mfma_f32_16x16x32_bf16 a[16:19], v[108:111], v[84:87], a[16:19]
    ds_read_b64_tr_b16 v[104:105], v15 offset:8192
    v_mfma_f32_16x16x32_bf16 a[32:35], v[108:111], v[88:91], a[32:35]
    ds_read_b64_tr_b16 v[106:107], v15 offset:8448
    v_mfma_f32_16x16x32_bf16 a[36:39], v[112:115], v[88:91], a[36:39]
    v_mfma_f32_16x16x32_bf16 a[40:43], v[116:119], v[88:91], a[40:43]
    v_mfma_f32_16x16x32_bf16 a[44:47], v[120:123], v[88:91], a[44:47]
    ds_read_b128 v[60:63], v9 offset:37632
    v_mfma_f32_16x16x32_bf16 a[60:63], v[120:123], v[40:43], a[60:63]
    s_add_u32 s22, s21, 1179648
    s_add_u32 m0, s23, 4096
    v_mfma_f32_16x16x32_bf16 a[56:59], v[116:119], v[40:43], a[56:59]
    buffer_load_dwordx4 v16, s[8:11], s22 offen offset:0 lds
    v_mfma_f32_16x16x32_bf16 a[52:55], v[112:115], v[40:43], a[52:55]
    buffer_load_dwordx4 v17, s[8:11], s22 offen offset:1024 lds
    v_mfma_f32_16x16x32_bf16 a[48:51], v[108:111], v[40:43], a[48:51]
    buffer_load_dwordx4 v18, s[8:11], s22 offen offset:2048 lds
    v_mfma_f32_16x16x32_bf16 a[64:67], v[108:111], v[44:47], a[64:67]
    buffer_load_dwordx4 v19, s[8:11], s22 offen offset:3072 lds
    v_mfma_f32_16x16x32_bf16 a[68:71], v[112:115], v[44:47], a[68:71]
    s_add_u32 m0, s25, 0
    v_mfma_f32_16x16x32_bf16 a[72:75], v[116:119], v[44:47], a[72:75]
    buffer_load_dwordx4 v28, s[4:7], s26 offen lds
    v_mfma_f32_16x16x32_bf16 a[76:79], v[120:123], v[44:47], a[76:79]
    v_mfma_f32_16x16x32_bf16 a[92:95], v[120:123], v[48:51], a[92:95]
    v_mfma_f32_16x16x32_bf16 a[88:91], v[116:119], v[48:51], a[88:91]
    v_mfma_f32_16x16x32_bf16 a[84:87], v[112:115], v[48:51], a[84:87]
    v_mfma_f32_16x16x32_bf16 a[80:83], v[108:111], v[48:51], a[80:83]
    v_mfma_f32_16x16x32_bf16 a[96:99], v[108:111], v[52:55], a[96:99]
    v_mfma_f32_16x16x32_bf16 a[100:103], v[112:115], v[52:55], a[100:103]
    v_mfma_f32_16x16x32_bf16 a[104:107], v[116:119], v[52:55], a[104:107]
    v_mfma_f32_16x16x32_bf16 a[108:111], v[120:123], v[52:55], a[108:111]
    s_waitcnt lgkmcnt(9)
    v_mfma_f32_16x16x32_bf16 a[124:127], v[120:123], v[56:59], a[124:127]
    v_mfma_f32_16x16x32_bf16 a[120:123], v[116:119], v[56:59], a[120:123]
    v_mfma_f32_16x16x32_bf16 a[116:119], v[112:115], v[56:59], a[116:119]
    v_mfma_f32_16x16x32_bf16 a[112:115], v[108:111], v[56:59], a[112:115]
    s_waitcnt lgkmcnt(1)
    v_mfma_f32_16x16x32_bf16 a[0:3], v[92:95], v[84:87], a[0:3]
    s_waitcnt vmcnt(20)
    v_mfma_f32_16x16x32_bf16 a[4:7], v[96:99], v[84:87], a[4:7]
    ds_read_b64_tr_b16 v[108:109], v12 offset:12288
    v_mfma_f32_16x16x32_bf16 a[8:11], v[100:103], v[84:87], a[8:11]
    ds_read_b64_tr_b16 v[110:111], v12 offset:12544
    buffer_load_dwordx2 v[124:125], v156, s[36:39], s60 offen offset:0
    buffer_load_dwordx2 v[126:127], v156, s[36:39], s60 offen offset:1024
    v_mfma_f32_16x16x32_bf16 a[12:15], v[104:107], v[84:87], a[12:15]
    ds_read_b64_tr_b16 v[112:113], v13 offset:12288
    buffer_load_dwordx2 v[128:129], v156, s[36:39], s61 offen offset:0
    buffer_load_dwordx2 v[130:131], v156, s[36:39], s61 offen offset:1024
    v_mfma_f32_16x16x32_bf16 a[28:31], v[104:107], v[88:91], a[28:31]
    ds_read_b64_tr_b16 v[114:115], v13 offset:12544
    v_mfma_f32_16x16x32_bf16 a[24:27], v[100:103], v[88:91], a[24:27]
    ds_read_b64_tr_b16 v[116:117], v14 offset:12288
    v_mfma_f32_16x16x32_bf16 a[20:23], v[96:99], v[88:91], a[20:23]
    ds_read_b64_tr_b16 v[118:119], v14 offset:12544
    v_mfma_f32_16x16x32_bf16 a[16:19], v[92:95], v[88:91], a[16:19]
    ds_read_b64_tr_b16 v[120:121], v15 offset:12288
    v_mfma_f32_16x16x32_bf16 a[32:35], v[92:95], v[40:43], a[32:35]
    ds_read_b64_tr_b16 v[122:123], v15 offset:12544
    v_mfma_f32_16x16x32_bf16 a[36:39], v[96:99], v[40:43], a[36:39]
    v_mfma_f32_16x16x32_bf16 a[40:43], v[100:103], v[40:43], a[40:43]
    v_mfma_f32_16x16x32_bf16 a[44:47], v[104:107], v[40:43], a[44:47]
    ds_read_b128 v[64:67], v9 offset:37888
    v_mfma_f32_16x16x32_bf16 a[60:63], v[104:107], v[44:47], a[60:63]
    s_add_u32 s22, s21, 2228224
    s_add_u32 m0, s23, 8192
    v_mfma_f32_16x16x32_bf16 a[56:59], v[100:103], v[44:47], a[56:59]
    buffer_load_dwordx4 v16, s[8:11], s22 offen offset:0 lds
    v_mfma_f32_16x16x32_bf16 a[52:55], v[96:99], v[44:47], a[52:55]
    buffer_load_dwordx4 v17, s[8:11], s22 offen offset:1024 lds
    v_mfma_f32_16x16x32_bf16 a[48:51], v[92:95], v[44:47], a[48:51]
    buffer_load_dwordx4 v18, s[8:11], s22 offen offset:2048 lds
    v_mfma_f32_16x16x32_bf16 a[64:67], v[92:95], v[48:51], a[64:67]
    buffer_load_dwordx4 v19, s[8:11], s22 offen offset:3072 lds
    v_mfma_f32_16x16x32_bf16 a[68:71], v[96:99], v[48:51], a[68:71]
    v_mfma_f32_16x16x32_bf16 a[72:75], v[100:103], v[48:51], a[72:75]
    v_mfma_f32_16x16x32_bf16 a[76:79], v[104:107], v[48:51], a[76:79]
    v_mfma_f32_16x16x32_bf16 a[92:95], v[104:107], v[52:55], a[92:95]
    v_mfma_f32_16x16x32_bf16 a[88:91], v[100:103], v[52:55], a[88:91]
    v_mfma_f32_16x16x32_bf16 a[84:87], v[96:99], v[52:55], a[84:87]
    v_mfma_f32_16x16x32_bf16 a[80:83], v[92:95], v[52:55], a[80:83]
    v_mfma_f32_16x16x32_bf16 a[96:99], v[92:95], v[56:59], a[96:99]
    v_mfma_f32_16x16x32_bf16 a[100:103], v[96:99], v[56:59], a[100:103]
    v_mfma_f32_16x16x32_bf16 a[104:107], v[100:103], v[56:59], a[104:107]
    v_mfma_f32_16x16x32_bf16 a[108:111], v[104:107], v[56:59], a[108:111]
    s_waitcnt lgkmcnt(9)
    v_mfma_f32_16x16x32_bf16 a[124:127], v[104:107], v[60:63], a[124:127]
    v_mfma_f32_16x16x32_bf16 a[120:123], v[100:103], v[60:63], a[120:123]
    v_mfma_f32_16x16x32_bf16 a[116:119], v[96:99], v[60:63], a[116:119]
    v_mfma_f32_16x16x32_bf16 a[112:115], v[92:95], v[60:63], a[112:115]
    s_waitcnt lgkmcnt(1)
    v_mfma_f32_16x16x32_bf16 a[0:3], v[108:111], v[88:91], a[0:3]
    s_waitcnt vmcnt(22)
    v_mfma_f32_16x16x32_bf16 a[4:7], v[112:115], v[88:91], a[4:7]
    ds_read_b64_tr_b16 v[92:93], v12 offset:16384
    v_mfma_f32_16x16x32_bf16 a[8:11], v[116:119], v[88:91], a[8:11]
    ds_read_b64_tr_b16 v[94:95], v12 offset:16640
    buffer_load_dwordx2 v[132:133], v156, s[36:39], s62 offen offset:0
    buffer_load_dwordx2 v[134:135], v156, s[36:39], s62 offen offset:1024
    v_mfma_f32_16x16x32_bf16 a[12:15], v[120:123], v[88:91], a[12:15]
    ds_read_b64_tr_b16 v[96:97], v13 offset:16384
    buffer_load_dwordx2 v[136:137], v156, s[36:39], s63 offen offset:0
    buffer_load_dwordx2 v[138:139], v156, s[36:39], s63 offen offset:1024
    v_mfma_f32_16x16x32_bf16 a[28:31], v[120:123], v[40:43], a[28:31]
    ds_read_b64_tr_b16 v[98:99], v13 offset:16640
    v_mfma_f32_16x16x32_bf16 a[24:27], v[116:119], v[40:43], a[24:27]
    ds_read_b64_tr_b16 v[100:101], v14 offset:16384
    v_mfma_f32_16x16x32_bf16 a[20:23], v[112:115], v[40:43], a[20:23]
    ds_read_b64_tr_b16 v[102:103], v14 offset:16640
    v_mfma_f32_16x16x32_bf16 a[16:19], v[108:111], v[40:43], a[16:19]
    ds_read_b64_tr_b16 v[104:105], v15 offset:16384
    v_mfma_f32_16x16x32_bf16 a[32:35], v[108:111], v[44:47], a[32:35]
    ds_read_b64_tr_b16 v[106:107], v15 offset:16640
    v_mfma_f32_16x16x32_bf16 a[36:39], v[112:115], v[44:47], a[36:39]
    v_mfma_f32_16x16x32_bf16 a[40:43], v[116:119], v[44:47], a[40:43]
    v_mfma_f32_16x16x32_bf16 a[44:47], v[120:123], v[44:47], a[44:47]
    ds_read_b128 v[68:71], v9 offset:38144
    v_mfma_f32_16x16x32_bf16 a[60:63], v[120:123], v[48:51], a[60:63]
    s_add_u32 s22, s21, 3276800
    s_add_u32 m0, s23, 12288
    v_mfma_f32_16x16x32_bf16 a[56:59], v[116:119], v[48:51], a[56:59]
    buffer_load_dwordx4 v16, s[8:11], s22 offen offset:0 lds
    v_mfma_f32_16x16x32_bf16 a[52:55], v[112:115], v[48:51], a[52:55]
    buffer_load_dwordx4 v17, s[8:11], s22 offen offset:1024 lds
    v_mfma_f32_16x16x32_bf16 a[48:51], v[108:111], v[48:51], a[48:51]
    buffer_load_dwordx4 v18, s[8:11], s22 offen offset:2048 lds
    v_mfma_f32_16x16x32_bf16 a[64:67], v[108:111], v[52:55], a[64:67]
    buffer_load_dwordx4 v19, s[8:11], s22 offen offset:3072 lds
    v_mfma_f32_16x16x32_bf16 a[68:71], v[112:115], v[52:55], a[68:71]
    v_mfma_f32_16x16x32_bf16 a[72:75], v[116:119], v[52:55], a[72:75]
    v_mfma_f32_16x16x32_bf16 a[76:79], v[120:123], v[52:55], a[76:79]
    v_mfma_f32_16x16x32_bf16 a[92:95], v[120:123], v[56:59], a[92:95]
    v_mfma_f32_16x16x32_bf16 a[88:91], v[116:119], v[56:59], a[88:91]
    v_mfma_f32_16x16x32_bf16 a[84:87], v[112:115], v[56:59], a[84:87]
    v_mfma_f32_16x16x32_bf16 a[80:83], v[108:111], v[56:59], a[80:83]
    v_mfma_f32_16x16x32_bf16 a[96:99], v[108:111], v[60:63], a[96:99]
    v_mfma_f32_16x16x32_bf16 a[100:103], v[112:115], v[60:63], a[100:103]
    v_mfma_f32_16x16x32_bf16 a[104:107], v[116:119], v[60:63], a[104:107]
    v_mfma_f32_16x16x32_bf16 a[108:111], v[120:123], v[60:63], a[108:111]
    s_waitcnt lgkmcnt(9)
    v_mfma_f32_16x16x32_bf16 a[124:127], v[120:123], v[64:67], a[124:127]
    v_mfma_f32_16x16x32_bf16 a[120:123], v[116:119], v[64:67], a[120:123]
    v_mfma_f32_16x16x32_bf16 a[116:119], v[112:115], v[64:67], a[116:119]
    v_mfma_f32_16x16x32_bf16 a[112:115], v[108:111], v[64:67], a[112:115]
    s_waitcnt lgkmcnt(1)
    v_mfma_f32_16x16x32_bf16 a[0:3], v[92:95], v[40:43], a[0:3]
    s_waitcnt vmcnt(16) lgkmcnt(0)
    s_barrier
    v_mfma_f32_16x16x32_bf16 a[4:7], v[96:99], v[40:43], a[4:7]
    ds_read_b64_tr_b16 v[108:109], v12 offset:0
    v_mfma_f32_16x16x32_bf16 a[8:11], v[100:103], v[40:43], a[8:11]
    ds_read_b64_tr_b16 v[110:111], v12 offset:256
    v_mfma_f32_16x16x32_bf16 a[12:15], v[104:107], v[40:43], a[12:15]
    ds_read_b64_tr_b16 v[112:113], v13 offset:0
    ds_read_b128 v[40:43], v8 offset:0
    v_mfma_f32_16x16x32_bf16 a[28:31], v[104:107], v[44:47], a[28:31]
    ds_read_b64_tr_b16 v[114:115], v13 offset:256
    v_mfma_f32_16x16x32_bf16 a[24:27], v[100:103], v[44:47], a[24:27]
    ds_read_b64_tr_b16 v[116:117], v14 offset:0
    v_mfma_f32_16x16x32_bf16 a[20:23], v[96:99], v[44:47], a[20:23]
    ds_read_b64_tr_b16 v[118:119], v14 offset:256
    v_mfma_f32_16x16x32_bf16 a[16:19], v[92:95], v[44:47], a[16:19]
    ds_read_b64_tr_b16 v[120:121], v15 offset:0
    ds_read_b128 v[44:47], v8 offset:256
    v_mfma_f32_16x16x32_bf16 a[32:35], v[92:95], v[48:51], a[32:35]
    ds_read_b64_tr_b16 v[122:123], v15 offset:256
    v_mfma_f32_16x16x32_bf16 a[36:39], v[96:99], v[48:51], a[36:39]
    v_mfma_f32_16x16x32_bf16 a[40:43], v[100:103], v[48:51], a[40:43]
    v_mfma_f32_16x16x32_bf16 a[44:47], v[104:107], v[48:51], a[44:47]
    ds_read_b128 v[48:51], v8 offset:512
    v_mfma_f32_16x16x32_bf16 a[60:63], v[104:107], v[52:55], a[60:63]
    s_add_u32 s22, s21, 4325376
    s_add_u32 m0, s23, 16384
    v_mfma_f32_16x16x32_bf16 a[56:59], v[100:103], v[52:55], a[56:59]
    buffer_load_dwordx4 v16, s[8:11], s22 offen offset:0 lds
    v_mfma_f32_16x16x32_bf16 a[52:55], v[96:99], v[52:55], a[52:55]
    buffer_load_dwordx4 v17, s[8:11], s22 offen offset:1024 lds
    v_mfma_f32_16x16x32_bf16 a[48:51], v[92:95], v[52:55], a[48:51]
    ds_read_b128 v[52:55], v8 offset:768
    buffer_load_dwordx4 v18, s[8:11], s22 offen offset:2048 lds
    v_mfma_f32_16x16x32_bf16 a[64:67], v[92:95], v[56:59], a[64:67]
    buffer_load_dwordx4 v19, s[8:11], s22 offen offset:3072 lds
    v_mfma_f32_16x16x32_bf16 a[68:71], v[96:99], v[56:59], a[68:71]
    s_mov_b32 s26, 256
    v_mfma_f32_16x16x32_bf16 a[72:75], v[100:103], v[56:59], a[72:75]
    s_add_u32 m0, s24, 34816
    v_mfma_f32_16x16x32_bf16 a[76:79], v[104:107], v[56:59], a[76:79]
    ds_read_b128 v[56:59], v8 offset:1024
    buffer_load_dwordx4 v29, s[4:7], s26 offen lds
    v_mfma_f32_16x16x32_bf16 a[92:95], v[104:107], v[60:63], a[92:95]
    s_add_u32 m0, s24, 38912
    v_mfma_f32_16x16x32_bf16 a[88:91], v[100:103], v[60:63], a[88:91]
    buffer_load_dwordx4 v30, s[4:7], s26 offen lds
    v_mfma_f32_16x16x32_bf16 a[84:87], v[96:99], v[60:63], a[84:87]
    v_mfma_f32_16x16x32_bf16 a[80:83], v[92:95], v[60:63], a[80:83]
    ds_read_b128 v[60:63], v8 offset:1280
    v_mfma_f32_16x16x32_bf16 a[96:99], v[92:95], v[64:67], a[96:99]
    v_mfma_f32_16x16x32_bf16 a[100:103], v[96:99], v[64:67], a[100:103]
    v_mfma_f32_16x16x32_bf16 a[104:107], v[100:103], v[64:67], a[104:107]
    v_mfma_f32_16x16x32_bf16 a[108:111], v[104:107], v[64:67], a[108:111]
    ds_read_b128 v[64:67], v8 offset:1536
    v_mfma_f32_16x16x32_bf16 a[124:127], v[104:107], v[68:71], a[124:127]
    v_mfma_f32_16x16x32_bf16 a[120:123], v[100:103], v[68:71], a[120:123]
    v_mfma_f32_16x16x32_bf16 a[116:119], v[96:99], v[68:71], a[116:119]
    v_mfma_f32_16x16x32_bf16 a[112:115], v[92:95], v[68:71], a[112:115]
    ds_read_b128 v[68:71], v8 offset:1792
    s_waitcnt lgkmcnt(6)
    v_mfma_f32_16x16x32_bf16 a[0:3], v[108:111], v[40:43], a[0:3]
    v_mfma_f32_16x16x32_bf16 a[4:7], v[112:115], v[40:43], a[4:7]
    ds_read_b64_tr_b16 v[92:93], v12 offset:4096
    v_mfma_f32_16x16x32_bf16 a[8:11], v[116:119], v[40:43], a[8:11]
    ds_read_b64_tr_b16 v[94:95], v12 offset:4352
    v_mfma_f32_16x16x32_bf16 a[12:15], v[120:123], v[40:43], a[12:15]
    ds_read_b64_tr_b16 v[96:97], v13 offset:4096
    v_mfma_f32_16x16x32_bf16 a[28:31], v[120:123], v[44:47], a[28:31]
    ds_read_b64_tr_b16 v[98:99], v13 offset:4352
    v_mfma_f32_16x16x32_bf16 a[24:27], v[116:119], v[44:47], a[24:27]
    ds_read_b64_tr_b16 v[100:101], v14 offset:4096
    v_mfma_f32_16x16x32_bf16 a[20:23], v[112:115], v[44:47], a[20:23]
    ds_read_b64_tr_b16 v[102:103], v14 offset:4352
    v_mfma_f32_16x16x32_bf16 a[16:19], v[108:111], v[44:47], a[16:19]
    ds_read_b64_tr_b16 v[104:105], v15 offset:4096
    s_waitcnt lgkmcnt(12)
    v_mfma_f32_16x16x32_bf16 a[32:35], v[108:111], v[48:51], a[32:35]
    ds_read_b64_tr_b16 v[106:107], v15 offset:4352
    v_mfma_f32_16x16x32_bf16 a[36:39], v[112:115], v[48:51], a[36:39]
    v_mfma_f32_16x16x32_bf16 a[40:43], v[116:119], v[48:51], a[40:43]
    v_mfma_f32_16x16x32_bf16 a[44:47], v[120:123], v[48:51], a[44:47]
    ds_read_b128 v[72:75], v9 offset:2048
    s_waitcnt lgkmcnt(13)
    v_mfma_f32_16x16x32_bf16 a[60:63], v[120:123], v[52:55], a[60:63]
    s_add_u32 s22, s21, 5373952
    s_add_u32 m0, s23, 0
    v_mfma_f32_16x16x32_bf16 a[56:59], v[116:119], v[52:55], a[56:59]
    buffer_load_dwordx4 v16, s[8:11], s22 offen offset:0 lds
    v_mfma_f32_16x16x32_bf16 a[52:55], v[112:115], v[52:55], a[52:55]
    buffer_load_dwordx4 v17, s[8:11], s22 offen offset:1024 lds
    v_mfma_f32_16x16x32_bf16 a[48:51], v[108:111], v[52:55], a[48:51]
    buffer_load_dwordx4 v18, s[8:11], s22 offen offset:2048 lds
    s_waitcnt lgkmcnt(12)
    v_mfma_f32_16x16x32_bf16 a[64:67], v[108:111], v[56:59], a[64:67]
    buffer_load_dwordx4 v19, s[8:11], s22 offen offset:3072 lds
    v_mfma_f32_16x16x32_bf16 a[68:71], v[112:115], v[56:59], a[68:71]
    s_add_u32 m0, s24, 43008
    v_mfma_f32_16x16x32_bf16 a[72:75], v[116:119], v[56:59], a[72:75]
    buffer_load_dwordx4 v31, s[4:7], s26 offen lds
    v_mfma_f32_16x16x32_bf16 a[76:79], v[120:123], v[56:59], a[76:79]
    s_add_u32 m0, s24, 47104
    s_waitcnt lgkmcnt(11)
    v_mfma_f32_16x16x32_bf16 a[92:95], v[120:123], v[60:63], a[92:95]
    buffer_load_dwordx4 v32, s[4:7], s26 offen lds
    v_mfma_f32_16x16x32_bf16 a[88:91], v[116:119], v[60:63], a[88:91]
    v_mfma_f32_16x16x32_bf16 a[84:87], v[112:115], v[60:63], a[84:87]
    v_mfma_f32_16x16x32_bf16 a[80:83], v[108:111], v[60:63], a[80:83]
    s_waitcnt lgkmcnt(10)
    v_mfma_f32_16x16x32_bf16 a[96:99], v[108:111], v[64:67], a[96:99]
    v_mfma_f32_16x16x32_bf16 a[100:103], v[112:115], v[64:67], a[100:103]
    v_mfma_f32_16x16x32_bf16 a[104:107], v[116:119], v[64:67], a[104:107]
    v_mfma_f32_16x16x32_bf16 a[108:111], v[120:123], v[64:67], a[108:111]
    s_waitcnt lgkmcnt(9)
    v_mfma_f32_16x16x32_bf16 a[124:127], v[120:123], v[68:71], a[124:127]
    v_mfma_f32_16x16x32_bf16 a[120:123], v[116:119], v[68:71], a[120:123]
    v_mfma_f32_16x16x32_bf16 a[116:119], v[112:115], v[68:71], a[116:119]
    v_mfma_f32_16x16x32_bf16 a[112:115], v[108:111], v[68:71], a[112:115]
    s_waitcnt lgkmcnt(1)
    v_mfma_f32_16x16x32_bf16 a[0:3], v[92:95], v[44:47], a[0:3]
    s_waitcnt vmcnt(20)
    v_mfma_f32_16x16x32_bf16 a[4:7], v[96:99], v[44:47], a[4:7]
    ds_read_b64_tr_b16 v[108:109], v12 offset:8192
    v_mfma_f32_16x16x32_bf16 a[8:11], v[100:103], v[44:47], a[8:11]
    ds_read_b64_tr_b16 v[110:111], v12 offset:8448
    v_mfma_f32_16x16x32_bf16 a[12:15], v[104:107], v[44:47], a[12:15]
    ds_read_b64_tr_b16 v[112:113], v13 offset:8192
    v_mfma_f32_16x16x32_bf16 a[28:31], v[104:107], v[48:51], a[28:31]
    ds_read_b64_tr_b16 v[114:115], v13 offset:8448
    v_mfma_f32_16x16x32_bf16 a[24:27], v[100:103], v[48:51], a[24:27]
    ds_read_b64_tr_b16 v[116:117], v14 offset:8192
    v_mfma_f32_16x16x32_bf16 a[20:23], v[96:99], v[48:51], a[20:23]
    ds_read_b64_tr_b16 v[118:119], v14 offset:8448
    v_mfma_f32_16x16x32_bf16 a[16:19], v[92:95], v[48:51], a[16:19]
    ds_read_b64_tr_b16 v[120:121], v15 offset:8192
    v_mfma_f32_16x16x32_bf16 a[32:35], v[92:95], v[52:55], a[32:35]
    ds_read_b64_tr_b16 v[122:123], v15 offset:8448
    v_mfma_f32_16x16x32_bf16 a[36:39], v[96:99], v[52:55], a[36:39]
    v_mfma_f32_16x16x32_bf16 a[40:43], v[100:103], v[52:55], a[40:43]
    v_mfma_f32_16x16x32_bf16 a[44:47], v[104:107], v[52:55], a[44:47]
    ds_read_b128 v[76:79], v9 offset:2304
    v_mfma_f32_16x16x32_bf16 a[60:63], v[104:107], v[56:59], a[60:63]
    s_add_u32 s22, s21, 6422528
    s_add_u32 m0, s23, 4096
    v_mfma_f32_16x16x32_bf16 a[56:59], v[100:103], v[56:59], a[56:59]
    buffer_load_dwordx4 v16, s[8:11], s22 offen offset:0 lds
    v_mfma_f32_16x16x32_bf16 a[52:55], v[96:99], v[56:59], a[52:55]
    buffer_load_dwordx4 v17, s[8:11], s22 offen offset:1024 lds
    v_mfma_f32_16x16x32_bf16 a[48:51], v[92:95], v[56:59], a[48:51]
    buffer_load_dwordx4 v18, s[8:11], s22 offen offset:2048 lds
    v_mfma_f32_16x16x32_bf16 a[64:67], v[92:95], v[60:63], a[64:67]
    buffer_load_dwordx4 v19, s[8:11], s22 offen offset:3072 lds
    v_mfma_f32_16x16x32_bf16 a[68:71], v[96:99], v[60:63], a[68:71]
    s_add_u32 m0, s24, 51200
    v_mfma_f32_16x16x32_bf16 a[72:75], v[100:103], v[60:63], a[72:75]
    buffer_load_dwordx4 v33, s[4:7], s26 offen lds
    v_mfma_f32_16x16x32_bf16 a[76:79], v[104:107], v[60:63], a[76:79]
    s_add_u32 m0, s24, 55296
    v_mfma_f32_16x16x32_bf16 a[92:95], v[104:107], v[64:67], a[92:95]
    buffer_load_dwordx4 v34, s[4:7], s26 offen lds
    v_mfma_f32_16x16x32_bf16 a[88:91], v[100:103], v[64:67], a[88:91]
    v_mfma_f32_16x16x32_bf16 a[84:87], v[96:99], v[64:67], a[84:87]
    v_mfma_f32_16x16x32_bf16 a[80:83], v[92:95], v[64:67], a[80:83]
    v_mfma_f32_16x16x32_bf16 a[96:99], v[92:95], v[68:71], a[96:99]
    v_mfma_f32_16x16x32_bf16 a[100:103], v[96:99], v[68:71], a[100:103]
    v_mfma_f32_16x16x32_bf16 a[104:107], v[100:103], v[68:71], a[104:107]
    v_mfma_f32_16x16x32_bf16 a[108:111], v[104:107], v[68:71], a[108:111]
    s_waitcnt lgkmcnt(9)
    v_mfma_f32_16x16x32_bf16 a[124:127], v[104:107], v[72:75], a[124:127]
    v_mfma_f32_16x16x32_bf16 a[120:123], v[100:103], v[72:75], a[120:123]
    v_mfma_f32_16x16x32_bf16 a[116:119], v[96:99], v[72:75], a[116:119]
    v_mfma_f32_16x16x32_bf16 a[112:115], v[92:95], v[72:75], a[112:115]
    s_waitcnt lgkmcnt(1)
    v_mfma_f32_16x16x32_bf16 a[0:3], v[108:111], v[48:51], a[0:3]
    s_waitcnt vmcnt(18)
    v_mfma_f32_16x16x32_bf16 a[4:7], v[112:115], v[48:51], a[4:7]
    ds_read_b64_tr_b16 v[92:93], v12 offset:12288
    v_mfma_f32_16x16x32_bf16 a[8:11], v[116:119], v[48:51], a[8:11]
    ds_read_b64_tr_b16 v[94:95], v12 offset:12544
    v_mfma_f32_16x16x32_bf16 a[12:15], v[120:123], v[48:51], a[12:15]
    ds_read_b64_tr_b16 v[96:97], v13 offset:12288
    v_mfma_f32_16x16x32_bf16 a[28:31], v[120:123], v[52:55], a[28:31]
    ds_read_b64_tr_b16 v[98:99], v13 offset:12544
    v_mfma_f32_16x16x32_bf16 a[24:27], v[116:119], v[52:55], a[24:27]
    ds_read_b64_tr_b16 v[100:101], v14 offset:12288
    v_mfma_f32_16x16x32_bf16 a[20:23], v[112:115], v[52:55], a[20:23]
    ds_read_b64_tr_b16 v[102:103], v14 offset:12544
    v_mfma_f32_16x16x32_bf16 a[16:19], v[108:111], v[52:55], a[16:19]
    ds_read_b64_tr_b16 v[104:105], v15 offset:12288
    v_mfma_f32_16x16x32_bf16 a[32:35], v[108:111], v[56:59], a[32:35]
    ds_read_b64_tr_b16 v[106:107], v15 offset:12544
    v_mfma_f32_16x16x32_bf16 a[36:39], v[112:115], v[56:59], a[36:39]
    v_mfma_f32_16x16x32_bf16 a[40:43], v[116:119], v[56:59], a[40:43]
    v_mfma_f32_16x16x32_bf16 a[44:47], v[120:123], v[56:59], a[44:47]
    ds_read_b128 v[80:83], v9 offset:2560
    v_mfma_f32_16x16x32_bf16 a[60:63], v[120:123], v[60:63], a[60:63]
    s_add_u32 s22, s21, 7471104
    s_add_u32 m0, s23, 8192
    v_mfma_f32_16x16x32_bf16 a[56:59], v[116:119], v[60:63], a[56:59]
    buffer_load_dwordx4 v16, s[8:11], s22 offen offset:0 lds
    v_mfma_f32_16x16x32_bf16 a[52:55], v[112:115], v[60:63], a[52:55]
    buffer_load_dwordx4 v17, s[8:11], s22 offen offset:1024 lds
    v_mfma_f32_16x16x32_bf16 a[48:51], v[108:111], v[60:63], a[48:51]
    buffer_load_dwordx4 v18, s[8:11], s22 offen offset:2048 lds
    v_mfma_f32_16x16x32_bf16 a[64:67], v[108:111], v[64:67], a[64:67]
    buffer_load_dwordx4 v19, s[8:11], s22 offen offset:3072 lds
    v_mfma_f32_16x16x32_bf16 a[68:71], v[112:115], v[64:67], a[68:71]
    s_add_u32 m0, s24, 59392
    v_mfma_f32_16x16x32_bf16 a[72:75], v[116:119], v[64:67], a[72:75]
    buffer_load_dwordx4 v35, s[4:7], s26 offen lds
    v_mfma_f32_16x16x32_bf16 a[76:79], v[120:123], v[64:67], a[76:79]
    s_add_u32 m0, s24, 63488
    v_mfma_f32_16x16x32_bf16 a[92:95], v[120:123], v[68:71], a[92:95]
    buffer_load_dwordx4 v36, s[4:7], s26 offen lds
    v_mfma_f32_16x16x32_bf16 a[88:91], v[116:119], v[68:71], a[88:91]
    v_mfma_f32_16x16x32_bf16 a[84:87], v[112:115], v[68:71], a[84:87]
    v_mfma_f32_16x16x32_bf16 a[80:83], v[108:111], v[68:71], a[80:83]
    v_mfma_f32_16x16x32_bf16 a[96:99], v[108:111], v[72:75], a[96:99]
    v_mfma_f32_16x16x32_bf16 a[100:103], v[112:115], v[72:75], a[100:103]
    v_mfma_f32_16x16x32_bf16 a[104:107], v[116:119], v[72:75], a[104:107]
    v_mfma_f32_16x16x32_bf16 a[108:111], v[120:123], v[72:75], a[108:111]
    s_waitcnt lgkmcnt(9)
    v_mfma_f32_16x16x32_bf16 a[124:127], v[120:123], v[76:79], a[124:127]
    v_mfma_f32_16x16x32_bf16 a[120:123], v[116:119], v[76:79], a[120:123]
    v_mfma_f32_16x16x32_bf16 a[116:119], v[112:115], v[76:79], a[116:119]
    v_mfma_f32_16x16x32_bf16 a[112:115], v[108:111], v[76:79], a[112:115]
    s_waitcnt lgkmcnt(1)
    v_mfma_f32_16x16x32_bf16 a[0:3], v[92:95], v[52:55], a[0:3]
    s_waitcnt vmcnt(20)
    v_mfma_f32_16x16x32_bf16 a[4:7], v[96:99], v[52:55], a[4:7]
    ds_read_b64_tr_b16 v[108:109], v12 offset:16384
    v_mfma_f32_16x16x32_bf16 a[8:11], v[100:103], v[52:55], a[8:11]
    ds_read_b64_tr_b16 v[110:111], v12 offset:16640
    v_mfma_f32_16x16x32_bf16 a[12:15], v[104:107], v[52:55], a[12:15]
    ds_read_b64_tr_b16 v[112:113], v13 offset:16384
    v_mfma_f32_16x16x32_bf16 a[28:31], v[104:107], v[56:59], a[28:31]
    ds_read_b64_tr_b16 v[114:115], v13 offset:16640
    v_mfma_f32_16x16x32_bf16 a[24:27], v[100:103], v[56:59], a[24:27]
    ds_read_b64_tr_b16 v[116:117], v14 offset:16384
    v_mfma_f32_16x16x32_bf16 a[20:23], v[96:99], v[56:59], a[20:23]
    ds_read_b64_tr_b16 v[118:119], v14 offset:16640
    v_mfma_f32_16x16x32_bf16 a[16:19], v[92:95], v[56:59], a[16:19]
    ds_read_b64_tr_b16 v[120:121], v15 offset:16384
    v_mfma_f32_16x16x32_bf16 a[32:35], v[92:95], v[60:63], a[32:35]
    ds_read_b64_tr_b16 v[122:123], v15 offset:16640
    v_mfma_f32_16x16x32_bf16 a[36:39], v[96:99], v[60:63], a[36:39]
    v_mfma_f32_16x16x32_bf16 a[40:43], v[100:103], v[60:63], a[40:43]
    v_mfma_f32_16x16x32_bf16 a[44:47], v[104:107], v[60:63], a[44:47]
    ds_read_b128 v[84:87], v9 offset:2816
    v_mfma_f32_16x16x32_bf16 a[60:63], v[104:107], v[64:67], a[60:63]
    s_add_u32 s22, s21, 655360
    s_add_u32 m0, s23, 12288
    v_mfma_f32_16x16x32_bf16 a[56:59], v[100:103], v[64:67], a[56:59]
    buffer_load_dwordx4 v16, s[8:11], s22 offen offset:0 lds
    v_mfma_f32_16x16x32_bf16 a[52:55], v[96:99], v[64:67], a[52:55]
    buffer_load_dwordx4 v17, s[8:11], s22 offen offset:1024 lds
    v_mfma_f32_16x16x32_bf16 a[48:51], v[92:95], v[64:67], a[48:51]
    buffer_load_dwordx4 v18, s[8:11], s22 offen offset:2048 lds
    v_mfma_f32_16x16x32_bf16 a[64:67], v[92:95], v[68:71], a[64:67]
    buffer_load_dwordx4 v19, s[8:11], s22 offen offset:3072 lds
    v_mfma_f32_16x16x32_bf16 a[68:71], v[96:99], v[68:71], a[68:71]
    s_add_u32 m0, s25, 34816
    v_mfma_f32_16x16x32_bf16 a[72:75], v[100:103], v[68:71], a[72:75]
    buffer_load_dwordx4 v37, s[4:7], s26 offen lds
    v_mfma_f32_16x16x32_bf16 a[76:79], v[104:107], v[68:71], a[76:79]
    v_mfma_f32_16x16x32_bf16 a[92:95], v[104:107], v[72:75], a[92:95]
    v_mfma_f32_16x16x32_bf16 a[88:91], v[100:103], v[72:75], a[88:91]
    v_mfma_f32_16x16x32_bf16 a[84:87], v[96:99], v[72:75], a[84:87]
    v_mfma_f32_16x16x32_bf16 a[80:83], v[92:95], v[72:75], a[80:83]
    v_mfma_f32_16x16x32_bf16 a[96:99], v[92:95], v[76:79], a[96:99]
    v_mfma_f32_16x16x32_bf16 a[100:103], v[96:99], v[76:79], a[100:103]
    v_mfma_f32_16x16x32_bf16 a[104:107], v[100:103], v[76:79], a[104:107]
    v_mfma_f32_16x16x32_bf16 a[108:111], v[104:107], v[76:79], a[108:111]
    s_waitcnt lgkmcnt(9)
    v_mfma_f32_16x16x32_bf16 a[124:127], v[104:107], v[80:83], a[124:127]
    v_mfma_f32_16x16x32_bf16 a[120:123], v[100:103], v[80:83], a[120:123]
    v_mfma_f32_16x16x32_bf16 a[116:119], v[96:99], v[80:83], a[116:119]
    v_mfma_f32_16x16x32_bf16 a[112:115], v[92:95], v[80:83], a[112:115]
    s_waitcnt lgkmcnt(1)
    v_mfma_f32_16x16x32_bf16 a[0:3], v[108:111], v[56:59], a[0:3]
    s_waitcnt vmcnt(19)
    v_mfma_f32_16x16x32_bf16 a[4:7], v[112:115], v[56:59], a[4:7]
    ds_read_b64_tr_b16 v[92:93], v12 offset:0
    v_mfma_f32_16x16x32_bf16 a[8:11], v[116:119], v[56:59], a[8:11]
    ds_read_b64_tr_b16 v[94:95], v12 offset:256
    v_perm_b32 v140, v126, v124, s98
    v_mfma_f32_16x16x32_bf16 a[12:15], v[120:123], v[56:59], a[12:15]
    ds_read_b64_tr_b16 v[96:97], v13 offset:0
    v_perm_b32 v141, v130, v128, s98
    v_perm_b32 v142, v134, v132, s98
    v_mfma_f32_16x16x32_bf16 a[28:31], v[120:123], v[60:63], a[28:31]
    ds_read_b64_tr_b16 v[98:99], v13 offset:256
    v_perm_b32 v143, v138, v136, s98
    v_perm_b32 v144, v126, v124, s99
    v_mfma_f32_16x16x32_bf16 a[24:27], v[116:119], v[60:63], a[24:27]
    ds_read_b64_tr_b16 v[100:101], v14 offset:0
    v_perm_b32 v145, v130, v128, s99
    v_perm_b32 v146, v134, v132, s99
    v_mfma_f32_16x16x32_bf16 a[20:23], v[112:115], v[60:63], a[20:23]
    ds_read_b64_tr_b16 v[102:103], v14 offset:256
    v_perm_b32 v147, v138, v136, s99
    v_mfma_f32_16x16x32_bf16 a[16:19], v[108:111], v[60:63], a[16:19]
    ds_read_b64_tr_b16 v[104:105], v15 offset:0
    v_mfma_f32_16x16x32_bf16 a[32:35], v[108:111], v[64:67], a[32:35]
    ds_read_b64_tr_b16 v[106:107], v15 offset:256
    v_mfma_f32_16x16x32_bf16 a[36:39], v[112:115], v[64:67], a[36:39]
    v_mfma_f32_16x16x32_bf16 a[40:43], v[116:119], v[64:67], a[40:43]
    v_mfma_f32_16x16x32_bf16 a[44:47], v[120:123], v[64:67], a[44:47]
    ds_read_b128 v[88:91], v9 offset:3072
    v_mfma_f32_16x16x32_bf16 a[60:63], v[120:123], v[68:71], a[60:63]
    s_add_u32 s22, s21, 1703936
    s_add_u32 m0, s23, 16384
    v_mfma_f32_16x16x32_bf16 a[56:59], v[116:119], v[68:71], a[56:59]
    buffer_load_dwordx4 v16, s[8:11], s22 offen offset:0 lds
    v_mfma_f32_16x16x32_bf16 a[52:55], v[112:115], v[68:71], a[52:55]
    buffer_load_dwordx4 v17, s[8:11], s22 offen offset:1024 lds
    v_mfma_f32_16x16x32_bf16 a[48:51], v[108:111], v[68:71], a[48:51]
    buffer_load_dwordx4 v18, s[8:11], s22 offen offset:2048 lds
    v_mfma_f32_16x16x32_bf16 a[64:67], v[108:111], v[72:75], a[64:67]
    buffer_load_dwordx4 v19, s[8:11], s22 offen offset:3072 lds
    v_mfma_f32_16x16x32_bf16 a[68:71], v[112:115], v[72:75], a[68:71]
    v_mfma_f32_16x16x32_bf16 a[72:75], v[116:119], v[72:75], a[72:75]
    v_mfma_f32_16x16x32_bf16 a[76:79], v[120:123], v[72:75], a[76:79]
    v_mfma_f32_16x16x32_bf16 a[92:95], v[120:123], v[76:79], a[92:95]
    v_mfma_f32_16x16x32_bf16 a[88:91], v[116:119], v[76:79], a[88:91]
    v_mfma_f32_16x16x32_bf16 a[84:87], v[112:115], v[76:79], a[84:87]
    v_mfma_f32_16x16x32_bf16 a[80:83], v[108:111], v[76:79], a[80:83]
    v_mfma_f32_16x16x32_bf16 a[96:99], v[108:111], v[80:83], a[96:99]
    v_mfma_f32_16x16x32_bf16 a[100:103], v[112:115], v[80:83], a[100:103]
    v_mfma_f32_16x16x32_bf16 a[104:107], v[116:119], v[80:83], a[104:107]
    v_mfma_f32_16x16x32_bf16 a[108:111], v[120:123], v[80:83], a[108:111]
    s_waitcnt lgkmcnt(9)
    v_mfma_f32_16x16x32_bf16 a[124:127], v[120:123], v[84:87], a[124:127]
    v_mfma_f32_16x16x32_bf16 a[120:123], v[116:119], v[84:87], a[120:123]
    v_mfma_f32_16x16x32_bf16 a[116:119], v[112:115], v[84:87], a[116:119]
    v_mfma_f32_16x16x32_bf16 a[112:115], v[108:111], v[84:87], a[112:115]
    s_waitcnt lgkmcnt(1)
    v_mfma_f32_16x16x32_bf16 a[0:3], v[92:95], v[60:63], a[0:3]
    s_waitcnt vmcnt(17)
    v_mfma_f32_16x16x32_bf16 a[4:7], v[96:99], v[60:63], a[4:7]
    ds_read_b64_tr_b16 v[108:109], v12 offset:4096
    v_mfma_f32_16x16x32_bf16 a[8:11], v[100:103], v[60:63], a[8:11]
    ds_read_b64_tr_b16 v[110:111], v12 offset:4352
    v_perm_b32 v148, v127, v125, s98
    v_perm_b32 v149, v131, v129, s98
    v_mfma_f32_16x16x32_bf16 a[12:15], v[104:107], v[60:63], a[12:15]
    ds_read_b64_tr_b16 v[112:113], v13 offset:4096
    v_perm_b32 v150, v135, v133, s98
    v_perm_b32 v151, v139, v137, s98
    v_mfma_f32_16x16x32_bf16 a[28:31], v[104:107], v[64:67], a[28:31]
    ds_read_b64_tr_b16 v[114:115], v13 offset:4352
    v_perm_b32 v152, v127, v125, s99
    v_perm_b32 v153, v131, v129, s99
    v_mfma_f32_16x16x32_bf16 a[24:27], v[100:103], v[64:67], a[24:27]
    ds_read_b64_tr_b16 v[116:117], v14 offset:4096
    v_perm_b32 v154, v135, v133, s99
    v_perm_b32 v155, v139, v137, s99
    v_mfma_f32_16x16x32_bf16 a[20:23], v[96:99], v[64:67], a[20:23]
    ds_read_b64_tr_b16 v[118:119], v14 offset:4352
    buffer_store_dwordx4 v[140:143], v158, s[32:35], s31 offen offset:0 sc0 sc1
    buffer_store_dwordx4 v[144:147], v158, s[32:35], s31 offen offset:1024 sc0 sc1
    v_mfma_f32_16x16x32_bf16 a[16:19], v[92:95], v[64:67], a[16:19]
    ds_read_b64_tr_b16 v[120:121], v15 offset:4096
    v_mfma_f32_16x16x32_bf16 a[32:35], v[92:95], v[68:71], a[32:35]
    ds_read_b64_tr_b16 v[122:123], v15 offset:4352
    v_mfma_f32_16x16x32_bf16 a[36:39], v[96:99], v[68:71], a[36:39]
    v_mfma_f32_16x16x32_bf16 a[40:43], v[100:103], v[68:71], a[40:43]
    v_mfma_f32_16x16x32_bf16 a[44:47], v[104:107], v[68:71], a[44:47]
    ds_read_b128 v[40:43], v9 offset:3328
    v_mfma_f32_16x16x32_bf16 a[60:63], v[104:107], v[72:75], a[60:63]
    s_add_u32 s22, s21, 2752512
    s_add_u32 m0, s23, 0
    v_mfma_f32_16x16x32_bf16 a[56:59], v[100:103], v[72:75], a[56:59]
    buffer_load_dwordx4 v16, s[8:11], s22 offen offset:0 lds
    v_mfma_f32_16x16x32_bf16 a[52:55], v[96:99], v[72:75], a[52:55]
    buffer_load_dwordx4 v17, s[8:11], s22 offen offset:1024 lds
    v_mfma_f32_16x16x32_bf16 a[48:51], v[92:95], v[72:75], a[48:51]
    buffer_load_dwordx4 v18, s[8:11], s22 offen offset:2048 lds
    v_mfma_f32_16x16x32_bf16 a[64:67], v[92:95], v[76:79], a[64:67]
    buffer_load_dwordx4 v19, s[8:11], s22 offen offset:3072 lds
    v_mfma_f32_16x16x32_bf16 a[68:71], v[96:99], v[76:79], a[68:71]
    v_mfma_f32_16x16x32_bf16 a[72:75], v[100:103], v[76:79], a[72:75]
    v_mfma_f32_16x16x32_bf16 a[76:79], v[104:107], v[76:79], a[76:79]
    v_mfma_f32_16x16x32_bf16 a[92:95], v[104:107], v[80:83], a[92:95]
    v_mfma_f32_16x16x32_bf16 a[88:91], v[100:103], v[80:83], a[88:91]
    v_mfma_f32_16x16x32_bf16 a[84:87], v[96:99], v[80:83], a[84:87]
    v_mfma_f32_16x16x32_bf16 a[80:83], v[92:95], v[80:83], a[80:83]
    v_mfma_f32_16x16x32_bf16 a[96:99], v[92:95], v[84:87], a[96:99]
    v_mfma_f32_16x16x32_bf16 a[100:103], v[96:99], v[84:87], a[100:103]
    v_mfma_f32_16x16x32_bf16 a[104:107], v[100:103], v[84:87], a[104:107]
    v_mfma_f32_16x16x32_bf16 a[108:111], v[104:107], v[84:87], a[108:111]
    s_waitcnt lgkmcnt(9)
    v_mfma_f32_16x16x32_bf16 a[124:127], v[104:107], v[88:91], a[124:127]
    v_mfma_f32_16x16x32_bf16 a[120:123], v[100:103], v[88:91], a[120:123]
    v_mfma_f32_16x16x32_bf16 a[116:119], v[96:99], v[88:91], a[116:119]
    v_mfma_f32_16x16x32_bf16 a[112:115], v[92:95], v[88:91], a[112:115]
    s_waitcnt lgkmcnt(1)
    v_mfma_f32_16x16x32_bf16 a[0:3], v[108:111], v[64:67], a[0:3]
    s_waitcnt vmcnt(17)
    v_mfma_f32_16x16x32_bf16 a[4:7], v[112:115], v[64:67], a[4:7]
    ds_read_b64_tr_b16 v[92:93], v12 offset:8192
    v_mfma_f32_16x16x32_bf16 a[8:11], v[116:119], v[64:67], a[8:11]
    ds_read_b64_tr_b16 v[94:95], v12 offset:8448
    buffer_store_dwordx4 v[148:151], v158, s[32:35], s54 offen offset:0 sc0 sc1
    buffer_store_dwordx4 v[152:155], v158, s[32:35], s54 offen offset:1024 sc0 sc1
    v_mfma_f32_16x16x32_bf16 a[12:15], v[120:123], v[64:67], a[12:15]
    ds_read_b64_tr_b16 v[96:97], v13 offset:8192
    v_mfma_f32_16x16x32_bf16 a[28:31], v[120:123], v[68:71], a[28:31]
    ds_read_b64_tr_b16 v[98:99], v13 offset:8448
    v_mfma_f32_16x16x32_bf16 a[24:27], v[116:119], v[68:71], a[24:27]
    ds_read_b64_tr_b16 v[100:101], v14 offset:8192
    v_mfma_f32_16x16x32_bf16 a[20:23], v[112:115], v[68:71], a[20:23]
    ds_read_b64_tr_b16 v[102:103], v14 offset:8448
    v_mfma_f32_16x16x32_bf16 a[16:19], v[108:111], v[68:71], a[16:19]
    ds_read_b64_tr_b16 v[104:105], v15 offset:8192
    v_mfma_f32_16x16x32_bf16 a[32:35], v[108:111], v[72:75], a[32:35]
    ds_read_b64_tr_b16 v[106:107], v15 offset:8448
    v_mfma_f32_16x16x32_bf16 a[36:39], v[112:115], v[72:75], a[36:39]
    v_mfma_f32_16x16x32_bf16 a[40:43], v[116:119], v[72:75], a[40:43]
    v_mfma_f32_16x16x32_bf16 a[44:47], v[120:123], v[72:75], a[44:47]
    ds_read_b128 v[44:47], v9 offset:3584
    v_mfma_f32_16x16x32_bf16 a[60:63], v[120:123], v[76:79], a[60:63]
    s_add_u32 s22, s21, 3801088
    s_add_u32 m0, s23, 4096
    v_mfma_f32_16x16x32_bf16 a[56:59], v[116:119], v[76:79], a[56:59]
    buffer_load_dwordx4 v16, s[8:11], s22 offen offset:0 lds
    v_mfma_f32_16x16x32_bf16 a[52:55], v[112:115], v[76:79], a[52:55]
    buffer_load_dwordx4 v17, s[8:11], s22 offen offset:1024 lds
    v_mfma_f32_16x16x32_bf16 a[48:51], v[108:111], v[76:79], a[48:51]
    buffer_load_dwordx4 v18, s[8:11], s22 offen offset:2048 lds
    v_mfma_f32_16x16x32_bf16 a[64:67], v[108:111], v[80:83], a[64:67]
    buffer_load_dwordx4 v19, s[8:11], s22 offen offset:3072 lds
    v_mfma_f32_16x16x32_bf16 a[68:71], v[112:115], v[80:83], a[68:71]
    v_mfma_f32_16x16x32_bf16 a[72:75], v[116:119], v[80:83], a[72:75]
    v_mfma_f32_16x16x32_bf16 a[76:79], v[120:123], v[80:83], a[76:79]
    v_mfma_f32_16x16x32_bf16 a[92:95], v[120:123], v[84:87], a[92:95]
    v_mfma_f32_16x16x32_bf16 a[88:91], v[116:119], v[84:87], a[88:91]
    v_mfma_f32_16x16x32_bf16 a[84:87], v[112:115], v[84:87], a[84:87]
    v_mfma_f32_16x16x32_bf16 a[80:83], v[108:111], v[84:87], a[80:83]
    v_mfma_f32_16x16x32_bf16 a[96:99], v[108:111], v[88:91], a[96:99]
    v_mfma_f32_16x16x32_bf16 a[100:103], v[112:115], v[88:91], a[100:103]
    v_mfma_f32_16x16x32_bf16 a[104:107], v[116:119], v[88:91], a[104:107]
    v_mfma_f32_16x16x32_bf16 a[108:111], v[120:123], v[88:91], a[108:111]
    s_waitcnt lgkmcnt(9)
    v_mfma_f32_16x16x32_bf16 a[124:127], v[120:123], v[40:43], a[124:127]
    v_mfma_f32_16x16x32_bf16 a[120:123], v[116:119], v[40:43], a[120:123]
    v_mfma_f32_16x16x32_bf16 a[116:119], v[112:115], v[40:43], a[116:119]
    v_mfma_f32_16x16x32_bf16 a[112:115], v[108:111], v[40:43], a[112:115]
    s_waitcnt lgkmcnt(1)
    v_mfma_f32_16x16x32_bf16 a[0:3], v[92:95], v[68:71], a[0:3]
    s_waitcnt vmcnt(16) lgkmcnt(0)
    s_barrier
    v_mfma_f32_16x16x32_bf16 a[4:7], v[96:99], v[68:71], a[4:7]
    ds_read_b64_tr_b16 v[108:109], v12 offset:12288
    v_mfma_f32_16x16x32_bf16 a[8:11], v[100:103], v[68:71], a[8:11]
    ds_read_b64_tr_b16 v[110:111], v12 offset:12544
    v_mfma_f32_16x16x32_bf16 a[12:15], v[104:107], v[68:71], a[12:15]
    ds_read_b64_tr_b16 v[112:113], v13 offset:12288
    ds_read_b128 v[68:71], v8 offset:34816
    v_mfma_f32_16x16x32_bf16 a[28:31], v[104:107], v[72:75], a[28:31]
    ds_read_b64_tr_b16 v[114:115], v13 offset:12544
    v_mfma_f32_16x16x32_bf16 a[24:27], v[100:103], v[72:75], a[24:27]
    ds_read_b64_tr_b16 v[116:117], v14 offset:12288
    v_mfma_f32_16x16x32_bf16 a[20:23], v[96:99], v[72:75], a[20:23]
    ds_read_b64_tr_b16 v[118:119], v14 offset:12544
    v_mfma_f32_16x16x32_bf16 a[16:19], v[92:95], v[72:75], a[16:19]
    ds_read_b64_tr_b16 v[120:121], v15 offset:12288
    ds_read_b128 v[72:75], v8 offset:35072
    v_mfma_f32_16x16x32_bf16 a[32:35], v[92:95], v[76:79], a[32:35]
    ds_read_b64_tr_b16 v[122:123], v15 offset:12544
    v_mfma_f32_16x16x32_bf16 a[36:39], v[96:99], v[76:79], a[36:39]
    v_mfma_f32_16x16x32_bf16 a[40:43], v[100:103], v[76:79], a[40:43]
    v_mfma_f32_16x16x32_bf16 a[44:47], v[104:107], v[76:79], a[44:47]
    ds_read_b128 v[76:79], v8 offset:35328
    v_mfma_f32_16x16x32_bf16 a[60:63], v[104:107], v[80:83], a[60:63]
    s_add_u32 s22, s21, 4849664
    s_add_u32 m0, s23, 8192
    v_mfma_f32_16x16x32_bf16 a[56:59], v[100:103], v[80:83], a[56:59]
    buffer_load_dwordx4 v16, s[8:11], s22 offen offset:0 lds
    v_mfma_f32_16x16x32_bf16 a[52:55], v[96:99], v[80:83], a[52:55]
    buffer_load_dwordx4 v17, s[8:11], s22 offen offset:1024 lds
    v_mfma_f32_16x16x32_bf16 a[48:51], v[92:95], v[80:83], a[48:51]
    ds_read_b128 v[80:83], v8 offset:35584
    buffer_load_dwordx4 v18, s[8:11], s22 offen offset:2048 lds
    v_mfma_f32_16x16x32_bf16 a[64:67], v[92:95], v[84:87], a[64:67]
    buffer_load_dwordx4 v19, s[8:11], s22 offen offset:3072 lds
    v_mfma_f32_16x16x32_bf16 a[68:71], v[96:99], v[84:87], a[68:71]
    s_mov_b32 s26, 512
    v_mfma_f32_16x16x32_bf16 a[72:75], v[100:103], v[84:87], a[72:75]
    s_add_u32 m0, s24, 0
    v_mfma_f32_16x16x32_bf16 a[76:79], v[104:107], v[84:87], a[76:79]
    ds_read_b128 v[84:87], v8 offset:35840
    buffer_load_dwordx4 v20, s[4:7], s26 offen lds
    v_mfma_f32_16x16x32_bf16 a[92:95], v[104:107], v[88:91], a[92:95]
    s_add_u32 m0, s24, 4096
    v_mfma_f32_16x16x32_bf16 a[88:91], v[100:103], v[88:91], a[88:91]
    buffer_load_dwordx4 v21, s[4:7], s26 offen lds
    v_mfma_f32_16x16x32_bf16 a[84:87], v[96:99], v[88:91], a[84:87]
    v_mfma_f32_16x16x32_bf16 a[80:83], v[92:95], v[88:91], a[80:83]
    ds_read_b128 v[88:91], v8 offset:36096
    v_mfma_f32_16x16x32_bf16 a[96:99], v[92:95], v[40:43], a[96:99]
    v_mfma_f32_16x16x32_bf16 a[100:103], v[96:99], v[40:43], a[100:103]
    v_mfma_f32_16x16x32_bf16 a[104:107], v[100:103], v[40:43], a[104:107]
    v_mfma_f32_16x16x32_bf16 a[108:111], v[104:107], v[40:43], a[108:111]
    ds_read_b128 v[40:43], v8 offset:36352
    v_mfma_f32_16x16x32_bf16 a[124:127], v[104:107], v[44:47], a[124:127]
    v_mfma_f32_16x16x32_bf16 a[120:123], v[100:103], v[44:47], a[120:123]
    v_mfma_f32_16x16x32_bf16 a[116:119], v[96:99], v[44:47], a[116:119]
    v_mfma_f32_16x16x32_bf16 a[112:115], v[92:95], v[44:47], a[112:115]
    ds_read_b128 v[44:47], v8 offset:36608
    s_waitcnt lgkmcnt(6)
    v_mfma_f32_16x16x32_bf16 a[0:3], v[108:111], v[68:71], a[0:3]
    s_waitcnt vmcnt(18)
    v_mfma_f32_16x16x32_bf16 a[4:7], v[112:115], v[68:71], a[4:7]
    ds_read_b64_tr_b16 v[92:93], v12 offset:16384
    v_mfma_f32_16x16x32_bf16 a[8:11], v[116:119], v[68:71], a[8:11]
    ds_read_b64_tr_b16 v[94:95], v12 offset:16640
    v_mfma_f32_16x16x32_bf16 a[12:15], v[120:123], v[68:71], a[12:15]
    ds_read_b64_tr_b16 v[96:97], v13 offset:16384
    v_mfma_f32_16x16x32_bf16 a[28:31], v[120:123], v[72:75], a[28:31]
    ds_read_b64_tr_b16 v[98:99], v13 offset:16640
    v_mfma_f32_16x16x32_bf16 a[24:27], v[116:119], v[72:75], a[24:27]
    ds_read_b64_tr_b16 v[100:101], v14 offset:16384
    v_mfma_f32_16x16x32_bf16 a[20:23], v[112:115], v[72:75], a[20:23]
    ds_read_b64_tr_b16 v[102:103], v14 offset:16640
    v_mfma_f32_16x16x32_bf16 a[16:19], v[108:111], v[72:75], a[16:19]
    ds_read_b64_tr_b16 v[104:105], v15 offset:16384
    s_waitcnt lgkmcnt(12)
    v_mfma_f32_16x16x32_bf16 a[32:35], v[108:111], v[76:79], a[32:35]
    ds_read_b64_tr_b16 v[106:107], v15 offset:16640
    v_mfma_f32_16x16x32_bf16 a[36:39], v[112:115], v[76:79], a[36:39]
    v_mfma_f32_16x16x32_bf16 a[40:43], v[116:119], v[76:79], a[40:43]
    v_mfma_f32_16x16x32_bf16 a[44:47], v[120:123], v[76:79], a[44:47]
    ds_read_b128 v[48:51], v9 offset:36864
    s_waitcnt lgkmcnt(13)
    v_mfma_f32_16x16x32_bf16 a[60:63], v[120:123], v[80:83], a[60:63]
    s_add_u32 s22, s21, 5898240
    s_add_u32 m0, s23, 12288
    v_mfma_f32_16x16x32_bf16 a[56:59], v[116:119], v[80:83], a[56:59]
    buffer_load_dwordx4 v16, s[8:11], s22 offen offset:0 lds
    v_mfma_f32_16x16x32_bf16 a[52:55], v[112:115], v[80:83], a[52:55]
    buffer_load_dwordx4 v17, s[8:11], s22 offen offset:1024 lds
    v_mfma_f32_16x16x32_bf16 a[48:51], v[108:111], v[80:83], a[48:51]
    buffer_load_dwordx4 v18, s[8:11], s22 offen offset:2048 lds
    s_waitcnt lgkmcnt(12)
    v_mfma_f32_16x16x32_bf16 a[64:67], v[108:111], v[84:87], a[64:67]
    buffer_load_dwordx4 v19, s[8:11], s22 offen offset:3072 lds
    v_mfma_f32_16x16x32_bf16 a[68:71], v[112:115], v[84:87], a[68:71]
    s_add_u32 m0, s24, 8192
    v_mfma_f32_16x16x32_bf16 a[72:75], v[116:119], v[84:87], a[72:75]
    buffer_load_dwordx4 v22, s[4:7], s26 offen lds
    v_mfma_f32_16x16x32_bf16 a[76:79], v[120:123], v[84:87], a[76:79]
    s_add_u32 m0, s24, 12288
    s_waitcnt lgkmcnt(11)
    v_mfma_f32_16x16x32_bf16 a[92:95], v[120:123], v[88:91], a[92:95]
    buffer_load_dwordx4 v23, s[4:7], s26 offen lds
    v_mfma_f32_16x16x32_bf16 a[88:91], v[116:119], v[88:91], a[88:91]
    v_mfma_f32_16x16x32_bf16 a[84:87], v[112:115], v[88:91], a[84:87]
    v_mfma_f32_16x16x32_bf16 a[80:83], v[108:111], v[88:91], a[80:83]
    s_waitcnt lgkmcnt(10)
    v_mfma_f32_16x16x32_bf16 a[96:99], v[108:111], v[40:43], a[96:99]
    v_mfma_f32_16x16x32_bf16 a[100:103], v[112:115], v[40:43], a[100:103]
    v_mfma_f32_16x16x32_bf16 a[104:107], v[116:119], v[40:43], a[104:107]
    v_mfma_f32_16x16x32_bf16 a[108:111], v[120:123], v[40:43], a[108:111]
    s_waitcnt lgkmcnt(9)
    v_mfma_f32_16x16x32_bf16 a[124:127], v[120:123], v[44:47], a[124:127]
    v_mfma_f32_16x16x32_bf16 a[120:123], v[116:119], v[44:47], a[120:123]
    v_mfma_f32_16x16x32_bf16 a[116:119], v[112:115], v[44:47], a[116:119]
    v_mfma_f32_16x16x32_bf16 a[112:115], v[108:111], v[44:47], a[112:115]
    s_waitcnt lgkmcnt(1)
    v_mfma_f32_16x16x32_bf16 a[0:3], v[92:95], v[72:75], a[0:3]
    s_waitcnt vmcnt(18)
    v_mfma_f32_16x16x32_bf16 a[4:7], v[96:99], v[72:75], a[4:7]
    ds_read_b64_tr_b16 v[108:109], v12 offset:0
    v_mfma_f32_16x16x32_bf16 a[8:11], v[100:103], v[72:75], a[8:11]
    ds_read_b64_tr_b16 v[110:111], v12 offset:256
    v_mfma_f32_16x16x32_bf16 a[12:15], v[104:107], v[72:75], a[12:15]
    ds_read_b64_tr_b16 v[112:113], v13 offset:0
    v_mfma_f32_16x16x32_bf16 a[28:31], v[104:107], v[76:79], a[28:31]
    ds_read_b64_tr_b16 v[114:115], v13 offset:256
    v_mfma_f32_16x16x32_bf16 a[24:27], v[100:103], v[76:79], a[24:27]
    ds_read_b64_tr_b16 v[116:117], v14 offset:0
    v_mfma_f32_16x16x32_bf16 a[20:23], v[96:99], v[76:79], a[20:23]
    ds_read_b64_tr_b16 v[118:119], v14 offset:256
    v_mfma_f32_16x16x32_bf16 a[16:19], v[92:95], v[76:79], a[16:19]
    ds_read_b64_tr_b16 v[120:121], v15 offset:0
    v_mfma_f32_16x16x32_bf16 a[32:35], v[92:95], v[80:83], a[32:35]
    ds_read_b64_tr_b16 v[122:123], v15 offset:256
    v_mfma_f32_16x16x32_bf16 a[36:39], v[96:99], v[80:83], a[36:39]
    v_mfma_f32_16x16x32_bf16 a[40:43], v[100:103], v[80:83], a[40:43]
    v_mfma_f32_16x16x32_bf16 a[44:47], v[104:107], v[80:83], a[44:47]
    ds_read_b128 v[52:55], v9 offset:37120
    v_mfma_f32_16x16x32_bf16 a[60:63], v[104:107], v[84:87], a[60:63]
    s_add_u32 s22, s21, 6946816
    s_add_u32 m0, s23, 16384
    v_mfma_f32_16x16x32_bf16 a[56:59], v[100:103], v[84:87], a[56:59]
    buffer_load_dwordx4 v16, s[8:11], s22 offen offset:0 lds
    v_mfma_f32_16x16x32_bf16 a[52:55], v[96:99], v[84:87], a[52:55]
    buffer_load_dwordx4 v17, s[8:11], s22 offen offset:1024 lds
    v_mfma_f32_16x16x32_bf16 a[48:51], v[92:95], v[84:87], a[48:51]
    buffer_load_dwordx4 v18, s[8:11], s22 offen offset:2048 lds
    v_mfma_f32_16x16x32_bf16 a[64:67], v[92:95], v[88:91], a[64:67]
    buffer_load_dwordx4 v19, s[8:11], s22 offen offset:3072 lds
    v_mfma_f32_16x16x32_bf16 a[68:71], v[96:99], v[88:91], a[68:71]
    s_add_u32 m0, s24, 16384
    v_mfma_f32_16x16x32_bf16 a[72:75], v[100:103], v[88:91], a[72:75]
    buffer_load_dwordx4 v24, s[4:7], s26 offen lds
    v_mfma_f32_16x16x32_bf16 a[76:79], v[104:107], v[88:91], a[76:79]
    s_add_u32 m0, s24, 20480
    v_mfma_f32_16x16x32_bf16 a[92:95], v[104:107], v[40:43], a[92:95]
    buffer_load_dwordx4 v25, s[4:7], s26 offen lds
    v_mfma_f32_16x16x32_bf16 a[88:91], v[100:103], v[40:43], a[88:91]
    v_mfma_f32_16x16x32_bf16 a[84:87], v[96:99], v[40:43], a[84:87]
    v_mfma_f32_16x16x32_bf16 a[80:83], v[92:95], v[40:43], a[80:83]
    v_mfma_f32_16x16x32_bf16 a[96:99], v[92:95], v[44:47], a[96:99]
    v_mfma_f32_16x16x32_bf16 a[100:103], v[96:99], v[44:47], a[100:103]
    v_mfma_f32_16x16x32_bf16 a[104:107], v[100:103], v[44:47], a[104:107]
    v_mfma_f32_16x16x32_bf16 a[108:111], v[104:107], v[44:47], a[108:111]
    s_waitcnt lgkmcnt(9)
    v_mfma_f32_16x16x32_bf16 a[124:127], v[104:107], v[48:51], a[124:127]
    v_mfma_f32_16x16x32_bf16 a[120:123], v[100:103], v[48:51], a[120:123]
    v_mfma_f32_16x16x32_bf16 a[116:119], v[96:99], v[48:51], a[116:119]
    v_mfma_f32_16x16x32_bf16 a[112:115], v[92:95], v[48:51], a[112:115]
    s_waitcnt lgkmcnt(1)
    v_mfma_f32_16x16x32_bf16 a[0:3], v[108:111], v[76:79], a[0:3]
    s_waitcnt vmcnt(18)
    v_mfma_f32_16x16x32_bf16 a[4:7], v[112:115], v[76:79], a[4:7]
    ds_read_b64_tr_b16 v[92:93], v12 offset:4096
    v_mfma_f32_16x16x32_bf16 a[8:11], v[116:119], v[76:79], a[8:11]
    ds_read_b64_tr_b16 v[94:95], v12 offset:4352
    v_mfma_f32_16x16x32_bf16 a[12:15], v[120:123], v[76:79], a[12:15]
    ds_read_b64_tr_b16 v[96:97], v13 offset:4096
    v_mfma_f32_16x16x32_bf16 a[28:31], v[120:123], v[80:83], a[28:31]
    ds_read_b64_tr_b16 v[98:99], v13 offset:4352
    v_mfma_f32_16x16x32_bf16 a[24:27], v[116:119], v[80:83], a[24:27]
    ds_read_b64_tr_b16 v[100:101], v14 offset:4096
    v_mfma_f32_16x16x32_bf16 a[20:23], v[112:115], v[80:83], a[20:23]
    ds_read_b64_tr_b16 v[102:103], v14 offset:4352
    v_mfma_f32_16x16x32_bf16 a[16:19], v[108:111], v[80:83], a[16:19]
    ds_read_b64_tr_b16 v[104:105], v15 offset:4096
    v_mfma_f32_16x16x32_bf16 a[32:35], v[108:111], v[84:87], a[32:35]
    ds_read_b64_tr_b16 v[106:107], v15 offset:4352
    v_mfma_f32_16x16x32_bf16 a[36:39], v[112:115], v[84:87], a[36:39]
    v_mfma_f32_16x16x32_bf16 a[40:43], v[116:119], v[84:87], a[40:43]
    v_mfma_f32_16x16x32_bf16 a[44:47], v[120:123], v[84:87], a[44:47]
    ds_read_b128 v[56:59], v9 offset:37376
    v_mfma_f32_16x16x32_bf16 a[60:63], v[120:123], v[88:91], a[60:63]
    s_add_u32 s22, s21, 262144
    s_add_u32 m0, s23, 0
    v_mfma_f32_16x16x32_bf16 a[56:59], v[116:119], v[88:91], a[56:59]
    buffer_load_dwordx4 v16, s[8:11], s22 offen offset:0 lds
    v_mfma_f32_16x16x32_bf16 a[52:55], v[112:115], v[88:91], a[52:55]
    buffer_load_dwordx4 v17, s[8:11], s22 offen offset:1024 lds
    v_mfma_f32_16x16x32_bf16 a[48:51], v[108:111], v[88:91], a[48:51]
    buffer_load_dwordx4 v18, s[8:11], s22 offen offset:2048 lds
    v_mfma_f32_16x16x32_bf16 a[64:67], v[108:111], v[40:43], a[64:67]
    buffer_load_dwordx4 v19, s[8:11], s22 offen offset:3072 lds
    v_mfma_f32_16x16x32_bf16 a[68:71], v[112:115], v[40:43], a[68:71]
    s_add_u32 m0, s24, 24576
    v_mfma_f32_16x16x32_bf16 a[72:75], v[116:119], v[40:43], a[72:75]
    buffer_load_dwordx4 v26, s[4:7], s26 offen lds
    v_mfma_f32_16x16x32_bf16 a[76:79], v[120:123], v[40:43], a[76:79]
    s_add_u32 m0, s24, 28672
    v_mfma_f32_16x16x32_bf16 a[92:95], v[120:123], v[44:47], a[92:95]
    buffer_load_dwordx4 v27, s[4:7], s26 offen lds
    v_mfma_f32_16x16x32_bf16 a[88:91], v[116:119], v[44:47], a[88:91]
    v_mfma_f32_16x16x32_bf16 a[84:87], v[112:115], v[44:47], a[84:87]
    v_mfma_f32_16x16x32_bf16 a[80:83], v[108:111], v[44:47], a[80:83]
    v_mfma_f32_16x16x32_bf16 a[96:99], v[108:111], v[48:51], a[96:99]
    v_mfma_f32_16x16x32_bf16 a[100:103], v[112:115], v[48:51], a[100:103]
    v_mfma_f32_16x16x32_bf16 a[104:107], v[116:119], v[48:51], a[104:107]
    v_mfma_f32_16x16x32_bf16 a[108:111], v[120:123], v[48:51], a[108:111]
    s_waitcnt lgkmcnt(9)
    v_mfma_f32_16x16x32_bf16 a[124:127], v[120:123], v[52:55], a[124:127]
    v_mfma_f32_16x16x32_bf16 a[120:123], v[116:119], v[52:55], a[120:123]
    v_mfma_f32_16x16x32_bf16 a[116:119], v[112:115], v[52:55], a[116:119]
    v_mfma_f32_16x16x32_bf16 a[112:115], v[108:111], v[52:55], a[112:115]
    s_waitcnt lgkmcnt(1)
    v_mfma_f32_16x16x32_bf16 a[0:3], v[92:95], v[80:83], a[0:3]
    s_waitcnt vmcnt(20)
    v_mfma_f32_16x16x32_bf16 a[4:7], v[96:99], v[80:83], a[4:7]
    ds_read_b64_tr_b16 v[108:109], v12 offset:8192
    v_mfma_f32_16x16x32_bf16 a[8:11], v[100:103], v[80:83], a[8:11]
    ds_read_b64_tr_b16 v[110:111], v12 offset:8448
    v_mfma_f32_16x16x32_bf16 a[12:15], v[104:107], v[80:83], a[12:15]
    ds_read_b64_tr_b16 v[112:113], v13 offset:8192
    v_mfma_f32_16x16x32_bf16 a[28:31], v[104:107], v[84:87], a[28:31]
    ds_read_b64_tr_b16 v[114:115], v13 offset:8448
    v_mfma_f32_16x16x32_bf16 a[24:27], v[100:103], v[84:87], a[24:27]
    ds_read_b64_tr_b16 v[116:117], v14 offset:8192
    v_mfma_f32_16x16x32_bf16 a[20:23], v[96:99], v[84:87], a[20:23]
    ds_read_b64_tr_b16 v[118:119], v14 offset:8448
    v_mfma_f32_16x16x32_bf16 a[16:19], v[92:95], v[84:87], a[16:19]
    ds_read_b64_tr_b16 v[120:121], v15 offset:8192
    v_mfma_f32_16x16x32_bf16 a[32:35], v[92:95], v[88:91], a[32:35]
    ds_read_b64_tr_b16 v[122:123], v15 offset:8448
    v_mfma_f32_16x16x32_bf16 a[36:39], v[96:99], v[88:91], a[36:39]
    v_mfma_f32_16x16x32_bf16 a[40:43], v[100:103], v[88:91], a[40:43]
    v_mfma_f32_16x16x32_bf16 a[44:47], v[104:107], v[88:91], a[44:47]
    ds_read_b128 v[60:63], v9 offset:37632
    v_mfma_f32_16x16x32_bf16 a[60:63], v[104:107], v[40:43], a[60:63]
    s_add_u32 s22, s21, 1310720
    s_add_u32 m0, s23, 4096
    v_mfma_f32_16x16x32_bf16 a[56:59], v[100:103], v[40:43], a[56:59]
    buffer_load_dwordx4 v16, s[8:11], s22 offen offset:0 lds
    v_mfma_f32_16x16x32_bf16 a[52:55], v[96:99], v[40:43], a[52:55]
    buffer_load_dwordx4 v17, s[8:11], s22 offen offset:1024 lds
    v_mfma_f32_16x16x32_bf16 a[48:51], v[92:95], v[40:43], a[48:51]
    buffer_load_dwordx4 v18, s[8:11], s22 offen offset:2048 lds
    v_mfma_f32_16x16x32_bf16 a[64:67], v[92:95], v[44:47], a[64:67]
    buffer_load_dwordx4 v19, s[8:11], s22 offen offset:3072 lds
    v_mfma_f32_16x16x32_bf16 a[68:71], v[96:99], v[44:47], a[68:71]
    s_add_u32 m0, s25, 0
    v_mfma_f32_16x16x32_bf16 a[72:75], v[100:103], v[44:47], a[72:75]
    buffer_load_dwordx4 v28, s[4:7], s26 offen lds
    v_mfma_f32_16x16x32_bf16 a[76:79], v[104:107], v[44:47], a[76:79]
    v_mfma_f32_16x16x32_bf16 a[92:95], v[104:107], v[48:51], a[92:95]
    v_mfma_f32_16x16x32_bf16 a[88:91], v[100:103], v[48:51], a[88:91]
    v_mfma_f32_16x16x32_bf16 a[84:87], v[96:99], v[48:51], a[84:87]
    v_mfma_f32_16x16x32_bf16 a[80:83], v[92:95], v[48:51], a[80:83]
    v_mfma_f32_16x16x32_bf16 a[96:99], v[92:95], v[52:55], a[96:99]
    v_mfma_f32_16x16x32_bf16 a[100:103], v[96:99], v[52:55], a[100:103]
    v_mfma_f32_16x16x32_bf16 a[104:107], v[100:103], v[52:55], a[104:107]
    v_mfma_f32_16x16x32_bf16 a[108:111], v[104:107], v[52:55], a[108:111]
    s_waitcnt lgkmcnt(9)
    v_mfma_f32_16x16x32_bf16 a[124:127], v[104:107], v[56:59], a[124:127]
    v_mfma_f32_16x16x32_bf16 a[120:123], v[100:103], v[56:59], a[120:123]
    v_mfma_f32_16x16x32_bf16 a[116:119], v[96:99], v[56:59], a[116:119]
    v_mfma_f32_16x16x32_bf16 a[112:115], v[92:95], v[56:59], a[112:115]
    s_waitcnt lgkmcnt(1)
    v_mfma_f32_16x16x32_bf16 a[0:3], v[108:111], v[84:87], a[0:3]
    s_waitcnt vmcnt(19)
    v_mfma_f32_16x16x32_bf16 a[4:7], v[112:115], v[84:87], a[4:7]
    ds_read_b64_tr_b16 v[92:93], v12 offset:12288
    v_mfma_f32_16x16x32_bf16 a[8:11], v[116:119], v[84:87], a[8:11]
    ds_read_b64_tr_b16 v[94:95], v12 offset:12544
    buffer_load_dwordx2 v[164:165], v157, s[64:67], s68 offen offset:0
    buffer_load_dwordx2 v[166:167], v157, s[64:67], s68 offen offset:1024
    v_mfma_f32_16x16x32_bf16 a[12:15], v[120:123], v[84:87], a[12:15]
    ds_read_b64_tr_b16 v[96:97], v13 offset:12288
    buffer_load_dwordx2 v[168:169], v157, s[64:67], s69 offen offset:0
    buffer_load_dwordx2 v[170:171], v157, s[64:67], s69 offen offset:1024
    v_mfma_f32_16x16x32_bf16 a[28:31], v[120:123], v[88:91], a[28:31]
    ds_read_b64_tr_b16 v[98:99], v13 offset:12544
    v_mfma_f32_16x16x32_bf16 a[24:27], v[116:119], v[88:91], a[24:27]
    ds_read_b64_tr_b16 v[100:101], v14 offset:12288
    v_mfma_f32_16x16x32_bf16 a[20:23], v[112:115], v[88:91], a[20:23]
    ds_read_b64_tr_b16 v[102:103], v14 offset:12544
    v_mfma_f32_16x16x32_bf16 a[16:19], v[108:111], v[88:91], a[16:19]
    ds_read_b64_tr_b16 v[104:105], v15 offset:12288
    v_mfma_f32_16x16x32_bf16 a[32:35], v[108:111], v[40:43], a[32:35]
    ds_read_b64_tr_b16 v[106:107], v15 offset:12544
    v_mfma_f32_16x16x32_bf16 a[36:39], v[112:115], v[40:43], a[36:39]
    v_mfma_f32_16x16x32_bf16 a[40:43], v[116:119], v[40:43], a[40:43]
    v_mfma_f32_16x16x32_bf16 a[44:47], v[120:123], v[40:43], a[44:47]
    ds_read_b128 v[64:67], v9 offset:37888
    v_mfma_f32_16x16x32_bf16 a[60:63], v[120:123], v[44:47], a[60:63]
    s_add_u32 s22, s21, 2359296
    s_add_u32 m0, s23, 8192
    v_mfma_f32_16x16x32_bf16 a[56:59], v[116:119], v[44:47], a[56:59]
    buffer_load_dwordx4 v16, s[8:11], s22 offen offset:0 lds
    v_mfma_f32_16x16x32_bf16 a[52:55], v[112:115], v[44:47], a[52:55]
    buffer_load_dwordx4 v17, s[8:11], s22 offen offset:1024 lds
    v_mfma_f32_16x16x32_bf16 a[48:51], v[108:111], v[44:47], a[48:51]
    buffer_load_dwordx4 v18, s[8:11], s22 offen offset:2048 lds
    v_mfma_f32_16x16x32_bf16 a[64:67], v[108:111], v[48:51], a[64:67]
    buffer_load_dwordx4 v19, s[8:11], s22 offen offset:3072 lds
    v_mfma_f32_16x16x32_bf16 a[68:71], v[112:115], v[48:51], a[68:71]
    v_mfma_f32_16x16x32_bf16 a[72:75], v[116:119], v[48:51], a[72:75]
    v_mfma_f32_16x16x32_bf16 a[76:79], v[120:123], v[48:51], a[76:79]
    v_mfma_f32_16x16x32_bf16 a[92:95], v[120:123], v[52:55], a[92:95]
    v_mfma_f32_16x16x32_bf16 a[88:91], v[116:119], v[52:55], a[88:91]
    v_mfma_f32_16x16x32_bf16 a[84:87], v[112:115], v[52:55], a[84:87]
    v_mfma_f32_16x16x32_bf16 a[80:83], v[108:111], v[52:55], a[80:83]
    v_mfma_f32_16x16x32_bf16 a[96:99], v[108:111], v[56:59], a[96:99]
    v_mfma_f32_16x16x32_bf16 a[100:103], v[112:115], v[56:59], a[100:103]
    v_mfma_f32_16x16x32_bf16 a[104:107], v[116:119], v[56:59], a[104:107]
    v_mfma_f32_16x16x32_bf16 a[108:111], v[120:123], v[56:59], a[108:111]
    s_waitcnt lgkmcnt(9)
    v_mfma_f32_16x16x32_bf16 a[124:127], v[120:123], v[60:63], a[124:127]
    v_mfma_f32_16x16x32_bf16 a[120:123], v[116:119], v[60:63], a[120:123]
    v_mfma_f32_16x16x32_bf16 a[116:119], v[112:115], v[60:63], a[116:119]
    v_mfma_f32_16x16x32_bf16 a[112:115], v[108:111], v[60:63], a[112:115]
    s_waitcnt lgkmcnt(1)
    v_mfma_f32_16x16x32_bf16 a[0:3], v[92:95], v[88:91], a[0:3]
    s_waitcnt vmcnt(21)
    v_mfma_f32_16x16x32_bf16 a[4:7], v[96:99], v[88:91], a[4:7]
    ds_read_b64_tr_b16 v[108:109], v12 offset:16384
    v_mfma_f32_16x16x32_bf16 a[8:11], v[100:103], v[88:91], a[8:11]
    ds_read_b64_tr_b16 v[110:111], v12 offset:16640
    buffer_load_dwordx2 v[172:173], v157, s[64:67], s86 offen offset:0
    buffer_load_dwordx2 v[174:175], v157, s[64:67], s86 offen offset:1024
    v_mfma_f32_16x16x32_bf16 a[12:15], v[104:107], v[88:91], a[12:15]
    ds_read_b64_tr_b16 v[112:113], v13 offset:16384
    buffer_load_dwordx2 v[176:177], v157, s[64:67], s87 offen offset:0
    buffer_load_dwordx2 v[178:179], v157, s[64:67], s87 offen offset:1024
    v_mfma_f32_16x16x32_bf16 a[28:31], v[104:107], v[40:43], a[28:31]
    ds_read_b64_tr_b16 v[114:115], v13 offset:16640
    v_mfma_f32_16x16x32_bf16 a[24:27], v[100:103], v[40:43], a[24:27]
    ds_read_b64_tr_b16 v[116:117], v14 offset:16384
    v_mfma_f32_16x16x32_bf16 a[20:23], v[96:99], v[40:43], a[20:23]
    ds_read_b64_tr_b16 v[118:119], v14 offset:16640
    v_mfma_f32_16x16x32_bf16 a[16:19], v[92:95], v[40:43], a[16:19]
    ds_read_b64_tr_b16 v[120:121], v15 offset:16384
    v_mfma_f32_16x16x32_bf16 a[32:35], v[92:95], v[44:47], a[32:35]
    ds_read_b64_tr_b16 v[122:123], v15 offset:16640
    v_mfma_f32_16x16x32_bf16 a[36:39], v[96:99], v[44:47], a[36:39]
    v_mfma_f32_16x16x32_bf16 a[40:43], v[100:103], v[44:47], a[40:43]
    v_mfma_f32_16x16x32_bf16 a[44:47], v[104:107], v[44:47], a[44:47]
    ds_read_b128 v[68:71], v9 offset:38144
    v_mfma_f32_16x16x32_bf16 a[60:63], v[104:107], v[48:51], a[60:63]
    s_add_u32 s22, s21, 3407872
    s_add_u32 m0, s23, 12288
    v_mfma_f32_16x16x32_bf16 a[56:59], v[100:103], v[48:51], a[56:59]
    buffer_load_dwordx4 v16, s[8:11], s22 offen offset:0 lds
    v_mfma_f32_16x16x32_bf16 a[52:55], v[96:99], v[48:51], a[52:55]
    buffer_load_dwordx4 v17, s[8:11], s22 offen offset:1024 lds
    v_mfma_f32_16x16x32_bf16 a[48:51], v[92:95], v[48:51], a[48:51]
    buffer_load_dwordx4 v18, s[8:11], s22 offen offset:2048 lds
    v_mfma_f32_16x16x32_bf16 a[64:67], v[92:95], v[52:55], a[64:67]
    buffer_load_dwordx4 v19, s[8:11], s22 offen offset:3072 lds
    v_mfma_f32_16x16x32_bf16 a[68:71], v[96:99], v[52:55], a[68:71]
    v_mfma_f32_16x16x32_bf16 a[72:75], v[100:103], v[52:55], a[72:75]
    v_mfma_f32_16x16x32_bf16 a[76:79], v[104:107], v[52:55], a[76:79]
    v_mfma_f32_16x16x32_bf16 a[92:95], v[104:107], v[56:59], a[92:95]
    v_mfma_f32_16x16x32_bf16 a[88:91], v[100:103], v[56:59], a[88:91]
    v_mfma_f32_16x16x32_bf16 a[84:87], v[96:99], v[56:59], a[84:87]
    v_mfma_f32_16x16x32_bf16 a[80:83], v[92:95], v[56:59], a[80:83]
    v_mfma_f32_16x16x32_bf16 a[96:99], v[92:95], v[60:63], a[96:99]
    v_mfma_f32_16x16x32_bf16 a[100:103], v[96:99], v[60:63], a[100:103]
    v_mfma_f32_16x16x32_bf16 a[104:107], v[100:103], v[60:63], a[104:107]
    v_mfma_f32_16x16x32_bf16 a[108:111], v[104:107], v[60:63], a[108:111]
    s_waitcnt lgkmcnt(9)
    v_mfma_f32_16x16x32_bf16 a[124:127], v[104:107], v[64:67], a[124:127]
    v_mfma_f32_16x16x32_bf16 a[120:123], v[100:103], v[64:67], a[120:123]
    v_mfma_f32_16x16x32_bf16 a[116:119], v[96:99], v[64:67], a[116:119]
    v_mfma_f32_16x16x32_bf16 a[112:115], v[92:95], v[64:67], a[112:115]
    s_waitcnt lgkmcnt(1)
    v_mfma_f32_16x16x32_bf16 a[0:3], v[108:111], v[40:43], a[0:3]
    s_waitcnt vmcnt(16) lgkmcnt(0)
    s_barrier
    v_mfma_f32_16x16x32_bf16 a[4:7], v[112:115], v[40:43], a[4:7]
    ds_read_b64_tr_b16 v[92:93], v12 offset:0
    v_mfma_f32_16x16x32_bf16 a[8:11], v[116:119], v[40:43], a[8:11]
    ds_read_b64_tr_b16 v[94:95], v12 offset:256
    v_mfma_f32_16x16x32_bf16 a[12:15], v[120:123], v[40:43], a[12:15]
    ds_read_b64_tr_b16 v[96:97], v13 offset:0
    ds_read_b128 v[40:43], v8 offset:0
    v_mfma_f32_16x16x32_bf16 a[28:31], v[120:123], v[44:47], a[28:31]
    ds_read_b64_tr_b16 v[98:99], v13 offset:256
    v_mfma_f32_16x16x32_bf16 a[24:27], v[116:119], v[44:47], a[24:27]
    ds_read_b64_tr_b16 v[100:101], v14 offset:0
    v_mfma_f32_16x16x32_bf16 a[20:23], v[112:115], v[44:47], a[20:23]
    ds_read_b64_tr_b16 v[102:103], v14 offset:256
    v_mfma_f32_16x16x32_bf16 a[16:19], v[108:111], v[44:47], a[16:19]
    ds_read_b64_tr_b16 v[104:105], v15 offset:0
    ds_read_b128 v[44:47], v8 offset:256
    v_mfma_f32_16x16x32_bf16 a[32:35], v[108:111], v[48:51], a[32:35]
    ds_read_b64_tr_b16 v[106:107], v15 offset:256
    v_mfma_f32_16x16x32_bf16 a[36:39], v[112:115], v[48:51], a[36:39]
    v_mfma_f32_16x16x32_bf16 a[40:43], v[116:119], v[48:51], a[40:43]
    v_mfma_f32_16x16x32_bf16 a[44:47], v[120:123], v[48:51], a[44:47]
    ds_read_b128 v[48:51], v8 offset:512
    v_mfma_f32_16x16x32_bf16 a[60:63], v[120:123], v[52:55], a[60:63]
    s_add_u32 s22, s21, 4456448
    s_add_u32 m0, s23, 16384
    v_mfma_f32_16x16x32_bf16 a[56:59], v[116:119], v[52:55], a[56:59]
    buffer_load_dwordx4 v16, s[8:11], s22 offen offset:0 lds
    v_mfma_f32_16x16x32_bf16 a[52:55], v[112:115], v[52:55], a[52:55]
    buffer_load_dwordx4 v17, s[8:11], s22 offen offset:1024 lds
    v_mfma_f32_16x16x32_bf16 a[48:51], v[108:111], v[52:55], a[48:51]
    ds_read_b128 v[52:55], v8 offset:768
    buffer_load_dwordx4 v18, s[8:11], s22 offen offset:2048 lds
    v_mfma_f32_16x16x32_bf16 a[64:67], v[108:111], v[56:59], a[64:67]
    buffer_load_dwordx4 v19, s[8:11], s22 offen offset:3072 lds
    v_mfma_f32_16x16x32_bf16 a[68:71], v[112:115], v[56:59], a[68:71]
    s_mov_b32 s26, 512
    v_mfma_f32_16x16x32_bf16 a[72:75], v[116:119], v[56:59], a[72:75]
    s_add_u32 m0, s24, 34816
    v_mfma_f32_16x16x32_bf16 a[76:79], v[120:123], v[56:59], a[76:79]
    ds_read_b128 v[56:59], v8 offset:1024
    buffer_load_dwordx4 v29, s[4:7], s26 offen lds
    v_mfma_f32_16x16x32_bf16 a[92:95], v[120:123], v[60:63], a[92:95]
    s_add_u32 m0, s24, 38912
    v_mfma_f32_16x16x32_bf16 a[88:91], v[116:119], v[60:63], a[88:91]
    buffer_load_dwordx4 v30, s[4:7], s26 offen lds
    v_mfma_f32_16x16x32_bf16 a[84:87], v[112:115], v[60:63], a[84:87]
    v_mfma_f32_16x16x32_bf16 a[80:83], v[108:111], v[60:63], a[80:83]
    ds_read_b128 v[60:63], v8 offset:1280
    v_mfma_f32_16x16x32_bf16 a[96:99], v[108:111], v[64:67], a[96:99]
    v_mfma_f32_16x16x32_bf16 a[100:103], v[112:115], v[64:67], a[100:103]
    v_mfma_f32_16x16x32_bf16 a[104:107], v[116:119], v[64:67], a[104:107]
    v_mfma_f32_16x16x32_bf16 a[108:111], v[120:123], v[64:67], a[108:111]
    ds_read_b128 v[64:67], v8 offset:1536
    v_mfma_f32_16x16x32_bf16 a[124:127], v[120:123], v[68:71], a[124:127]
    v_mfma_f32_16x16x32_bf16 a[120:123], v[116:119], v[68:71], a[120:123]
    v_mfma_f32_16x16x32_bf16 a[116:119], v[112:115], v[68:71], a[116:119]
    v_mfma_f32_16x16x32_bf16 a[112:115], v[108:111], v[68:71], a[112:115]
    ds_read_b128 v[68:71], v8 offset:1792
    s_waitcnt lgkmcnt(6)
    v_mfma_f32_16x16x32_bf16 a[0:3], v[92:95], v[40:43], a[0:3]
    v_mfma_f32_16x16x32_bf16 a[4:7], v[96:99], v[40:43], a[4:7]
    ds_read_b64_tr_b16 v[108:109], v12 offset:4096
    v_mfma_f32_16x16x32_bf16 a[8:11], v[100:103], v[40:43], a[8:11]
    ds_read_b64_tr_b16 v[110:111], v12 offset:4352
    v_mfma_f32_16x16x32_bf16 a[12:15], v[104:107], v[40:43], a[12:15]
    ds_read_b64_tr_b16 v[112:113], v13 offset:4096
    v_mfma_f32_16x16x32_bf16 a[28:31], v[104:107], v[44:47], a[28:31]
    ds_read_b64_tr_b16 v[114:115], v13 offset:4352
    v_mfma_f32_16x16x32_bf16 a[24:27], v[100:103], v[44:47], a[24:27]
    ds_read_b64_tr_b16 v[116:117], v14 offset:4096
    v_mfma_f32_16x16x32_bf16 a[20:23], v[96:99], v[44:47], a[20:23]
    ds_read_b64_tr_b16 v[118:119], v14 offset:4352
    v_mfma_f32_16x16x32_bf16 a[16:19], v[92:95], v[44:47], a[16:19]
    ds_read_b64_tr_b16 v[120:121], v15 offset:4096
    s_waitcnt lgkmcnt(12)
    v_mfma_f32_16x16x32_bf16 a[32:35], v[92:95], v[48:51], a[32:35]
    ds_read_b64_tr_b16 v[122:123], v15 offset:4352
    v_mfma_f32_16x16x32_bf16 a[36:39], v[96:99], v[48:51], a[36:39]
    v_mfma_f32_16x16x32_bf16 a[40:43], v[100:103], v[48:51], a[40:43]
    v_mfma_f32_16x16x32_bf16 a[44:47], v[104:107], v[48:51], a[44:47]
    ds_read_b128 v[72:75], v9 offset:2048
    s_waitcnt lgkmcnt(13)
    v_mfma_f32_16x16x32_bf16 a[60:63], v[104:107], v[52:55], a[60:63]
    s_add_u32 s22, s21, 5505024
    s_add_u32 m0, s23, 0
    v_mfma_f32_16x16x32_bf16 a[56:59], v[100:103], v[52:55], a[56:59]
    buffer_load_dwordx4 v16, s[8:11], s22 offen offset:0 lds
    v_mfma_f32_16x16x32_bf16 a[52:55], v[96:99], v[52:55], a[52:55]
    buffer_load_dwordx4 v17, s[8:11], s22 offen offset:1024 lds
    v_mfma_f32_16x16x32_bf16 a[48:51], v[92:95], v[52:55], a[48:51]
    buffer_load_dwordx4 v18, s[8:11], s22 offen offset:2048 lds
    s_waitcnt lgkmcnt(12)
    v_mfma_f32_16x16x32_bf16 a[64:67], v[92:95], v[56:59], a[64:67]
    buffer_load_dwordx4 v19, s[8:11], s22 offen offset:3072 lds
    v_mfma_f32_16x16x32_bf16 a[68:71], v[96:99], v[56:59], a[68:71]
    s_add_u32 m0, s24, 43008
    v_mfma_f32_16x16x32_bf16 a[72:75], v[100:103], v[56:59], a[72:75]
    buffer_load_dwordx4 v31, s[4:7], s26 offen lds
    v_mfma_f32_16x16x32_bf16 a[76:79], v[104:107], v[56:59], a[76:79]
    s_add_u32 m0, s24, 47104
    s_waitcnt lgkmcnt(11)
    v_mfma_f32_16x16x32_bf16 a[92:95], v[104:107], v[60:63], a[92:95]
    buffer_load_dwordx4 v32, s[4:7], s26 offen lds
    v_mfma_f32_16x16x32_bf16 a[88:91], v[100:103], v[60:63], a[88:91]
    v_mfma_f32_16x16x32_bf16 a[84:87], v[96:99], v[60:63], a[84:87]
    v_mfma_f32_16x16x32_bf16 a[80:83], v[92:95], v[60:63], a[80:83]
    s_waitcnt lgkmcnt(10)
    v_mfma_f32_16x16x32_bf16 a[96:99], v[92:95], v[64:67], a[96:99]
    v_mfma_f32_16x16x32_bf16 a[100:103], v[96:99], v[64:67], a[100:103]
    v_mfma_f32_16x16x32_bf16 a[104:107], v[100:103], v[64:67], a[104:107]
    v_mfma_f32_16x16x32_bf16 a[108:111], v[104:107], v[64:67], a[108:111]
    s_waitcnt lgkmcnt(9)
    v_mfma_f32_16x16x32_bf16 a[124:127], v[104:107], v[68:71], a[124:127]
    v_mfma_f32_16x16x32_bf16 a[120:123], v[100:103], v[68:71], a[120:123]
    v_mfma_f32_16x16x32_bf16 a[116:119], v[96:99], v[68:71], a[116:119]
    v_mfma_f32_16x16x32_bf16 a[112:115], v[92:95], v[68:71], a[112:115]
    s_waitcnt lgkmcnt(1)
    v_mfma_f32_16x16x32_bf16 a[0:3], v[108:111], v[44:47], a[0:3]
    s_waitcnt vmcnt(20)
    v_mfma_f32_16x16x32_bf16 a[4:7], v[112:115], v[44:47], a[4:7]
    ds_read_b64_tr_b16 v[92:93], v12 offset:8192
    v_mfma_f32_16x16x32_bf16 a[8:11], v[116:119], v[44:47], a[8:11]
    ds_read_b64_tr_b16 v[94:95], v12 offset:8448
    v_mfma_f32_16x16x32_bf16 a[12:15], v[120:123], v[44:47], a[12:15]
    ds_read_b64_tr_b16 v[96:97], v13 offset:8192
    v_mfma_f32_16x16x32_bf16 a[28:31], v[120:123], v[48:51], a[28:31]
    ds_read_b64_tr_b16 v[98:99], v13 offset:8448
    v_mfma_f32_16x16x32_bf16 a[24:27], v[116:119], v[48:51], a[24:27]
    ds_read_b64_tr_b16 v[100:101], v14 offset:8192
    v_mfma_f32_16x16x32_bf16 a[20:23], v[112:115], v[48:51], a[20:23]
    ds_read_b64_tr_b16 v[102:103], v14 offset:8448
    v_mfma_f32_16x16x32_bf16 a[16:19], v[108:111], v[48:51], a[16:19]
    ds_read_b64_tr_b16 v[104:105], v15 offset:8192
    v_mfma_f32_16x16x32_bf16 a[32:35], v[108:111], v[52:55], a[32:35]
    ds_read_b64_tr_b16 v[106:107], v15 offset:8448
    v_mfma_f32_16x16x32_bf16 a[36:39], v[112:115], v[52:55], a[36:39]
    v_mfma_f32_16x16x32_bf16 a[40:43], v[116:119], v[52:55], a[40:43]
    v_mfma_f32_16x16x32_bf16 a[44:47], v[120:123], v[52:55], a[44:47]
    ds_read_b128 v[76:79], v9 offset:2304
    v_mfma_f32_16x16x32_bf16 a[60:63], v[120:123], v[56:59], a[60:63]
    s_add_u32 s22, s21, 6553600
    s_add_u32 m0, s23, 4096
    v_mfma_f32_16x16x32_bf16 a[56:59], v[116:119], v[56:59], a[56:59]
    buffer_load_dwordx4 v16, s[8:11], s22 offen offset:0 lds
    v_mfma_f32_16x16x32_bf16 a[52:55], v[112:115], v[56:59], a[52:55]
    buffer_load_dwordx4 v17, s[8:11], s22 offen offset:1024 lds
    v_mfma_f32_16x16x32_bf16 a[48:51], v[108:111], v[56:59], a[48:51]
    buffer_load_dwordx4 v18, s[8:11], s22 offen offset:2048 lds
    v_mfma_f32_16x16x32_bf16 a[64:67], v[108:111], v[60:63], a[64:67]
    buffer_load_dwordx4 v19, s[8:11], s22 offen offset:3072 lds
    v_mfma_f32_16x16x32_bf16 a[68:71], v[112:115], v[60:63], a[68:71]
    s_add_u32 m0, s24, 51200
    v_mfma_f32_16x16x32_bf16 a[72:75], v[116:119], v[60:63], a[72:75]
    buffer_load_dwordx4 v33, s[4:7], s26 offen lds
    v_mfma_f32_16x16x32_bf16 a[76:79], v[120:123], v[60:63], a[76:79]
    s_add_u32 m0, s24, 55296
    v_mfma_f32_16x16x32_bf16 a[92:95], v[120:123], v[64:67], a[92:95]
    buffer_load_dwordx4 v34, s[4:7], s26 offen lds
    v_mfma_f32_16x16x32_bf16 a[88:91], v[116:119], v[64:67], a[88:91]
    v_mfma_f32_16x16x32_bf16 a[84:87], v[112:115], v[64:67], a[84:87]
    v_mfma_f32_16x16x32_bf16 a[80:83], v[108:111], v[64:67], a[80:83]
    v_mfma_f32_16x16x32_bf16 a[96:99], v[108:111], v[68:71], a[96:99]
    v_mfma_f32_16x16x32_bf16 a[100:103], v[112:115], v[68:71], a[100:103]
    v_mfma_f32_16x16x32_bf16 a[104:107], v[116:119], v[68:71], a[104:107]
    v_mfma_f32_16x16x32_bf16 a[108:111], v[120:123], v[68:71], a[108:111]
    s_waitcnt lgkmcnt(9)
    v_mfma_f32_16x16x32_bf16 a[124:127], v[120:123], v[72:75], a[124:127]
    v_mfma_f32_16x16x32_bf16 a[120:123], v[116:119], v[72:75], a[120:123]
    v_mfma_f32_16x16x32_bf16 a[116:119], v[112:115], v[72:75], a[116:119]
    v_mfma_f32_16x16x32_bf16 a[112:115], v[108:111], v[72:75], a[112:115]
    s_waitcnt lgkmcnt(1)
    v_mfma_f32_16x16x32_bf16 a[0:3], v[92:95], v[48:51], a[0:3]
    s_waitcnt vmcnt(18)
    v_mfma_f32_16x16x32_bf16 a[4:7], v[96:99], v[48:51], a[4:7]
    ds_read_b64_tr_b16 v[108:109], v12 offset:12288
    v_mfma_f32_16x16x32_bf16 a[8:11], v[100:103], v[48:51], a[8:11]
    ds_read_b64_tr_b16 v[110:111], v12 offset:12544
    v_mfma_f32_16x16x32_bf16 a[12:15], v[104:107], v[48:51], a[12:15]
    ds_read_b64_tr_b16 v[112:113], v13 offset:12288
    v_mfma_f32_16x16x32_bf16 a[28:31], v[104:107], v[52:55], a[28:31]
    ds_read_b64_tr_b16 v[114:115], v13 offset:12544
    v_mfma_f32_16x16x32_bf16 a[24:27], v[100:103], v[52:55], a[24:27]
    ds_read_b64_tr_b16 v[116:117], v14 offset:12288
    v_mfma_f32_16x16x32_bf16 a[20:23], v[96:99], v[52:55], a[20:23]
    ds_read_b64_tr_b16 v[118:119], v14 offset:12544
    v_mfma_f32_16x16x32_bf16 a[16:19], v[92:95], v[52:55], a[16:19]
    ds_read_b64_tr_b16 v[120:121], v15 offset:12288
    v_mfma_f32_16x16x32_bf16 a[32:35], v[92:95], v[56:59], a[32:35]
    ds_read_b64_tr_b16 v[122:123], v15 offset:12544
    v_mfma_f32_16x16x32_bf16 a[36:39], v[96:99], v[56:59], a[36:39]
    v_mfma_f32_16x16x32_bf16 a[40:43], v[100:103], v[56:59], a[40:43]
    v_mfma_f32_16x16x32_bf16 a[44:47], v[104:107], v[56:59], a[44:47]
    ds_read_b128 v[80:83], v9 offset:2560
    v_mfma_f32_16x16x32_bf16 a[60:63], v[104:107], v[60:63], a[60:63]
    s_add_u32 s22, s21, 7602176
    s_add_u32 m0, s23, 8192
    v_mfma_f32_16x16x32_bf16 a[56:59], v[100:103], v[60:63], a[56:59]
    buffer_load_dwordx4 v16, s[8:11], s22 offen offset:0 lds
    v_mfma_f32_16x16x32_bf16 a[52:55], v[96:99], v[60:63], a[52:55]
    buffer_load_dwordx4 v17, s[8:11], s22 offen offset:1024 lds
    v_mfma_f32_16x16x32_bf16 a[48:51], v[92:95], v[60:63], a[48:51]
    buffer_load_dwordx4 v18, s[8:11], s22 offen offset:2048 lds
    v_mfma_f32_16x16x32_bf16 a[64:67], v[92:95], v[64:67], a[64:67]
    buffer_load_dwordx4 v19, s[8:11], s22 offen offset:3072 lds
    v_mfma_f32_16x16x32_bf16 a[68:71], v[96:99], v[64:67], a[68:71]
    s_add_u32 m0, s24, 59392
    v_mfma_f32_16x16x32_bf16 a[72:75], v[100:103], v[64:67], a[72:75]
    buffer_load_dwordx4 v35, s[4:7], s26 offen lds
    v_mfma_f32_16x16x32_bf16 a[76:79], v[104:107], v[64:67], a[76:79]
    s_add_u32 m0, s24, 63488
    v_mfma_f32_16x16x32_bf16 a[92:95], v[104:107], v[68:71], a[92:95]
    buffer_load_dwordx4 v36, s[4:7], s26 offen lds
    v_mfma_f32_16x16x32_bf16 a[88:91], v[100:103], v[68:71], a[88:91]
    v_mfma_f32_16x16x32_bf16 a[84:87], v[96:99], v[68:71], a[84:87]
    v_mfma_f32_16x16x32_bf16 a[80:83], v[92:95], v[68:71], a[80:83]
    v_mfma_f32_16x16x32_bf16 a[96:99], v[92:95], v[72:75], a[96:99]
    v_mfma_f32_16x16x32_bf16 a[100:103], v[96:99], v[72:75], a[100:103]
    v_mfma_f32_16x16x32_bf16 a[104:107], v[100:103], v[72:75], a[104:107]
    v_mfma_f32_16x16x32_bf16 a[108:111], v[104:107], v[72:75], a[108:111]
    s_waitcnt lgkmcnt(9)
    v_mfma_f32_16x16x32_bf16 a[124:127], v[104:107], v[76:79], a[124:127]
    v_mfma_f32_16x16x32_bf16 a[120:123], v[100:103], v[76:79], a[120:123]
    v_mfma_f32_16x16x32_bf16 a[116:119], v[96:99], v[76:79], a[116:119]
    v_mfma_f32_16x16x32_bf16 a[112:115], v[92:95], v[76:79], a[112:115]
    s_waitcnt lgkmcnt(1)
    v_mfma_f32_16x16x32_bf16 a[0:3], v[108:111], v[52:55], a[0:3]
    s_waitcnt vmcnt(20)
    v_mfma_f32_16x16x32_bf16 a[4:7], v[112:115], v[52:55], a[4:7]
    ds_read_b64_tr_b16 v[92:93], v12 offset:16384
    v_mfma_f32_16x16x32_bf16 a[8:11], v[116:119], v[52:55], a[8:11]
    ds_read_b64_tr_b16 v[94:95], v12 offset:16640
    v_mfma_f32_16x16x32_bf16 a[12:15], v[120:123], v[52:55], a[12:15]
    ds_read_b64_tr_b16 v[96:97], v13 offset:16384
    v_mfma_f32_16x16x32_bf16 a[28:31], v[120:123], v[56:59], a[28:31]
    ds_read_b64_tr_b16 v[98:99], v13 offset:16640
    v_mfma_f32_16x16x32_bf16 a[24:27], v[116:119], v[56:59], a[24:27]
    ds_read_b64_tr_b16 v[100:101], v14 offset:16384
    v_mfma_f32_16x16x32_bf16 a[20:23], v[112:115], v[56:59], a[20:23]
    ds_read_b64_tr_b16 v[102:103], v14 offset:16640
    v_mfma_f32_16x16x32_bf16 a[16:19], v[108:111], v[56:59], a[16:19]
    ds_read_b64_tr_b16 v[104:105], v15 offset:16384
    v_mfma_f32_16x16x32_bf16 a[32:35], v[108:111], v[60:63], a[32:35]
    ds_read_b64_tr_b16 v[106:107], v15 offset:16640
    v_mfma_f32_16x16x32_bf16 a[36:39], v[112:115], v[60:63], a[36:39]
    v_mfma_f32_16x16x32_bf16 a[40:43], v[116:119], v[60:63], a[40:43]
    v_mfma_f32_16x16x32_bf16 a[44:47], v[120:123], v[60:63], a[44:47]
    ds_read_b128 v[84:87], v9 offset:2816
    v_mfma_f32_16x16x32_bf16 a[60:63], v[120:123], v[64:67], a[60:63]
    s_add_u32 s22, s21, 786432
    s_add_u32 m0, s23, 12288
    v_mfma_f32_16x16x32_bf16 a[56:59], v[116:119], v[64:67], a[56:59]
    buffer_load_dwordx4 v16, s[8:11], s22 offen offset:0 lds
    v_mfma_f32_16x16x32_bf16 a[52:55], v[112:115], v[64:67], a[52:55]
    buffer_load_dwordx4 v17, s[8:11], s22 offen offset:1024 lds
    v_mfma_f32_16x16x32_bf16 a[48:51], v[108:111], v[64:67], a[48:51]
    buffer_load_dwordx4 v18, s[8:11], s22 offen offset:2048 lds
    v_mfma_f32_16x16x32_bf16 a[64:67], v[108:111], v[68:71], a[64:67]
    buffer_load_dwordx4 v19, s[8:11], s22 offen offset:3072 lds
    v_mfma_f32_16x16x32_bf16 a[68:71], v[112:115], v[68:71], a[68:71]
    s_add_u32 m0, s25, 34816
    v_mfma_f32_16x16x32_bf16 a[72:75], v[116:119], v[68:71], a[72:75]
    buffer_load_dwordx4 v37, s[4:7], s26 offen lds
    v_mfma_f32_16x16x32_bf16 a[76:79], v[120:123], v[68:71], a[76:79]
    v_mfma_f32_16x16x32_bf16 a[92:95], v[120:123], v[72:75], a[92:95]
    v_mfma_f32_16x16x32_bf16 a[88:91], v[116:119], v[72:75], a[88:91]
    v_mfma_f32_16x16x32_bf16 a[84:87], v[112:115], v[72:75], a[84:87]
    v_mfma_f32_16x16x32_bf16 a[80:83], v[108:111], v[72:75], a[80:83]
    v_mfma_f32_16x16x32_bf16 a[96:99], v[108:111], v[76:79], a[96:99]
    v_mfma_f32_16x16x32_bf16 a[100:103], v[112:115], v[76:79], a[100:103]
    v_mfma_f32_16x16x32_bf16 a[104:107], v[116:119], v[76:79], a[104:107]
    v_mfma_f32_16x16x32_bf16 a[108:111], v[120:123], v[76:79], a[108:111]
    s_waitcnt lgkmcnt(9)
    v_mfma_f32_16x16x32_bf16 a[124:127], v[120:123], v[80:83], a[124:127]
    v_mfma_f32_16x16x32_bf16 a[120:123], v[116:119], v[80:83], a[120:123]
    v_mfma_f32_16x16x32_bf16 a[116:119], v[112:115], v[80:83], a[116:119]
    v_mfma_f32_16x16x32_bf16 a[112:115], v[108:111], v[80:83], a[112:115]
    s_waitcnt lgkmcnt(1)
    v_mfma_f32_16x16x32_bf16 a[0:3], v[92:95], v[56:59], a[0:3]
    s_waitcnt vmcnt(19)
    v_mfma_f32_16x16x32_bf16 a[4:7], v[96:99], v[56:59], a[4:7]
    ds_read_b64_tr_b16 v[108:109], v12 offset:0
    v_mfma_f32_16x16x32_bf16 a[8:11], v[100:103], v[56:59], a[8:11]
    ds_read_b64_tr_b16 v[110:111], v12 offset:256
    v_perm_b32 v140, v166, v164, s98
    v_mfma_f32_16x16x32_bf16 a[12:15], v[104:107], v[56:59], a[12:15]
    ds_read_b64_tr_b16 v[112:113], v13 offset:0
    v_perm_b32 v141, v170, v168, s98
    v_perm_b32 v142, v174, v172, s98
    v_mfma_f32_16x16x32_bf16 a[28:31], v[104:107], v[60:63], a[28:31]
    ds_read_b64_tr_b16 v[114:115], v13 offset:256
    v_perm_b32 v143, v178, v176, s98
    v_perm_b32 v144, v166, v164, s99
    v_mfma_f32_16x16x32_bf16 a[24:27], v[100:103], v[60:63], a[24:27]
    ds_read_b64_tr_b16 v[116:117], v14 offset:0
    v_perm_b32 v145, v170, v168, s99
    v_perm_b32 v146, v174, v172, s99
    v_mfma_f32_16x16x32_bf16 a[20:23], v[96:99], v[60:63], a[20:23]
    ds_read_b64_tr_b16 v[118:119], v14 offset:256
    v_perm_b32 v147, v178, v176, s99
    v_mfma_f32_16x16x32_bf16 a[16:19], v[92:95], v[60:63], a[16:19]
    ds_read_b64_tr_b16 v[120:121], v15 offset:0
    v_mfma_f32_16x16x32_bf16 a[32:35], v[92:95], v[64:67], a[32:35]
    ds_read_b64_tr_b16 v[122:123], v15 offset:256
    v_mfma_f32_16x16x32_bf16 a[36:39], v[96:99], v[64:67], a[36:39]
    v_mfma_f32_16x16x32_bf16 a[40:43], v[100:103], v[64:67], a[40:43]
    v_mfma_f32_16x16x32_bf16 a[44:47], v[104:107], v[64:67], a[44:47]
    ds_read_b128 v[88:91], v9 offset:3072
    v_mfma_f32_16x16x32_bf16 a[60:63], v[104:107], v[68:71], a[60:63]
    s_add_u32 s22, s21, 1835008
    s_add_u32 m0, s23, 16384
    v_mfma_f32_16x16x32_bf16 a[56:59], v[100:103], v[68:71], a[56:59]
    buffer_load_dwordx4 v16, s[8:11], s22 offen offset:0 lds
    v_mfma_f32_16x16x32_bf16 a[52:55], v[96:99], v[68:71], a[52:55]
    buffer_load_dwordx4 v17, s[8:11], s22 offen offset:1024 lds
    v_mfma_f32_16x16x32_bf16 a[48:51], v[92:95], v[68:71], a[48:51]
    buffer_load_dwordx4 v18, s[8:11], s22 offen offset:2048 lds
    v_mfma_f32_16x16x32_bf16 a[64:67], v[92:95], v[72:75], a[64:67]
    buffer_load_dwordx4 v19, s[8:11], s22 offen offset:3072 lds
    v_mfma_f32_16x16x32_bf16 a[68:71], v[96:99], v[72:75], a[68:71]
    v_mfma_f32_16x16x32_bf16 a[72:75], v[100:103], v[72:75], a[72:75]
    v_mfma_f32_16x16x32_bf16 a[76:79], v[104:107], v[72:75], a[76:79]
    v_mfma_f32_16x16x32_bf16 a[92:95], v[104:107], v[76:79], a[92:95]
    v_mfma_f32_16x16x32_bf16 a[88:91], v[100:103], v[76:79], a[88:91]
    v_mfma_f32_16x16x32_bf16 a[84:87], v[96:99], v[76:79], a[84:87]
    v_mfma_f32_16x16x32_bf16 a[80:83], v[92:95], v[76:79], a[80:83]
    v_mfma_f32_16x16x32_bf16 a[96:99], v[92:95], v[80:83], a[96:99]
    v_mfma_f32_16x16x32_bf16 a[100:103], v[96:99], v[80:83], a[100:103]
    v_mfma_f32_16x16x32_bf16 a[104:107], v[100:103], v[80:83], a[104:107]
    v_mfma_f32_16x16x32_bf16 a[108:111], v[104:107], v[80:83], a[108:111]
    s_waitcnt lgkmcnt(9)
    v_mfma_f32_16x16x32_bf16 a[124:127], v[104:107], v[84:87], a[124:127]
    v_mfma_f32_16x16x32_bf16 a[120:123], v[100:103], v[84:87], a[120:123]
    v_mfma_f32_16x16x32_bf16 a[116:119], v[96:99], v[84:87], a[116:119]
    v_mfma_f32_16x16x32_bf16 a[112:115], v[92:95], v[84:87], a[112:115]
    s_waitcnt lgkmcnt(1)
    v_mfma_f32_16x16x32_bf16 a[0:3], v[108:111], v[60:63], a[0:3]
    s_waitcnt vmcnt(17)
    v_mfma_f32_16x16x32_bf16 a[4:7], v[112:115], v[60:63], a[4:7]
    ds_read_b64_tr_b16 v[92:93], v12 offset:4096
    v_mfma_f32_16x16x32_bf16 a[8:11], v[116:119], v[60:63], a[8:11]
    ds_read_b64_tr_b16 v[94:95], v12 offset:4352
    v_perm_b32 v148, v167, v165, s98
    v_perm_b32 v149, v171, v169, s98
    v_mfma_f32_16x16x32_bf16 a[12:15], v[120:123], v[60:63], a[12:15]
    ds_read_b64_tr_b16 v[96:97], v13 offset:4096
    v_perm_b32 v150, v175, v173, s98
    v_perm_b32 v151, v179, v177, s98
    v_mfma_f32_16x16x32_bf16 a[28:31], v[120:123], v[64:67], a[28:31]
    ds_read_b64_tr_b16 v[98:99], v13 offset:4352
    v_perm_b32 v152, v167, v165, s99
    v_perm_b32 v153, v171, v169, s99
    v_mfma_f32_16x16x32_bf16 a[24:27], v[116:119], v[64:67], a[24:27]
    ds_read_b64_tr_b16 v[100:101], v14 offset:4096
    v_perm_b32 v154, v175, v173, s99
    v_perm_b32 v155, v179, v177, s99
    v_mfma_f32_16x16x32_bf16 a[20:23], v[112:115], v[64:67], a[20:23]
    ds_read_b64_tr_b16 v[102:103], v14 offset:4352
    buffer_store_dwordx4 v[140:143], v158, s[32:35], s55 offen offset:0 sc0 sc1
    buffer_store_dwordx4 v[144:147], v158, s[32:35], s55 offen offset:1024 sc0 sc1
    v_mfma_f32_16x16x32_bf16 a[16:19], v[108:111], v[64:67], a[16:19]
    ds_read_b64_tr_b16 v[104:105], v15 offset:4096
    v_mfma_f32_16x16x32_bf16 a[32:35], v[108:111], v[68:71], a[32:35]
    ds_read_b64_tr_b16 v[106:107], v15 offset:4352
    v_mfma_f32_16x16x32_bf16 a[36:39], v[112:115], v[68:71], a[36:39]
    v_mfma_f32_16x16x32_bf16 a[40:43], v[116:119], v[68:71], a[40:43]
    v_mfma_f32_16x16x32_bf16 a[44:47], v[120:123], v[68:71], a[44:47]
    ds_read_b128 v[40:43], v9 offset:3328
    v_mfma_f32_16x16x32_bf16 a[60:63], v[120:123], v[72:75], a[60:63]
    s_add_u32 s22, s21, 2883584
    s_add_u32 m0, s23, 0
    v_mfma_f32_16x16x32_bf16 a[56:59], v[116:119], v[72:75], a[56:59]
    buffer_load_dwordx4 v16, s[8:11], s22 offen offset:0 lds
    v_mfma_f32_16x16x32_bf16 a[52:55], v[112:115], v[72:75], a[52:55]
    buffer_load_dwordx4 v17, s[8:11], s22 offen offset:1024 lds
    v_mfma_f32_16x16x32_bf16 a[48:51], v[108:111], v[72:75], a[48:51]
    buffer_load_dwordx4 v18, s[8:11], s22 offen offset:2048 lds
    v_mfma_f32_16x16x32_bf16 a[64:67], v[108:111], v[76:79], a[64:67]
    buffer_load_dwordx4 v19, s[8:11], s22 offen offset:3072 lds
    v_mfma_f32_16x16x32_bf16 a[68:71], v[112:115], v[76:79], a[68:71]
    v_mfma_f32_16x16x32_bf16 a[72:75], v[116:119], v[76:79], a[72:75]
    v_mfma_f32_16x16x32_bf16 a[76:79], v[120:123], v[76:79], a[76:79]
    v_mfma_f32_16x16x32_bf16 a[92:95], v[120:123], v[80:83], a[92:95]
    v_mfma_f32_16x16x32_bf16 a[88:91], v[116:119], v[80:83], a[88:91]
    v_mfma_f32_16x16x32_bf16 a[84:87], v[112:115], v[80:83], a[84:87]
    v_mfma_f32_16x16x32_bf16 a[80:83], v[108:111], v[80:83], a[80:83]
    v_mfma_f32_16x16x32_bf16 a[96:99], v[108:111], v[84:87], a[96:99]
    v_mfma_f32_16x16x32_bf16 a[100:103], v[112:115], v[84:87], a[100:103]
    v_mfma_f32_16x16x32_bf16 a[104:107], v[116:119], v[84:87], a[104:107]
    v_mfma_f32_16x16x32_bf16 a[108:111], v[120:123], v[84:87], a[108:111]
    s_waitcnt lgkmcnt(9)
    v_mfma_f32_16x16x32_bf16 a[124:127], v[120:123], v[88:91], a[124:127]
    v_mfma_f32_16x16x32_bf16 a[120:123], v[116:119], v[88:91], a[120:123]
    v_mfma_f32_16x16x32_bf16 a[116:119], v[112:115], v[88:91], a[116:119]
    v_mfma_f32_16x16x32_bf16 a[112:115], v[108:111], v[88:91], a[112:115]
    s_waitcnt lgkmcnt(1)
    v_mfma_f32_16x16x32_bf16 a[0:3], v[92:95], v[64:67], a[0:3]
    s_waitcnt vmcnt(17)
    v_mfma_f32_16x16x32_bf16 a[4:7], v[96:99], v[64:67], a[4:7]
    ds_read_b64_tr_b16 v[108:109], v12 offset:8192
    v_mfma_f32_16x16x32_bf16 a[8:11], v[100:103], v[64:67], a[8:11]
    ds_read_b64_tr_b16 v[110:111], v12 offset:8448
    buffer_store_dwordx4 v[148:151], v158, s[32:35], s84 offen offset:0 sc0 sc1
    buffer_store_dwordx4 v[152:155], v158, s[32:35], s84 offen offset:1024 sc0 sc1
    v_mfma_f32_16x16x32_bf16 a[12:15], v[104:107], v[64:67], a[12:15]
    ds_read_b64_tr_b16 v[112:113], v13 offset:8192
    v_mfma_f32_16x16x32_bf16 a[28:31], v[104:107], v[68:71], a[28:31]
    ds_read_b64_tr_b16 v[114:115], v13 offset:8448
    v_mfma_f32_16x16x32_bf16 a[24:27], v[100:103], v[68:71], a[24:27]
    ds_read_b64_tr_b16 v[116:117], v14 offset:8192
    v_mfma_f32_16x16x32_bf16 a[20:23], v[96:99], v[68:71], a[20:23]
    ds_read_b64_tr_b16 v[118:119], v14 offset:8448
    v_mfma_f32_16x16x32_bf16 a[16:19], v[92:95], v[68:71], a[16:19]
    ds_read_b64_tr_b16 v[120:121], v15 offset:8192
    v_mfma_f32_16x16x32_bf16 a[32:35], v[92:95], v[72:75], a[32:35]
    ds_read_b64_tr_b16 v[122:123], v15 offset:8448
    v_mfma_f32_16x16x32_bf16 a[36:39], v[96:99], v[72:75], a[36:39]
    v_mfma_f32_16x16x32_bf16 a[40:43], v[100:103], v[72:75], a[40:43]
    v_mfma_f32_16x16x32_bf16 a[44:47], v[104:107], v[72:75], a[44:47]
    ds_read_b128 v[44:47], v9 offset:3584
    v_mfma_f32_16x16x32_bf16 a[60:63], v[104:107], v[76:79], a[60:63]
    s_add_u32 s22, s21, 3932160
    s_add_u32 m0, s23, 4096
    v_mfma_f32_16x16x32_bf16 a[56:59], v[100:103], v[76:79], a[56:59]
    buffer_load_dwordx4 v16, s[8:11], s22 offen offset:0 lds
    v_mfma_f32_16x16x32_bf16 a[52:55], v[96:99], v[76:79], a[52:55]
    buffer_load_dwordx4 v17, s[8:11], s22 offen offset:1024 lds
    v_mfma_f32_16x16x32_bf16 a[48:51], v[92:95], v[76:79], a[48:51]
    buffer_load_dwordx4 v18, s[8:11], s22 offen offset:2048 lds
    v_mfma_f32_16x16x32_bf16 a[64:67], v[92:95], v[80:83], a[64:67]
    buffer_load_dwordx4 v19, s[8:11], s22 offen offset:3072 lds
    v_mfma_f32_16x16x32_bf16 a[68:71], v[96:99], v[80:83], a[68:71]
    v_mfma_f32_16x16x32_bf16 a[72:75], v[100:103], v[80:83], a[72:75]
    v_mfma_f32_16x16x32_bf16 a[76:79], v[104:107], v[80:83], a[76:79]
    v_mfma_f32_16x16x32_bf16 a[92:95], v[104:107], v[84:87], a[92:95]
    v_mfma_f32_16x16x32_bf16 a[88:91], v[100:103], v[84:87], a[88:91]
    v_mfma_f32_16x16x32_bf16 a[84:87], v[96:99], v[84:87], a[84:87]
    v_mfma_f32_16x16x32_bf16 a[80:83], v[92:95], v[84:87], a[80:83]
    v_mfma_f32_16x16x32_bf16 a[96:99], v[92:95], v[88:91], a[96:99]
    v_mfma_f32_16x16x32_bf16 a[100:103], v[96:99], v[88:91], a[100:103]
    v_mfma_f32_16x16x32_bf16 a[104:107], v[100:103], v[88:91], a[104:107]
    v_mfma_f32_16x16x32_bf16 a[108:111], v[104:107], v[88:91], a[108:111]
    s_waitcnt lgkmcnt(9)
    v_mfma_f32_16x16x32_bf16 a[124:127], v[104:107], v[40:43], a[124:127]
    v_mfma_f32_16x16x32_bf16 a[120:123], v[100:103], v[40:43], a[120:123]
    v_mfma_f32_16x16x32_bf16 a[116:119], v[96:99], v[40:43], a[116:119]
    v_mfma_f32_16x16x32_bf16 a[112:115], v[92:95], v[40:43], a[112:115]
    s_waitcnt lgkmcnt(1)
    v_mfma_f32_16x16x32_bf16 a[0:3], v[108:111], v[68:71], a[0:3]
    s_waitcnt vmcnt(16) lgkmcnt(0)
    s_barrier
    v_mfma_f32_16x16x32_bf16 a[4:7], v[112:115], v[68:71], a[4:7]
    ds_read_b64_tr_b16 v[92:93], v12 offset:12288
    v_mfma_f32_16x16x32_bf16 a[8:11], v[116:119], v[68:71], a[8:11]
    ds_read_b64_tr_b16 v[94:95], v12 offset:12544
    v_mfma_f32_16x16x32_bf16 a[12:15], v[120:123], v[68:71], a[12:15]
    ds_read_b64_tr_b16 v[96:97], v13 offset:12288
    ds_read_b128 v[68:71], v8 offset:34816
    v_mfma_f32_16x16x32_bf16 a[28:31], v[120:123], v[72:75], a[28:31]
    ds_read_b64_tr_b16 v[98:99], v13 offset:12544
    v_mfma_f32_16x16x32_bf16 a[24:27], v[116:119], v[72:75], a[24:27]
    ds_read_b64_tr_b16 v[100:101], v14 offset:12288
    v_mfma_f32_16x16x32_bf16 a[20:23], v[112:115], v[72:75], a[20:23]
    ds_read_b64_tr_b16 v[102:103], v14 offset:12544
    v_mfma_f32_16x16x32_bf16 a[16:19], v[108:111], v[72:75], a[16:19]
    ds_read_b64_tr_b16 v[104:105], v15 offset:12288
    ds_read_b128 v[72:75], v8 offset:35072
    v_mfma_f32_16x16x32_bf16 a[32:35], v[108:111], v[76:79], a[32:35]
    ds_read_b64_tr_b16 v[106:107], v15 offset:12544
    v_mfma_f32_16x16x32_bf16 a[36:39], v[112:115], v[76:79], a[36:39]
    v_mfma_f32_16x16x32_bf16 a[40:43], v[116:119], v[76:79], a[40:43]
    v_mfma_f32_16x16x32_bf16 a[44:47], v[120:123], v[76:79], a[44:47]
    ds_read_b128 v[76:79], v8 offset:35328
    v_mfma_f32_16x16x32_bf16 a[60:63], v[120:123], v[80:83], a[60:63]
    s_add_u32 s22, s21, 4980736
    s_add_u32 m0, s23, 8192
    v_mfma_f32_16x16x32_bf16 a[56:59], v[116:119], v[80:83], a[56:59]
    buffer_load_dwordx4 v16, s[8:11], s22 offen offset:0 lds
    v_mfma_f32_16x16x32_bf16 a[52:55], v[112:115], v[80:83], a[52:55]
    buffer_load_dwordx4 v17, s[8:11], s22 offen offset:1024 lds
    v_mfma_f32_16x16x32_bf16 a[48:51], v[108:111], v[80:83], a[48:51]
    ds_read_b128 v[80:83], v8 offset:35584
    buffer_load_dwordx4 v18, s[8:11], s22 offen offset:2048 lds
    v_mfma_f32_16x16x32_bf16 a[64:67], v[108:111], v[84:87], a[64:67]
    buffer_load_dwordx4 v19, s[8:11], s22 offen offset:3072 lds
    v_mfma_f32_16x16x32_bf16 a[68:71], v[112:115], v[84:87], a[68:71]
    s_mov_b32 s26, 768
    v_mfma_f32_16x16x32_bf16 a[72:75], v[116:119], v[84:87], a[72:75]
    s_add_u32 m0, s24, 0
    v_mfma_f32_16x16x32_bf16 a[76:79], v[120:123], v[84:87], a[76:79]
    ds_read_b128 v[84:87], v8 offset:35840
    buffer_load_dwordx4 v20, s[4:7], s26 offen lds
    v_mfma_f32_16x16x32_bf16 a[92:95], v[120:123], v[88:91], a[92:95]
    s_add_u32 m0, s24, 4096
    v_mfma_f32_16x16x32_bf16 a[88:91], v[116:119], v[88:91], a[88:91]
    buffer_load_dwordx4 v21, s[4:7], s26 offen lds
    v_mfma_f32_16x16x32_bf16 a[84:87], v[112:115], v[88:91], a[84:87]
    v_mfma_f32_16x16x32_bf16 a[80:83], v[108:111], v[88:91], a[80:83]
    ds_read_b128 v[88:91], v8 offset:36096
    v_mfma_f32_16x16x32_bf16 a[96:99], v[108:111], v[40:43], a[96:99]
    v_mfma_f32_16x16x32_bf16 a[100:103], v[112:115], v[40:43], a[100:103]
    v_mfma_f32_16x16x32_bf16 a[104:107], v[116:119], v[40:43], a[104:107]
    v_mfma_f32_16x16x32_bf16 a[108:111], v[120:123], v[40:43], a[108:111]
    ds_read_b128 v[40:43], v8 offset:36352
    v_mfma_f32_16x16x32_bf16 a[124:127], v[120:123], v[44:47], a[124:127]
    v_mfma_f32_16x16x32_bf16 a[120:123], v[116:119], v[44:47], a[120:123]
    v_mfma_f32_16x16x32_bf16 a[116:119], v[112:115], v[44:47], a[116:119]
    v_mfma_f32_16x16x32_bf16 a[112:115], v[108:111], v[44:47], a[112:115]
    ds_read_b128 v[44:47], v8 offset:36608
    s_waitcnt lgkmcnt(6)
    v_mfma_f32_16x16x32_bf16 a[0:3], v[92:95], v[68:71], a[0:3]
    s_waitcnt vmcnt(18)
    v_mfma_f32_16x16x32_bf16 a[4:7], v[96:99], v[68:71], a[4:7]
    ds_read_b64_tr_b16 v[108:109], v12 offset:16384
    v_mfma_f32_16x16x32_bf16 a[8:11], v[100:103], v[68:71], a[8:11]
    ds_read_b64_tr_b16 v[110:111], v12 offset:16640
    v_mfma_f32_16x16x32_bf16 a[12:15], v[104:107], v[68:71], a[12:15]
    ds_read_b64_tr_b16 v[112:113], v13 offset:16384
    v_mfma_f32_16x16x32_bf16 a[28:31], v[104:107], v[72:75], a[28:31]
    ds_read_b64_tr_b16 v[114:115], v13 offset:16640
    v_mfma_f32_16x16x32_bf16 a[24:27], v[100:103], v[72:75], a[24:27]
    ds_read_b64_tr_b16 v[116:117], v14 offset:16384
    v_mfma_f32_16x16x32_bf16 a[20:23], v[96:99], v[72:75], a[20:23]
    ds_read_b64_tr_b16 v[118:119], v14 offset:16640
    v_mfma_f32_16x16x32_bf16 a[16:19], v[92:95], v[72:75], a[16:19]
    ds_read_b64_tr_b16 v[120:121], v15 offset:16384
    s_waitcnt lgkmcnt(12)
    v_mfma_f32_16x16x32_bf16 a[32:35], v[92:95], v[76:79], a[32:35]
    ds_read_b64_tr_b16 v[122:123], v15 offset:16640
    v_mfma_f32_16x16x32_bf16 a[36:39], v[96:99], v[76:79], a[36:39]
    v_mfma_f32_16x16x32_bf16 a[40:43], v[100:103], v[76:79], a[40:43]
    v_mfma_f32_16x16x32_bf16 a[44:47], v[104:107], v[76:79], a[44:47]
    ds_read_b128 v[48:51], v9 offset:36864
    s_waitcnt lgkmcnt(13)
    v_mfma_f32_16x16x32_bf16 a[60:63], v[104:107], v[80:83], a[60:63]
    s_add_u32 s22, s21, 6029312
    s_add_u32 m0, s23, 12288
    v_mfma_f32_16x16x32_bf16 a[56:59], v[100:103], v[80:83], a[56:59]
    buffer_load_dwordx4 v16, s[8:11], s22 offen offset:0 lds
    v_mfma_f32_16x16x32_bf16 a[52:55], v[96:99], v[80:83], a[52:55]
    buffer_load_dwordx4 v17, s[8:11], s22 offen offset:1024 lds
    v_mfma_f32_16x16x32_bf16 a[48:51], v[92:95], v[80:83], a[48:51]
    buffer_load_dwordx4 v18, s[8:11], s22 offen offset:2048 lds
    s_waitcnt lgkmcnt(12)
    v_mfma_f32_16x16x32_bf16 a[64:67], v[92:95], v[84:87], a[64:67]
    buffer_load_dwordx4 v19, s[8:11], s22 offen offset:3072 lds
    v_mfma_f32_16x16x32_bf16 a[68:71], v[96:99], v[84:87], a[68:71]
    s_add_u32 m0, s24, 8192
    v_mfma_f32_16x16x32_bf16 a[72:75], v[100:103], v[84:87], a[72:75]
    buffer_load_dwordx4 v22, s[4:7], s26 offen lds
    v_mfma_f32_16x16x32_bf16 a[76:79], v[104:107], v[84:87], a[76:79]
    s_add_u32 m0, s24, 12288
    s_waitcnt lgkmcnt(11)
    v_mfma_f32_16x16x32_bf16 a[92:95], v[104:107], v[88:91], a[92:95]
    buffer_load_dwordx4 v23, s[4:7], s26 offen lds
    v_mfma_f32_16x16x32_bf16 a[88:91], v[100:103], v[88:91], a[88:91]
    v_mfma_f32_16x16x32_bf16 a[84:87], v[96:99], v[88:91], a[84:87]
    v_mfma_f32_16x16x32_bf16 a[80:83], v[92:95], v[88:91], a[80:83]
    s_waitcnt lgkmcnt(10)
    v_mfma_f32_16x16x32_bf16 a[96:99], v[92:95], v[40:43], a[96:99]
    v_mfma_f32_16x16x32_bf16 a[100:103], v[96:99], v[40:43], a[100:103]
    v_mfma_f32_16x16x32_bf16 a[104:107], v[100:103], v[40:43], a[104:107]
    v_mfma_f32_16x16x32_bf16 a[108:111], v[104:107], v[40:43], a[108:111]
    s_waitcnt lgkmcnt(9)
    v_mfma_f32_16x16x32_bf16 a[124:127], v[104:107], v[44:47], a[124:127]
    v_mfma_f32_16x16x32_bf16 a[120:123], v[100:103], v[44:47], a[120:123]
    v_mfma_f32_16x16x32_bf16 a[116:119], v[96:99], v[44:47], a[116:119]
    v_mfma_f32_16x16x32_bf16 a[112:115], v[92:95], v[44:47], a[112:115]
    s_waitcnt lgkmcnt(1)
    v_mfma_f32_16x16x32_bf16 a[0:3], v[108:111], v[72:75], a[0:3]
    s_waitcnt vmcnt(18)
    v_mfma_f32_16x16x32_bf16 a[4:7], v[112:115], v[72:75], a[4:7]
    ds_read_b64_tr_b16 v[92:93], v12 offset:0
    v_mfma_f32_16x16x32_bf16 a[8:11], v[116:119], v[72:75], a[8:11]
    ds_read_b64_tr_b16 v[94:95], v12 offset:256
    v_mfma_f32_16x16x32_bf16 a[12:15], v[120:123], v[72:75], a[12:15]
    ds_read_b64_tr_b16 v[96:97], v13 offset:0
    v_mfma_f32_16x16x32_bf16 a[28:31], v[120:123], v[76:79], a[28:31]
    ds_read_b64_tr_b16 v[98:99], v13 offset:256
    v_mfma_f32_16x16x32_bf16 a[24:27], v[116:119], v[76:79], a[24:27]
    ds_read_b64_tr_b16 v[100:101], v14 offset:0
    v_mfma_f32_16x16x32_bf16 a[20:23], v[112:115], v[76:79], a[20:23]
    ds_read_b64_tr_b16 v[102:103], v14 offset:256
    v_mfma_f32_16x16x32_bf16 a[16:19], v[108:111], v[76:79], a[16:19]
    ds_read_b64_tr_b16 v[104:105], v15 offset:0
    v_mfma_f32_16x16x32_bf16 a[32:35], v[108:111], v[80:83], a[32:35]
    ds_read_b64_tr_b16 v[106:107], v15 offset:256
    v_mfma_f32_16x16x32_bf16 a[36:39], v[112:115], v[80:83], a[36:39]
    v_mfma_f32_16x16x32_bf16 a[40:43], v[116:119], v[80:83], a[40:43]
    v_mfma_f32_16x16x32_bf16 a[44:47], v[120:123], v[80:83], a[44:47]
    ds_read_b128 v[52:55], v9 offset:37120
    v_mfma_f32_16x16x32_bf16 a[60:63], v[120:123], v[84:87], a[60:63]
    s_add_u32 s22, s21, 7077888
    s_add_u32 m0, s23, 16384
    v_mfma_f32_16x16x32_bf16 a[56:59], v[116:119], v[84:87], a[56:59]
    buffer_load_dwordx4 v16, s[8:11], s22 offen offset:0 lds
    v_mfma_f32_16x16x32_bf16 a[52:55], v[112:115], v[84:87], a[52:55]
    buffer_load_dwordx4 v17, s[8:11], s22 offen offset:1024 lds
    v_mfma_f32_16x16x32_bf16 a[48:51], v[108:111], v[84:87], a[48:51]
    buffer_load_dwordx4 v18, s[8:11], s22 offen offset:2048 lds
    v_mfma_f32_16x16x32_bf16 a[64:67], v[108:111], v[88:91], a[64:67]
    buffer_load_dwordx4 v19, s[8:11], s22 offen offset:3072 lds
    v_mfma_f32_16x16x32_bf16 a[68:71], v[112:115], v[88:91], a[68:71]
    s_add_u32 m0, s24, 16384
    v_mfma_f32_16x16x32_bf16 a[72:75], v[116:119], v[88:91], a[72:75]
    buffer_load_dwordx4 v24, s[4:7], s26 offen lds
    v_mfma_f32_16x16x32_bf16 a[76:79], v[120:123], v[88:91], a[76:79]
    s_add_u32 m0, s24, 20480
    v_mfma_f32_16x16x32_bf16 a[92:95], v[120:123], v[40:43], a[92:95]
    buffer_load_dwordx4 v25, s[4:7], s26 offen lds
    v_mfma_f32_16x16x32_bf16 a[88:91], v[116:119], v[40:43], a[88:91]
    v_mfma_f32_16x16x32_bf16 a[84:87], v[112:115], v[40:43], a[84:87]
    v_mfma_f32_16x16x32_bf16 a[80:83], v[108:111], v[40:43], a[80:83]
    v_mfma_f32_16x16x32_bf16 a[96:99], v[108:111], v[44:47], a[96:99]
    v_mfma_f32_16x16x32_bf16 a[100:103], v[112:115], v[44:47], a[100:103]
    v_mfma_f32_16x16x32_bf16 a[104:107], v[116:119], v[44:47], a[104:107]
    v_mfma_f32_16x16x32_bf16 a[108:111], v[120:123], v[44:47], a[108:111]
    s_waitcnt lgkmcnt(9)
    v_mfma_f32_16x16x32_bf16 a[124:127], v[120:123], v[48:51], a[124:127]
    v_mfma_f32_16x16x32_bf16 a[120:123], v[116:119], v[48:51], a[120:123]
    v_mfma_f32_16x16x32_bf16 a[116:119], v[112:115], v[48:51], a[116:119]
    v_mfma_f32_16x16x32_bf16 a[112:115], v[108:111], v[48:51], a[112:115]
    s_waitcnt lgkmcnt(1)
    v_mfma_f32_16x16x32_bf16 a[0:3], v[92:95], v[76:79], a[0:3]
    s_waitcnt vmcnt(18)
    v_mfma_f32_16x16x32_bf16 a[4:7], v[96:99], v[76:79], a[4:7]
    ds_read_b64_tr_b16 v[108:109], v12 offset:4096
    v_mfma_f32_16x16x32_bf16 a[8:11], v[100:103], v[76:79], a[8:11]
    ds_read_b64_tr_b16 v[110:111], v12 offset:4352
    v_mfma_f32_16x16x32_bf16 a[12:15], v[104:107], v[76:79], a[12:15]
    ds_read_b64_tr_b16 v[112:113], v13 offset:4096
    v_mfma_f32_16x16x32_bf16 a[28:31], v[104:107], v[80:83], a[28:31]
    ds_read_b64_tr_b16 v[114:115], v13 offset:4352
    v_mfma_f32_16x16x32_bf16 a[24:27], v[100:103], v[80:83], a[24:27]
    ds_read_b64_tr_b16 v[116:117], v14 offset:4096
    v_mfma_f32_16x16x32_bf16 a[20:23], v[96:99], v[80:83], a[20:23]
    ds_read_b64_tr_b16 v[118:119], v14 offset:4352
    v_mfma_f32_16x16x32_bf16 a[16:19], v[92:95], v[80:83], a[16:19]
    ds_read_b64_tr_b16 v[120:121], v15 offset:4096
    v_mfma_f32_16x16x32_bf16 a[32:35], v[92:95], v[84:87], a[32:35]
    ds_read_b64_tr_b16 v[122:123], v15 offset:4352
    v_mfma_f32_16x16x32_bf16 a[36:39], v[96:99], v[84:87], a[36:39]
    v_mfma_f32_16x16x32_bf16 a[40:43], v[100:103], v[84:87], a[40:43]
    v_mfma_f32_16x16x32_bf16 a[44:47], v[104:107], v[84:87], a[44:47]
    ds_read_b128 v[56:59], v9 offset:37376
    v_mfma_f32_16x16x32_bf16 a[60:63], v[104:107], v[88:91], a[60:63]
    s_add_u32 s22, s21, 393216
    s_add_u32 m0, s23, 0
    v_mfma_f32_16x16x32_bf16 a[56:59], v[100:103], v[88:91], a[56:59]
    buffer_load_dwordx4 v16, s[8:11], s22 offen offset:0 lds
    v_mfma_f32_16x16x32_bf16 a[52:55], v[96:99], v[88:91], a[52:55]
    buffer_load_dwordx4 v17, s[8:11], s22 offen offset:1024 lds
    v_mfma_f32_16x16x32_bf16 a[48:51], v[92:95], v[88:91], a[48:51]
    buffer_load_dwordx4 v18, s[8:11], s22 offen offset:2048 lds
    v_mfma_f32_16x16x32_bf16 a[64:67], v[92:95], v[40:43], a[64:67]
    buffer_load_dwordx4 v19, s[8:11], s22 offen offset:3072 lds
    v_mfma_f32_16x16x32_bf16 a[68:71], v[96:99], v[40:43], a[68:71]
    s_add_u32 m0, s24, 24576
    v_mfma_f32_16x16x32_bf16 a[72:75], v[100:103], v[40:43], a[72:75]
    buffer_load_dwordx4 v26, s[4:7], s26 offen lds
    v_mfma_f32_16x16x32_bf16 a[76:79], v[104:107], v[40:43], a[76:79]
    s_add_u32 m0, s24, 28672
    v_mfma_f32_16x16x32_bf16 a[92:95], v[104:107], v[44:47], a[92:95]
    buffer_load_dwordx4 v27, s[4:7], s26 offen lds
    v_mfma_f32_16x16x32_bf16 a[88:91], v[100:103], v[44:47], a[88:91]
    v_mfma_f32_16x16x32_bf16 a[84:87], v[96:99], v[44:47], a[84:87]
    v_mfma_f32_16x16x32_bf16 a[80:83], v[92:95], v[44:47], a[80:83]
    v_mfma_f32_16x16x32_bf16 a[96:99], v[92:95], v[48:51], a[96:99]
    v_mfma_f32_16x16x32_bf16 a[100:103], v[96:99], v[48:51], a[100:103]
    v_mfma_f32_16x16x32_bf16 a[104:107], v[100:103], v[48:51], a[104:107]
    v_mfma_f32_16x16x32_bf16 a[108:111], v[104:107], v[48:51], a[108:111]
    s_waitcnt lgkmcnt(9)
    v_mfma_f32_16x16x32_bf16 a[124:127], v[104:107], v[52:55], a[124:127]
    v_mfma_f32_16x16x32_bf16 a[120:123], v[100:103], v[52:55], a[120:123]
    v_mfma_f32_16x16x32_bf16 a[116:119], v[96:99], v[52:55], a[116:119]
    v_mfma_f32_16x16x32_bf16 a[112:115], v[92:95], v[52:55], a[112:115]
    s_waitcnt lgkmcnt(1)
    v_mfma_f32_16x16x32_bf16 a[0:3], v[108:111], v[80:83], a[0:3]
    s_waitcnt vmcnt(20)
    v_mfma_f32_16x16x32_bf16 a[4:7], v[112:115], v[80:83], a[4:7]
    ds_read_b64_tr_b16 v[92:93], v12 offset:8192
    v_mfma_f32_16x16x32_bf16 a[8:11], v[116:119], v[80:83], a[8:11]
    ds_read_b64_tr_b16 v[94:95], v12 offset:8448
    v_mfma_f32_16x16x32_bf16 a[12:15], v[120:123], v[80:83], a[12:15]
    ds_read_b64_tr_b16 v[96:97], v13 offset:8192
    v_mfma_f32_16x16x32_bf16 a[28:31], v[120:123], v[84:87], a[28:31]
    ds_read_b64_tr_b16 v[98:99], v13 offset:8448
    v_mfma_f32_16x16x32_bf16 a[24:27], v[116:119], v[84:87], a[24:27]
    ds_read_b64_tr_b16 v[100:101], v14 offset:8192
    v_mfma_f32_16x16x32_bf16 a[20:23], v[112:115], v[84:87], a[20:23]
    ds_read_b64_tr_b16 v[102:103], v14 offset:8448
    v_mfma_f32_16x16x32_bf16 a[16:19], v[108:111], v[84:87], a[16:19]
    ds_read_b64_tr_b16 v[104:105], v15 offset:8192
    v_mfma_f32_16x16x32_bf16 a[32:35], v[108:111], v[88:91], a[32:35]
    ds_read_b64_tr_b16 v[106:107], v15 offset:8448
    v_mfma_f32_16x16x32_bf16 a[36:39], v[112:115], v[88:91], a[36:39]
    s_mov_b32 s36, s94
    s_mov_b32 s37, s95
    s_mov_b32 s38, 524288
    v_mfma_f32_16x16x32_bf16 a[40:43], v[116:119], v[88:91], a[40:43]
    s_mov_b32 s60, s88
    s_add_u32 s61, s88, 2048
    s_add_u32 s62, s88, 4096
    v_mfma_f32_16x16x32_bf16 a[44:47], v[120:123], v[88:91], a[44:47]
    ds_read_b128 v[60:63], v9 offset:37632
    s_add_u32 s63, s88, 6144
    v_mfma_f32_16x16x32_bf16 a[60:63], v[120:123], v[40:43], a[60:63]
    s_add_u32 s22, s21, 1441792
    s_add_u32 m0, s23, 4096
    v_mfma_f32_16x16x32_bf16 a[56:59], v[116:119], v[40:43], a[56:59]
    buffer_load_dwordx4 v16, s[8:11], s22 offen offset:0 lds
    v_mfma_f32_16x16x32_bf16 a[52:55], v[112:115], v[40:43], a[52:55]
    buffer_load_dwordx4 v17, s[8:11], s22 offen offset:1024 lds
    v_mfma_f32_16x16x32_bf16 a[48:51], v[108:111], v[40:43], a[48:51]
    buffer_load_dwordx4 v18, s[8:11], s22 offen offset:2048 lds
    v_mfma_f32_16x16x32_bf16 a[64:67], v[108:111], v[44:47], a[64:67]
    buffer_load_dwordx4 v19, s[8:11], s22 offen offset:3072 lds
    v_mfma_f32_16x16x32_bf16 a[68:71], v[112:115], v[44:47], a[68:71]
    s_add_u32 m0, s25, 0
    v_mfma_f32_16x16x32_bf16 a[72:75], v[116:119], v[44:47], a[72:75]
    buffer_load_dwordx4 v28, s[4:7], s26 offen lds
    v_mfma_f32_16x16x32_bf16 a[76:79], v[120:123], v[44:47], a[76:79]
    v_mfma_f32_16x16x32_bf16 a[92:95], v[120:123], v[48:51], a[92:95]
    v_mfma_f32_16x16x32_bf16 a[88:91], v[116:119], v[48:51], a[88:91]
    v_mfma_f32_16x16x32_bf16 a[84:87], v[112:115], v[48:51], a[84:87]
    v_mfma_f32_16x16x32_bf16 a[80:83], v[108:111], v[48:51], a[80:83]
    v_mfma_f32_16x16x32_bf16 a[96:99], v[108:111], v[52:55], a[96:99]
    v_mfma_f32_16x16x32_bf16 a[100:103], v[112:115], v[52:55], a[100:103]
    v_mfma_f32_16x16x32_bf16 a[104:107], v[116:119], v[52:55], a[104:107]
    v_mfma_f32_16x16x32_bf16 a[108:111], v[120:123], v[52:55], a[108:111]
    s_waitcnt lgkmcnt(9)
    v_mfma_f32_16x16x32_bf16 a[124:127], v[120:123], v[56:59], a[124:127]
    v_mfma_f32_16x16x32_bf16 a[120:123], v[116:119], v[56:59], a[120:123]
    v_mfma_f32_16x16x32_bf16 a[116:119], v[112:115], v[56:59], a[116:119]
    v_mfma_f32_16x16x32_bf16 a[112:115], v[108:111], v[56:59], a[112:115]
    s_waitcnt lgkmcnt(1)
    v_mfma_f32_16x16x32_bf16 a[0:3], v[92:95], v[84:87], a[0:3]
    s_waitcnt vmcnt(19)
    v_mfma_f32_16x16x32_bf16 a[4:7], v[96:99], v[84:87], a[4:7]
    ds_read_b64_tr_b16 v[108:109], v12 offset:12288
    v_mfma_f32_16x16x32_bf16 a[8:11], v[100:103], v[84:87], a[8:11]
    ds_read_b64_tr_b16 v[110:111], v12 offset:12544
    buffer_load_dwordx2 v[124:125], v156, s[36:39], s60 offen offset:0
    buffer_load_dwordx2 v[126:127], v156, s[36:39], s60 offen offset:1024
    v_mfma_f32_16x16x32_bf16 a[12:15], v[104:107], v[84:87], a[12:15]
    ds_read_b64_tr_b16 v[112:113], v13 offset:12288
    buffer_load_dwordx2 v[128:129], v156, s[36:39], s61 offen offset:0
    buffer_load_dwordx2 v[130:131], v156, s[36:39], s61 offen offset:1024
    v_mfma_f32_16x16x32_bf16 a[28:31], v[104:107], v[88:91], a[28:31]
    ds_read_b64_tr_b16 v[114:115], v13 offset:12544
    v_mfma_f32_16x16x32_bf16 a[24:27], v[100:103], v[88:91], a[24:27]
    ds_read_b64_tr_b16 v[116:117], v14 offset:12288
    v_mfma_f32_16x16x32_bf16 a[20:23], v[96:99], v[88:91], a[20:23]
    ds_read_b64_tr_b16 v[118:119], v14 offset:12544
    v_mfma_f32_16x16x32_bf16 a[16:19], v[92:95], v[88:91], a[16:19]
    ds_read_b64_tr_b16 v[120:121], v15 offset:12288
    v_mfma_f32_16x16x32_bf16 a[32:35], v[92:95], v[40:43], a[32:35]
    ds_read_b64_tr_b16 v[122:123], v15 offset:12544
    v_mfma_f32_16x16x32_bf16 a[36:39], v[96:99], v[40:43], a[36:39]
    v_mfma_f32_16x16x32_bf16 a[40:43], v[100:103], v[40:43], a[40:43]
    v_mfma_f32_16x16x32_bf16 a[44:47], v[104:107], v[40:43], a[44:47]
    ds_read_b128 v[64:67], v9 offset:37888
    v_mfma_f32_16x16x32_bf16 a[60:63], v[104:107], v[44:47], a[60:63]
    s_add_u32 s22, s21, 2490368
    s_add_u32 m0, s23, 8192
    v_mfma_f32_16x16x32_bf16 a[56:59], v[100:103], v[44:47], a[56:59]
    buffer_load_dwordx4 v16, s[8:11], s22 offen offset:0 lds
    v_mfma_f32_16x16x32_bf16 a[52:55], v[96:99], v[44:47], a[52:55]
    buffer_load_dwordx4 v17, s[8:11], s22 offen offset:1024 lds
    v_mfma_f32_16x16x32_bf16 a[48:51], v[92:95], v[44:47], a[48:51]
    buffer_load_dwordx4 v18, s[8:11], s22 offen offset:2048 lds
    v_mfma_f32_16x16x32_bf16 a[64:67], v[92:95], v[48:51], a[64:67]
    buffer_load_dwordx4 v19, s[8:11], s22 offen offset:3072 lds
    v_mfma_f32_16x16x32_bf16 a[68:71], v[96:99], v[48:51], a[68:71]
    v_mfma_f32_16x16x32_bf16 a[72:75], v[100:103], v[48:51], a[72:75]
    v_mfma_f32_16x16x32_bf16 a[76:79], v[104:107], v[48:51], a[76:79]
    v_mfma_f32_16x16x32_bf16 a[92:95], v[104:107], v[52:55], a[92:95]
    v_mfma_f32_16x16x32_bf16 a[88:91], v[100:103], v[52:55], a[88:91]
    v_mfma_f32_16x16x32_bf16 a[84:87], v[96:99], v[52:55], a[84:87]
    v_mfma_f32_16x16x32_bf16 a[80:83], v[92:95], v[52:55], a[80:83]
    v_mfma_f32_16x16x32_bf16 a[96:99], v[92:95], v[56:59], a[96:99]
    v_mfma_f32_16x16x32_bf16 a[100:103], v[96:99], v[56:59], a[100:103]
    v_mfma_f32_16x16x32_bf16 a[104:107], v[100:103], v[56:59], a[104:107]
    v_mfma_f32_16x16x32_bf16 a[108:111], v[104:107], v[56:59], a[108:111]
    s_waitcnt lgkmcnt(9)
    v_mfma_f32_16x16x32_bf16 a[124:127], v[104:107], v[60:63], a[124:127]
    v_mfma_f32_16x16x32_bf16 a[120:123], v[100:103], v[60:63], a[120:123]
    v_mfma_f32_16x16x32_bf16 a[116:119], v[96:99], v[60:63], a[116:119]
    v_mfma_f32_16x16x32_bf16 a[112:115], v[92:95], v[60:63], a[112:115]
    s_waitcnt lgkmcnt(1)
    v_mfma_f32_16x16x32_bf16 a[0:3], v[108:111], v[88:91], a[0:3]
    s_waitcnt vmcnt(21)
    v_mfma_f32_16x16x32_bf16 a[4:7], v[112:115], v[88:91], a[4:7]
    ds_read_b64_tr_b16 v[92:93], v12 offset:16384
    v_mfma_f32_16x16x32_bf16 a[8:11], v[116:119], v[88:91], a[8:11]
    ds_read_b64_tr_b16 v[94:95], v12 offset:16640
    buffer_load_dwordx2 v[132:133], v156, s[36:39], s62 offen offset:0
    buffer_load_dwordx2 v[134:135], v156, s[36:39], s62 offen offset:1024
    v_mfma_f32_16x16x32_bf16 a[12:15], v[120:123], v[88:91], a[12:15]
    ds_read_b64_tr_b16 v[96:97], v13 offset:16384
    buffer_load_dwordx2 v[136:137], v156, s[36:39], s63 offen offset:0
    buffer_load_dwordx2 v[138:139], v156, s[36:39], s63 offen offset:1024
    v_mfma_f32_16x16x32_bf16 a[28:31], v[120:123], v[40:43], a[28:31]
    ds_read_b64_tr_b16 v[98:99], v13 offset:16640
    v_mfma_f32_16x16x32_bf16 a[24:27], v[116:119], v[40:43], a[24:27]
    ds_read_b64_tr_b16 v[100:101], v14 offset:16384
    v_mfma_f32_16x16x32_bf16 a[20:23], v[112:115], v[40:43], a[20:23]
    ds_read_b64_tr_b16 v[102:103], v14 offset:16640
    v_mfma_f32_16x16x32_bf16 a[16:19], v[108:111], v[40:43], a[16:19]
    ds_read_b64_tr_b16 v[104:105], v15 offset:16384
    v_mfma_f32_16x16x32_bf16 a[32:35], v[108:111], v[44:47], a[32:35]
    ds_read_b64_tr_b16 v[106:107], v15 offset:16640
    v_mfma_f32_16x16x32_bf16 a[36:39], v[112:115], v[44:47], a[36:39]
    v_mfma_f32_16x16x32_bf16 a[40:43], v[116:119], v[44:47], a[40:43]
    v_mfma_f32_16x16x32_bf16 a[44:47], v[120:123], v[44:47], a[44:47]
    ds_read_b128 v[68:71], v9 offset:38144
    v_mfma_f32_16x16x32_bf16 a[60:63], v[120:123], v[48:51], a[60:63]
    s_add_u32 s22, s21, 3538944
    s_add_u32 m0, s23, 12288
    v_mfma_f32_16x16x32_bf16 a[56:59], v[116:119], v[48:51], a[56:59]
    buffer_load_dwordx4 v16, s[8:11], s22 offen offset:0 lds
    v_mfma_f32_16x16x32_bf16 a[52:55], v[112:115], v[48:51], a[52:55]
    buffer_load_dwordx4 v17, s[8:11], s22 offen offset:1024 lds
    v_mfma_f32_16x16x32_bf16 a[48:51], v[108:111], v[48:51], a[48:51]
    buffer_load_dwordx4 v18, s[8:11], s22 offen offset:2048 lds
    v_mfma_f32_16x16x32_bf16 a[64:67], v[108:111], v[52:55], a[64:67]
    buffer_load_dwordx4 v19, s[8:11], s22 offen offset:3072 lds
    v_mfma_f32_16x16x32_bf16 a[68:71], v[112:115], v[52:55], a[68:71]
    v_mfma_f32_16x16x32_bf16 a[72:75], v[116:119], v[52:55], a[72:75]
    v_mfma_f32_16x16x32_bf16 a[76:79], v[120:123], v[52:55], a[76:79]
    v_mfma_f32_16x16x32_bf16 a[92:95], v[120:123], v[56:59], a[92:95]
    v_mfma_f32_16x16x32_bf16 a[88:91], v[116:119], v[56:59], a[88:91]
    v_mfma_f32_16x16x32_bf16 a[84:87], v[112:115], v[56:59], a[84:87]
    v_mfma_f32_16x16x32_bf16 a[80:83], v[108:111], v[56:59], a[80:83]
    v_mfma_f32_16x16x32_bf16 a[96:99], v[108:111], v[60:63], a[96:99]
    v_mfma_f32_16x16x32_bf16 a[100:103], v[112:115], v[60:63], a[100:103]
    v_mfma_f32_16x16x32_bf16 a[104:107], v[116:119], v[60:63], a[104:107]
    v_mfma_f32_16x16x32_bf16 a[108:111], v[120:123], v[60:63], a[108:111]
    s_waitcnt lgkmcnt(9)
    v_mfma_f32_16x16x32_bf16 a[124:127], v[120:123], v[64:67], a[124:127]
    v_mfma_f32_16x16x32_bf16 a[120:123], v[116:119], v[64:67], a[120:123]
    v_mfma_f32_16x16x32_bf16 a[116:119], v[112:115], v[64:67], a[116:119]
    v_mfma_f32_16x16x32_bf16 a[112:115], v[108:111], v[64:67], a[112:115]
    s_waitcnt lgkmcnt(1)
    v_mfma_f32_16x16x32_bf16 a[0:3], v[92:95], v[40:43], a[0:3]
    s_waitcnt vmcnt(16) lgkmcnt(0)
    s_barrier
    v_mfma_f32_16x16x32_bf16 a[4:7], v[96:99], v[40:43], a[4:7]
    ds_read_b64_tr_b16 v[108:109], v12 offset:0
    v_mfma_f32_16x16x32_bf16 a[8:11], v[100:103], v[40:43], a[8:11]
    ds_read_b64_tr_b16 v[110:111], v12 offset:256
    v_mfma_f32_16x16x32_bf16 a[12:15], v[104:107], v[40:43], a[12:15]
    ds_read_b64_tr_b16 v[112:113], v13 offset:0
    ds_read_b128 v[40:43], v8 offset:0
    v_mfma_f32_16x16x32_bf16 a[28:31], v[104:107], v[44:47], a[28:31]
    ds_read_b64_tr_b16 v[114:115], v13 offset:256
    v_mfma_f32_16x16x32_bf16 a[24:27], v[100:103], v[44:47], a[24:27]
    ds_read_b64_tr_b16 v[116:117], v14 offset:0
    v_mfma_f32_16x16x32_bf16 a[20:23], v[96:99], v[44:47], a[20:23]
    ds_read_b64_tr_b16 v[118:119], v14 offset:256
    v_mfma_f32_16x16x32_bf16 a[16:19], v[92:95], v[44:47], a[16:19]
    ds_read_b64_tr_b16 v[120:121], v15 offset:0
    ds_read_b128 v[44:47], v8 offset:256
    v_mfma_f32_16x16x32_bf16 a[32:35], v[92:95], v[48:51], a[32:35]
    ds_read_b64_tr_b16 v[122:123], v15 offset:256
    v_mfma_f32_16x16x32_bf16 a[36:39], v[96:99], v[48:51], a[36:39]
    v_mfma_f32_16x16x32_bf16 a[40:43], v[100:103], v[48:51], a[40:43]
    v_mfma_f32_16x16x32_bf16 a[44:47], v[104:107], v[48:51], a[44:47]
    ds_read_b128 v[48:51], v8 offset:512
    v_mfma_f32_16x16x32_bf16 a[60:63], v[104:107], v[52:55], a[60:63]
    s_add_u32 s22, s21, 4587520
    s_add_u32 m0, s23, 16384
    v_mfma_f32_16x16x32_bf16 a[56:59], v[100:103], v[52:55], a[56:59]
    buffer_load_dwordx4 v16, s[8:11], s22 offen offset:0 lds
    v_mfma_f32_16x16x32_bf16 a[52:55], v[96:99], v[52:55], a[52:55]
    buffer_load_dwordx4 v17, s[8:11], s22 offen offset:1024 lds
    v_mfma_f32_16x16x32_bf16 a[48:51], v[92:95], v[52:55], a[48:51]
    ds_read_b128 v[52:55], v8 offset:768
    buffer_load_dwordx4 v18, s[8:11], s22 offen offset:2048 lds
    v_mfma_f32_16x16x32_bf16 a[64:67], v[92:95], v[56:59], a[64:67]
    buffer_load_dwordx4 v19, s[8:11], s22 offen offset:3072 lds
    v_mfma_f32_16x16x32_bf16 a[68:71], v[96:99], v[56:59], a[68:71]
    s_mov_b32 s26, 768
    v_mfma_f32_16x16x32_bf16 a[72:75], v[100:103], v[56:59], a[72:75]
    s_add_u32 m0, s24, 34816
    v_mfma_f32_16x16x32_bf16 a[76:79], v[104:107], v[56:59], a[76:79]
    ds_read_b128 v[56:59], v8 offset:1024
    buffer_load_dwordx4 v29, s[4:7], s26 offen lds
    v_mfma_f32_16x16x32_bf16 a[92:95], v[104:107], v[60:63], a[92:95]
    s_add_u32 m0, s24, 38912
    v_mfma_f32_16x16x32_bf16 a[88:91], v[100:103], v[60:63], a[88:91]
    buffer_load_dwordx4 v30, s[4:7], s26 offen lds
    v_mfma_f32_16x16x32_bf16 a[84:87], v[96:99], v[60:63], a[84:87]
    v_mfma_f32_16x16x32_bf16 a[80:83], v[92:95], v[60:63], a[80:83]
    ds_read_b128 v[60:63], v8 offset:1280
    v_mfma_f32_16x16x32_bf16 a[96:99], v[92:95], v[64:67], a[96:99]
    v_mfma_f32_16x16x32_bf16 a[100:103], v[96:99], v[64:67], a[100:103]
    v_mfma_f32_16x16x32_bf16 a[104:107], v[100:103], v[64:67], a[104:107]
    v_mfma_f32_16x16x32_bf16 a[108:111], v[104:107], v[64:67], a[108:111]
    ds_read_b128 v[64:67], v8 offset:1536
    v_mfma_f32_16x16x32_bf16 a[124:127], v[104:107], v[68:71], a[124:127]
    v_mfma_f32_16x16x32_bf16 a[120:123], v[100:103], v[68:71], a[120:123]
    v_mfma_f32_16x16x32_bf16 a[116:119], v[96:99], v[68:71], a[116:119]
    v_mfma_f32_16x16x32_bf16 a[112:115], v[92:95], v[68:71], a[112:115]
    ds_read_b128 v[68:71], v8 offset:1792
    s_waitcnt lgkmcnt(6)
    v_mfma_f32_16x16x32_bf16 a[0:3], v[108:111], v[40:43], a[0:3]
    v_mfma_f32_16x16x32_bf16 a[4:7], v[112:115], v[40:43], a[4:7]
    ds_read_b64_tr_b16 v[92:93], v12 offset:4096
    v_mfma_f32_16x16x32_bf16 a[8:11], v[116:119], v[40:43], a[8:11]
    ds_read_b64_tr_b16 v[94:95], v12 offset:4352
    v_mfma_f32_16x16x32_bf16 a[12:15], v[120:123], v[40:43], a[12:15]
    ds_read_b64_tr_b16 v[96:97], v13 offset:4096
    v_mfma_f32_16x16x32_bf16 a[28:31], v[120:123], v[44:47], a[28:31]
    ds_read_b64_tr_b16 v[98:99], v13 offset:4352
    v_mfma_f32_16x16x32_bf16 a[24:27], v[116:119], v[44:47], a[24:27]
    ds_read_b64_tr_b16 v[100:101], v14 offset:4096
    v_mfma_f32_16x16x32_bf16 a[20:23], v[112:115], v[44:47], a[20:23]
    ds_read_b64_tr_b16 v[102:103], v14 offset:4352
    v_mfma_f32_16x16x32_bf16 a[16:19], v[108:111], v[44:47], a[16:19]
    ds_read_b64_tr_b16 v[104:105], v15 offset:4096
    s_waitcnt lgkmcnt(12)
    v_mfma_f32_16x16x32_bf16 a[32:35], v[108:111], v[48:51], a[32:35]
    ds_read_b64_tr_b16 v[106:107], v15 offset:4352
    v_mfma_f32_16x16x32_bf16 a[36:39], v[112:115], v[48:51], a[36:39]
    v_mfma_f32_16x16x32_bf16 a[40:43], v[116:119], v[48:51], a[40:43]
    v_mfma_f32_16x16x32_bf16 a[44:47], v[120:123], v[48:51], a[44:47]
    ds_read_b128 v[72:75], v9 offset:2048
    s_waitcnt lgkmcnt(13)
    v_mfma_f32_16x16x32_bf16 a[60:63], v[120:123], v[52:55], a[60:63]
    s_add_u32 s22, s21, 5636096
    s_add_u32 m0, s23, 0
    v_mfma_f32_16x16x32_bf16 a[56:59], v[116:119], v[52:55], a[56:59]
    buffer_load_dwordx4 v16, s[8:11], s22 offen offset:0 lds
    v_mfma_f32_16x16x32_bf16 a[52:55], v[112:115], v[52:55], a[52:55]
    buffer_load_dwordx4 v17, s[8:11], s22 offen offset:1024 lds
    v_mfma_f32_16x16x32_bf16 a[48:51], v[108:111], v[52:55], a[48:51]
    buffer_load_dwordx4 v18, s[8:11], s22 offen offset:2048 lds
    s_waitcnt lgkmcnt(12)
    v_mfma_f32_16x16x32_bf16 a[64:67], v[108:111], v[56:59], a[64:67]
    buffer_load_dwordx4 v19, s[8:11], s22 offen offset:3072 lds
    v_mfma_f32_16x16x32_bf16 a[68:71], v[112:115], v[56:59], a[68:71]
    s_add_u32 m0, s24, 43008
    v_mfma_f32_16x16x32_bf16 a[72:75], v[116:119], v[56:59], a[72:75]
    buffer_load_dwordx4 v31, s[4:7], s26 offen lds
    v_mfma_f32_16x16x32_bf16 a[76:79], v[120:123], v[56:59], a[76:79]
    s_add_u32 m0, s24, 47104
    s_waitcnt lgkmcnt(11)
    v_mfma_f32_16x16x32_bf16 a[92:95], v[120:123], v[60:63], a[92:95]
    buffer_load_dwordx4 v32, s[4:7], s26 offen lds
    v_mfma_f32_16x16x32_bf16 a[88:91], v[116:119], v[60:63], a[88:91]
    v_mfma_f32_16x16x32_bf16 a[84:87], v[112:115], v[60:63], a[84:87]
    v_mfma_f32_16x16x32_bf16 a[80:83], v[108:111], v[60:63], a[80:83]
    s_waitcnt lgkmcnt(10)
    v_mfma_f32_16x16x32_bf16 a[96:99], v[108:111], v[64:67], a[96:99]
    v_mfma_f32_16x16x32_bf16 a[100:103], v[112:115], v[64:67], a[100:103]
    v_mfma_f32_16x16x32_bf16 a[104:107], v[116:119], v[64:67], a[104:107]
    v_mfma_f32_16x16x32_bf16 a[108:111], v[120:123], v[64:67], a[108:111]
    s_waitcnt lgkmcnt(9)
    v_mfma_f32_16x16x32_bf16 a[124:127], v[120:123], v[68:71], a[124:127]
    v_mfma_f32_16x16x32_bf16 a[120:123], v[116:119], v[68:71], a[120:123]
    v_mfma_f32_16x16x32_bf16 a[116:119], v[112:115], v[68:71], a[116:119]
    v_mfma_f32_16x16x32_bf16 a[112:115], v[108:111], v[68:71], a[112:115]
    s_waitcnt lgkmcnt(1)
    v_mfma_f32_16x16x32_bf16 a[0:3], v[92:95], v[44:47], a[0:3]
    s_waitcnt vmcnt(20)
    v_mfma_f32_16x16x32_bf16 a[4:7], v[96:99], v[44:47], a[4:7]
    ds_read_b64_tr_b16 v[108:109], v12 offset:8192
    v_mfma_f32_16x16x32_bf16 a[8:11], v[100:103], v[44:47], a[8:11]
    ds_read_b64_tr_b16 v[110:111], v12 offset:8448
    v_mfma_f32_16x16x32_bf16 a[12:15], v[104:107], v[44:47], a[12:15]
    ds_read_b64_tr_b16 v[112:113], v13 offset:8192
    v_mfma_f32_16x16x32_bf16 a[28:31], v[104:107], v[48:51], a[28:31]
    ds_read_b64_tr_b16 v[114:115], v13 offset:8448
    v_mfma_f32_16x16x32_bf16 a[24:27], v[100:103], v[48:51], a[24:27]
    ds_read_b64_tr_b16 v[116:117], v14 offset:8192
    v_mfma_f32_16x16x32_bf16 a[20:23], v[96:99], v[48:51], a[20:23]
    ds_read_b64_tr_b16 v[118:119], v14 offset:8448
    v_mfma_f32_16x16x32_bf16 a[16:19], v[92:95], v[48:51], a[16:19]
    ds_read_b64_tr_b16 v[120:121], v15 offset:8192
    v_mfma_f32_16x16x32_bf16 a[32:35], v[92:95], v[52:55], a[32:35]
    ds_read_b64_tr_b16 v[122:123], v15 offset:8448
    v_mfma_f32_16x16x32_bf16 a[36:39], v[96:99], v[52:55], a[36:39]
    v_mfma_f32_16x16x32_bf16 a[40:43], v[100:103], v[52:55], a[40:43]
    v_mfma_f32_16x16x32_bf16 a[44:47], v[104:107], v[52:55], a[44:47]
    ds_read_b128 v[76:79], v9 offset:2304
    v_mfma_f32_16x16x32_bf16 a[60:63], v[104:107], v[56:59], a[60:63]
    s_add_u32 s22, s21, 6684672
    s_add_u32 m0, s23, 4096
    v_mfma_f32_16x16x32_bf16 a[56:59], v[100:103], v[56:59], a[56:59]
    buffer_load_dwordx4 v16, s[8:11], s22 offen offset:0 lds
    v_mfma_f32_16x16x32_bf16 a[52:55], v[96:99], v[56:59], a[52:55]
    buffer_load_dwordx4 v17, s[8:11], s22 offen offset:1024 lds
    v_mfma_f32_16x16x32_bf16 a[48:51], v[92:95], v[56:59], a[48:51]
    buffer_load_dwordx4 v18, s[8:11], s22 offen offset:2048 lds
    v_mfma_f32_16x16x32_bf16 a[64:67], v[92:95], v[60:63], a[64:67]
    buffer_load_dwordx4 v19, s[8:11], s22 offen offset:3072 lds
    v_mfma_f32_16x16x32_bf16 a[68:71], v[96:99], v[60:63], a[68:71]
    s_add_u32 m0, s24, 51200
    v_mfma_f32_16x16x32_bf16 a[72:75], v[100:103], v[60:63], a[72:75]
    buffer_load_dwordx4 v33, s[4:7], s26 offen lds
    v_mfma_f32_16x16x32_bf16 a[76:79], v[104:107], v[60:63], a[76:79]
    s_add_u32 m0, s24, 55296
    v_mfma_f32_16x16x32_bf16 a[92:95], v[104:107], v[64:67], a[92:95]
    buffer_load_dwordx4 v34, s[4:7], s26 offen lds
    v_mfma_f32_16x16x32_bf16 a[88:91], v[100:103], v[64:67], a[88:91]
    v_mfma_f32_16x16x32_bf16 a[84:87], v[96:99], v[64:67], a[84:87]
    v_mfma_f32_16x16x32_bf16 a[80:83], v[92:95], v[64:67], a[80:83]
    v_mfma_f32_16x16x32_bf16 a[96:99], v[92:95], v[68:71], a[96:99]
    v_mfma_f32_16x16x32_bf16 a[100:103], v[96:99], v[68:71], a[100:103]
    v_mfma_f32_16x16x32_bf16 a[104:107], v[100:103], v[68:71], a[104:107]
    v_mfma_f32_16x16x32_bf16 a[108:111], v[104:107], v[68:71], a[108:111]
    s_waitcnt lgkmcnt(9)
    v_mfma_f32_16x16x32_bf16 a[124:127], v[104:107], v[72:75], a[124:127]
    v_mfma_f32_16x16x32_bf16 a[120:123], v[100:103], v[72:75], a[120:123]
    v_mfma_f32_16x16x32_bf16 a[116:119], v[96:99], v[72:75], a[116:119]
    v_mfma_f32_16x16x32_bf16 a[112:115], v[92:95], v[72:75], a[112:115]
    s_waitcnt lgkmcnt(1)
    v_mfma_f32_16x16x32_bf16 a[0:3], v[108:111], v[48:51], a[0:3]
    s_waitcnt vmcnt(18)
    v_mfma_f32_16x16x32_bf16 a[4:7], v[112:115], v[48:51], a[4:7]
    ds_read_b64_tr_b16 v[92:93], v12 offset:12288
    v_mfma_f32_16x16x32_bf16 a[8:11], v[116:119], v[48:51], a[8:11]
    ds_read_b64_tr_b16 v[94:95], v12 offset:12544
    v_perm_b32 v140, v126, v124, s98
    v_mfma_f32_16x16x32_bf16 a[12:15], v[120:123], v[48:51], a[12:15]
    ds_read_b64_tr_b16 v[96:97], v13 offset:12288
    v_perm_b32 v141, v130, v128, s98
    v_perm_b32 v142, v134, v132, s98
    v_mfma_f32_16x16x32_bf16 a[28:31], v[120:123], v[52:55], a[28:31]
    ds_read_b64_tr_b16 v[98:99], v13 offset:12544
    v_perm_b32 v143, v138, v136, s98
    v_perm_b32 v144, v126, v124, s99
    v_mfma_f32_16x16x32_bf16 a[24:27], v[116:119], v[52:55], a[24:27]
    ds_read_b64_tr_b16 v[100:101], v14 offset:12288
    v_perm_b32 v145, v130, v128, s99
    v_perm_b32 v146, v134, v132, s99
    v_mfma_f32_16x16x32_bf16 a[20:23], v[112:115], v[52:55], a[20:23]
    ds_read_b64_tr_b16 v[102:103], v14 offset:12544
    v_perm_b32 v147, v138, v136, s99
    v_mfma_f32_16x16x32_bf16 a[16:19], v[108:111], v[52:55], a[16:19]
    ds_read_b64_tr_b16 v[104:105], v15 offset:12288
    v_mfma_f32_16x16x32_bf16 a[32:35], v[108:111], v[56:59], a[32:35]
    ds_read_b64_tr_b16 v[106:107], v15 offset:12544
    v_mfma_f32_16x16x32_bf16 a[36:39], v[112:115], v[56:59], a[36:39]
    v_mfma_f32_16x16x32_bf16 a[40:43], v[116:119], v[56:59], a[40:43]
    v_mfma_f32_16x16x32_bf16 a[44:47], v[120:123], v[56:59], a[44:47]
    ds_read_b128 v[80:83], v9 offset:2560
    v_mfma_f32_16x16x32_bf16 a[60:63], v[120:123], v[60:63], a[60:63]
    s_add_u32 s22, s21, 7733248
    s_add_u32 m0, s23, 8192
    v_mfma_f32_16x16x32_bf16 a[56:59], v[116:119], v[60:63], a[56:59]
    buffer_load_dwordx4 v16, s[8:11], s22 offen offset:0 lds
    v_mfma_f32_16x16x32_bf16 a[52:55], v[112:115], v[60:63], a[52:55]
    buffer_load_dwordx4 v17, s[8:11], s22 offen offset:1024 lds
    v_mfma_f32_16x16x32_bf16 a[48:51], v[108:111], v[60:63], a[48:51]
    buffer_load_dwordx4 v18, s[8:11], s22 offen offset:2048 lds
    v_mfma_f32_16x16x32_bf16 a[64:67], v[108:111], v[64:67], a[64:67]
    buffer_load_dwordx4 v19, s[8:11], s22 offen offset:3072 lds
    v_mfma_f32_16x16x32_bf16 a[68:71], v[112:115], v[64:67], a[68:71]
    s_add_u32 m0, s24, 59392
    v_mfma_f32_16x16x32_bf16 a[72:75], v[116:119], v[64:67], a[72:75]
    buffer_load_dwordx4 v35, s[4:7], s26 offen lds
    v_mfma_f32_16x16x32_bf16 a[76:79], v[120:123], v[64:67], a[76:79]
    s_add_u32 m0, s24, 63488
    v_mfma_f32_16x16x32_bf16 a[92:95], v[120:123], v[68:71], a[92:95]
    buffer_load_dwordx4 v36, s[4:7], s26 offen lds
    v_mfma_f32_16x16x32_bf16 a[88:91], v[116:119], v[68:71], a[88:91]
    v_mfma_f32_16x16x32_bf16 a[84:87], v[112:115], v[68:71], a[84:87]
    v_mfma_f32_16x16x32_bf16 a[80:83], v[108:111], v[68:71], a[80:83]
    v_mfma_f32_16x16x32_bf16 a[96:99], v[108:111], v[72:75], a[96:99]
    v_mfma_f32_16x16x32_bf16 a[100:103], v[112:115], v[72:75], a[100:103]
    v_mfma_f32_16x16x32_bf16 a[104:107], v[116:119], v[72:75], a[104:107]
    v_mfma_f32_16x16x32_bf16 a[108:111], v[120:123], v[72:75], a[108:111]
    s_waitcnt lgkmcnt(9)
    v_mfma_f32_16x16x32_bf16 a[124:127], v[120:123], v[76:79], a[124:127]
    v_mfma_f32_16x16x32_bf16 a[120:123], v[116:119], v[76:79], a[120:123]
    v_mfma_f32_16x16x32_bf16 a[116:119], v[112:115], v[76:79], a[116:119]
    v_mfma_f32_16x16x32_bf16 a[112:115], v[108:111], v[76:79], a[112:115]
    s_waitcnt lgkmcnt(1)
    v_mfma_f32_16x16x32_bf16 a[0:3], v[92:95], v[52:55], a[0:3]
    s_waitcnt vmcnt(20)
    v_mfma_f32_16x16x32_bf16 a[4:7], v[96:99], v[52:55], a[4:7]
    ds_read_b64_tr_b16 v[108:109], v12 offset:16384
    v_mfma_f32_16x16x32_bf16 a[8:11], v[100:103], v[52:55], a[8:11]
    ds_read_b64_tr_b16 v[110:111], v12 offset:16640
    v_perm_b32 v148, v127, v125, s98
    v_perm_b32 v149, v131, v129, s98
    v_mfma_f32_16x16x32_bf16 a[12:15], v[104:107], v[52:55], a[12:15]
    ds_read_b64_tr_b16 v[112:113], v13 offset:16384
    v_perm_b32 v150, v135, v133, s98
    v_perm_b32 v151, v139, v137, s98
    v_mfma_f32_16x16x32_bf16 a[28:31], v[104:107], v[56:59], a[28:31]
    ds_read_b64_tr_b16 v[114:115], v13 offset:16640
    v_perm_b32 v152, v127, v125, s99
    v_perm_b32 v153, v131, v129, s99
    v_mfma_f32_16x16x32_bf16 a[24:27], v[100:103], v[56:59], a[24:27]
    ds_read_b64_tr_b16 v[116:117], v14 offset:16384
    v_perm_b32 v154, v135, v133, s99
    v_perm_b32 v155, v139, v137, s99
    v_mfma_f32_16x16x32_bf16 a[20:23], v[96:99], v[56:59], a[20:23]
    ds_read_b64_tr_b16 v[118:119], v14 offset:16640
    buffer_store_dwordx4 v[140:143], v158, s[32:35], s89 offen offset:0 sc0 sc1
    buffer_store_dwordx4 v[144:147], v158, s[32:35], s89 offen offset:1024 sc0 sc1
    v_mfma_f32_16x16x32_bf16 a[16:19], v[92:95], v[56:59], a[16:19]
    ds_read_b64_tr_b16 v[120:121], v15 offset:16384
    v_mfma_f32_16x16x32_bf16 a[32:35], v[92:95], v[60:63], a[32:35]
    ds_read_b64_tr_b16 v[122:123], v15 offset:16640
    v_mfma_f32_16x16x32_bf16 a[36:39], v[96:99], v[60:63], a[36:39]
    v_mfma_f32_16x16x32_bf16 a[40:43], v[100:103], v[60:63], a[40:43]
    v_mfma_f32_16x16x32_bf16 a[44:47], v[104:107], v[60:63], a[44:47]
    ds_read_b128 v[84:87], v9 offset:2816
    v_mfma_f32_16x16x32_bf16 a[60:63], v[104:107], v[64:67], a[60:63]
    s_add_u32 s22, s21, 917504
    s_add_u32 m0, s23, 12288
    v_mfma_f32_16x16x32_bf16 a[56:59], v[100:103], v[64:67], a[56:59]
    buffer_load_dwordx4 v16, s[8:11], s22 offen offset:0 lds
    v_mfma_f32_16x16x32_bf16 a[52:55], v[96:99], v[64:67], a[52:55]
    buffer_load_dwordx4 v17, s[8:11], s22 offen offset:1024 lds
    v_mfma_f32_16x16x32_bf16 a[48:51], v[92:95], v[64:67], a[48:51]
    buffer_load_dwordx4 v18, s[8:11], s22 offen offset:2048 lds
    v_mfma_f32_16x16x32_bf16 a[64:67], v[92:95], v[68:71], a[64:67]
    buffer_load_dwordx4 v19, s[8:11], s22 offen offset:3072 lds
    v_mfma_f32_16x16x32_bf16 a[68:71], v[96:99], v[68:71], a[68:71]
    s_add_u32 m0, s25, 34816
    v_mfma_f32_16x16x32_bf16 a[72:75], v[100:103], v[68:71], a[72:75]
    buffer_load_dwordx4 v37, s[4:7], s26 offen lds
    v_mfma_f32_16x16x32_bf16 a[76:79], v[104:107], v[68:71], a[76:79]
    v_mfma_f32_16x16x32_bf16 a[92:95], v[104:107], v[72:75], a[92:95]
    v_mfma_f32_16x16x32_bf16 a[88:91], v[100:103], v[72:75], a[88:91]
    v_mfma_f32_16x16x32_bf16 a[84:87], v[96:99], v[72:75], a[84:87]
    v_mfma_f32_16x16x32_bf16 a[80:83], v[92:95], v[72:75], a[80:83]
    v_mfma_f32_16x16x32_bf16 a[96:99], v[92:95], v[76:79], a[96:99]
    v_mfma_f32_16x16x32_bf16 a[100:103], v[96:99], v[76:79], a[100:103]
    v_mfma_f32_16x16x32_bf16 a[104:107], v[100:103], v[76:79], a[104:107]
    v_mfma_f32_16x16x32_bf16 a[108:111], v[104:107], v[76:79], a[108:111]
    s_waitcnt lgkmcnt(9)
    v_mfma_f32_16x16x32_bf16 a[124:127], v[104:107], v[80:83], a[124:127]
    v_mfma_f32_16x16x32_bf16 a[120:123], v[100:103], v[80:83], a[120:123]
    v_mfma_f32_16x16x32_bf16 a[116:119], v[96:99], v[80:83], a[116:119]
    v_mfma_f32_16x16x32_bf16 a[112:115], v[92:95], v[80:83], a[112:115]
    s_waitcnt lgkmcnt(1)
    v_mfma_f32_16x16x32_bf16 a[0:3], v[108:111], v[56:59], a[0:3]
    s_waitcnt vmcnt(21)
    v_mfma_f32_16x16x32_bf16 a[4:7], v[112:115], v[56:59], a[4:7]
    ds_read_b64_tr_b16 v[92:93], v12 offset:0
    v_mfma_f32_16x16x32_bf16 a[8:11], v[116:119], v[56:59], a[8:11]
    ds_read_b64_tr_b16 v[94:95], v12 offset:256
    buffer_store_dwordx4 v[148:151], v158, s[32:35], s85 offen offset:0 sc0 sc1
    buffer_store_dwordx4 v[152:155], v158, s[32:35], s85 offen offset:1024 sc0 sc1
    v_mfma_f32_16x16x32_bf16 a[12:15], v[120:123], v[56:59], a[12:15]
    ds_read_b64_tr_b16 v[96:97], v13 offset:0
    v_mfma_f32_16x16x32_bf16 a[28:31], v[120:123], v[60:63], a[28:31]
    ds_read_b64_tr_b16 v[98:99], v13 offset:256
    v_mfma_f32_16x16x32_bf16 a[24:27], v[116:119], v[60:63], a[24:27]
    ds_read_b64_tr_b16 v[100:101], v14 offset:0
    v_mfma_f32_16x16x32_bf16 a[20:23], v[112:115], v[60:63], a[20:23]
    ds_read_b64_tr_b16 v[102:103], v14 offset:256
    v_mfma_f32_16x16x32_bf16 a[16:19], v[108:111], v[60:63], a[16:19]
    ds_read_b64_tr_b16 v[104:105], v15 offset:0
    v_mfma_f32_16x16x32_bf16 a[32:35], v[108:111], v[64:67], a[32:35]
    ds_read_b64_tr_b16 v[106:107], v15 offset:256
    v_mfma_f32_16x16x32_bf16 a[36:39], v[112:115], v[64:67], a[36:39]
    v_mfma_f32_16x16x32_bf16 a[40:43], v[116:119], v[64:67], a[40:43]
    v_mfma_f32_16x16x32_bf16 a[44:47], v[120:123], v[64:67], a[44:47]
    ds_read_b128 v[88:91], v9 offset:3072
    v_mfma_f32_16x16x32_bf16 a[60:63], v[120:123], v[68:71], a[60:63]
    s_add_u32 s22, s21, 1966080
    s_add_u32 m0, s23, 16384
    v_mfma_f32_16x16x32_bf16 a[56:59], v[116:119], v[68:71], a[56:59]
    buffer_load_dwordx4 v16, s[8:11], s22 offen offset:0 lds
    v_mfma_f32_16x16x32_bf16 a[52:55], v[112:115], v[68:71], a[52:55]
    buffer_load_dwordx4 v17, s[8:11], s22 offen offset:1024 lds
    v_mfma_f32_16x16x32_bf16 a[48:51], v[108:111], v[68:71], a[48:51]
    buffer_load_dwordx4 v18, s[8:11], s22 offen offset:2048 lds
    v_mfma_f32_16x16x32_bf16 a[64:67], v[108:111], v[72:75], a[64:67]
    buffer_load_dwordx4 v19, s[8:11], s22 offen offset:3072 lds
    v_mfma_f32_16x16x32_bf16 a[68:71], v[112:115], v[72:75], a[68:71]
    v_mfma_f32_16x16x32_bf16 a[72:75], v[116:119], v[72:75], a[72:75]
    v_mfma_f32_16x16x32_bf16 a[76:79], v[120:123], v[72:75], a[76:79]
    v_mfma_f32_16x16x32_bf16 a[92:95], v[120:123], v[76:79], a[92:95]
    v_mfma_f32_16x16x32_bf16 a[88:91], v[116:119], v[76:79], a[88:91]
    v_mfma_f32_16x16x32_bf16 a[84:87], v[112:115], v[76:79], a[84:87]
    v_mfma_f32_16x16x32_bf16 a[80:83], v[108:111], v[76:79], a[80:83]
    v_mfma_f32_16x16x32_bf16 a[96:99], v[108:111], v[80:83], a[96:99]
    v_mfma_f32_16x16x32_bf16 a[100:103], v[112:115], v[80:83], a[100:103]
    v_mfma_f32_16x16x32_bf16 a[104:107], v[116:119], v[80:83], a[104:107]
    v_mfma_f32_16x16x32_bf16 a[108:111], v[120:123], v[80:83], a[108:111]
    s_waitcnt lgkmcnt(9)
    v_mfma_f32_16x16x32_bf16 a[124:127], v[120:123], v[84:87], a[124:127]
    v_mfma_f32_16x16x32_bf16 a[120:123], v[116:119], v[84:87], a[120:123]
    v_mfma_f32_16x16x32_bf16 a[116:119], v[112:115], v[84:87], a[116:119]
    v_mfma_f32_16x16x32_bf16 a[112:115], v[108:111], v[84:87], a[112:115]
    s_waitcnt lgkmcnt(1)
    v_mfma_f32_16x16x32_bf16 a[0:3], v[92:95], v[60:63], a[0:3]
    s_waitcnt vmcnt(21)
    v_mfma_f32_16x16x32_bf16 a[4:7], v[96:99], v[60:63], a[4:7]
    ds_read_b64_tr_b16 v[108:109], v12 offset:4096
    v_mfma_f32_16x16x32_bf16 a[8:11], v[100:103], v[60:63], a[8:11]
    ds_read_b64_tr_b16 v[110:111], v12 offset:4352
    v_mfma_f32_16x16x32_bf16 a[12:15], v[104:107], v[60:63], a[12:15]
    ds_read_b64_tr_b16 v[112:113], v13 offset:4096
    v_mfma_f32_16x16x32_bf16 a[28:31], v[104:107], v[64:67], a[28:31]
    ds_read_b64_tr_b16 v[114:115], v13 offset:4352
    v_mfma_f32_16x16x32_bf16 a[24:27], v[100:103], v[64:67], a[24:27]
    ds_read_b64_tr_b16 v[116:117], v14 offset:4096
    v_mfma_f32_16x16x32_bf16 a[20:23], v[96:99], v[64:67], a[20:23]
    ds_read_b64_tr_b16 v[118:119], v14 offset:4352
    v_mfma_f32_16x16x32_bf16 a[16:19], v[92:95], v[64:67], a[16:19]
    ds_read_b64_tr_b16 v[120:121], v15 offset:4096
    v_mfma_f32_16x16x32_bf16 a[32:35], v[92:95], v[68:71], a[32:35]
    ds_read_b64_tr_b16 v[122:123], v15 offset:4352
    v_mfma_f32_16x16x32_bf16 a[36:39], v[96:99], v[68:71], a[36:39]
    v_mfma_f32_16x16x32_bf16 a[40:43], v[100:103], v[68:71], a[40:43]
    v_mfma_f32_16x16x32_bf16 a[44:47], v[104:107], v[68:71], a[44:47]
    ds_read_b128 v[40:43], v9 offset:3328
    v_mfma_f32_16x16x32_bf16 a[60:63], v[104:107], v[72:75], a[60:63]
    s_add_u32 s22, s21, 3014656
    s_add_u32 m0, s23, 0
    v_mfma_f32_16x16x32_bf16 a[56:59], v[100:103], v[72:75], a[56:59]
    buffer_load_dwordx4 v16, s[8:11], s22 offen offset:0 lds
    v_mfma_f32_16x16x32_bf16 a[52:55], v[96:99], v[72:75], a[52:55]
    buffer_load_dwordx4 v17, s[8:11], s22 offen offset:1024 lds
    v_mfma_f32_16x16x32_bf16 a[48:51], v[92:95], v[72:75], a[48:51]
    buffer_load_dwordx4 v18, s[8:11], s22 offen offset:2048 lds
    v_mfma_f32_16x16x32_bf16 a[64:67], v[92:95], v[76:79], a[64:67]
    buffer_load_dwordx4 v19, s[8:11], s22 offen offset:3072 lds
    v_mfma_f32_16x16x32_bf16 a[68:71], v[96:99], v[76:79], a[68:71]
    v_mfma_f32_16x16x32_bf16 a[72:75], v[100:103], v[76:79], a[72:75]
    v_mfma_f32_16x16x32_bf16 a[76:79], v[104:107], v[76:79], a[76:79]
    v_mfma_f32_16x16x32_bf16 a[92:95], v[104:107], v[80:83], a[92:95]
    v_mfma_f32_16x16x32_bf16 a[88:91], v[100:103], v[80:83], a[88:91]
    v_mfma_f32_16x16x32_bf16 a[84:87], v[96:99], v[80:83], a[84:87]
    v_mfma_f32_16x16x32_bf16 a[80:83], v[92:95], v[80:83], a[80:83]
    v_mfma_f32_16x16x32_bf16 a[96:99], v[92:95], v[84:87], a[96:99]
    v_mfma_f32_16x16x32_bf16 a[100:103], v[96:99], v[84:87], a[100:103]
    v_mfma_f32_16x16x32_bf16 a[104:107], v[100:103], v[84:87], a[104:107]
    v_mfma_f32_16x16x32_bf16 a[108:111], v[104:107], v[84:87], a[108:111]
    s_waitcnt lgkmcnt(9)
    v_mfma_f32_16x16x32_bf16 a[124:127], v[104:107], v[88:91], a[124:127]
    v_mfma_f32_16x16x32_bf16 a[120:123], v[100:103], v[88:91], a[120:123]
    v_mfma_f32_16x16x32_bf16 a[116:119], v[96:99], v[88:91], a[116:119]
    v_mfma_f32_16x16x32_bf16 a[112:115], v[92:95], v[88:91], a[112:115]
    s_waitcnt lgkmcnt(1)
    v_mfma_f32_16x16x32_bf16 a[0:3], v[108:111], v[64:67], a[0:3]
    s_waitcnt vmcnt(19)
    v_mfma_f32_16x16x32_bf16 a[4:7], v[112:115], v[64:67], a[4:7]
    ds_read_b64_tr_b16 v[92:93], v12 offset:8192
    v_mfma_f32_16x16x32_bf16 a[8:11], v[116:119], v[64:67], a[8:11]
    ds_read_b64_tr_b16 v[94:95], v12 offset:8448
    v_mfma_f32_16x16x32_bf16 a[12:15], v[120:123], v[64:67], a[12:15]
    ds_read_b64_tr_b16 v[96:97], v13 offset:8192
    v_mfma_f32_16x16x32_bf16 a[28:31], v[120:123], v[68:71], a[28:31]
    ds_read_b64_tr_b16 v[98:99], v13 offset:8448
    v_mfma_f32_16x16x32_bf16 a[24:27], v[116:119], v[68:71], a[24:27]
    ds_read_b64_tr_b16 v[100:101], v14 offset:8192
    v_mfma_f32_16x16x32_bf16 a[20:23], v[112:115], v[68:71], a[20:23]
    ds_read_b64_tr_b16 v[102:103], v14 offset:8448
    v_mfma_f32_16x16x32_bf16 a[16:19], v[108:111], v[68:71], a[16:19]
    ds_read_b64_tr_b16 v[104:105], v15 offset:8192
    v_mfma_f32_16x16x32_bf16 a[32:35], v[108:111], v[72:75], a[32:35]
    ds_read_b64_tr_b16 v[106:107], v15 offset:8448
    v_mfma_f32_16x16x32_bf16 a[36:39], v[112:115], v[72:75], a[36:39]
    v_mfma_f32_16x16x32_bf16 a[40:43], v[116:119], v[72:75], a[40:43]
    v_mfma_f32_16x16x32_bf16 a[44:47], v[120:123], v[72:75], a[44:47]
    ds_read_b128 v[44:47], v9 offset:3584
    v_mfma_f32_16x16x32_bf16 a[60:63], v[120:123], v[76:79], a[60:63]
    s_add_u32 s22, s21, 4063232
    s_add_u32 m0, s23, 4096
    v_mfma_f32_16x16x32_bf16 a[56:59], v[116:119], v[76:79], a[56:59]
    buffer_load_dwordx4 v16, s[8:11], s22 offen offset:0 lds
    v_mfma_f32_16x16x32_bf16 a[52:55], v[112:115], v[76:79], a[52:55]
    buffer_load_dwordx4 v17, s[8:11], s22 offen offset:1024 lds
    v_mfma_f32_16x16x32_bf16 a[48:51], v[108:111], v[76:79], a[48:51]
    buffer_load_dwordx4 v18, s[8:11], s22 offen offset:2048 lds
    v_mfma_f32_16x16x32_bf16 a[64:67], v[108:111], v[80:83], a[64:67]
    buffer_load_dwordx4 v19, s[8:11], s22 offen offset:3072 lds
    v_mfma_f32_16x16x32_bf16 a[68:71], v[112:115], v[80:83], a[68:71]
    v_mfma_f32_16x16x32_bf16 a[72:75], v[116:119], v[80:83], a[72:75]
    v_mfma_f32_16x16x32_bf16 a[76:79], v[120:123], v[80:83], a[76:79]
    v_mfma_f32_16x16x32_bf16 a[92:95], v[120:123], v[84:87], a[92:95]
    v_mfma_f32_16x16x32_bf16 a[88:91], v[116:119], v[84:87], a[88:91]
    v_mfma_f32_16x16x32_bf16 a[84:87], v[112:115], v[84:87], a[84:87]
    v_mfma_f32_16x16x32_bf16 a[80:83], v[108:111], v[84:87], a[80:83]
    v_mfma_f32_16x16x32_bf16 a[96:99], v[108:111], v[88:91], a[96:99]
    v_mfma_f32_16x16x32_bf16 a[100:103], v[112:115], v[88:91], a[100:103]
    v_mfma_f32_16x16x32_bf16 a[104:107], v[116:119], v[88:91], a[104:107]
    v_mfma_f32_16x16x32_bf16 a[108:111], v[120:123], v[88:91], a[108:111]
    s_waitcnt lgkmcnt(9)
    v_mfma_f32_16x16x32_bf16 a[124:127], v[120:123], v[40:43], a[124:127]
    v_mfma_f32_16x16x32_bf16 a[120:123], v[116:119], v[40:43], a[120:123]
    v_mfma_f32_16x16x32_bf16 a[116:119], v[112:115], v[40:43], a[116:119]
    v_mfma_f32_16x16x32_bf16 a[112:115], v[108:111], v[40:43], a[112:115]
    s_waitcnt lgkmcnt(1)
    v_mfma_f32_16x16x32_bf16 a[0:3], v[92:95], v[68:71], a[0:3]
    s_waitcnt vmcnt(12) lgkmcnt(0)
    s_barrier
    s_add_u32 s92, s12, 11534336
    s_addc_u32 s93, s13, 0
    s_mov_b32 s94, 24576
    s_mov_b32 s95, 0x00020000
    s_lshl_b32 s27, s2, 2
    s_add_u32 s27, s27, 4096
    s_cmp_lg_u32 s16, 0
    s_cbranch_scc1 p1_sig1
    v_mov_b32 v180, s100
    v_mov_b32 v181, 0
    s_mov_b64 exec, 1
    buffer_store_dword v180, v181, s[92:95], s27 offen sc0 sc1
    s_mov_b64 exec, -1
p1_sig1:
    v_mfma_f32_16x16x32_bf16 a[4:7], v[96:99], v[68:71], a[4:7]
    ds_read_b64_tr_b16 v[108:109], v12 offset:12288
    v_mfma_f32_16x16x32_bf16 a[8:11], v[100:103], v[68:71], a[8:11]
    ds_read_b64_tr_b16 v[110:111], v12 offset:12544
    v_mfma_f32_16x16x32_bf16 a[12:15], v[104:107], v[68:71], a[12:15]
    ds_read_b64_tr_b16 v[112:113], v13 offset:12288
    ds_read_b128 v[68:71], v8 offset:34816
    v_mfma_f32_16x16x32_bf16 a[28:31], v[104:107], v[72:75], a[28:31]
    ds_read_b64_tr_b16 v[114:115], v13 offset:12544
    v_mfma_f32_16x16x32_bf16 a[24:27], v[100:103], v[72:75], a[24:27]
    ds_read_b64_tr_b16 v[116:117], v14 offset:12288
    v_mfma_f32_16x16x32_bf16 a[20:23], v[96:99], v[72:75], a[20:23]
    ds_read_b64_tr_b16 v[118:119], v14 offset:12544
    v_mfma_f32_16x16x32_bf16 a[16:19], v[92:95], v[72:75], a[16:19]
    ds_read_b64_tr_b16 v[120:121], v15 offset:12288
    ds_read_b128 v[72:75], v8 offset:35072
    v_mfma_f32_16x16x32_bf16 a[32:35], v[92:95], v[76:79], a[32:35]
    ds_read_b64_tr_b16 v[122:123], v15 offset:12544
    v_mfma_f32_16x16x32_bf16 a[36:39], v[96:99], v[76:79], a[36:39]
    v_mfma_f32_16x16x32_bf16 a[40:43], v[100:103], v[76:79], a[40:43]
    v_mfma_f32_16x16x32_bf16 a[44:47], v[104:107], v[76:79], a[44:47]
    ds_read_b128 v[76:79], v8 offset:35328
    v_mfma_f32_16x16x32_bf16 a[60:63], v[104:107], v[80:83], a[60:63]
    s_add_u32 s22, s21, 5111808
    s_add_u32 m0, s23, 8192
    v_mfma_f32_16x16x32_bf16 a[56:59], v[100:103], v[80:83], a[56:59]
    buffer_load_dwordx4 v16, s[8:11], s22 offen offset:0 lds
    v_mfma_f32_16x16x32_bf16 a[52:55], v[96:99], v[80:83], a[52:55]
    buffer_load_dwordx4 v17, s[8:11], s22 offen offset:1024 lds
    v_mfma_f32_16x16x32_bf16 a[48:51], v[92:95], v[80:83], a[48:51]
    ds_read_b128 v[80:83], v8 offset:35584
    buffer_load_dwordx4 v18, s[8:11], s22 offen offset:2048 lds
    v_mfma_f32_16x16x32_bf16 a[64:67], v[92:95], v[84:87], a[64:67]
    buffer_load_dwordx4 v19, s[8:11], s22 offen offset:3072 lds
    v_mfma_f32_16x16x32_bf16 a[68:71], v[96:99], v[84:87], a[68:71]
    v_mfma_f32_16x16x32_bf16 a[72:75], v[100:103], v[84:87], a[72:75]
    v_mfma_f32_16x16x32_bf16 a[76:79], v[104:107], v[84:87], a[76:79]
    ds_read_b128 v[84:87], v8 offset:35840
    v_mfma_f32_16x16x32_bf16 a[92:95], v[104:107], v[88:91], a[92:95]
    v_mfma_f32_16x16x32_bf16 a[88:91], v[100:103], v[88:91], a[88:91]
    v_mfma_f32_16x16x32_bf16 a[84:87], v[96:99], v[88:91], a[84:87]
    v_mfma_f32_16x16x32_bf16 a[80:83], v[92:95], v[88:91], a[80:83]
    ds_read_b128 v[88:91], v8 offset:36096
    v_mfma_f32_16x16x32_bf16 a[96:99], v[92:95], v[40:43], a[96:99]
    v_mfma_f32_16x16x32_bf16 a[100:103], v[96:99], v[40:43], a[100:103]
    v_mfma_f32_16x16x32_bf16 a[104:107], v[100:103], v[40:43], a[104:107]
    v_mfma_f32_16x16x32_bf16 a[108:111], v[104:107], v[40:43], a[108:111]
    ds_read_b128 v[40:43], v8 offset:36352
    v_mfma_f32_16x16x32_bf16 a[124:127], v[104:107], v[44:47], a[124:127]
    v_mfma_f32_16x16x32_bf16 a[120:123], v[100:103], v[44:47], a[120:123]
    v_mfma_f32_16x16x32_bf16 a[116:119], v[96:99], v[44:47], a[116:119]
    v_mfma_f32_16x16x32_bf16 a[112:115], v[92:95], v[44:47], a[112:115]
    ds_read_b128 v[44:47], v8 offset:36608
    s_waitcnt lgkmcnt(6)
    v_mfma_f32_16x16x32_bf16 a[0:3], v[108:111], v[68:71], a[0:3]
    s_waitcnt vmcnt(12)
    v_mfma_f32_16x16x32_bf16 a[4:7], v[112:115], v[68:71], a[4:7]
    ds_read_b64_tr_b16 v[92:93], v12 offset:16384
    v_mfma_f32_16x16x32_bf16 a[8:11], v[116:119], v[68:71], a[8:11]
    ds_read_b64_tr_b16 v[94:95], v12 offset:16640
    v_mfma_f32_16x16x32_bf16 a[12:15], v[120:123], v[68:71], a[12:15]
    ds_read_b64_tr_b16 v[96:97], v13 offset:16384
    v_mfma_f32_16x16x32_bf16 a[28:31], v[120:123], v[72:75], a[28:31]
    ds_read_b64_tr_b16 v[98:99], v13 offset:16640
    v_mfma_f32_16x16x32_bf16 a[24:27], v[116:119], v[72:75], a[24:27]
    ds_read_b64_tr_b16 v[100:101], v14 offset:16384
    v_mfma_f32_16x16x32_bf16 a[20:23], v[112:115], v[72:75], a[20:23]
    ds_read_b64_tr_b16 v[102:103], v14 offset:16640
    v_mfma_f32_16x16x32_bf16 a[16:19], v[108:111], v[72:75], a[16:19]
    ds_read_b64_tr_b16 v[104:105], v15 offset:16384
    s_waitcnt lgkmcnt(12)
    v_mfma_f32_16x16x32_bf16 a[32:35], v[108:111], v[76:79], a[32:35]
    ds_read_b64_tr_b16 v[106:107], v15 offset:16640
    v_mfma_f32_16x16x32_bf16 a[36:39], v[112:115], v[76:79], a[36:39]
    v_mfma_f32_16x16x32_bf16 a[40:43], v[116:119], v[76:79], a[40:43]
    v_mfma_f32_16x16x32_bf16 a[44:47], v[120:123], v[76:79], a[44:47]
    ds_read_b128 v[48:51], v9 offset:36864
    s_waitcnt lgkmcnt(13)
    v_mfma_f32_16x16x32_bf16 a[60:63], v[120:123], v[80:83], a[60:63]
    s_add_u32 s22, s21, 6160384
    s_add_u32 m0, s23, 12288
    v_mfma_f32_16x16x32_bf16 a[56:59], v[116:119], v[80:83], a[56:59]
    buffer_load_dwordx4 v16, s[8:11], s22 offen offset:0 lds
    v_mfma_f32_16x16x32_bf16 a[52:55], v[112:115], v[80:83], a[52:55]
    buffer_load_dwordx4 v17, s[8:11], s22 offen offset:1024 lds
    v_mfma_f32_16x16x32_bf16 a[48:51], v[108:111], v[80:83], a[48:51]
    buffer_load_dwordx4 v18, s[8:11], s22 offen offset:2048 lds
    s_waitcnt lgkmcnt(12)
    v_mfma_f32_16x16x32_bf16 a[64:67], v[108:111], v[84:87], a[64:67]
    buffer_load_dwordx4 v19, s[8:11], s22 offen offset:3072 lds
    v_mfma_f32_16x16x32_bf16 a[68:71], v[112:115], v[84:87], a[68:71]
    v_mfma_f32_16x16x32_bf16 a[72:75], v[116:119], v[84:87], a[72:75]
    v_mfma_f32_16x16x32_bf16 a[76:79], v[120:123], v[84:87], a[76:79]
    s_waitcnt lgkmcnt(11)
    v_mfma_f32_16x16x32_bf16 a[92:95], v[120:123], v[88:91], a[92:95]
    v_mfma_f32_16x16x32_bf16 a[88:91], v[116:119], v[88:91], a[88:91]
    v_mfma_f32_16x16x32_bf16 a[84:87], v[112:115], v[88:91], a[84:87]
    v_mfma_f32_16x16x32_bf16 a[80:83], v[108:111], v[88:91], a[80:83]
    s_waitcnt lgkmcnt(10)
    v_mfma_f32_16x16x32_bf16 a[96:99], v[108:111], v[40:43], a[96:99]
    v_mfma_f32_16x16x32_bf16 a[100:103], v[112:115], v[40:43], a[100:103]
    v_mfma_f32_16x16x32_bf16 a[104:107], v[116:119], v[40:43], a[104:107]
    v_mfma_f32_16x16x32_bf16 a[108:111], v[120:123], v[40:43], a[108:111]
    s_waitcnt lgkmcnt(9)
    v_mfma_f32_16x16x32_bf16 a[124:127], v[120:123], v[44:47], a[124:127]
    v_mfma_f32_16x16x32_bf16 a[120:123], v[116:119], v[44:47], a[120:123]
    v_mfma_f32_16x16x32_bf16 a[116:119], v[112:115], v[44:47], a[116:119]
    v_mfma_f32_16x16x32_bf16 a[112:115], v[108:111], v[44:47], a[112:115]
    s_waitcnt lgkmcnt(1)
    v_mfma_f32_16x16x32_bf16 a[0:3], v[92:95], v[72:75], a[0:3]
    s_waitcnt vmcnt(12)
    v_mfma_f32_16x16x32_bf16 a[4:7], v[96:99], v[72:75], a[4:7]
    ds_read_b64_tr_b16 v[108:109], v12 offset:0
    v_mfma_f32_16x16x32_bf16 a[8:11], v[100:103], v[72:75], a[8:11]
    ds_read_b64_tr_b16 v[110:111], v12 offset:256
    v_mfma_f32_16x16x32_bf16 a[12:15], v[104:107], v[72:75], a[12:15]
    ds_read_b64_tr_b16 v[112:113], v13 offset:0
    v_mfma_f32_16x16x32_bf16 a[28:31], v[104:107], v[76:79], a[28:31]
    ds_read_b64_tr_b16 v[114:115], v13 offset:256
    v_mfma_f32_16x16x32_bf16 a[24:27], v[100:103], v[76:79], a[24:27]
    ds_read_b64_tr_b16 v[116:117], v14 offset:0
    v_mfma_f32_16x16x32_bf16 a[20:23], v[96:99], v[76:79], a[20:23]
    ds_read_b64_tr_b16 v[118:119], v14 offset:256
    v_mfma_f32_16x16x32_bf16 a[16:19], v[92:95], v[76:79], a[16:19]
    ds_read_b64_tr_b16 v[120:121], v15 offset:0
    v_mfma_f32_16x16x32_bf16 a[32:35], v[92:95], v[80:83], a[32:35]
    ds_read_b64_tr_b16 v[122:123], v15 offset:256
    v_mfma_f32_16x16x32_bf16 a[36:39], v[96:99], v[80:83], a[36:39]
    v_mfma_f32_16x16x32_bf16 a[40:43], v[100:103], v[80:83], a[40:43]
    v_mfma_f32_16x16x32_bf16 a[44:47], v[104:107], v[80:83], a[44:47]
    ds_read_b128 v[52:55], v9 offset:37120
    v_mfma_f32_16x16x32_bf16 a[60:63], v[104:107], v[84:87], a[60:63]
    s_add_u32 s22, s21, 7208960
    s_add_u32 m0, s23, 16384
    v_mfma_f32_16x16x32_bf16 a[56:59], v[100:103], v[84:87], a[56:59]
    buffer_load_dwordx4 v16, s[8:11], s22 offen offset:0 lds
    v_mfma_f32_16x16x32_bf16 a[52:55], v[96:99], v[84:87], a[52:55]
    buffer_load_dwordx4 v17, s[8:11], s22 offen offset:1024 lds
    v_mfma_f32_16x16x32_bf16 a[48:51], v[92:95], v[84:87], a[48:51]
    buffer_load_dwordx4 v18, s[8:11], s22 offen offset:2048 lds
    v_mfma_f32_16x16x32_bf16 a[64:67], v[92:95], v[88:91], a[64:67]
    buffer_load_dwordx4 v19, s[8:11], s22 offen offset:3072 lds
    v_mfma_f32_16x16x32_bf16 a[68:71], v[96:99], v[88:91], a[68:71]
    v_mfma_f32_16x16x32_bf16 a[72:75], v[100:103], v[88:91], a[72:75]
    v_mfma_f32_16x16x32_bf16 a[76:79], v[104:107], v[88:91], a[76:79]
    v_mfma_f32_16x16x32_bf16 a[92:95], v[104:107], v[40:43], a[92:95]
    v_mfma_f32_16x16x32_bf16 a[88:91], v[100:103], v[40:43], a[88:91]
    v_mfma_f32_16x16x32_bf16 a[84:87], v[96:99], v[40:43], a[84:87]
    v_mfma_f32_16x16x32_bf16 a[80:83], v[92:95], v[40:43], a[80:83]
    v_mfma_f32_16x16x32_bf16 a[96:99], v[92:95], v[44:47], a[96:99]
    v_mfma_f32_16x16x32_bf16 a[100:103], v[96:99], v[44:47], a[100:103]
    v_mfma_f32_16x16x32_bf16 a[104:107], v[100:103], v[44:47], a[104:107]
    v_mfma_f32_16x16x32_bf16 a[108:111], v[104:107], v[44:47], a[108:111]
    s_waitcnt lgkmcnt(9)
    v_mfma_f32_16x16x32_bf16 a[124:127], v[104:107], v[48:51], a[124:127]
    v_mfma_f32_16x16x32_bf16 a[120:123], v[100:103], v[48:51], a[120:123]
    v_mfma_f32_16x16x32_bf16 a[116:119], v[96:99], v[48:51], a[116:119]
    v_mfma_f32_16x16x32_bf16 a[112:115], v[92:95], v[48:51], a[112:115]
    s_waitcnt lgkmcnt(1)
    v_mfma_f32_16x16x32_bf16 a[0:3], v[108:111], v[76:79], a[0:3]
    s_waitcnt vmcnt(12)
    v_mfma_f32_16x16x32_bf16 a[4:7], v[112:115], v[76:79], a[4:7]
    ds_read_b64_tr_b16 v[92:93], v12 offset:4096
    v_mfma_f32_16x16x32_bf16 a[8:11], v[116:119], v[76:79], a[8:11]
    ds_read_b64_tr_b16 v[94:95], v12 offset:4352
    v_mfma_f32_16x16x32_bf16 a[12:15], v[120:123], v[76:79], a[12:15]
    ds_read_b64_tr_b16 v[96:97], v13 offset:4096
    v_mfma_f32_16x16x32_bf16 a[28:31], v[120:123], v[80:83], a[28:31]
    ds_read_b64_tr_b16 v[98:99], v13 offset:4352
    v_mfma_f32_16x16x32_bf16 a[24:27], v[116:119], v[80:83], a[24:27]
    ds_read_b64_tr_b16 v[100:101], v14 offset:4096
    v_mfma_f32_16x16x32_bf16 a[20:23], v[112:115], v[80:83], a[20:23]
    ds_read_b64_tr_b16 v[102:103], v14 offset:4352
    v_mfma_f32_16x16x32_bf16 a[16:19], v[108:111], v[80:83], a[16:19]
    ds_read_b64_tr_b16 v[104:105], v15 offset:4096
    v_mfma_f32_16x16x32_bf16 a[32:35], v[108:111], v[84:87], a[32:35]
    ds_read_b64_tr_b16 v[106:107], v15 offset:4352
    v_mfma_f32_16x16x32_bf16 a[36:39], v[112:115], v[84:87], a[36:39]
    v_mfma_f32_16x16x32_bf16 a[40:43], v[116:119], v[84:87], a[40:43]
    v_mfma_f32_16x16x32_bf16 a[44:47], v[120:123], v[84:87], a[44:47]
    ds_read_b128 v[56:59], v9 offset:37376
    v_mfma_f32_16x16x32_bf16 a[60:63], v[120:123], v[88:91], a[60:63]
    v_mfma_f32_16x16x32_bf16 a[56:59], v[116:119], v[88:91], a[56:59]
    v_mfma_f32_16x16x32_bf16 a[52:55], v[112:115], v[88:91], a[52:55]
    v_mfma_f32_16x16x32_bf16 a[48:51], v[108:111], v[88:91], a[48:51]
    v_mfma_f32_16x16x32_bf16 a[64:67], v[108:111], v[40:43], a[64:67]
    v_mfma_f32_16x16x32_bf16 a[68:71], v[112:115], v[40:43], a[68:71]
    v_mfma_f32_16x16x32_bf16 a[72:75], v[116:119], v[40:43], a[72:75]
    v_mfma_f32_16x16x32_bf16 a[76:79], v[120:123], v[40:43], a[76:79]
    v_mfma_f32_16x16x32_bf16 a[92:95], v[120:123], v[44:47], a[92:95]
    v_mfma_f32_16x16x32_bf16 a[88:91], v[116:119], v[44:47], a[88:91]
    v_mfma_f32_16x16x32_bf16 a[84:87], v[112:115], v[44:47], a[84:87]
    v_mfma_f32_16x16x32_bf16 a[80:83], v[108:111], v[44:47], a[80:83]
    v_mfma_f32_16x16x32_bf16 a[96:99], v[108:111], v[48:51], a[96:99]
    v_mfma_f32_16x16x32_bf16 a[100:103], v[112:115], v[48:51], a[100:103]
    v_mfma_f32_16x16x32_bf16 a[104:107], v[116:119], v[48:51], a[104:107]
    v_mfma_f32_16x16x32_bf16 a[108:111], v[120:123], v[48:51], a[108:111]
    s_waitcnt lgkmcnt(9)
    v_mfma_f32_16x16x32_bf16 a[124:127], v[120:123], v[52:55], a[124:127]
    v_mfma_f32_16x16x32_bf16 a[120:123], v[116:119], v[52:55], a[120:123]
    v_mfma_f32_16x16x32_bf16 a[116:119], v[112:115], v[52:55], a[116:119]
    v_mfma_f32_16x16x32_bf16 a[112:115], v[108:111], v[52:55], a[112:115]
    s_waitcnt lgkmcnt(1)
    v_mfma_f32_16x16x32_bf16 a[0:3], v[92:95], v[80:83], a[0:3]
    s_waitcnt vmcnt(8)
    v_mfma_f32_16x16x32_bf16 a[4:7], v[96:99], v[80:83], a[4:7]
    ds_read_b64_tr_b16 v[108:109], v12 offset:8192
    v_mfma_f32_16x16x32_bf16 a[8:11], v[100:103], v[80:83], a[8:11]
    ds_read_b64_tr_b16 v[110:111], v12 offset:8448
    v_mfma_f32_16x16x32_bf16 a[12:15], v[104:107], v[80:83], a[12:15]
    ds_read_b64_tr_b16 v[112:113], v13 offset:8192
    v_mfma_f32_16x16x32_bf16 a[28:31], v[104:107], v[84:87], a[28:31]
    ds_read_b64_tr_b16 v[114:115], v13 offset:8448
    v_mfma_f32_16x16x32_bf16 a[24:27], v[100:103], v[84:87], a[24:27]
    ds_read_b64_tr_b16 v[116:117], v14 offset:8192
    v_mfma_f32_16x16x32_bf16 a[20:23], v[96:99], v[84:87], a[20:23]
    ds_read_b64_tr_b16 v[118:119], v14 offset:8448
    v_mfma_f32_16x16x32_bf16 a[16:19], v[92:95], v[84:87], a[16:19]
    ds_read_b64_tr_b16 v[120:121], v15 offset:8192
    v_mfma_f32_16x16x32_bf16 a[32:35], v[92:95], v[88:91], a[32:35]
    ds_read_b64_tr_b16 v[122:123], v15 offset:8448
    v_mfma_f32_16x16x32_bf16 a[36:39], v[96:99], v[88:91], a[36:39]
    v_mfma_f32_16x16x32_bf16 a[40:43], v[100:103], v[88:91], a[40:43]
    v_mfma_f32_16x16x32_bf16 a[44:47], v[104:107], v[88:91], a[44:47]
    ds_read_b128 v[60:63], v9 offset:37632
    v_mfma_f32_16x16x32_bf16 a[60:63], v[104:107], v[40:43], a[60:63]
    v_mfma_f32_16x16x32_bf16 a[56:59], v[100:103], v[40:43], a[56:59]
    v_mfma_f32_16x16x32_bf16 a[52:55], v[96:99], v[40:43], a[52:55]
    v_mfma_f32_16x16x32_bf16 a[48:51], v[92:95], v[40:43], a[48:51]
    v_mfma_f32_16x16x32_bf16 a[64:67], v[92:95], v[44:47], a[64:67]
    v_mfma_f32_16x16x32_bf16 a[68:71], v[96:99], v[44:47], a[68:71]
    v_mfma_f32_16x16x32_bf16 a[72:75], v[100:103], v[44:47], a[72:75]
    v_mfma_f32_16x16x32_bf16 a[76:79], v[104:107], v[44:47], a[76:79]
    v_mfma_f32_16x16x32_bf16 a[92:95], v[104:107], v[48:51], a[92:95]
    v_mfma_f32_16x16x32_bf16 a[88:91], v[100:103], v[48:51], a[88:91]
    v_mfma_f32_16x16x32_bf16 a[84:87], v[96:99], v[48:51], a[84:87]
    v_mfma_f32_16x16x32_bf16 a[80:83], v[92:95], v[48:51], a[80:83]
    v_mfma_f32_16x16x32_bf16 a[96:99], v[92:95], v[52:55], a[96:99]
    v_mfma_f32_16x16x32_bf16 a[100:103], v[96:99], v[52:55], a[100:103]
    v_mfma_f32_16x16x32_bf16 a[104:107], v[100:103], v[52:55], a[104:107]
    v_mfma_f32_16x16x32_bf16 a[108:111], v[104:107], v[52:55], a[108:111]
    s_waitcnt lgkmcnt(9)
    v_mfma_f32_16x16x32_bf16 a[124:127], v[104:107], v[56:59], a[124:127]
    v_mfma_f32_16x16x32_bf16 a[120:123], v[100:103], v[56:59], a[120:123]
    v_mfma_f32_16x16x32_bf16 a[116:119], v[96:99], v[56:59], a[116:119]
    v_mfma_f32_16x16x32_bf16 a[112:115], v[92:95], v[56:59], a[112:115]
    s_waitcnt lgkmcnt(1)
    v_mfma_f32_16x16x32_bf16 a[0:3], v[108:111], v[84:87], a[0:3]
    s_waitcnt vmcnt(4)
    v_mfma_f32_16x16x32_bf16 a[4:7], v[112:115], v[84:87], a[4:7]
    ds_read_b64_tr_b16 v[92:93], v12 offset:12288
    v_mfma_f32_16x16x32_bf16 a[8:11], v[116:119], v[84:87], a[8:11]
    ds_read_b64_tr_b16 v[94:95], v12 offset:12544
    v_mfma_f32_16x16x32_bf16 a[12:15], v[120:123], v[84:87], a[12:15]
    ds_read_b64_tr_b16 v[96:97], v13 offset:12288
    v_mfma_f32_16x16x32_bf16 a[28:31], v[120:123], v[88:91], a[28:31]
    ds_read_b64_tr_b16 v[98:99], v13 offset:12544
    v_mfma_f32_16x16x32_bf16 a[24:27], v[116:119], v[88:91], a[24:27]
    ds_read_b64_tr_b16 v[100:101], v14 offset:12288
    v_mfma_f32_16x16x32_bf16 a[20:23], v[112:115], v[88:91], a[20:23]
    ds_read_b64_tr_b16 v[102:103], v14 offset:12544
    v_mfma_f32_16x16x32_bf16 a[16:19], v[108:111], v[88:91], a[16:19]
    ds_read_b64_tr_b16 v[104:105], v15 offset:12288
    v_mfma_f32_16x16x32_bf16 a[32:35], v[108:111], v[40:43], a[32:35]
    ds_read_b64_tr_b16 v[106:107], v15 offset:12544
    v_mfma_f32_16x16x32_bf16 a[36:39], v[112:115], v[40:43], a[36:39]
    v_mfma_f32_16x16x32_bf16 a[40:43], v[116:119], v[40:43], a[40:43]
    v_mfma_f32_16x16x32_bf16 a[44:47], v[120:123], v[40:43], a[44:47]
    ds_read_b128 v[64:67], v9 offset:37888
    v_mfma_f32_16x16x32_bf16 a[60:63], v[120:123], v[44:47], a[60:63]
    v_mfma_f32_16x16x32_bf16 a[56:59], v[116:119], v[44:47], a[56:59]
    v_mfma_f32_16x16x32_bf16 a[52:55], v[112:115], v[44:47], a[52:55]
    v_mfma_f32_16x16x32_bf16 a[48:51], v[108:111], v[44:47], a[48:51]
    v_mfma_f32_16x16x32_bf16 a[64:67], v[108:111], v[48:51], a[64:67]
    v_mfma_f32_16x16x32_bf16 a[68:71], v[112:115], v[48:51], a[68:71]
    v_mfma_f32_16x16x32_bf16 a[72:75], v[116:119], v[48:51], a[72:75]
    v_mfma_f32_16x16x32_bf16 a[76:79], v[120:123], v[48:51], a[76:79]
    v_mfma_f32_16x16x32_bf16 a[92:95], v[120:123], v[52:55], a[92:95]
    v_mfma_f32_16x16x32_bf16 a[88:91], v[116:119], v[52:55], a[88:91]
    v_mfma_f32_16x16x32_bf16 a[84:87], v[112:115], v[52:55], a[84:87]
    v_mfma_f32_16x16x32_bf16 a[80:83], v[108:111], v[52:55], a[80:83]
    v_mfma_f32_16x16x32_bf16 a[96:99], v[108:111], v[56:59], a[96:99]
    v_mfma_f32_16x16x32_bf16 a[100:103], v[112:115], v[56:59], a[100:103]
    v_mfma_f32_16x16x32_bf16 a[104:107], v[116:119], v[56:59], a[104:107]
    v_mfma_f32_16x16x32_bf16 a[108:111], v[120:123], v[56:59], a[108:111]
    s_waitcnt lgkmcnt(9)
    v_mfma_f32_16x16x32_bf16 a[124:127], v[120:123], v[60:63], a[124:127]
    v_mfma_f32_16x16x32_bf16 a[120:123], v[116:119], v[60:63], a[120:123]
    v_mfma_f32_16x16x32_bf16 a[116:119], v[112:115], v[60:63], a[116:119]
    v_mfma_f32_16x16x32_bf16 a[112:115], v[108:111], v[60:63], a[112:115]
    s_waitcnt lgkmcnt(1)
    v_mfma_f32_16x16x32_bf16 a[0:3], v[92:95], v[88:91], a[0:3]
    s_waitcnt vmcnt(0)
    v_mfma_f32_16x16x32_bf16 a[4:7], v[96:99], v[88:91], a[4:7]
    ds_read_b64_tr_b16 v[108:109], v12 offset:16384
    v_mfma_f32_16x16x32_bf16 a[8:11], v[100:103], v[88:91], a[8:11]
    ds_read_b64_tr_b16 v[110:111], v12 offset:16640
    v_mfma_f32_16x16x32_bf16 a[12:15], v[104:107], v[88:91], a[12:15]
    ds_read_b64_tr_b16 v[112:113], v13 offset:16384
    v_mfma_f32_16x16x32_bf16 a[28:31], v[104:107], v[40:43], a[28:31]
    ds_read_b64_tr_b16 v[114:115], v13 offset:16640
    v_mfma_f32_16x16x32_bf16 a[24:27], v[100:103], v[40:43], a[24:27]
    ds_read_b64_tr_b16 v[116:117], v14 offset:16384
    v_mfma_f32_16x16x32_bf16 a[20:23], v[96:99], v[40:43], a[20:23]
    ds_read_b64_tr_b16 v[118:119], v14 offset:16640
    v_mfma_f32_16x16x32_bf16 a[16:19], v[92:95], v[40:43], a[16:19]
    ds_read_b64_tr_b16 v[120:121], v15 offset:16384
    v_mfma_f32_16x16x32_bf16 a[32:35], v[92:95], v[44:47], a[32:35]
    ds_read_b64_tr_b16 v[122:123], v15 offset:16640
    v_mfma_f32_16x16x32_bf16 a[36:39], v[96:99], v[44:47], a[36:39]
    v_mfma_f32_16x16x32_bf16 a[40:43], v[100:103], v[44:47], a[40:43]
    v_mfma_f32_16x16x32_bf16 a[44:47], v[104:107], v[44:47], a[44:47]
    ds_read_b128 v[68:71], v9 offset:38144
    v_mfma_f32_16x16x32_bf16 a[60:63], v[104:107], v[48:51], a[60:63]
    v_mfma_f32_16x16x32_bf16 a[56:59], v[100:103], v[48:51], a[56:59]
    v_mfma_f32_16x16x32_bf16 a[52:55], v[96:99], v[48:51], a[52:55]
    v_mfma_f32_16x16x32_bf16 a[48:51], v[92:95], v[48:51], a[48:51]
    v_mfma_f32_16x16x32_bf16 a[64:67], v[92:95], v[52:55], a[64:67]
    v_mfma_f32_16x16x32_bf16 a[68:71], v[96:99], v[52:55], a[68:71]
    v_mfma_f32_16x16x32_bf16 a[72:75], v[100:103], v[52:55], a[72:75]
    v_mfma_f32_16x16x32_bf16 a[76:79], v[104:107], v[52:55], a[76:79]
    v_mfma_f32_16x16x32_bf16 a[92:95], v[104:107], v[56:59], a[92:95]
    v_mfma_f32_16x16x32_bf16 a[88:91], v[100:103], v[56:59], a[88:91]
    v_mfma_f32_16x16x32_bf16 a[84:87], v[96:99], v[56:59], a[84:87]
    v_mfma_f32_16x16x32_bf16 a[80:83], v[92:95], v[56:59], a[80:83]
    v_mfma_f32_16x16x32_bf16 a[96:99], v[92:95], v[60:63], a[96:99]
    v_mfma_f32_16x16x32_bf16 a[100:103], v[96:99], v[60:63], a[100:103]
    v_mfma_f32_16x16x32_bf16 a[104:107], v[100:103], v[60:63], a[104:107]
    v_mfma_f32_16x16x32_bf16 a[108:111], v[104:107], v[60:63], a[108:111]
    s_waitcnt lgkmcnt(9)
    v_mfma_f32_16x16x32_bf16 a[124:127], v[104:107], v[64:67], a[124:127]
    v_mfma_f32_16x16x32_bf16 a[120:123], v[100:103], v[64:67], a[120:123]
    v_mfma_f32_16x16x32_bf16 a[116:119], v[96:99], v[64:67], a[116:119]
    v_mfma_f32_16x16x32_bf16 a[112:115], v[92:95], v[64:67], a[112:115]
    s_waitcnt lgkmcnt(1)
    v_mfma_f32_16x16x32_bf16 a[0:3], v[108:111], v[40:43], a[0:3]
    v_mfma_f32_16x16x32_bf16 a[4:7], v[112:115], v[40:43], a[4:7]
    v_mfma_f32_16x16x32_bf16 a[8:11], v[116:119], v[40:43], a[8:11]
    v_mfma_f32_16x16x32_bf16 a[12:15], v[120:123], v[40:43], a[12:15]
    v_mfma_f32_16x16x32_bf16 a[28:31], v[120:123], v[44:47], a[28:31]
    v_mfma_f32_16x16x32_bf16 a[24:27], v[116:119], v[44:47], a[24:27]
    v_mfma_f32_16x16x32_bf16 a[20:23], v[112:115], v[44:47], a[20:23]
    v_mfma_f32_16x16x32_bf16 a[16:19], v[108:111], v[44:47], a[16:19]
    v_mfma_f32_16x16x32_bf16 a[32:35], v[108:111], v[48:51], a[32:35]
    v_mfma_f32_16x16x32_bf16 a[36:39], v[112:115], v[48:51], a[36:39]
    v_mfma_f32_16x16x32_bf16 a[40:43], v[116:119], v[48:51], a[40:43]
    v_mfma_f32_16x16x32_bf16 a[44:47], v[120:123], v[48:51], a[44:47]
    v_mfma_f32_16x16x32_bf16 a[60:63], v[120:123], v[52:55], a[60:63]
    v_mfma_f32_16x16x32_bf16 a[56:59], v[116:119], v[52:55], a[56:59]
    v_mfma_f32_16x16x32_bf16 a[52:55], v[112:115], v[52:55], a[52:55]
    v_mfma_f32_16x16x32_bf16 a[48:51], v[108:111], v[52:55], a[48:51]
    v_mfma_f32_16x16x32_bf16 a[64:67], v[108:111], v[56:59], a[64:67]
    v_mfma_f32_16x16x32_bf16 a[68:71], v[112:115], v[56:59], a[68:71]
    v_mfma_f32_16x16x32_bf16 a[72:75], v[116:119], v[56:59], a[72:75]
    v_mfma_f32_16x16x32_bf16 a[76:79], v[120:123], v[56:59], a[76:79]
    v_mfma_f32_16x16x32_bf16 a[92:95], v[120:123], v[60:63], a[92:95]
    v_mfma_f32_16x16x32_bf16 a[88:91], v[116:119], v[60:63], a[88:91]
    v_mfma_f32_16x16x32_bf16 a[84:87], v[112:115], v[60:63], a[84:87]
    v_mfma_f32_16x16x32_bf16 a[80:83], v[108:111], v[60:63], a[80:83]
    v_mfma_f32_16x16x32_bf16 a[96:99], v[108:111], v[64:67], a[96:99]
    v_mfma_f32_16x16x32_bf16 a[100:103], v[112:115], v[64:67], a[100:103]
    v_mfma_f32_16x16x32_bf16 a[104:107], v[116:119], v[64:67], a[104:107]
    v_mfma_f32_16x16x32_bf16 a[108:111], v[120:123], v[64:67], a[108:111]
    s_waitcnt lgkmcnt(0)
    v_mfma_f32_16x16x32_bf16 a[124:127], v[120:123], v[68:71], a[124:127]
    v_mfma_f32_16x16x32_bf16 a[120:123], v[116:119], v[68:71], a[120:123]
    v_mfma_f32_16x16x32_bf16 a[116:119], v[112:115], v[68:71], a[116:119]
    v_mfma_f32_16x16x32_bf16 a[112:115], v[108:111], v[68:71], a[112:115]
    v_lshlrev_b32 v184, 4, v0
    v_add_u32 v184, 4096, v184
    buffer_load_dwordx4 v[180:183], v184, s[92:95], 0 offen sc1
    v_mov_b32 v18, 0xc0135761
    v_mov_b32 v19, 0xc0135761
    s_mov_b32 s28, 0xbdd2d3e8
    s_mov_b32 s29, 0xbdd2d3e8
    v_lshlrev_b32 v4, 4, v0
    s_add_u32 s27, s16, 1
    s_and_b32 s27, s27, 3
    s_mul_i32 s30, s27, 24576
    v_add_u32 v9, s30, v4
    s_add_u32 s27, s16, 2
    s_and_b32 s27, s27, 3
    s_mul_i32 s30, s27, 24576
    v_add_u32 v10, s30, v4
    s_add_u32 s27, s16, 3
    s_and_b32 s27, s27, 3
    s_mul_i32 s30, s27, 24576
    v_add_u32 v11, s30, v4
    s_mul_i32 s30, s16, 24576
    v_add_u32 v8, s30, v4
    s_waitcnt lgkmcnt(0)
    s_barrier
    s_cmp_eq_u32 s16, 0
    s_cbranch_scc1 p1_w0
    s_cmp_eq_u32 s16, 1
    s_cbranch_scc1 p1_w1
    s_cmp_eq_u32 s16, 2
    s_cbranch_scc1 p1_w2
p1_w3:
    ds_write_b128 v9, a[0:3] offset:16384
    ds_write_b128 v9, a[4:7] offset:17408
    ds_write_b128 v9, a[8:11] offset:18432
    ds_write_b128 v9, a[12:15] offset:19456
    ds_write_b128 v10, a[32:35] offset:8192
    ds_write_b128 v10, a[36:39] offset:9216
    ds_write_b128 v10, a[40:43] offset:10240
    ds_write_b128 v10, a[44:47] offset:11264
    ds_write_b128 v11, a[64:67] offset:0
    ds_write_b128 v11, a[68:71] offset:1024
    ds_write_b128 v11, a[72:75] offset:2048
    ds_write_b128 v11, a[76:79] offset:3072
    v_accvgpr_read_b32 v20, a96
    v_accvgpr_read_b32 v21, a97
    v_accvgpr_read_b32 v22, a98
    v_accvgpr_read_b32 v23, a99
    v_accvgpr_read_b32 v24, a100
    v_accvgpr_read_b32 v25, a101
    v_accvgpr_read_b32 v26, a102
    v_accvgpr_read_b32 v27, a103
    v_accvgpr_read_b32 v28, a104
    v_accvgpr_read_b32 v29, a105
    v_accvgpr_read_b32 v30, a106
    v_accvgpr_read_b32 v31, a107
    v_accvgpr_read_b32 v32, a108
    v_accvgpr_read_b32 v33, a109
    v_accvgpr_read_b32 v34, a110
    v_accvgpr_read_b32 v35, a111
    v_accvgpr_read_b32 v36, a112
    v_accvgpr_read_b32 v37, a113
    v_accvgpr_read_b32 v38, a114
    v_accvgpr_read_b32 v39, a115
    v_accvgpr_read_b32 v40, a116
    v_accvgpr_read_b32 v41, a117
    v_accvgpr_read_b32 v42, a118
    v_accvgpr_read_b32 v43, a119
    v_accvgpr_read_b32 v44, a120
    v_accvgpr_read_b32 v45, a121
    v_accvgpr_read_b32 v46, a122
    v_accvgpr_read_b32 v47, a123
    v_accvgpr_read_b32 v48, a124
    v_accvgpr_read_b32 v49, a125
    v_accvgpr_read_b32 v50, a126
    v_accvgpr_read_b32 v51, a127
    s_waitcnt lgkmcnt(0)
    s_barrier
    ds_read_b128 v[52:55], v8 offset:0
    ds_read_b128 v[56:59], v8 offset:1024
    ds_read_b128 v[60:63], v8 offset:2048
    ds_read_b128 v[64:67], v8 offset:3072
    ds_read_b128 v[68:71], v8 offset:8192
    ds_read_b128 v[72:75], v8 offset:9216
    ds_read_b128 v[76:79], v8 offset:10240
    ds_read_b128 v[80:83], v8 offset:11264
    ds_read_b128 v[84:87], v8 offset:16384
    ds_read_b128 v[88:91], v8 offset:17408
    ds_read_b128 v[92:95], v8 offset:18432
    ds_read_b128 v[96:99], v8 offset:19456
    ds_write_b128 v9, a[16:19] offset:20480
    ds_write_b128 v9, a[20:23] offset:21504
    ds_write_b128 v9, a[24:27] offset:22528
    ds_write_b128 v9, a[28:31] offset:23552
    ds_write_b128 v10, a[48:51] offset:12288
    ds_write_b128 v10, a[52:55] offset:13312
    ds_write_b128 v10, a[56:59] offset:14336
    ds_write_b128 v10, a[60:63] offset:15360
    ds_write_b128 v11, a[80:83] offset:4096
    ds_write_b128 v11, a[84:87] offset:5120
    ds_write_b128 v11, a[88:91] offset:6144
    ds_write_b128 v11, a[92:95] offset:7168
    s_branch p1_wj
p1_w0:
    ds_write_b128 v9, a[32:35] offset:16384
    ds_write_b128 v9, a[36:39] offset:17408
    ds_write_b128 v9, a[40:43] offset:18432
    ds_write_b128 v9, a[44:47] offset:19456
    ds_write_b128 v10, a[64:67] offset:8192
    ds_write_b128 v10, a[68:71] offset:9216
    ds_write_b128 v10, a[72:75] offset:10240
    ds_write_b128 v10, a[76:79] offset:11264
    ds_write_b128 v11, a[96:99] offset:0
    ds_write_b128 v11, a[100:103] offset:1024
    ds_write_b128 v11, a[104:107] offset:2048
    ds_write_b128 v11, a[108:111] offset:3072
    v_accvgpr_read_b32 v20, a0
    v_accvgpr_read_b32 v21, a1
    v_accvgpr_read_b32 v22, a2
    v_accvgpr_read_b32 v23, a3
    v_accvgpr_read_b32 v24, a4
    v_accvgpr_read_b32 v25, a5
    v_accvgpr_read_b32 v26, a6
    v_accvgpr_read_b32 v27, a7
    v_accvgpr_read_b32 v28, a8
    v_accvgpr_read_b32 v29, a9
    v_accvgpr_read_b32 v30, a10
    v_accvgpr_read_b32 v31, a11
    v_accvgpr_read_b32 v32, a12
    v_accvgpr_read_b32 v33, a13
    v_accvgpr_read_b32 v34, a14
    v_accvgpr_read_b32 v35, a15
    v_accvgpr_read_b32 v36, a16
    v_accvgpr_read_b32 v37, a17
    v_accvgpr_read_b32 v38, a18
    v_accvgpr_read_b32 v39, a19
    v_accvgpr_read_b32 v40, a20
    v_accvgpr_read_b32 v41, a21
    v_accvgpr_read_b32 v42, a22
    v_accvgpr_read_b32 v43, a23
    v_accvgpr_read_b32 v44, a24
    v_accvgpr_read_b32 v45, a25
    v_accvgpr_read_b32 v46, a26
    v_accvgpr_read_b32 v47, a27
    v_accvgpr_read_b32 v48, a28
    v_accvgpr_read_b32 v49, a29
    v_accvgpr_read_b32 v50, a30
    v_accvgpr_read_b32 v51, a31
    s_waitcnt lgkmcnt(0)
    s_barrier
    ds_read_b128 v[52:55], v8 offset:0
    ds_read_b128 v[56:59], v8 offset:1024
    ds_read_b128 v[60:63], v8 offset:2048
    ds_read_b128 v[64:67], v8 offset:3072
    ds_read_b128 v[68:71], v8 offset:8192
    ds_read_b128 v[72:75], v8 offset:9216
    ds_read_b128 v[76:79], v8 offset:10240
    ds_read_b128 v[80:83], v8 offset:11264
    ds_read_b128 v[84:87], v8 offset:16384
    ds_read_b128 v[88:91], v8 offset:17408
    ds_read_b128 v[92:95], v8 offset:18432
    ds_read_b128 v[96:99], v8 offset:19456
    ds_write_b128 v9, a[48:51] offset:20480
    ds_write_b128 v9, a[52:55] offset:21504
    ds_write_b128 v9, a[56:59] offset:22528
    ds_write_b128 v9, a[60:63] offset:23552
    ds_write_b128 v10, a[80:83] offset:12288
    ds_write_b128 v10, a[84:87] offset:13312
    ds_write_b128 v10, a[88:91] offset:14336
    ds_write_b128 v10, a[92:95] offset:15360
    ds_write_b128 v11, a[112:115] offset:4096
    ds_write_b128 v11, a[116:119] offset:5120
    ds_write_b128 v11, a[120:123] offset:6144
    ds_write_b128 v11, a[124:127] offset:7168
    s_branch p1_wj
p1_w1:
    ds_write_b128 v9, a[64:67] offset:16384
    ds_write_b128 v9, a[68:71] offset:17408
    ds_write_b128 v9, a[72:75] offset:18432
    ds_write_b128 v9, a[76:79] offset:19456
    ds_write_b128 v10, a[96:99] offset:8192
    ds_write_b128 v10, a[100:103] offset:9216
    ds_write_b128 v10, a[104:107] offset:10240
    ds_write_b128 v10, a[108:111] offset:11264
    ds_write_b128 v11, a[0:3] offset:0
    ds_write_b128 v11, a[4:7] offset:1024
    ds_write_b128 v11, a[8:11] offset:2048
    ds_write_b128 v11, a[12:15] offset:3072
    v_accvgpr_read_b32 v20, a32
    v_accvgpr_read_b32 v21, a33
    v_accvgpr_read_b32 v22, a34
    v_accvgpr_read_b32 v23, a35
    v_accvgpr_read_b32 v24, a36
    v_accvgpr_read_b32 v25, a37
    v_accvgpr_read_b32 v26, a38
    v_accvgpr_read_b32 v27, a39
    v_accvgpr_read_b32 v28, a40
    v_accvgpr_read_b32 v29, a41
    v_accvgpr_read_b32 v30, a42
    v_accvgpr_read_b32 v31, a43
    v_accvgpr_read_b32 v32, a44
    v_accvgpr_read_b32 v33, a45
    v_accvgpr_read_b32 v34, a46
    v_accvgpr_read_b32 v35, a47
    v_accvgpr_read_b32 v36, a48
    v_accvgpr_read_b32 v37, a49
    v_accvgpr_read_b32 v38, a50
    v_accvgpr_read_b32 v39, a51
    v_accvgpr_read_b32 v40, a52
    v_accvgpr_read_b32 v41, a53
    v_accvgpr_read_b32 v42, a54
    v_accvgpr_read_b32 v43, a55
    v_accvgpr_read_b32 v44, a56
    v_accvgpr_read_b32 v45, a57
    v_accvgpr_read_b32 v46, a58
    v_accvgpr_read_b32 v47, a59
    v_accvgpr_read_b32 v48, a60
    v_accvgpr_read_b32 v49, a61
    v_accvgpr_read_b32 v50, a62
    v_accvgpr_read_b32 v51, a63
    s_waitcnt lgkmcnt(0)
    s_barrier
    ds_read_b128 v[52:55], v8 offset:0
    ds_read_b128 v[56:59], v8 offset:1024
    ds_read_b128 v[60:63], v8 offset:2048
    ds_read_b128 v[64:67], v8 offset:3072
    ds_read_b128 v[68:71], v8 offset:8192
    ds_read_b128 v[72:75], v8 offset:9216
    ds_read_b128 v[76:79], v8 offset:10240
    ds_read_b128 v[80:83], v8 offset:11264
    ds_read_b128 v[84:87], v8 offset:16384
    ds_read_b128 v[88:91], v8 offset:17408
    ds_read_b128 v[92:95], v8 offset:18432
    ds_read_b128 v[96:99], v8 offset:19456
    ds_write_b128 v9, a[80:83] offset:20480
    ds_write_b128 v9, a[84:87] offset:21504
    ds_write_b128 v9, a[88:91] offset:22528
    ds_write_b128 v9, a[92:95] offset:23552
    ds_write_b128 v10, a[112:115] offset:12288
    ds_write_b128 v10, a[116:119] offset:13312
    ds_write_b128 v10, a[120:123] offset:14336
    ds_write_b128 v10, a[124:127] offset:15360
    ds_write_b128 v11, a[16:19] offset:4096
    ds_write_b128 v11, a[20:23] offset:5120
    ds_write_b128 v11, a[24:27] offset:6144
    ds_write_b128 v11, a[28:31] offset:7168
    s_branch p1_wj
p1_w2:
    ds_write_b128 v9, a[96:99] offset:16384
    ds_write_b128 v9, a[100:103] offset:17408
    ds_write_b128 v9, a[104:107] offset:18432
    ds_write_b128 v9, a[108:111] offset:19456
    ds_write_b128 v10, a[0:3] offset:8192
    ds_write_b128 v10, a[4:7] offset:9216
    ds_write_b128 v10, a[8:11] offset:10240
    ds_write_b128 v10, a[12:15] offset:11264
    ds_write_b128 v11, a[32:35] offset:0
    ds_write_b128 v11, a[36:39] offset:1024
    ds_write_b128 v11, a[40:43] offset:2048
    ds_write_b128 v11, a[44:47] offset:3072
    v_accvgpr_read_b32 v20, a64
    v_accvgpr_read_b32 v21, a65
    v_accvgpr_read_b32 v22, a66
    v_accvgpr_read_b32 v23, a67
    v_accvgpr_read_b32 v24, a68
    v_accvgpr_read_b32 v25, a69
    v_accvgpr_read_b32 v26, a70
    v_accvgpr_read_b32 v27, a71
    v_accvgpr_read_b32 v28, a72
    v_accvgpr_read_b32 v29, a73
    v_accvgpr_read_b32 v30, a74
    v_accvgpr_read_b32 v31, a75
    v_accvgpr_read_b32 v32, a76
    v_accvgpr_read_b32 v33, a77
    v_accvgpr_read_b32 v34, a78
    v_accvgpr_read_b32 v35, a79
    v_accvgpr_read_b32 v36, a80
    v_accvgpr_read_b32 v37, a81
    v_accvgpr_read_b32 v38, a82
    v_accvgpr_read_b32 v39, a83
    v_accvgpr_read_b32 v40, a84
    v_accvgpr_read_b32 v41, a85
    v_accvgpr_read_b32 v42, a86
    v_accvgpr_read_b32 v43, a87
    v_accvgpr_read_b32 v44, a88
    v_accvgpr_read_b32 v45, a89
    v_accvgpr_read_b32 v46, a90
    v_accvgpr_read_b32 v47, a91
    v_accvgpr_read_b32 v48, a92
    v_accvgpr_read_b32 v49, a93
    v_accvgpr_read_b32 v50, a94
    v_accvgpr_read_b32 v51, a95
    s_waitcnt lgkmcnt(0)
    s_barrier
    ds_read_b128 v[52:55], v8 offset:0
    ds_read_b128 v[56:59], v8 offset:1024
    ds_read_b128 v[60:63], v8 offset:2048
    ds_read_b128 v[64:67], v8 offset:3072
    ds_read_b128 v[68:71], v8 offset:8192
    ds_read_b128 v[72:75], v8 offset:9216
    ds_read_b128 v[76:79], v8 offset:10240
    ds_read_b128 v[80:83], v8 offset:11264
    ds_read_b128 v[84:87], v8 offset:16384
    ds_read_b128 v[88:91], v8 offset:17408
    ds_read_b128 v[92:95], v8 offset:18432
    ds_read_b128 v[96:99], v8 offset:19456
    ds_write_b128 v9, a[112:115] offset:20480
    ds_write_b128 v9, a[116:119] offset:21504
    ds_write_b128 v9, a[120:123] offset:22528
    ds_write_b128 v9, a[124:127] offset:23552
    ds_write_b128 v10, a[16:19] offset:12288
    ds_write_b128 v10, a[20:23] offset:13312
    ds_write_b128 v10, a[24:27] offset:14336
    ds_write_b128 v10, a[28:31] offset:15360
    ds_write_b128 v11, a[48:51] offset:4096
    ds_write_b128 v11, a[52:55] offset:5120
    ds_write_b128 v11, a[56:59] offset:6144
    ds_write_b128 v11, a[60:63] offset:7168
p1_wj:
    v_and_b32 v5, 7, v1
    v_lshrrev_b32 v6, 1, v2
    v_xor_b32 v5, v5, v6
    v_lshlrev_b32 v5, 4, v5
    v_and_b32 v6, 1, v2
    v_lshl_add_u32 v5, v6, 3, v5
    v_lshl_add_u32 v5, v1, 7, v5
    s_lshl_b32 s27, s16, 12
    s_add_u32 s27, s27, 98304
    v_add_u32 v12, s27, v5
    v_xor_b32 v13, 32, v12
    v_xor_b32 v14, 64, v12
    v_xor_b32 v15, 96, v12
    v_lshrrev_b32 v5, 3, v0
    v_and_b32 v6, 7, v0
    v_xor_b32 v6, v6, v5
    v_lshlrev_b32 v6, 4, v6
    v_lshl_add_u32 v6, v5, 7, v6
    v_add_u32 v16, s27, v6
    s_mul_i32 s27, s19, 2048000
    s_add_u32 s12, s12, s27
    s_addc_u32 s13, s13, 0
    s_mov_b32 s14, 2048000
    s_mov_b32 s15, 0x00020000
    v_lshlrev_b32 v5, 3, v5
    s_lshl_b32 s27, s16, 1
    v_add_u32 v5, s27, v5
    s_sub_u32 s30, 2000, s20
    s_min_u32 s30, s30, 126
    v_and_b32 v6, 7, v0
    v_lshlrev_b32 v6, 4, v6
    s_lshl_b32 s27, s18, 7
    v_add_u32 v6, s27, v6
    v_mov_b32 v7, 0x80000000
    s_waitcnt lgkmcnt(15)
    v_pk_add_f32 v[20:21], v[20:21], v[52:53]
    v_pk_add_f32 v[22:23], v[22:23], v[54:55]
    v_pk_add_f32 v[24:25], v[24:25], v[56:57]
    v_pk_add_f32 v[26:27], v[26:27], v[58:59]
    v_pk_add_f32 v[28:29], v[28:29], v[60:61]
    v_pk_add_f32 v[30:31], v[30:31], v[62:63]
    v_pk_add_f32 v[32:33], v[32:33], v[64:65]
    v_pk_add_f32 v[34:35], v[34:35], v[66:67]
    v_pk_add_f32 v[20:21], v[20:21], v[68:69]
    v_pk_add_f32 v[22:23], v[22:23], v[70:71]
    v_pk_add_f32 v[24:25], v[24:25], v[72:73]
    v_pk_add_f32 v[26:27], v[26:27], v[74:75]
    v_pk_add_f32 v[28:29], v[28:29], v[76:77]
    v_pk_add_f32 v[30:31], v[30:31], v[78:79]
    v_pk_add_f32 v[32:33], v[32:33], v[80:81]
    v_pk_add_f32 v[34:35], v[34:35], v[82:83]
    s_waitcnt lgkmcnt(12)
    v_pk_add_f32 v[20:21], v[20:21], v[84:85]
    v_pk_add_f32 v[22:23], v[22:23], v[86:87]
    v_pk_add_f32 v[24:25], v[24:25], v[88:89]
    v_pk_add_f32 v[26:27], v[26:27], v[90:91]
    v_pk_add_f32 v[28:29], v[28:29], v[92:93]
    v_pk_add_f32 v[30:31], v[30:31], v[94:95]
    v_pk_add_f32 v[32:33], v[32:33], v[96:97]
    v_pk_add_f32 v[34:35], v[34:35], v[98:99]
    s_waitcnt lgkmcnt(0)
    s_barrier
    ds_read_b128 v[52:55], v8 offset:4096
    ds_read_b128 v[56:59], v8 offset:5120
    ds_read_b128 v[60:63], v8 offset:6144
    ds_read_b128 v[64:67], v8 offset:7168
    ds_read_b128 v[68:71], v8 offset:12288
    ds_read_b128 v[72:75], v8 offset:13312
    ds_read_b128 v[76:79], v8 offset:14336
    ds_read_b128 v[80:83], v8 offset:15360
    ds_read_b128 v[84:87], v8 offset:20480
    ds_read_b128 v[88:91], v8 offset:21504
    ds_read_b128 v[92:95], v8 offset:22528
    ds_read_b128 v[96:99], v8 offset:23552
    v_pk_mul_f32 v[100:101], v[20:21], v[20:21]
    v_pk_mul_f32 v[102:103], v[22:23], v[22:23]
    v_pk_mul_f32 v[104:105], v[24:25], v[24:25]
    v_pk_mul_f32 v[106:107], v[26:27], v[26:27]
    v_pk_mul_f32 v[108:109], v[28:29], v[28:29]
    v_pk_mul_f32 v[110:111], v[30:31], v[30:31]
    v_pk_mul_f32 v[112:113], v[32:33], v[32:33]
    v_pk_mul_f32 v[114:115], v[34:35], v[34:35]
    v_pk_fma_f32 v[100:101], v[100:101], s[28:29], v[18:19]
    v_pk_fma_f32 v[102:103], v[102:103], s[28:29], v[18:19]
    v_pk_fma_f32 v[104:105], v[104:105], s[28:29], v[18:19]
    v_pk_fma_f32 v[106:107], v[106:107], s[28:29], v[18:19]
    v_pk_fma_f32 v[108:109], v[108:109], s[28:29], v[18:19]
    v_pk_fma_f32 v[110:111], v[110:111], s[28:29], v[18:19]
    v_pk_fma_f32 v[112:113], v[112:113], s[28:29], v[18:19]
    v_pk_fma_f32 v[114:115], v[114:115], s[28:29], v[18:19]
    v_pk_mul_f32 v[100:101], v[100:101], v[20:21]
    v_pk_mul_f32 v[102:103], v[102:103], v[22:23]
    v_pk_mul_f32 v[104:105], v[104:105], v[24:25]
    v_pk_mul_f32 v[106:107], v[106:107], v[26:27]
    v_pk_mul_f32 v[108:109], v[108:109], v[28:29]
    v_pk_mul_f32 v[110:111], v[110:111], v[30:31]
    v_pk_mul_f32 v[112:113], v[112:113], v[32:33]
    v_pk_mul_f32 v[114:115], v[114:115], v[34:35]
    v_exp_f32 v100, v100
    v_exp_f32 v101, v101
    v_exp_f32 v102, v102
    v_exp_f32 v103, v103
    v_exp_f32 v104, v104
    v_exp_f32 v105, v105
    v_exp_f32 v106, v106
    v_exp_f32 v107, v107
    v_exp_f32 v108, v108
    v_exp_f32 v109, v109
    v_exp_f32 v110, v110
    v_exp_f32 v111, v111
    v_exp_f32 v112, v112
    v_exp_f32 v113, v113
    v_exp_f32 v114, v114
    v_exp_f32 v115, v115
    v_pk_add_f32 v[100:101], v[100:101], 1.0 op_sel_hi:[1,0]
    v_pk_add_f32 v[102:103], v[102:103], 1.0 op_sel_hi:[1,0]
    v_pk_add_f32 v[104:105], v[104:105], 1.0 op_sel_hi:[1,0]
    v_pk_add_f32 v[106:107], v[106:107], 1.0 op_sel_hi:[1,0]
    v_pk_add_f32 v[108:109], v[108:109], 1.0 op_sel_hi:[1,0]
    v_pk_add_f32 v[110:111], v[110:111], 1.0 op_sel_hi:[1,0]
    v_pk_add_f32 v[112:113], v[112:113], 1.0 op_sel_hi:[1,0]
    v_pk_add_f32 v[114:115], v[114:115], 1.0 op_sel_hi:[1,0]
    v_rcp_f32 v100, v100
    v_rcp_f32 v101, v101
    v_rcp_f32 v102, v102
    v_rcp_f32 v103, v103
    v_rcp_f32 v104, v104
    v_rcp_f32 v105, v105
    v_rcp_f32 v106, v106
    v_rcp_f32 v107, v107
    v_rcp_f32 v108, v108
    v_rcp_f32 v109, v109
    v_rcp_f32 v110, v110
    v_rcp_f32 v111, v111
    v_rcp_f32 v112, v112
    v_rcp_f32 v113, v113
    v_rcp_f32 v114, v114
    v_rcp_f32 v115, v115
    v_pk_mul_f32 v[100:101], v[100:101], v[20:21]
    v_pk_mul_f32 v[102:103], v[102:103], v[22:23]
    v_pk_mul_f32 v[104:105], v[104:105], v[24:25]
    v_pk_mul_f32 v[106:107], v[106:107], v[26:27]
    v_pk_mul_f32 v[108:109], v[108:109], v[28:29]
    v_pk_mul_f32 v[110:111], v[110:111], v[30:31]
    v_pk_mul_f32 v[112:113], v[112:113], v[32:33]
    v_pk_mul_f32 v[114:115], v[114:115], v[34:35]
    v_cvt_pk_bf16_f32 v116, v100, v101
    v_cvt_pk_bf16_f32 v117, v102, v103
    ds_write_b64 v12, v[116:117] offset:0
    v_cvt_pk_bf16_f32 v118, v104, v105
    v_cvt_pk_bf16_f32 v119, v106, v107
    ds_write_b64 v13, v[118:119] offset:0
    v_cvt_pk_bf16_f32 v120, v108, v109
    v_cvt_pk_bf16_f32 v121, v110, v111
    ds_write_b64 v14, v[120:121] offset:0
    v_cvt_pk_bf16_f32 v122, v112, v113
    v_cvt_pk_bf16_f32 v123, v114, v115
    ds_write_b64 v15, v[122:123] offset:0
    s_waitcnt lgkmcnt(0)
    ds_read_b128 v[124:127], v16 offset:0
    ds_read_b128 v[128:131], v16 offset:1024
    v_add_u32 v9, 0, v5
    v_cmp_gt_u32 vcc, s30, v9
    v_add_u32 v9, s20, v9
    v_lshl_add_u32 v9, v9, 10, v6
    v_cndmask_b32 v9, v7, v9, vcc
    s_waitcnt lgkmcnt(1)
    buffer_store_dwordx4 v[124:127], v9, s[12:15], 0 offen sc0 sc1
    v_add_u32 v9, 64, v5
    v_cmp_gt_u32 vcc, s30, v9
    v_add_u32 v9, s20, v9
    v_lshl_add_u32 v9, v9, 10, v6
    v_cndmask_b32 v9, v7, v9, vcc
    s_waitcnt lgkmcnt(0)
    buffer_store_dwordx4 v[128:131], v9, s[12:15], 0 offen sc0 sc1
    v_pk_add_f32 v[36:37], v[36:37], v[52:53]
    v_pk_add_f32 v[38:39], v[38:39], v[54:55]
    v_pk_add_f32 v[40:41], v[40:41], v[56:57]
    v_pk_add_f32 v[42:43], v[42:43], v[58:59]
    v_pk_add_f32 v[44:45], v[44:45], v[60:61]
    v_pk_add_f32 v[46:47], v[46:47], v[62:63]
    v_pk_add_f32 v[48:49], v[48:49], v[64:65]
    v_pk_add_f32 v[50:51], v[50:51], v[66:67]
    v_pk_add_f32 v[36:37], v[36:37], v[68:69]
    v_pk_add_f32 v[38:39], v[38:39], v[70:71]
    v_pk_add_f32 v[40:41], v[40:41], v[72:73]
    v_pk_add_f32 v[42:43], v[42:43], v[74:75]
    v_pk_add_f32 v[44:45], v[44:45], v[76:77]
    v_pk_add_f32 v[46:47], v[46:47], v[78:79]
    v_pk_add_f32 v[48:49], v[48:49], v[80:81]
    v_pk_add_f32 v[50:51], v[50:51], v[82:83]
    v_pk_add_f32 v[36:37], v[36:37], v[84:85]
    v_pk_add_f32 v[38:39], v[38:39], v[86:87]
    v_pk_add_f32 v[40:41], v[40:41], v[88:89]
    v_pk_add_f32 v[42:43], v[42:43], v[90:91]
    v_pk_add_f32 v[44:45], v[44:45], v[92:93]
    v_pk_add_f32 v[46:47], v[46:47], v[94:95]
    v_pk_add_f32 v[48:49], v[48:49], v[96:97]
    v_pk_add_f32 v[50:51], v[50:51], v[98:99]
    v_pk_mul_f32 v[100:101], v[36:37], v[36:37]
    v_pk_mul_f32 v[102:103], v[38:39], v[38:39]
    v_pk_mul_f32 v[104:105], v[40:41], v[40:41]
    v_pk_mul_f32 v[106:107], v[42:43], v[42:43]
    v_pk_mul_f32 v[108:109], v[44:45], v[44:45]
    v_pk_mul_f32 v[110:111], v[46:47], v[46:47]
    v_pk_mul_f32 v[112:113], v[48:49], v[48:49]
    v_pk_mul_f32 v[114:115], v[50:51], v[50:51]
    v_pk_fma_f32 v[100:101], v[100:101], s[28:29], v[18:19]
    v_pk_fma_f32 v[102:103], v[102:103], s[28:29], v[18:19]
    v_pk_fma_f32 v[104:105], v[104:105], s[28:29], v[18:19]
    v_pk_fma_f32 v[106:107], v[106:107], s[28:29], v[18:19]
    v_pk_fma_f32 v[108:109], v[108:109], s[28:29], v[18:19]
    v_pk_fma_f32 v[110:111], v[110:111], s[28:29], v[18:19]
    v_pk_fma_f32 v[112:113], v[112:113], s[28:29], v[18:19]
    v_pk_fma_f32 v[114:115], v[114:115], s[28:29], v[18:19]
    v_pk_mul_f32 v[100:101], v[100:101], v[36:37]
    v_pk_mul_f32 v[102:103], v[102:103], v[38:39]
    v_pk_mul_f32 v[104:105], v[104:105], v[40:41]
    v_pk_mul_f32 v[106:107], v[106:107], v[42:43]
    v_pk_mul_f32 v[108:109], v[108:109], v[44:45]
    v_pk_mul_f32 v[110:111], v[110:111], v[46:47]
    v_pk_mul_f32 v[112:113], v[112:113], v[48:49]
    v_pk_mul_f32 v[114:115], v[114:115], v[50:51]
    v_exp_f32 v100, v100
    v_exp_f32 v101, v101
    v_exp_f32 v102, v102
    v_exp_f32 v103, v103
    v_exp_f32 v104, v104
    v_exp_f32 v105, v105
    v_exp_f32 v106, v106
    v_exp_f32 v107, v107
    v_exp_f32 v108, v108
    v_exp_f32 v109, v109
    v_exp_f32 v110, v110
    v_exp_f32 v111, v111
    v_exp_f32 v112, v112
    v_exp_f32 v113, v113
    v_exp_f32 v114, v114
    v_exp_f32 v115, v115
    v_pk_add_f32 v[100:101], v[100:101], 1.0 op_sel_hi:[1,0]
    v_pk_add_f32 v[102:103], v[102:103], 1.0 op_sel_hi:[1,0]
    v_pk_add_f32 v[104:105], v[104:105], 1.0 op_sel_hi:[1,0]
    v_pk_add_f32 v[106:107], v[106:107], 1.0 op_sel_hi:[1,0]
    v_pk_add_f32 v[108:109], v[108:109], 1.0 op_sel_hi:[1,0]
    v_pk_add_f32 v[110:111], v[110:111], 1.0 op_sel_hi:[1,0]
    v_pk_add_f32 v[112:113], v[112:113], 1.0 op_sel_hi:[1,0]
    v_pk_add_f32 v[114:115], v[114:115], 1.0 op_sel_hi:[1,0]
    v_rcp_f32 v100, v100
    v_rcp_f32 v101, v101
    v_rcp_f32 v102, v102
    v_rcp_f32 v103, v103
    v_rcp_f32 v104, v104
    v_rcp_f32 v105, v105
    v_rcp_f32 v106, v106
    v_rcp_f32 v107, v107
    v_rcp_f32 v108, v108
    v_rcp_f32 v109, v109
    v_rcp_f32 v110, v110
    v_rcp_f32 v111, v111
    v_rcp_f32 v112, v112
    v_rcp_f32 v113, v113
    v_rcp_f32 v114, v114
    v_rcp_f32 v115, v115
    v_pk_mul_f32 v[100:101], v[100:101], v[36:37]
    v_pk_mul_f32 v[102:103], v[102:103], v[38:39]
    v_pk_mul_f32 v[104:105], v[104:105], v[40:41]
    v_pk_mul_f32 v[106:107], v[106:107], v[42:43]
    v_pk_mul_f32 v[108:109], v[108:109], v[44:45]
    v_pk_mul_f32 v[110:111], v[110:111], v[46:47]
    v_pk_mul_f32 v[112:113], v[112:113], v[48:49]
    v_pk_mul_f32 v[114:115], v[114:115], v[50:51]
    v_cvt_pk_bf16_f32 v116, v100, v101
    v_cvt_pk_bf16_f32 v117, v102, v103
    ds_write_b64 v12, v[116:117] offset:2048
    v_cvt_pk_bf16_f32 v118, v104, v105
    v_cvt_pk_bf16_f32 v119, v106, v107
    ds_write_b64 v13, v[118:119] offset:2048
    v_cvt_pk_bf16_f32 v120, v108, v109
    v_cvt_pk_bf16_f32 v121, v110, v111
    ds_write_b64 v14, v[120:121] offset:2048
    v_cvt_pk_bf16_f32 v122, v112, v113
    v_cvt_pk_bf16_f32 v123, v114, v115
    ds_write_b64 v15, v[122:123] offset:2048
    s_waitcnt lgkmcnt(0)
    ds_read_b128 v[124:127], v16 offset:2048
    ds_read_b128 v[128:131], v16 offset:3072
    v_add_u32 v9, 1, v5
    v_cmp_gt_u32 vcc, s30, v9
    v_add_u32 v9, s20, v9
    v_lshl_add_u32 v9, v9, 10, v6
    v_cndmask_b32 v9, v7, v9, vcc
    s_waitcnt lgkmcnt(1)
    buffer_store_dwordx4 v[124:127], v9, s[12:15], 0 offen sc0 sc1
    v_add_u32 v9, 65, v5
    v_cmp_gt_u32 vcc, s30, v9
    v_add_u32 v9, s20, v9
    v_lshl_add_u32 v9, v9, 10, v6
    v_cndmask_b32 v9, v7, v9, vcc
    s_waitcnt lgkmcnt(0)
    buffer_store_dwordx4 v[128:131], v9, s[12:15], 0 offen sc0 sc1
    s_lshl_b32 s101, s17, 3
    s_add_u32 s101, s101, s18
    s_lshl_b32 s101, s101, 2
    s_add_u32 s101, s101, 8192
    s_load_dwordx2 s[4:5], s[0:1], 72
    s_load_dwordx2 s[8:9], s[0:1], 72
    s_load_dwordx2 s[12:13], s[0:1], 72
    s_and_b32 s18, s2, 3
    s_lshl_b32 s18, s18, 2
    s_bfe_u32 s27, s2, 0x20003
    s_add_u32 s18, s18, s27
    s_lshr_b32 s17, s2, 5
    s_bfe_u32 s27, s2, 0x10002
    s_lshl_b32 s27, s27, 3
    s_add_u32 s17, s17, s27
    s_lshr_b32 s19, s17, 3
    s_and_b32 s20, s17, 7
    s_mul_i32 s20, s20, 126
    v_and_b32 v1, 15, v0
    v_lshrrev_b32 v2, 4, v0
    s_lshl_b32 s27, s16, 2
    s_add_u32 s27, s27, s20
    v_add_u32 v3, s27, v2
    v_lshlrev_b32 v3, 11, v3
    v_subrev_u32 v3, 7168, v3
    s_lshr_b32 s28, s16, 1
    s_lshl_b32 s28, s28, 1
    v_xor_b32 v4, s28, v1
    v_lshlrev_b32 v4, 4, v4
    s_lshl_b32 s24, s16, 10
    s_mov_b32 s26, 0
    s_mul_i32 s27, s19, 2048000
    v_xor_b32 v5, 0, v4
    v_add_u32 v20, v5, v3
    v_xor_b32 v5, 64, v4
    v_add_u32 v21, v5, v3
    v_add_u32 v21, 32768, v21
    v_xor_b32 v5, 128, v4
    v_add_u32 v22, v5, v3
    v_add_u32 v22, 65536, v22
    v_xor_b32 v5, 192, v4
    v_add_u32 v23, v5, v3
    v_add_u32 v23, 98304, v23
    v_add_u32 v24, 131072, v20
    v_add_u32 v25, 131072, v21
    v_add_u32 v26, 131072, v22
    v_add_u32 v27, 131072, v23
    s_and_b32 s25, s16, 1
    s_lshl_b32 s29, s25, 2
    s_add_u32 s29, s29, s20
    s_add_u32 s29, s29, 128
    v_add_u32 v5, s29, v2
    v_lshlrev_b32 v5, 11, v5
    v_subrev_u32 v5, 7168, v5
    v_lshl_add_u32 v28, v1, 4, v5
    s_add_u32 s25, s25, 32
    s_lshl_b32 s25, s25, 10
    v_lshlrev_b32 v12, 4, v0
    s_lshl_b32 s21, s16, 11
    s_mul_i32 s28, s18, 491520
    s_add_u32 s21, s21, s28
    s_mov_b32 s10, 9453568
    s_mov_b32 s11, 0x00020000
    s_mov_b32 s6, 2048000
    s_mov_b32 s7, 0x00020000
    s_waitcnt lgkmcnt(0)
    s_add_u32 s8, s8, 16777216
    s_addc_u32 s9, s9, 0
    s_add_u32 s4, s4, s27
    s_addc_u32 s5, s5, 0
    s_add_u32 s92, s12, 11534336
    s_addc_u32 s93, s13, 0
    s_mov_b32 s94, 24576
    s_mov_b32 s95, 0x00020000
    s_waitcnt vmcnt(4)
    v_xor_b32 v180, s100, v180
    v_xor_b32 v181, s100, v181
    v_xor_b32 v182, s100, v182
    v_xor_b32 v183, s100, v183
    v_or_b32 v180, v180, v181
    v_or_b32 v182, v182, v183
    v_or_b32 v180, v180, v182
    v_cmp_ne_u32 vcc, 0, v180
    s_nop 4
    s_cbranch_vccz p2_chk2
    s_mov_b32 s27, 0x20000
p2_poll3:
    buffer_load_dwordx4 v[180:183], v184, s[92:95], 0 offen sc1
    s_waitcnt vmcnt(0)
    v_xor_b32 v180, s100, v180
    v_xor_b32 v181, s100, v181
    v_xor_b32 v182, s100, v182
    v_xor_b32 v183, s100, v183
    v_or_b32 v180, v180, v181
    v_or_b32 v182, v182, v183
    v_or_b32 v180, v180, v182
    v_cmp_ne_u32 vcc, 0, v180
    s_sub_u32 s27, s27, 1
    s_cmp_eq_u32 s27, 0
    s_cbranch_scc1 p2_poll3_done
    s_cbranch_vccz p2_poll3_done
    s_sleep 4
    s_branch p2_poll3
p2_poll3_done:
p2_chk2:
    s_waitcnt vmcnt(0)
    s_barrier
    s_cmp_lg_u32 s16, 0
    s_cbranch_scc1 p1_sig4
    v_mov_b32 v64, s100
    v_mov_b32 v65, 0
    s_mov_b64 exec, 1
    buffer_store_dword v64, v65, s[92:95], s101 offen sc0 sc1
    s_mov_b64 exec, -1
p1_sig4:
    s_and_b32 s88, s2, 7
    s_cmp_lg_u32 s88, 0
    s_cbranch_scc1 p2_noge0
    s_cmp_lg_u32 s16, 3
    s_cbranch_scc1 p2_noge0
    s_lshr_b32 s88, s2, 5
    s_bfe_u32 s89, s2, 0x20003
    v_lshlrev_b32 v164, 4, v0
    s_lshl_b32 s90, s88, 12
    s_lshl_b32 s91, s89, 10
    s_add_u32 s90, s90, s91
    s_add_u32 s90, s90, 8912896
    s_mov_b32 s86, 9437184
    s_add_u32 s91, s90, 0
    buffer_load_dwordx4 v[168:171], v164, s[8:11], s91 offen
    buffer_load_dwordx4 a[64:67], v164, s[8:11], s86 offen offset:0
    s_add_u32 s91, s90, 32768
    buffer_load_dwordx4 v[172:175], v164, s[8:11], s91 offen
    buffer_load_dwordx4 a[68:71], v164, s[8:11], s86 offen offset:1024
    s_add_u32 s91, s90, 65536
    buffer_load_dwordx4 v[176:179], v164, s[8:11], s91 offen
    buffer_load_dwordx4 a[72:75], v164, s[8:11], s86 offen offset:2048
    s_add_u32 s91, s90, 98304
    buffer_load_dwordx4 v[180:183], v164, s[8:11], s91 offen
    buffer_load_dwordx4 a[76:79], v164, s[8:11], s86 offen offset:3072
    s_add_u32 s86, s86, 4096
    s_add_u32 s91, s90, 131072
    buffer_load_dwordx4 v[184:187], v164, s[8:11], s91 offen
    buffer_load_dwordx4 a[80:83], v164, s[8:11], s86 offen offset:0
    s_add_u32 s91, s90, 163840
    buffer_load_dwordx4 v[188:191], v164, s[8:11], s91 offen
    buffer_load_dwordx4 a[84:87], v164, s[8:11], s86 offen offset:1024
    s_add_u32 s91, s90, 196608
    buffer_load_dwordx4 v[192:195], v164, s[8:11], s91 offen
    buffer_load_dwordx4 a[88:91], v164, s[8:11], s86 offen offset:2048
    s_add_u32 s91, s90, 229376
    buffer_load_dwordx4 v[196:199], v164, s[8:11], s91 offen
    buffer_load_dwordx4 a[92:95], v164, s[8:11], s86 offen offset:3072
    s_add_u32 s86, s86, 4096
    s_add_u32 s91, s90, 262144
    buffer_load_dwordx4 v[200:203], v164, s[8:11], s91 offen
    buffer_load_dwordx4 a[96:99], v164, s[8:11], s86 offen offset:0
    s_add_u32 s91, s90, 294912
    buffer_load_dwordx4 v[204:207], v164, s[8:11], s91 offen
    buffer_load_dwordx4 a[100:103], v164, s[8:11], s86 offen offset:1024
    s_add_u32 s91, s90, 327680
    buffer_load_dwordx4 v[208:211], v164, s[8:11], s91 offen
    buffer_load_dwordx4 a[104:107], v164, s[8:11], s86 offen offset:2048
    s_add_u32 s91, s90, 360448
    buffer_load_dwordx4 v[212:215], v164, s[8:11], s91 offen
    buffer_load_dwordx4 a[108:111], v164, s[8:11], s86 offen offset:3072
    s_add_u32 s86, s86, 4096
    s_add_u32 s91, s90, 393216
    buffer_load_dwordx4 v[216:219], v164, s[8:11], s91 offen
    buffer_load_dwordx4 a[112:115], v164, s[8:11], s86 offen offset:0
    s_add_u32 s91, s90, 425984
    buffer_load_dwordx4 v[220:223], v164, s[8:11], s91 offen
    buffer_load_dwordx4 a[116:119], v164, s[8:11], s86 offen offset:1024
    s_add_u32 s91, s90, 458752
    buffer_load_dwordx4 v[224:227], v164, s[8:11], s91 offen
    buffer_load_dwordx4 a[120:123], v164, s[8:11], s86 offen offset:2048
    s_add_u32 s91, s90, 491520
    buffer_load_dwordx4 v[228:231], v164, s[8:11], s91 offen
    buffer_load_dwordx4 a[124:127], v164, s[8:11], s86 offen offset:3072
    s_add_u32 s86, s86, 4096
p2_noge0:
    s_add_u32 s22, s21, 0
    s_nop 0
    buffer_load_dwordx4 v[92:95], v12, s[8:11], s22 offen offset:0
    buffer_load_dwordx4 v[96:99], v12, s[8:11], s22 offen offset:1024
    s_add_u32 s22, s21, 65536
    s_nop 0
    buffer_load_dwordx4 v[100:103], v12, s[8:11], s22 offen offset:0
    buffer_load_dwordx4 v[104:107], v12, s[8:11], s22 offen offset:1024
    s_add_u32 s22, s21, 131072
    s_nop 0
    buffer_load_dwordx4 v[108:111], v12, s[8:11], s22 offen offset:0
    buffer_load_dwordx4 v[112:115], v12, s[8:11], s22 offen offset:1024
    s_add_u32 s22, s21, 196608
    s_nop 0
    buffer_load_dwordx4 v[116:119], v12, s[8:11], s22 offen offset:0
    buffer_load_dwordx4 v[120:123], v12, s[8:11], s22 offen offset:1024
    s_add_u32 s22, s21, 262144
    s_nop 0
    buffer_load_dwordx4 v[124:127], v12, s[8:11], s22 offen offset:0
    buffer_load_dwordx4 v[128:131], v12, s[8:11], s22 offen offset:1024
    s_add_u32 s22, s21, 327680
    s_nop 0
    buffer_load_dwordx4 v[132:135], v12, s[8:11], s22 offen offset:0
    buffer_load_dwordx4 v[136:139], v12, s[8:11], s22 offen offset:1024
    s_add_u32 s22, s21, 393216
    s_nop 0
    buffer_load_dwordx4 v[140:143], v12, s[8:11], s22 offen offset:0
    buffer_load_dwordx4 v[144:147], v12, s[8:11], s22 offen offset:1024
    s_and_b32 s88, s2, 7
    s_cmp_lg_u32 s88, 0
    s_cbranch_scc1 p2_noge1
    s_cmp_lg_u32 s16, 3
    s_cbranch_scc1 p2_noge1
    s_lshr_b32 s88, s2, 5
    s_bfe_u32 s89, s2, 0x20003
    s_waitcnt vmcnt(0)
    v_mfma_f32_16x16x32_bf16 v[232:235], v[168:171], a[64:67], 0
    v_mfma_f32_16x16x32_bf16 v[232:235], v[172:175], a[68:71], v[232:235]
    v_mfma_f32_16x16x32_bf16 v[232:235], v[176:179], a[72:75], v[232:235]
    v_mfma_f32_16x16x32_bf16 v[232:235], v[180:183], a[76:79], v[232:235]
    v_mfma_f32_16x16x32_bf16 v[232:235], v[184:187], a[80:83], v[232:235]
    v_mfma_f32_16x16x32_bf16 v[232:235], v[188:191], a[84:87], v[232:235]
    v_mfma_f32_16x16x32_bf16 v[232:235], v[192:195], a[88:91], v[232:235]
    v_mfma_f32_16x16x32_bf16 v[232:235], v[196:199], a[92:95], v[232:235]
    v_mfma_f32_16x16x32_bf16 v[232:235], v[200:203], a[96:99], v[232:235]
    v_mfma_f32_16x16x32_bf16 v[232:235], v[204:207], a[100:103], v[232:235]
    v_mfma_f32_16x16x32_bf16 v[232:235], v[208:211], a[104:107], v[232:235]
    v_mfma_f32_16x16x32_bf16 v[232:235], v[212:215], a[108:111], v[232:235]
    v_mfma_f32_16x16x32_bf16 v[232:235], v[216:219], a[112:115], v[232:235]
    v_mfma_f32_16x16x32_bf16 v[232:235], v[220:223], a[116:119], v[232:235]
    v_mfma_f32_16x16x32_bf16 v[232:235], v[224:227], a[120:123], v[232:235]
    v_mfma_f32_16x16x32_bf16 v[232:235], v[228:231], a[124:127], v[232:235]
    s_mov_b32 s84, s12
    s_mov_b32 s85, s13
    s_mov_b32 s86, 10559488
    s_mov_b32 s87, 0x00020000
    v_lshlrev_b32 v165, 11, v1
    v_lshl_add_u32 v165, v2, 6, v165
    s_lshl_b32 s90, s88, 8
    s_lshl_b32 s91, s89, 2
    s_add_u32 s90, s90, s91
    s_nop 3
    s_mov_b32 s91, 0x4038aa3b
    v_mul_f32 v232, s91, v232
    v_mul_f32 v233, s91, v233
    v_mul_f32 v234, s91, v234
    v_mul_f32 v235, s91, v235
    s_add_u32 s91, s90, 10485760
    buffer_store_dword v232, v165, s[84:87], s91 offen offset:0 sc0 sc1
    buffer_store_dword v233, v165, s[84:87], s91 offen offset:16 sc0 sc1
    buffer_store_dword v234, v165, s[84:87], s91 offen offset:32 sc0 sc1
    buffer_store_dword v235, v165, s[84:87], s91 offen offset:48 sc0 sc1
    v_max3_f32 v166, |v232|, |v233|, |v234|
    v_max3_f32 v166, v166, |v235|, |v235|
    s_mov_b32 s88, 0x42fc0000
    v_cmp_le_f32 vcc, s88, v166
    s_nop 4
    s_cmp_lg_u64 vcc, 0
    s_cselect_b32 s88, 1, 0
    v_exp_f32 v236, v232
    v_exp_f32 v237, v233
    v_exp_f32 v238, v234
    v_exp_f32 v239, v235
    s_add_u32 s91, s90, 10518528
    s_nop 0
    buffer_store_dword v236, v165, s[84:87], s91 offen offset:0 sc0 sc1
    buffer_store_dword v237, v165, s[84:87], s91 offen offset:16 sc0 sc1
    buffer_store_dword v238, v165, s[84:87], s91 offen offset:32 sc0 sc1
    buffer_store_dword v239, v165, s[84:87], s91 offen offset:48 sc0 sc1
    v_mov_b32 v166, s88
    v_mov_b32 v167, 0
    s_lshr_b32 s91, s2, 3
    s_lshl_b32 s91, s91, 2
    s_add_u32 s91, s91, 10555392
    s_mov_b64 exec, 1
    buffer_store_dword v166, v167, s[84:87], s91 offen sc0 sc1
    s_mov_b64 exec, -1
p2_noge1:
    s_and_b32 s28, s17, 7
    s_lshl_b32 s28, s28, 1
    s_sub_u32 s28, s28, 1
    v_lshrrev_b32 v5, 1, v0
    v_add_u32 v5, s28, v5
    v_cmp_gt_u32 vcc, 16, v5
    s_nop 3
    s_and_b32 s56, vcc_lo, 0xff
    s_mov_b32 s57, 0
    s_lshl_b32 s29, s19, 4
    v_add_u32 v5, s29, v5
    v_lshlrev_b32 v5, 3, v5
    v_and_b32 v6, 1, v0
    v_add_u32 v5, v5, v6
    v_lshlrev_b32 v5, 2, v5
    v_add_u32 v244, 8192, v5
    v_add_u32 v245, 8208, v5
    v_add_u32 v246, 8216, v5
    v_add_u32 v247, 8200, v5
    v_mov_b32 v5, v244
    s_mov_b64 s[30:31], s[56:57]
    s_mov_b64 exec, s[30:31]
    s_mov_b32 s27, 0x20000
p2_poll5:
    buffer_load_dword v64, v5, s[92:95], 0 offen sc1
    s_waitcnt vmcnt(0)
    v_cmp_ne_u32 vcc, s100, v64
    s_sub_u32 s27, s27, 1
    s_cmp_eq_u32 s27, 0
    s_cbranch_scc1 p2_poll5_done
    s_cbranch_vccz p2_poll5_done
    s_sleep 4
    s_branch p2_poll5
p2_poll5_done:
    s_mov_b64 exec, -1
    s_add_u32 m0, s24, 0
    s_nop 0
    buffer_load_dwordx4 v20, s[4:7], s26 offen lds
    s_add_u32 m0, s24, 4096
    s_nop 0
    buffer_load_dwordx4 v21, s[4:7], s26 offen lds
    s_add_u32 m0, s24, 8192
    s_nop 0
    buffer_load_dwordx4 v22, s[4:7], s26 offen lds
    s_add_u32 m0, s24, 12288
    s_nop 0
    buffer_load_dwordx4 v23, s[4:7], s26 offen lds
    s_add_u32 m0, s24, 16384
    s_nop 0
    buffer_load_dwordx4 v24, s[4:7], s26 offen lds
    s_add_u32 m0, s24, 20480
    s_nop 0
    buffer_load_dwordx4 v25, s[4:7], s26 offen lds
    s_add_u32 m0, s24, 24576
    s_nop 0
    buffer_load_dwordx4 v26, s[4:7], s26 offen lds
    s_add_u32 m0, s24, 28672
    s_nop 0
    buffer_load_dwordx4 v27, s[4:7], s26 offen lds
    s_add_u32 m0, s25, 0
    s_nop 0
    buffer_load_dwordx4 v28, s[4:7], s26 offen lds
    s_and_b32 s88, s2, 7
    s_cmp_lg_u32 s88, 0
    s_cbranch_scc1 p2_nogs
    s_cmp_lg_u32 s16, 3
    s_cbranch_scc1 p2_nogs
    v_mov_b32 v166, s100
    v_mov_b32 v167, 0
    s_lshr_b32 s91, s2, 3
    s_lshl_b32 s91, s91, 2
    s_add_u32 s91, s91, 20480
    s_mov_b64 exec, 1
    buffer_store_dword v166, v167, s[92:95], s91 offen sc0 sc1
    s_mov_b64 exec, -1
p2_nogs:
    v_add_u32 v29, 1024, v20
    v_add_u32 v30, 1024, v21
    v_add_u32 v31, 1024, v22
    v_add_u32 v32, 1024, v23
    v_add_u32 v33, 1024, v24
    v_add_u32 v34, 1024, v25
    v_add_u32 v35, 1024, v26
    v_add_u32 v36, 1024, v27
    v_add_u32 v37, 1024, v28
    s_lshl_b32 s28, s16, 2
    v_add_u32 v3, s28, v2
    v_lshlrev_b32 v6, 11, v1
    v_add_u32 v4, 0, v1
    v_and_b32 v4, 7, v4
    v_lshlrev_b32 v4, 1, v4
    v_xor_b32 v4, v4, v3
    v_lshl_add_u32 v8, v4, 4, v6
    v_add_u32 v4, 1, v1
    v_and_b32 v4, 7, v4
    v_lshlrev_b32 v4, 1, v4
    v_xor_b32 v4, v4, v3
    v_lshl_add_u32 v9, v4, 4, v6
    s_waitcnt vmcnt(0)
    s_barrier
    ds_read_b128 v[40:43], v8 offset:0
    ds_read_b128 v[44:47], v8 offset:256
    ds_read_b128 v[48:51], v8 offset:512
    ds_read_b128 v[52:55], v8 offset:768
    ds_read_b128 v[56:59], v8 offset:1024
    ds_read_b128 v[60:63], v8 offset:1280
    ds_read_b128 v[64:67], v8 offset:1536
    ds_read_b128 v[68:71], v8 offset:1792
    s_waitcnt lgkmcnt(7)
    v_mfma_f32_16x16x32_bf16 a[0:3], v[92:95], v[40:43], 0
    v_mfma_f32_16x16x32_bf16 a[4:7], v[96:99], v[40:43], 0
    s_add_u32 s22, s21, 458752
    s_waitcnt lgkmcnt(6)
    v_mfma_f32_16x16x32_bf16 a[12:15], v[96:99], v[44:47], 0
    buffer_load_dwordx4 v[148:151], v12, s[8:11], s22 offen offset:0
    v_mfma_f32_16x16x32_bf16 a[8:11], v[92:95], v[44:47], 0
    buffer_load_dwordx4 v[152:155], v12, s[8:11], s22 offen offset:1024
    s_waitcnt lgkmcnt(5)
    v_mfma_f32_16x16x32_bf16 a[16:19], v[92:95], v[48:51], 0
    s_mov_b32 s26, 0
    v_mfma_f32_16x16x32_bf16 a[20:23], v[96:99], v[48:51], 0
    ds_read_b128 v[72:75], v9 offset:2048
    s_add_u32 m0, s24, 34816
    s_waitcnt lgkmcnt(5)
    v_mfma_f32_16x16x32_bf16 a[28:31], v[96:99], v[52:55], 0
    buffer_load_dwordx4 v29, s[4:7], s26 offen lds
    v_mfma_f32_16x16x32_bf16 a[24:27], v[92:95], v[52:55], 0
    s_add_u32 m0, s24, 38912
    s_waitcnt lgkmcnt(4)
    v_mfma_f32_16x16x32_bf16 a[32:35], v[92:95], v[56:59], 0
    buffer_load_dwordx4 v30, s[4:7], s26 offen lds
    v_mfma_f32_16x16x32_bf16 a[36:39], v[96:99], v[56:59], 0
    s_add_u32 m0, s24, 43008
    s_waitcnt lgkmcnt(3)
    v_mfma_f32_16x16x32_bf16 a[44:47], v[96:99], v[60:63], 0
    buffer_load_dwordx4 v31, s[4:7], s26 offen lds
    v_mfma_f32_16x16x32_bf16 a[40:43], v[92:95], v[60:63], 0
    s_waitcnt lgkmcnt(2)
    v_mfma_f32_16x16x32_bf16 a[48:51], v[92:95], v[64:67], 0
    v_mfma_f32_16x16x32_bf16 a[52:55], v[96:99], v[64:67], 0
    s_waitcnt lgkmcnt(1)
    v_mfma_f32_16x16x32_bf16 a[60:63], v[96:99], v[68:71], 0
    v_mfma_f32_16x16x32_bf16 a[56:59], v[92:95], v[68:71], 0
    v_mfma_f32_16x16x32_bf16 a[0:3], v[100:103], v[44:47], a[0:3]
    v_mfma_f32_16x16x32_bf16 a[4:7], v[104:107], v[44:47], a[4:7]
    s_add_u32 s22, s21, 32768
    v_mfma_f32_16x16x32_bf16 a[12:15], v[104:107], v[48:51], a[12:15]
    buffer_load_dwordx4 v[92:95], v12, s[8:11], s22 offen offset:0
    v_mfma_f32_16x16x32_bf16 a[8:11], v[100:103], v[48:51], a[8:11]
    buffer_load_dwordx4 v[96:99], v12, s[8:11], s22 offen offset:1024
    v_mfma_f32_16x16x32_bf16 a[16:19], v[100:103], v[52:55], a[16:19]
    s_add_u32 m0, s24, 47104
    v_mfma_f32_16x16x32_bf16 a[20:23], v[104:107], v[52:55], a[20:23]
    ds_read_b128 v[76:79], v9 offset:2304
    buffer_load_dwordx4 v32, s[4:7], s26 offen lds
    v_mfma_f32_16x16x32_bf16 a[28:31], v[104:107], v[56:59], a[28:31]
    s_add_u32 m0, s24, 51200
    v_mfma_f32_16x16x32_bf16 a[24:27], v[100:103], v[56:59], a[24:27]
    buffer_load_dwordx4 v33, s[4:7], s26 offen lds
    v_mfma_f32_16x16x32_bf16 a[32:35], v[100:103], v[60:63], a[32:35]
    s_add_u32 m0, s24, 55296
    v_mfma_f32_16x16x32_bf16 a[36:39], v[104:107], v[60:63], a[36:39]
    buffer_load_dwordx4 v34, s[4:7], s26 offen lds
    v_mfma_f32_16x16x32_bf16 a[44:47], v[104:107], v[64:67], a[44:47]
    v_mfma_f32_16x16x32_bf16 a[40:43], v[100:103], v[64:67], a[40:43]
    v_mfma_f32_16x16x32_bf16 a[48:51], v[100:103], v[68:71], a[48:51]
    v_mfma_f32_16x16x32_bf16 a[52:55], v[104:107], v[68:71], a[52:55]
    s_waitcnt lgkmcnt(1)
    v_mfma_f32_16x16x32_bf16 a[60:63], v[104:107], v[72:75], a[60:63]
    v_mfma_f32_16x16x32_bf16 a[56:59], v[100:103], v[72:75], a[56:59]
    v_mfma_f32_16x16x32_bf16 a[0:3], v[108:111], v[48:51], a[0:3]
    v_mfma_f32_16x16x32_bf16 a[4:7], v[112:115], v[48:51], a[4:7]
    s_add_u32 s22, s21, 98304
    v_mfma_f32_16x16x32_bf16 a[12:15], v[112:115], v[52:55], a[12:15]
    buffer_load_dwordx4 v[100:103], v12, s[8:11], s22 offen offset:0
    v_mfma_f32_16x16x32_bf16 a[8:11], v[108:111], v[52:55], a[8:11]
    buffer_load_dwordx4 v[104:107], v12, s[8:11], s22 offen offset:1024
    v_mfma_f32_16x16x32_bf16 a[16:19], v[108:111], v[56:59], a[16:19]
    s_add_u32 m0, s24, 59392
    v_mfma_f32_16x16x32_bf16 a[20:23], v[112:115], v[56:59], a[20:23]
    ds_read_b128 v[80:83], v9 offset:2560
    buffer_load_dwordx4 v35, s[4:7], s26 offen lds
    v_mfma_f32_16x16x32_bf16 a[28:31], v[112:115], v[60:63], a[28:31]
    s_add_u32 m0, s24, 63488
    v_mfma_f32_16x16x32_bf16 a[24:27], v[108:111], v[60:63], a[24:27]
    buffer_load_dwordx4 v36, s[4:7], s26 offen lds
    v_mfma_f32_16x16x32_bf16 a[32:35], v[108:111], v[64:67], a[32:35]
    s_add_u32 m0, s25, 34816
    v_mfma_f32_16x16x32_bf16 a[36:39], v[112:115], v[64:67], a[36:39]
    buffer_load_dwordx4 v37, s[4:7], s26 offen lds
    v_mfma_f32_16x16x32_bf16 a[44:47], v[112:115], v[68:71], a[44:47]
    v_mfma_f32_16x16x32_bf16 a[40:43], v[108:111], v[68:71], a[40:43]
    v_mfma_f32_16x16x32_bf16 a[48:51], v[108:111], v[72:75], a[48:51]
    v_mfma_f32_16x16x32_bf16 a[52:55], v[112:115], v[72:75], a[52:55]
    s_waitcnt lgkmcnt(1)
    v_mfma_f32_16x16x32_bf16 a[60:63], v[112:115], v[76:79], a[60:63]
    v_mfma_f32_16x16x32_bf16 a[56:59], v[108:111], v[76:79], a[56:59]
    v_mfma_f32_16x16x32_bf16 a[0:3], v[116:119], v[52:55], a[0:3]
    v_mfma_f32_16x16x32_bf16 a[4:7], v[120:123], v[52:55], a[4:7]
    s_add_u32 s22, s21, 163840
    v_mfma_f32_16x16x32_bf16 a[12:15], v[120:123], v[56:59], a[12:15]
    buffer_load_dwordx4 v[108:111], v12, s[8:11], s22 offen offset:0
    v_mfma_f32_16x16x32_bf16 a[8:11], v[116:119], v[56:59], a[8:11]
    buffer_load_dwordx4 v[112:115], v12, s[8:11], s22 offen offset:1024
    v_mfma_f32_16x16x32_bf16 a[16:19], v[116:119], v[60:63], a[16:19]
    s_mov_b64 exec, s[56:57]
    buffer_load_dword v248, v245, s[92:95], 0 offen sc1
    s_mov_b64 exec, -1
    v_mfma_f32_16x16x32_bf16 a[20:23], v[120:123], v[60:63], a[20:23]
    ds_read_b128 v[84:87], v9 offset:2816
    v_mfma_f32_16x16x32_bf16 a[28:31], v[120:123], v[64:67], a[28:31]
    v_mfma_f32_16x16x32_bf16 a[24:27], v[116:119], v[64:67], a[24:27]
    v_mfma_f32_16x16x32_bf16 a[32:35], v[116:119], v[68:71], a[32:35]
    v_mfma_f32_16x16x32_bf16 a[36:39], v[120:123], v[68:71], a[36:39]
    v_mfma_f32_16x16x32_bf16 a[44:47], v[120:123], v[72:75], a[44:47]
    v_mfma_f32_16x16x32_bf16 a[40:43], v[116:119], v[72:75], a[40:43]
    v_mfma_f32_16x16x32_bf16 a[48:51], v[116:119], v[76:79], a[48:51]
    v_mfma_f32_16x16x32_bf16 a[52:55], v[120:123], v[76:79], a[52:55]
    s_waitcnt lgkmcnt(1)
    v_mfma_f32_16x16x32_bf16 a[60:63], v[120:123], v[80:83], a[60:63]
    v_mfma_f32_16x16x32_bf16 a[56:59], v[116:119], v[80:83], a[56:59]
    v_mfma_f32_16x16x32_bf16 a[0:3], v[124:127], v[56:59], a[0:3]
    v_mfma_f32_16x16x32_bf16 a[4:7], v[128:131], v[56:59], a[4:7]
    s_add_u32 s22, s21, 229376
    v_mfma_f32_16x16x32_bf16 a[12:15], v[128:131], v[60:63], a[12:15]
    buffer_load_dwordx4 v[116:119], v12, s[8:11], s22 offen offset:0
    v_mfma_f32_16x16x32_bf16 a[8:11], v[124:127], v[60:63], a[8:11]
    buffer_load_dwordx4 v[120:123], v12, s[8:11], s22 offen offset:1024
    v_mfma_f32_16x16x32_bf16 a[16:19], v[124:127], v[64:67], a[16:19]
    v_mfma_f32_16x16x32_bf16 a[20:23], v[128:131], v[64:67], a[20:23]
    ds_read_b128 v[88:91], v9 offset:3072
    v_mfma_f32_16x16x32_bf16 a[28:31], v[128:131], v[68:71], a[28:31]
    v_mfma_f32_16x16x32_bf16 a[24:27], v[124:127], v[68:71], a[24:27]
    v_mfma_f32_16x16x32_bf16 a[32:35], v[124:127], v[72:75], a[32:35]
    v_mfma_f32_16x16x32_bf16 a[36:39], v[128:131], v[72:75], a[36:39]
    v_mfma_f32_16x16x32_bf16 a[44:47], v[128:131], v[76:79], a[44:47]
    v_mfma_f32_16x16x32_bf16 a[40:43], v[124:127], v[76:79], a[40:43]
    v_mfma_f32_16x16x32_bf16 a[48:51], v[124:127], v[80:83], a[48:51]
    v_mfma_f32_16x16x32_bf16 a[52:55], v[128:131], v[80:83], a[52:55]
    s_waitcnt lgkmcnt(1)
    v_mfma_f32_16x16x32_bf16 a[60:63], v[128:131], v[84:87], a[60:63]
    v_mfma_f32_16x16x32_bf16 a[56:59], v[124:127], v[84:87], a[56:59]
    v_mfma_f32_16x16x32_bf16 a[0:3], v[132:135], v[60:63], a[0:3]
    v_mfma_f32_16x16x32_bf16 a[4:7], v[136:139], v[60:63], a[4:7]
    s_add_u32 s22, s21, 294912
    v_mfma_f32_16x16x32_bf16 a[12:15], v[136:139], v[64:67], a[12:15]
    buffer_load_dwordx4 v[124:127], v12, s[8:11], s22 offen offset:0
    v_mfma_f32_16x16x32_bf16 a[8:11], v[132:135], v[64:67], a[8:11]
    buffer_load_dwordx4 v[128:131], v12, s[8:11], s22 offen offset:1024
    v_mfma_f32_16x16x32_bf16 a[16:19], v[132:135], v[68:71], a[16:19]
    v_mfma_f32_16x16x32_bf16 a[20:23], v[136:139], v[68:71], a[20:23]
    ds_read_b128 v[40:43], v9 offset:3328
    v_mfma_f32_16x16x32_bf16 a[28:31], v[136:139], v[72:75], a[28:31]
    v_mfma_f32_16x16x32_bf16 a[24:27], v[132:135], v[72:75], a[24:27]
    v_mfma_f32_16x16x32_bf16 a[32:35], v[132:135], v[76:79], a[32:35]
    v_mfma_f32_16x16x32_bf16 a[36:39], v[136:139], v[76:79], a[36:39]
    v_mfma_f32_16x16x32_bf16 a[44:47], v[136:139], v[80:83], a[44:47]
    v_mfma_f32_16x16x32_bf16 a[40:43], v[132:135], v[80:83], a[40:43]
    v_mfma_f32_16x16x32_bf16 a[48:51], v[132:135], v[84:87], a[48:51]
    v_mfma_f32_16x16x32_bf16 a[52:55], v[136:139], v[84:87], a[52:55]
    s_waitcnt lgkmcnt(1)
    v_mfma_f32_16x16x32_bf16 a[60:63], v[136:139], v[88:91], a[60:63]
    v_mfma_f32_16x16x32_bf16 a[56:59], v[132:135], v[88:91], a[56:59]
    v_mfma_f32_16x16x32_bf16 a[0:3], v[140:143], v[64:67], a[0:3]
    v_mfma_f32_16x16x32_bf16 a[4:7], v[144:147], v[64:67], a[4:7]
    s_add_u32 s22, s21, 360448
    v_mfma_f32_16x16x32_bf16 a[12:15], v[144:147], v[68:71], a[12:15]
    buffer_load_dwordx4 v[132:135], v12, s[8:11], s22 offen offset:0
    v_mfma_f32_16x16x32_bf16 a[8:11], v[140:143], v[68:71], a[8:11]
    buffer_load_dwordx4 v[136:139], v12, s[8:11], s22 offen offset:1024
    v_mfma_f32_16x16x32_bf16 a[16:19], v[140:143], v[72:75], a[16:19]
    v_mfma_f32_16x16x32_bf16 a[20:23], v[144:147], v[72:75], a[20:23]
    ds_read_b128 v[44:47], v9 offset:3584
    v_mfma_f32_16x16x32_bf16 a[28:31], v[144:147], v[76:79], a[28:31]
    v_mfma_f32_16x16x32_bf16 a[24:27], v[140:143], v[76:79], a[24:27]
    v_mfma_f32_16x16x32_bf16 a[32:35], v[140:143], v[80:83], a[32:35]
    v_mfma_f32_16x16x32_bf16 a[36:39], v[144:147], v[80:83], a[36:39]
    v_mfma_f32_16x16x32_bf16 a[44:47], v[144:147], v[84:87], a[44:47]
    v_mfma_f32_16x16x32_bf16 a[40:43], v[140:143], v[84:87], a[40:43]
    v_mfma_f32_16x16x32_bf16 a[48:51], v[140:143], v[88:91], a[48:51]
    v_mfma_f32_16x16x32_bf16 a[52:55], v[144:147], v[88:91], a[52:55]
    s_waitcnt lgkmcnt(1)
    v_mfma_f32_16x16x32_bf16 a[60:63], v[144:147], v[40:43], a[60:63]
    v_mfma_f32_16x16x32_bf16 a[56:59], v[140:143], v[40:43], a[56:59]
    s_waitcnt vmcnt(22)
    v_mfma_f32_16x16x32_bf16 a[0:3], v[148:151], v[68:71], a[0:3]
    s_waitcnt vmcnt(9) lgkmcnt(0)
    s_barrier
    v_mfma_f32_16x16x32_bf16 a[4:7], v[152:155], v[68:71], a[4:7]
    ds_read_b128 v[68:71], v8 offset:34816
    s_add_u32 s22, s21, 425984
    v_mfma_f32_16x16x32_bf16 a[12:15], v[152:155], v[72:75], a[12:15]
    buffer_load_dwordx4 v[140:143], v12, s[8:11], s22 offen offset:0
    v_mfma_f32_16x16x32_bf16 a[8:11], v[148:151], v[72:75], a[8:11]
    ds_read_b128 v[72:75], v8 offset:35072
    buffer_load_dwordx4 v[144:147], v12, s[8:11], s22 offen offset:1024
    v_mfma_f32_16x16x32_bf16 a[16:19], v[148:151], v[76:79], a[16:19]
    s_mov_b64 exec, s[56:57]
    s_waitcnt vmcnt(8)
    v_cmp_ne_u32 vcc, s100, v248
    s_nop 4
    s_cbranch_vccz p2_chk6
    s_mov_b32 s27, 0x20000
p2_poll7:
    buffer_load_dword v248, v245, s[92:95], 0 offen sc1
    s_waitcnt vmcnt(0)
    v_cmp_ne_u32 vcc, s100, v248
    s_sub_u32 s27, s27, 1
    s_cmp_eq_u32 s27, 0
    s_cbranch_scc1 p2_poll7_done
    s_cbranch_vccz p2_poll7_done
    s_sleep 4
    s_branch p2_poll7
p2_poll7_done:
p2_chk6:
    s_mov_b64 exec, -1
    v_mfma_f32_16x16x32_bf16 a[20:23], v[152:155], v[76:79], a[20:23]
    ds_read_b128 v[76:79], v8 offset:35328
    s_mov_b32 s26, 512
    v_mfma_f32_16x16x32_bf16 a[28:31], v[152:155], v[80:83], a[28:31]
    s_add_u32 m0, s24, 0
    v_mfma_f32_16x16x32_bf16 a[24:27], v[148:151], v[80:83], a[24:27]
    ds_read_b128 v[80:83], v8 offset:35584
    buffer_load_dwordx4 v20, s[4:7], s26 offen lds
    v_mfma_f32_16x16x32_bf16 a[32:35], v[148:151], v[84:87], a[32:35]
    s_add_u32 m0, s24, 4096
    v_mfma_f32_16x16x32_bf16 a[36:39], v[152:155], v[84:87], a[36:39]
    ds_read_b128 v[84:87], v8 offset:35840
    buffer_load_dwordx4 v21, s[4:7], s26 offen lds
    v_mfma_f32_16x16x32_bf16 a[44:47], v[152:155], v[88:91], a[44:47]
    s_add_u32 m0, s24, 8192
    v_mfma_f32_16x16x32_bf16 a[40:43], v[148:151], v[88:91], a[40:43]
    ds_read_b128 v[88:91], v8 offset:36096
    buffer_load_dwordx4 v22, s[4:7], s26 offen lds
    v_mfma_f32_16x16x32_bf16 a[48:51], v[148:151], v[40:43], a[48:51]
    v_mfma_f32_16x16x32_bf16 a[52:55], v[152:155], v[40:43], a[52:55]
    ds_read_b128 v[40:43], v8 offset:36352
    v_mfma_f32_16x16x32_bf16 a[60:63], v[152:155], v[44:47], a[60:63]
    v_mfma_f32_16x16x32_bf16 a[56:59], v[148:151], v[44:47], a[56:59]
    ds_read_b128 v[44:47], v8 offset:36608
    s_waitcnt lgkmcnt(7)
    v_mfma_f32_16x16x32_bf16 a[0:3], v[92:95], v[68:71], a[0:3]
    v_mfma_f32_16x16x32_bf16 a[4:7], v[96:99], v[68:71], a[4:7]
    s_add_u32 s22, s21, 16384
    s_waitcnt lgkmcnt(6)
    v_mfma_f32_16x16x32_bf16 a[12:15], v[96:99], v[72:75], a[12:15]
    buffer_load_dwordx4 v[148:151], v12, s[8:11], s22 offen offset:0
    v_mfma_f32_16x16x32_bf16 a[8:11], v[92:95], v[72:75], a[8:11]
    buffer_load_dwordx4 v[152:155], v12, s[8:11], s22 offen offset:1024
    s_waitcnt lgkmcnt(5)
    v_mfma_f32_16x16x32_bf16 a[16:19], v[92:95], v[76:79], a[16:19]
    s_add_u32 m0, s24, 12288
    v_mfma_f32_16x16x32_bf16 a[20:23], v[96:99], v[76:79], a[20:23]
    ds_read_b128 v[48:51], v9 offset:36864
    buffer_load_dwordx4 v23, s[4:7], s26 offen lds
    s_waitcnt lgkmcnt(5)
    v_mfma_f32_16x16x32_bf16 a[28:31], v[96:99], v[80:83], a[28:31]
    s_add_u32 m0, s24, 16384
    v_mfma_f32_16x16x32_bf16 a[24:27], v[92:95], v[80:83], a[24:27]
    buffer_load_dwordx4 v24, s[4:7], s26 offen lds
    s_waitcnt lgkmcnt(4)
    v_mfma_f32_16x16x32_bf16 a[32:35], v[92:95], v[84:87], a[32:35]
    s_add_u32 m0, s24, 20480
    v_mfma_f32_16x16x32_bf16 a[36:39], v[96:99], v[84:87], a[36:39]
    buffer_load_dwordx4 v25, s[4:7], s26 offen lds
    s_waitcnt lgkmcnt(3)
    v_mfma_f32_16x16x32_bf16 a[44:47], v[96:99], v[88:91], a[44:47]
    v_mfma_f32_16x16x32_bf16 a[40:43], v[92:95], v[88:91], a[40:43]
    s_waitcnt lgkmcnt(2)
    v_mfma_f32_16x16x32_bf16 a[48:51], v[92:95], v[40:43], a[48:51]
    v_mfma_f32_16x16x32_bf16 a[52:55], v[96:99], v[40:43], a[52:55]
    s_waitcnt lgkmcnt(1)
    v_mfma_f32_16x16x32_bf16 a[60:63], v[96:99], v[44:47], a[60:63]
    v_mfma_f32_16x16x32_bf16 a[56:59], v[92:95], v[44:47], a[56:59]
    v_mfma_f32_16x16x32_bf16 a[0:3], v[100:103], v[72:75], a[0:3]
    v_mfma_f32_16x16x32_bf16 a[4:7], v[104:107], v[72:75], a[4:7]
    s_add_u32 s22, s21, 81920
    v_mfma_f32_16x16x32_bf16 a[12:15], v[104:107], v[76:79], a[12:15]
    buffer_load_dwordx4 v[92:95], v12, s[8:11], s22 offen offset:0
    v_mfma_f32_16x16x32_bf16 a[8:11], v[100:103], v[76:79], a[8:11]
    buffer_load_dwordx4 v[96:99], v12, s[8:11], s22 offen offset:1024
    v_mfma_f32_16x16x32_bf16 a[16:19], v[100:103], v[80:83], a[16:19]
    s_add_u32 m0, s24, 24576
    v_mfma_f32_16x16x32_bf16 a[20:23], v[104:107], v[80:83], a[20:23]
    ds_read_b128 v[52:55], v9 offset:37120
    buffer_load_dwordx4 v26, s[4:7], s26 offen lds
    v_mfma_f32_16x16x32_bf16 a[28:31], v[104:107], v[84:87], a[28:31]
    s_add_u32 m0, s24, 28672
    v_mfma_f32_16x16x32_bf16 a[24:27], v[100:103], v[84:87], a[24:27]
    buffer_load_dwordx4 v27, s[4:7], s26 offen lds
    v_mfma_f32_16x16x32_bf16 a[32:35], v[100:103], v[88:91], a[32:35]
    s_add_u32 m0, s25, 0
    v_mfma_f32_16x16x32_bf16 a[36:39], v[104:107], v[88:91], a[36:39]
    buffer_load_dwordx4 v28, s[4:7], s26 offen lds
    v_mfma_f32_16x16x32_bf16 a[44:47], v[104:107], v[40:43], a[44:47]
    v_mfma_f32_16x16x32_bf16 a[40:43], v[100:103], v[40:43], a[40:43]
    v_mfma_f32_16x16x32_bf16 a[48:51], v[100:103], v[44:47], a[48:51]
    v_mfma_f32_16x16x32_bf16 a[52:55], v[104:107], v[44:47], a[52:55]
    s_waitcnt lgkmcnt(1)
    v_mfma_f32_16x16x32_bf16 a[60:63], v[104:107], v[48:51], a[60:63]
    v_mfma_f32_16x16x32_bf16 a[56:59], v[100:103], v[48:51], a[56:59]
    v_mfma_f32_16x16x32_bf16 a[0:3], v[108:111], v[76:79], a[0:3]
    v_mfma_f32_16x16x32_bf16 a[4:7], v[112:115], v[76:79], a[4:7]
    s_add_u32 s22, s21, 147456
    v_mfma_f32_16x16x32_bf16 a[12:15], v[112:115], v[80:83], a[12:15]
    buffer_load_dwordx4 v[100:103], v12, s[8:11], s22 offen offset:0
    v_mfma_f32_16x16x32_bf16 a[8:11], v[108:111], v[80:83], a[8:11]
    buffer_load_dwordx4 v[104:107], v12, s[8:11], s22 offen offset:1024
    v_mfma_f32_16x16x32_bf16 a[16:19], v[108:111], v[84:87], a[16:19]
    v_mfma_f32_16x16x32_bf16 a[20:23], v[112:115], v[84:87], a[20:23]
    ds_read_b128 v[56:59], v9 offset:37376
    v_mfma_f32_16x16x32_bf16 a[28:31], v[112:115], v[88:91], a[28:31]
    v_mfma_f32_16x16x32_bf16 a[24:27], v[108:111], v[88:91], a[24:27]
    v_mfma_f32_16x16x32_bf16 a[32:35], v[108:111], v[40:43], a[32:35]
    v_mfma_f32_16x16x32_bf16 a[36:39], v[112:115], v[40:43], a[36:39]
    v_mfma_f32_16x16x32_bf16 a[44:47], v[112:115], v[44:47], a[44:47]
    v_mfma_f32_16x16x32_bf16 a[40:43], v[108:111], v[44:47], a[40:43]
    v_mfma_f32_16x16x32_bf16 a[48:51], v[108:111], v[48:51], a[48:51]
    v_mfma_f32_16x16x32_bf16 a[52:55], v[112:115], v[48:51], a[52:55]
    s_waitcnt lgkmcnt(1)
    v_mfma_f32_16x16x32_bf16 a[60:63], v[112:115], v[52:55], a[60:63]
    v_mfma_f32_16x16x32_bf16 a[56:59], v[108:111], v[52:55], a[56:59]
    s_waitcnt vmcnt(21)
    v_mfma_f32_16x16x32_bf16 a[0:3], v[116:119], v[80:83], a[0:3]
    v_mfma_f32_16x16x32_bf16 a[4:7], v[120:123], v[80:83], a[4:7]
    s_add_u32 s22, s21, 212992
    v_mfma_f32_16x16x32_bf16 a[12:15], v[120:123], v[84:87], a[12:15]
    buffer_load_dwordx4 v[108:111], v12, s[8:11], s22 offen offset:0
    v_mfma_f32_16x16x32_bf16 a[8:11], v[116:119], v[84:87], a[8:11]
    buffer_load_dwordx4 v[112:115], v12, s[8:11], s22 offen offset:1024
    v_mfma_f32_16x16x32_bf16 a[16:19], v[116:119], v[88:91], a[16:19]
    v_mfma_f32_16x16x32_bf16 a[20:23], v[120:123], v[88:91], a[20:23]
    ds_read_b128 v[60:63], v9 offset:37632
    v_mfma_f32_16x16x32_bf16 a[28:31], v[120:123], v[40:43], a[28:31]
    v_mfma_f32_16x16x32_bf16 a[24:27], v[116:119], v[40:43], a[24:27]
    v_mfma_f32_16x16x32_bf16 a[32:35], v[116:119], v[44:47], a[32:35]
    v_mfma_f32_16x16x32_bf16 a[36:39], v[120:123], v[44:47], a[36:39]
    v_mfma_f32_16x16x32_bf16 a[44:47], v[120:123], v[48:51], a[44:47]
    v_mfma_f32_16x16x32_bf16 a[40:43], v[116:119], v[48:51], a[40:43]
    v_mfma_f32_16x16x32_bf16 a[48:51], v[116:119], v[52:55], a[48:51]
    v_mfma_f32_16x16x32_bf16 a[52:55], v[120:123], v[52:55], a[52:55]
    s_waitcnt lgkmcnt(1)
    v_mfma_f32_16x16x32_bf16 a[60:63], v[120:123], v[56:59], a[60:63]
    v_mfma_f32_16x16x32_bf16 a[56:59], v[116:119], v[56:59], a[56:59]
    s_waitcnt vmcnt(21)
    v_mfma_f32_16x16x32_bf16 a[0:3], v[124:127], v[84:87], a[0:3]
    v_mfma_f32_16x16x32_bf16 a[4:7], v[128:131], v[84:87], a[4:7]
    s_add_u32 s22, s21, 278528
    v_mfma_f32_16x16x32_bf16 a[12:15], v[128:131], v[88:91], a[12:15]
    buffer_load_dwordx4 v[116:119], v12, s[8:11], s22 offen offset:0
    v_mfma_f32_16x16x32_bf16 a[8:11], v[124:127], v[88:91], a[8:11]
    buffer_load_dwordx4 v[120:123], v12, s[8:11], s22 offen offset:1024
    v_mfma_f32_16x16x32_bf16 a[16:19], v[124:127], v[40:43], a[16:19]
    v_mfma_f32_16x16x32_bf16 a[20:23], v[128:131], v[40:43], a[20:23]
    ds_read_b128 v[64:67], v9 offset:37888
    v_mfma_f32_16x16x32_bf16 a[28:31], v[128:131], v[44:47], a[28:31]
    v_mfma_f32_16x16x32_bf16 a[24:27], v[124:127], v[44:47], a[24:27]
    v_mfma_f32_16x16x32_bf16 a[32:35], v[124:127], v[48:51], a[32:35]
    v_mfma_f32_16x16x32_bf16 a[36:39], v[128:131], v[48:51], a[36:39]
    v_mfma_f32_16x16x32_bf16 a[44:47], v[128:131], v[52:55], a[44:47]
    v_mfma_f32_16x16x32_bf16 a[40:43], v[124:127], v[52:55], a[40:43]
    v_mfma_f32_16x16x32_bf16 a[48:51], v[124:127], v[56:59], a[48:51]
    v_mfma_f32_16x16x32_bf16 a[52:55], v[128:131], v[56:59], a[52:55]
    s_waitcnt lgkmcnt(1)
    v_mfma_f32_16x16x32_bf16 a[60:63], v[128:131], v[60:63], a[60:63]
    v_mfma_f32_16x16x32_bf16 a[56:59], v[124:127], v[60:63], a[56:59]
    s_waitcnt vmcnt(21)
    v_mfma_f32_16x16x32_bf16 a[0:3], v[132:135], v[88:91], a[0:3]
    v_mfma_f32_16x16x32_bf16 a[4:7], v[136:139], v[88:91], a[4:7]
    s_add_u32 s22, s21, 344064
    v_mfma_f32_16x16x32_bf16 a[12:15], v[136:139], v[40:43], a[12:15]
    buffer_load_dwordx4 v[124:127], v12, s[8:11], s22 offen offset:0
    v_mfma_f32_16x16x32_bf16 a[8:11], v[132:135], v[40:43], a[8:11]
    buffer_load_dwordx4 v[128:131], v12, s[8:11], s22 offen offset:1024
    v_mfma_f32_16x16x32_bf16 a[16:19], v[132:135], v[44:47], a[16:19]
    v_mfma_f32_16x16x32_bf16 a[20:23], v[136:139], v[44:47], a[20:23]
    ds_read_b128 v[68:71], v9 offset:38144
    v_mfma_f32_16x16x32_bf16 a[28:31], v[136:139], v[48:51], a[28:31]
    v_mfma_f32_16x16x32_bf16 a[24:27], v[132:135], v[48:51], a[24:27]
    v_mfma_f32_16x16x32_bf16 a[32:35], v[132:135], v[52:55], a[32:35]
    v_mfma_f32_16x16x32_bf16 a[36:39], v[136:139], v[52:55], a[36:39]
    v_mfma_f32_16x16x32_bf16 a[44:47], v[136:139], v[56:59], a[44:47]
    v_mfma_f32_16x16x32_bf16 a[40:43], v[132:135], v[56:59], a[40:43]
    v_mfma_f32_16x16x32_bf16 a[48:51], v[132:135], v[60:63], a[48:51]
    v_mfma_f32_16x16x32_bf16 a[52:55], v[136:139], v[60:63], a[52:55]
    s_waitcnt lgkmcnt(1)
    v_mfma_f32_16x16x32_bf16 a[60:63], v[136:139], v[64:67], a[60:63]
    v_mfma_f32_16x16x32_bf16 a[56:59], v[132:135], v[64:67], a[56:59]
    s_waitcnt vmcnt(21)
    v_mfma_f32_16x16x32_bf16 a[0:3], v[140:143], v[40:43], a[0:3]
    s_waitcnt vmcnt(8) lgkmcnt(0)
    s_barrier
    v_mfma_f32_16x16x32_bf16 a[4:7], v[144:147], v[40:43], a[4:7]
    ds_read_b128 v[40:43], v8 offset:0
    s_add_u32 s22, s21, 409600
    v_mfma_f32_16x16x32_bf16 a[12:15], v[144:147], v[44:47], a[12:15]
    buffer_load_dwordx4 v[132:135], v12, s[8:11], s22 offen offset:0
    v_mfma_f32_16x16x32_bf16 a[8:11], v[140:143], v[44:47], a[8:11]
    ds_read_b128 v[44:47], v8 offset:256
    buffer_load_dwordx4 v[136:139], v12, s[8:11], s22 offen offset:1024
    v_mfma_f32_16x16x32_bf16 a[16:19], v[140:143], v[48:51], a[16:19]
    s_mov_b32 s26, 512
    v_mfma_f32_16x16x32_bf16 a[20:23], v[144:147], v[48:51], a[20:23]
    ds_read_b128 v[48:51], v8 offset:512
    s_add_u32 m0, s24, 34816
    v_mfma_f32_16x16x32_bf16 a[28:31], v[144:147], v[52:55], a[28:31]
    buffer_load_dwordx4 v29, s[4:7], s26 offen lds
    v_mfma_f32_16x16x32_bf16 a[24:27], v[140:143], v[52:55], a[24:27]
    ds_read_b128 v[52:55], v8 offset:768
    s_add_u32 m0, s24, 38912
    v_mfma_f32_16x16x32_bf16 a[32:35], v[140:143], v[56:59], a[32:35]
    buffer_load_dwordx4 v30, s[4:7], s26 offen lds
    v_mfma_f32_16x16x32_bf16 a[36:39], v[144:147], v[56:59], a[36:39]
    ds_read_b128 v[56:59], v8 offset:1024
    s_add_u32 m0, s24, 43008
    v_mfma_f32_16x16x32_bf16 a[44:47], v[144:147], v[60:63], a[44:47]
    buffer_load_dwordx4 v31, s[4:7], s26 offen lds
    v_mfma_f32_16x16x32_bf16 a[40:43], v[140:143], v[60:63], a[40:43]
    ds_read_b128 v[60:63], v8 offset:1280
    v_mfma_f32_16x16x32_bf16 a[48:51], v[140:143], v[64:67], a[48:51]
    v_mfma_f32_16x16x32_bf16 a[52:55], v[144:147], v[64:67], a[52:55]
    ds_read_b128 v[64:67], v8 offset:1536
    v_mfma_f32_16x16x32_bf16 a[60:63], v[144:147], v[68:71], a[60:63]
    v_mfma_f32_16x16x32_bf16 a[56:59], v[140:143], v[68:71], a[56:59]
    ds_read_b128 v[68:71], v8 offset:1792
    s_waitcnt lgkmcnt(7)
    v_mfma_f32_16x16x32_bf16 a[0:3], v[148:151], v[40:43], a[0:3]
    v_mfma_f32_16x16x32_bf16 a[4:7], v[152:155], v[40:43], a[4:7]
    s_add_u32 s22, s21, 475136
    s_waitcnt lgkmcnt(6)
    v_mfma_f32_16x16x32_bf16 a[12:15], v[152:155], v[44:47], a[12:15]
    buffer_load_dwordx4 v[140:143], v12, s[8:11], s22 offen offset:0
    v_mfma_f32_16x16x32_bf16 a[8:11], v[148:151], v[44:47], a[8:11]
    buffer_load_dwordx4 v[144:147], v12, s[8:11], s22 offen offset:1024
    s_waitcnt lgkmcnt(5)
    v_mfma_f32_16x16x32_bf16 a[16:19], v[148:151], v[48:51], a[16:19]
    s_add_u32 m0, s24, 47104
    v_mfma_f32_16x16x32_bf16 a[20:23], v[152:155], v[48:51], a[20:23]
    ds_read_b128 v[72:75], v9 offset:2048
    buffer_load_dwordx4 v32, s[4:7], s26 offen lds
    s_waitcnt lgkmcnt(5)
    v_mfma_f32_16x16x32_bf16 a[28:31], v[152:155], v[52:55], a[28:31]
    s_add_u32 m0, s24, 51200
    v_mfma_f32_16x16x32_bf16 a[24:27], v[148:151], v[52:55], a[24:27]
    buffer_load_dwordx4 v33, s[4:7], s26 offen lds
    s_waitcnt lgkmcnt(4)
    v_mfma_f32_16x16x32_bf16 a[32:35], v[148:151], v[56:59], a[32:35]
    s_add_u32 m0, s24, 55296
    v_mfma_f32_16x16x32_bf16 a[36:39], v[152:155], v[56:59], a[36:39]
    buffer_load_dwordx4 v34, s[4:7], s26 offen lds
    s_waitcnt lgkmcnt(3)
    v_mfma_f32_16x16x32_bf16 a[44:47], v[152:155], v[60:63], a[44:47]
    v_mfma_f32_16x16x32_bf16 a[40:43], v[148:151], v[60:63], a[40:43]
    s_waitcnt lgkmcnt(2)
    v_mfma_f32_16x16x32_bf16 a[48:51], v[148:151], v[64:67], a[48:51]
    v_mfma_f32_16x16x32_bf16 a[52:55], v[152:155], v[64:67], a[52:55]
    s_waitcnt lgkmcnt(1)
    v_mfma_f32_16x16x32_bf16 a[60:63], v[152:155], v[68:71], a[60:63]
    v_mfma_f32_16x16x32_bf16 a[56:59], v[148:151], v[68:71], a[56:59]
    v_mfma_f32_16x16x32_bf16 a[0:3], v[92:95], v[44:47], a[0:3]
    v_mfma_f32_16x16x32_bf16 a[4:7], v[96:99], v[44:47], a[4:7]
    s_add_u32 s22, s21, 49152
    v_mfma_f32_16x16x32_bf16 a[12:15], v[96:99], v[48:51], a[12:15]
    buffer_load_dwordx4 v[148:151], v12, s[8:11], s22 offen offset:0
    v_mfma_f32_16x16x32_bf16 a[8:11], v[92:95], v[48:51], a[8:11]
    buffer_load_dwordx4 v[152:155], v12, s[8:11], s22 offen offset:1024
    v_mfma_f32_16x16x32_bf16 a[16:19], v[92:95], v[52:55], a[16:19]
    s_add_u32 m0, s24, 59392
    v_mfma_f32_16x16x32_bf16 a[20:23], v[96:99], v[52:55], a[20:23]
    ds_read_b128 v[76:79], v9 offset:2304
    buffer_load_dwordx4 v35, s[4:7], s26 offen lds
    v_mfma_f32_16x16x32_bf16 a[28:31], v[96:99], v[56:59], a[28:31]
    s_add_u32 m0, s24, 63488
    v_mfma_f32_16x16x32_bf16 a[24:27], v[92:95], v[56:59], a[24:27]
    buffer_load_dwordx4 v36, s[4:7], s26 offen lds
    v_mfma_f32_16x16x32_bf16 a[32:35], v[92:95], v[60:63], a[32:35]
    s_add_u32 m0, s25, 34816
    v_mfma_f32_16x16x32_bf16 a[36:39], v[96:99], v[60:63], a[36:39]
    buffer_load_dwordx4 v37, s[4:7], s26 offen lds
    v_mfma_f32_16x16x32_bf16 a[44:47], v[96:99], v[64:67], a[44:47]
    v_mfma_f32_16x16x32_bf16 a[40:43], v[92:95], v[64:67], a[40:43]
    v_mfma_f32_16x16x32_bf16 a[48:51], v[92:95], v[68:71], a[48:51]
    v_mfma_f32_16x16x32_bf16 a[52:55], v[96:99], v[68:71], a[52:55]
    s_waitcnt lgkmcnt(1)
    v_mfma_f32_16x16x32_bf16 a[60:63], v[96:99], v[72:75], a[60:63]
    v_mfma_f32_16x16x32_bf16 a[56:59], v[92:95], v[72:75], a[56:59]
    s_waitcnt vmcnt(21)
    v_mfma_f32_16x16x32_bf16 a[0:3], v[100:103], v[48:51], a[0:3]
    v_mfma_f32_16x16x32_bf16 a[4:7], v[104:107], v[48:51], a[4:7]
    s_add_u32 s22, s21, 114688
    v_mfma_f32_16x16x32_bf16 a[12:15], v[104:107], v[52:55], a[12:15]
    buffer_load_dwordx4 v[92:95], v12, s[8:11], s22 offen offset:0
    v_mfma_f32_16x16x32_bf16 a[8:11], v[100:103], v[52:55], a[8:11]
    buffer_load_dwordx4 v[96:99], v12, s[8:11], s22 offen offset:1024
    v_mfma_f32_16x16x32_bf16 a[16:19], v[100:103], v[56:59], a[16:19]
    v_mfma_f32_16x16x32_bf16 a[20:23], v[104:107], v[56:59], a[20:23]
    ds_read_b128 v[80:83], v9 offset:2560
    v_mfma_f32_16x16x32_bf16 a[28:31], v[104:107], v[60:63], a[28:31]
    v_mfma_f32_16x16x32_bf16 a[24:27], v[100:103], v[60:63], a[24:27]
    v_mfma_f32_16x16x32_bf16 a[32:35], v[100:103], v[64:67], a[32:35]
    v_mfma_f32_16x16x32_bf16 a[36:39], v[104:107], v[64:67], a[36:39]
    v_mfma_f32_16x16x32_bf16 a[44:47], v[104:107], v[68:71], a[44:47]
    v_mfma_f32_16x16x32_bf16 a[40:43], v[100:103], v[68:71], a[40:43]
    v_mfma_f32_16x16x32_bf16 a[48:51], v[100:103], v[72:75], a[48:51]
    v_mfma_f32_16x16x32_bf16 a[52:55], v[104:107], v[72:75], a[52:55]
    s_waitcnt lgkmcnt(1)
    v_mfma_f32_16x16x32_bf16 a[60:63], v[104:107], v[76:79], a[60:63]
    v_mfma_f32_16x16x32_bf16 a[56:59], v[100:103], v[76:79], a[56:59]
    s_waitcnt vmcnt(21)
    v_mfma_f32_16x16x32_bf16 a[0:3], v[108:111], v[52:55], a[0:3]
    v_mfma_f32_16x16x32_bf16 a[4:7], v[112:115], v[52:55], a[4:7]
    s_add_u32 s22, s21, 180224
    v_mfma_f32_16x16x32_bf16 a[12:15], v[112:115], v[56:59], a[12:15]
    buffer_load_dwordx4 v[100:103], v12, s[8:11], s22 offen offset:0
    v_mfma_f32_16x16x32_bf16 a[8:11], v[108:111], v[56:59], a[8:11]
    buffer_load_dwordx4 v[104:107], v12, s[8:11], s22 offen offset:1024
    v_mfma_f32_16x16x32_bf16 a[16:19], v[108:111], v[60:63], a[16:19]
    s_mov_b64 exec, s[56:57]
    buffer_load_dword v248, v246, s[92:95], 0 offen sc1
    s_mov_b64 exec, -1
    v_mfma_f32_16x16x32_bf16 a[20:23], v[112:115], v[60:63], a[20:23]
    ds_read_b128 v[84:87], v9 offset:2816
    v_mfma_f32_16x16x32_bf16 a[28:31], v[112:115], v[64:67], a[28:31]
    v_mfma_f32_16x16x32_bf16 a[24:27], v[108:111], v[64:67], a[24:27]
    v_mfma_f32_16x16x32_bf16 a[32:35], v[108:111], v[68:71], a[32:35]
    v_mfma_f32_16x16x32_bf16 a[36:39], v[112:115], v[68:71], a[36:39]
    v_mfma_f32_16x16x32_bf16 a[44:47], v[112:115], v[72:75], a[44:47]
    v_mfma_f32_16x16x32_bf16 a[40:43], v[108:111], v[72:75], a[40:43]
    v_mfma_f32_16x16x32_bf16 a[48:51], v[108:111], v[76:79], a[48:51]
    v_mfma_f32_16x16x32_bf16 a[52:55], v[112:115], v[76:79], a[52:55]
    s_waitcnt lgkmcnt(1)
    v_mfma_f32_16x16x32_bf16 a[60:63], v[112:115], v[80:83], a[60:63]
    v_mfma_f32_16x16x32_bf16 a[56:59], v[108:111], v[80:83], a[56:59]
    s_waitcnt vmcnt(22)
    v_mfma_f32_16x16x32_bf16 a[0:3], v[116:119], v[56:59], a[0:3]
    v_mfma_f32_16x16x32_bf16 a[4:7], v[120:123], v[56:59], a[4:7]
    s_add_u32 s22, s21, 245760
    v_mfma_f32_16x16x32_bf16 a[12:15], v[120:123], v[60:63], a[12:15]
    buffer_load_dwordx4 v[108:111], v12, s[8:11], s22 offen offset:0
    v_mfma_f32_16x16x32_bf16 a[8:11], v[116:119], v[60:63], a[8:11]
    buffer_load_dwordx4 v[112:115], v12, s[8:11], s22 offen offset:1024
    v_mfma_f32_16x16x32_bf16 a[16:19], v[116:119], v[64:67], a[16:19]
    v_mfma_f32_16x16x32_bf16 a[20:23], v[120:123], v[64:67], a[20:23]
    ds_read_b128 v[88:91], v9 offset:3072
    v_mfma_f32_16x16x32_bf16 a[28:31], v[120:123], v[68:71], a[28:31]
    v_mfma_f32_16x16x32_bf16 a[24:27], v[116:119], v[68:71], a[24:27]
    v_mfma_f32_16x16x32_bf16 a[32:35], v[116:119], v[72:75], a[32:35]
    v_mfma_f32_16x16x32_bf16 a[36:39], v[120:123], v[72:75], a[36:39]
    v_mfma_f32_16x16x32_bf16 a[44:47], v[120:123], v[76:79], a[44:47]
    v_mfma_f32_16x16x32_bf16 a[40:43], v[116:119], v[76:79], a[40:43]
    v_mfma_f32_16x16x32_bf16 a[48:51], v[116:119], v[80:83], a[48:51]
    v_mfma_f32_16x16x32_bf16 a[52:55], v[120:123], v[80:83], a[52:55]
    s_waitcnt lgkmcnt(1)
    v_mfma_f32_16x16x32_bf16 a[60:63], v[120:123], v[84:87], a[60:63]
    v_mfma_f32_16x16x32_bf16 a[56:59], v[116:119], v[84:87], a[56:59]
    s_waitcnt vmcnt(22)
    v_mfma_f32_16x16x32_bf16 a[0:3], v[124:127], v[60:63], a[0:3]
    v_mfma_f32_16x16x32_bf16 a[4:7], v[128:131], v[60:63], a[4:7]
    s_add_u32 s22, s21, 311296
    v_mfma_f32_16x16x32_bf16 a[12:15], v[128:131], v[64:67], a[12:15]
    buffer_load_dwordx4 v[116:119], v12, s[8:11], s22 offen offset:0
    v_mfma_f32_16x16x32_bf16 a[8:11], v[124:127], v[64:67], a[8:11]
    buffer_load_dwordx4 v[120:123], v12, s[8:11], s22 offen offset:1024
    v_mfma_f32_16x16x32_bf16 a[16:19], v[124:127], v[68:71], a[16:19]
    v_mfma_f32_16x16x32_bf16 a[20:23], v[128:131], v[68:71], a[20:23]
    ds_read_b128 v[40:43], v9 offset:3328
    v_mfma_f32_16x16x32_bf16 a[28:31], v[128:131], v[72:75], a[28:31]
    v_mfma_f32_16x16x32_bf16 a[24:27], v[124:127], v[72:75], a[24:27]
    v_mfma_f32_16x16x32_bf16 a[32:35], v[124:127], v[76:79], a[32:35]
    v_mfma_f32_16x16x32_bf16 a[36:39], v[128:131], v[76:79], a[36:39]
    v_mfma_f32_16x16x32_bf16 a[44:47], v[128:131], v[80:83], a[44:47]
    v_mfma_f32_16x16x32_bf16 a[40:43], v[124:127], v[80:83], a[40:43]
    v_mfma_f32_16x16x32_bf16 a[48:51], v[124:127], v[84:87], a[48:51]
    v_mfma_f32_16x16x32_bf16 a[52:55], v[128:131], v[84:87], a[52:55]
    s_waitcnt lgkmcnt(1)
    v_mfma_f32_16x16x32_bf16 a[60:63], v[128:131], v[88:91], a[60:63]
    v_mfma_f32_16x16x32_bf16 a[56:59], v[124:127], v[88:91], a[56:59]
    s_waitcnt vmcnt(22)
    v_mfma_f32_16x16x32_bf16 a[0:3], v[132:135], v[64:67], a[0:3]
    v_mfma_f32_16x16x32_bf16 a[4:7], v[136:139], v[64:67], a[4:7]
    s_add_u32 s22, s21, 376832
    v_mfma_f32_16x16x32_bf16 a[12:15], v[136:139], v[68:71], a[12:15]
    buffer_load_dwordx4 v[124:127], v12, s[8:11], s22 offen offset:0
    v_mfma_f32_16x16x32_bf16 a[8:11], v[132:135], v[68:71], a[8:11]
    buffer_load_dwordx4 v[128:131], v12, s[8:11], s22 offen offset:1024
    v_mfma_f32_16x16x32_bf16 a[16:19], v[132:135], v[72:75], a[16:19]
    v_mfma_f32_16x16x32_bf16 a[20:23], v[136:139], v[72:75], a[20:23]
    ds_read_b128 v[44:47], v9 offset:3584
    v_mfma_f32_16x16x32_bf16 a[28:31], v[136:139], v[76:79], a[28:31]
    v_mfma_f32_16x16x32_bf16 a[24:27], v[132:135], v[76:79], a[24:27]
    v_mfma_f32_16x16x32_bf16 a[32:35], v[132:135], v[80:83], a[32:35]
    v_mfma_f32_16x16x32_bf16 a[36:39], v[136:139], v[80:83], a[36:39]
    v_mfma_f32_16x16x32_bf16 a[44:47], v[136:139], v[84:87], a[44:47]
    v_mfma_f32_16x16x32_bf16 a[40:43], v[132:135], v[84:87], a[40:43]
    v_mfma_f32_16x16x32_bf16 a[48:51], v[132:135], v[88:91], a[48:51]
    v_mfma_f32_16x16x32_bf16 a[52:55], v[136:139], v[88:91], a[52:55]
    s_waitcnt lgkmcnt(1)
    v_mfma_f32_16x16x32_bf16 a[60:63], v[136:139], v[40:43], a[60:63]
    v_mfma_f32_16x16x32_bf16 a[56:59], v[132:135], v[40:43], a[56:59]
    s_waitcnt vmcnt(19)
    v_mfma_f32_16x16x32_bf16 a[0:3], v[140:143], v[68:71], a[0:3]
    s_waitcnt vmcnt(11) lgkmcnt(0)
    s_barrier
    v_mfma_f32_16x16x32_bf16 a[4:7], v[144:147], v[68:71], a[4:7]
    ds_read_b128 v[68:71], v8 offset:34816
    s_add_u32 s22, s21, 442368
    v_mfma_f32_16x16x32_bf16 a[12:15], v[144:147], v[72:75], a[12:15]
    buffer_load_dwordx4 v[132:135], v12, s[8:11], s22 offen offset:0
    v_mfma_f32_16x16x32_bf16 a[8:11], v[140:143], v[72:75], a[8:11]
    ds_read_b128 v[72:75], v8 offset:35072
    buffer_load_dwordx4 v[136:139], v12, s[8:11], s22 offen offset:1024
    v_mfma_f32_16x16x32_bf16 a[16:19], v[140:143], v[76:79], a[16:19]
    s_mov_b64 exec, s[56:57]
    s_waitcnt vmcnt(8)
    v_cmp_ne_u32 vcc, s100, v248
    s_nop 4
    s_cbranch_vccz p2_chk8
    s_mov_b32 s27, 0x20000
p2_poll9:
    buffer_load_dword v248, v246, s[92:95], 0 offen sc1
    s_waitcnt vmcnt(0)
    v_cmp_ne_u32 vcc, s100, v248
    s_sub_u32 s27, s27, 1
    s_cmp_eq_u32 s27, 0
    s_cbranch_scc1 p2_poll9_done
    s_cbranch_vccz p2_poll9_done
    s_sleep 4
    s_branch p2_poll9
p2_poll9_done:
p2_chk8:
    s_mov_b64 exec, -1
    v_mfma_f32_16x16x32_bf16 a[20:23], v[144:147], v[76:79], a[20:23]
    ds_read_b128 v[76:79], v8 offset:35328
    s_mov_b32 s26, 768
    v_mfma_f32_16x16x32_bf16 a[28:31], v[144:147], v[80:83], a[28:31]
    s_add_u32 m0, s24, 0
    v_mfma_f32_16x16x32_bf16 a[24:27], v[140:143], v[80:83], a[24:27]
    ds_read_b128 v[80:83], v8 offset:35584
    buffer_load_dwordx4 v20, s[4:7], s26 offen lds
    v_mfma_f32_16x16x32_bf16 a[32:35], v[140:143], v[84:87], a[32:35]
    s_add_u32 m0, s24, 4096
    v_mfma_f32_16x16x32_bf16 a[36:39], v[144:147], v[84:87], a[36:39]
    ds_read_b128 v[84:87], v8 offset:35840
    buffer_load_dwordx4 v21, s[4:7], s26 offen lds
    v_mfma_f32_16x16x32_bf16 a[44:47], v[144:147], v[88:91], a[44:47]
    s_add_u32 m0, s24, 8192
    v_mfma_f32_16x16x32_bf16 a[40:43], v[140:143], v[88:91], a[40:43]
    ds_read_b128 v[88:91], v8 offset:36096
    buffer_load_dwordx4 v22, s[4:7], s26 offen lds
    v_mfma_f32_16x16x32_bf16 a[48:51], v[140:143], v[40:43], a[48:51]
    v_mfma_f32_16x16x32_bf16 a[52:55], v[144:147], v[40:43], a[52:55]
    ds_read_b128 v[40:43], v8 offset:36352
    v_mfma_f32_16x16x32_bf16 a[60:63], v[144:147], v[44:47], a[60:63]
    v_mfma_f32_16x16x32_bf16 a[56:59], v[140:143], v[44:47], a[56:59]
    ds_read_b128 v[44:47], v8 offset:36608
    s_waitcnt lgkmcnt(7)
    v_mfma_f32_16x16x32_bf16 a[0:3], v[148:151], v[68:71], a[0:3]
    v_mfma_f32_16x16x32_bf16 a[4:7], v[152:155], v[68:71], a[4:7]
    s_add_u32 s22, s21, 24576
    s_waitcnt lgkmcnt(6)
    v_mfma_f32_16x16x32_bf16 a[12:15], v[152:155], v[72:75], a[12:15]
    buffer_load_dwordx4 v[140:143], v12, s[8:11], s22 offen offset:0
    v_mfma_f32_16x16x32_bf16 a[8:11], v[148:151], v[72:75], a[8:11]
    buffer_load_dwordx4 v[144:147], v12, s[8:11], s22 offen offset:1024
    s_waitcnt lgkmcnt(5)
    v_mfma_f32_16x16x32_bf16 a[16:19], v[148:151], v[76:79], a[16:19]
    s_add_u32 m0, s24, 12288
    v_mfma_f32_16x16x32_bf16 a[20:23], v[152:155], v[76:79], a[20:23]
    ds_read_b128 v[48:51], v9 offset:36864
    buffer_load_dwordx4 v23, s[4:7], s26 offen lds
    s_waitcnt lgkmcnt(5)
    v_mfma_f32_16x16x32_bf16 a[28:31], v[152:155], v[80:83], a[28:31]
    s_add_u32 m0, s24, 16384
    v_mfma_f32_16x16x32_bf16 a[24:27], v[148:151], v[80:83], a[24:27]
    buffer_load_dwordx4 v24, s[4:7], s26 offen lds
    s_waitcnt lgkmcnt(4)
    v_mfma_f32_16x16x32_bf16 a[32:35], v[148:151], v[84:87], a[32:35]
    s_add_u32 m0, s24, 20480
    v_mfma_f32_16x16x32_bf16 a[36:39], v[152:155], v[84:87], a[36:39]
    buffer_load_dwordx4 v25, s[4:7], s26 offen lds
    s_waitcnt lgkmcnt(3)
    v_mfma_f32_16x16x32_bf16 a[44:47], v[152:155], v[88:91], a[44:47]
    v_mfma_f32_16x16x32_bf16 a[40:43], v[148:151], v[88:91], a[40:43]
    s_waitcnt lgkmcnt(2)
    v_mfma_f32_16x16x32_bf16 a[48:51], v[148:151], v[40:43], a[48:51]
    v_mfma_f32_16x16x32_bf16 a[52:55], v[152:155], v[40:43], a[52:55]
    s_waitcnt lgkmcnt(1)
    v_mfma_f32_16x16x32_bf16 a[60:63], v[152:155], v[44:47], a[60:63]
    v_mfma_f32_16x16x32_bf16 a[56:59], v[148:151], v[44:47], a[56:59]
    v_mfma_f32_16x16x32_bf16 a[0:3], v[92:95], v[72:75], a[0:3]
    v_mfma_f32_16x16x32_bf16 a[4:7], v[96:99], v[72:75], a[4:7]
    s_add_u32 s22, s21, 90112
    v_mfma_f32_16x16x32_bf16 a[12:15], v[96:99], v[76:79], a[12:15]
    buffer_load_dwordx4 v[148:151], v12, s[8:11], s22 offen offset:0
    v_mfma_f32_16x16x32_bf16 a[8:11], v[92:95], v[76:79], a[8:11]
    buffer_load_dwordx4 v[152:155], v12, s[8:11], s22 offen offset:1024
    v_mfma_f32_16x16x32_bf16 a[16:19], v[92:95], v[80:83], a[16:19]
    s_add_u32 m0, s24, 24576
    v_mfma_f32_16x16x32_bf16 a[20:23], v[96:99], v[80:83], a[20:23]
    ds_read_b128 v[52:55], v9 offset:37120
    buffer_load_dwordx4 v26, s[4:7], s26 offen lds
    v_mfma_f32_16x16x32_bf16 a[28:31], v[96:99], v[84:87], a[28:31]
    s_add_u32 m0, s24, 28672
    v_mfma_f32_16x16x32_bf16 a[24:27], v[92:95], v[84:87], a[24:27]
    buffer_load_dwordx4 v27, s[4:7], s26 offen lds
    v_mfma_f32_16x16x32_bf16 a[32:35], v[92:95], v[88:91], a[32:35]
    s_add_u32 m0, s25, 0
    v_mfma_f32_16x16x32_bf16 a[36:39], v[96:99], v[88:91], a[36:39]
    buffer_load_dwordx4 v28, s[4:7], s26 offen lds
    v_mfma_f32_16x16x32_bf16 a[44:47], v[96:99], v[40:43], a[44:47]
    v_mfma_f32_16x16x32_bf16 a[40:43], v[92:95], v[40:43], a[40:43]
    v_mfma_f32_16x16x32_bf16 a[48:51], v[92:95], v[44:47], a[48:51]
    v_mfma_f32_16x16x32_bf16 a[52:55], v[96:99], v[44:47], a[52:55]
    s_waitcnt lgkmcnt(1)
    v_mfma_f32_16x16x32_bf16 a[60:63], v[96:99], v[48:51], a[60:63]
    v_mfma_f32_16x16x32_bf16 a[56:59], v[92:95], v[48:51], a[56:59]
    v_mfma_f32_16x16x32_bf16 a[0:3], v[100:103], v[76:79], a[0:3]
    v_mfma_f32_16x16x32_bf16 a[4:7], v[104:107], v[76:79], a[4:7]
    s_add_u32 s22, s21, 155648
    v_mfma_f32_16x16x32_bf16 a[12:15], v[104:107], v[80:83], a[12:15]
    buffer_load_dwordx4 v[92:95], v12, s[8:11], s22 offen offset:0
    v_mfma_f32_16x16x32_bf16 a[8:11], v[100:103], v[80:83], a[8:11]
    buffer_load_dwordx4 v[96:99], v12, s[8:11], s22 offen offset:1024
    v_mfma_f32_16x16x32_bf16 a[16:19], v[100:103], v[84:87], a[16:19]
    v_mfma_f32_16x16x32_bf16 a[20:23], v[104:107], v[84:87], a[20:23]
    ds_read_b128 v[56:59], v9 offset:37376
    v_mfma_f32_16x16x32_bf16 a[28:31], v[104:107], v[88:91], a[28:31]
    v_mfma_f32_16x16x32_bf16 a[24:27], v[100:103], v[88:91], a[24:27]
    v_mfma_f32_16x16x32_bf16 a[32:35], v[100:103], v[40:43], a[32:35]
    v_mfma_f32_16x16x32_bf16 a[36:39], v[104:107], v[40:43], a[36:39]
    v_mfma_f32_16x16x32_bf16 a[44:47], v[104:107], v[44:47], a[44:47]
    v_mfma_f32_16x16x32_bf16 a[40:43], v[100:103], v[44:47], a[40:43]
    v_mfma_f32_16x16x32_bf16 a[48:51], v[100:103], v[48:51], a[48:51]
    v_mfma_f32_16x16x32_bf16 a[52:55], v[104:107], v[48:51], a[52:55]
    s_waitcnt lgkmcnt(1)
    v_mfma_f32_16x16x32_bf16 a[60:63], v[104:107], v[52:55], a[60:63]
    v_mfma_f32_16x16x32_bf16 a[56:59], v[100:103], v[52:55], a[56:59]
    s_waitcnt vmcnt(21)
    v_mfma_f32_16x16x32_bf16 a[0:3], v[108:111], v[80:83], a[0:3]
    v_mfma_f32_16x16x32_bf16 a[4:7], v[112:115], v[80:83], a[4:7]
    s_add_u32 s22, s21, 221184
    v_mfma_f32_16x16x32_bf16 a[12:15], v[112:115], v[84:87], a[12:15]
    buffer_load_dwordx4 v[100:103], v12, s[8:11], s22 offen offset:0
    v_mfma_f32_16x16x32_bf16 a[8:11], v[108:111], v[84:87], a[8:11]
    buffer_load_dwordx4 v[104:107], v12, s[8:11], s22 offen offset:1024
    v_mfma_f32_16x16x32_bf16 a[16:19], v[108:111], v[88:91], a[16:19]
    v_mfma_f32_16x16x32_bf16 a[20:23], v[112:115], v[88:91], a[20:23]
    ds_read_b128 v[60:63], v9 offset:37632
    v_mfma_f32_16x16x32_bf16 a[28:31], v[112:115], v[40:43], a[28:31]
    v_mfma_f32_16x16x32_bf16 a[24:27], v[108:111], v[40:43], a[24:27]
    v_mfma_f32_16x16x32_bf16 a[32:35], v[108:111], v[44:47], a[32:35]
    v_mfma_f32_16x16x32_bf16 a[36:39], v[112:115], v[44:47], a[36:39]
    v_mfma_f32_16x16x32_bf16 a[44:47], v[112:115], v[48:51], a[44:47]
    v_mfma_f32_16x16x32_bf16 a[40:43], v[108:111], v[48:51], a[40:43]
    v_mfma_f32_16x16x32_bf16 a[48:51], v[108:111], v[52:55], a[48:51]
    v_mfma_f32_16x16x32_bf16 a[52:55], v[112:115], v[52:55], a[52:55]
    s_waitcnt lgkmcnt(1)
    v_mfma_f32_16x16x32_bf16 a[60:63], v[112:115], v[56:59], a[60:63]
    v_mfma_f32_16x16x32_bf16 a[56:59], v[108:111], v[56:59], a[56:59]
    s_waitcnt vmcnt(21)
    v_mfma_f32_16x16x32_bf16 a[0:3], v[116:119], v[84:87], a[0:3]
    v_mfma_f32_16x16x32_bf16 a[4:7], v[120:123], v[84:87], a[4:7]
    s_add_u32 s22, s21, 286720
    v_mfma_f32_16x16x32_bf16 a[12:15], v[120:123], v[88:91], a[12:15]
    buffer_load_dwordx4 v[108:111], v12, s[8:11], s22 offen offset:0
    v_mfma_f32_16x16x32_bf16 a[8:11], v[116:119], v[88:91], a[8:11]
    buffer_load_dwordx4 v[112:115], v12, s[8:11], s22 offen offset:1024
    v_mfma_f32_16x16x32_bf16 a[16:19], v[116:119], v[40:43], a[16:19]
    v_mfma_f32_16x16x32_bf16 a[20:23], v[120:123], v[40:43], a[20:23]
    ds_read_b128 v[64:67], v9 offset:37888
    v_mfma_f32_16x16x32_bf16 a[28:31], v[120:123], v[44:47], a[28:31]
    v_mfma_f32_16x16x32_bf16 a[24:27], v[116:119], v[44:47], a[24:27]
    v_mfma_f32_16x16x32_bf16 a[32:35], v[116:119], v[48:51], a[32:35]
    v_mfma_f32_16x16x32_bf16 a[36:39], v[120:123], v[48:51], a[36:39]
    v_mfma_f32_16x16x32_bf16 a[44:47], v[120:123], v[52:55], a[44:47]
    v_mfma_f32_16x16x32_bf16 a[40:43], v[116:119], v[52:55], a[40:43]
    v_mfma_f32_16x16x32_bf16 a[48:51], v[116:119], v[56:59], a[48:51]
    v_mfma_f32_16x16x32_bf16 a[52:55], v[120:123], v[56:59], a[52:55]
    s_waitcnt lgkmcnt(1)
    v_mfma_f32_16x16x32_bf16 a[60:63], v[120:123], v[60:63], a[60:63]
    v_mfma_f32_16x16x32_bf16 a[56:59], v[116:119], v[60:63], a[56:59]
    s_waitcnt vmcnt(21)
    v_mfma_f32_16x16x32_bf16 a[0:3], v[124:127], v[88:91], a[0:3]
    v_mfma_f32_16x16x32_bf16 a[4:7], v[128:131], v[88:91], a[4:7]
    s_add_u32 s22, s21, 352256
    v_mfma_f32_16x16x32_bf16 a[12:15], v[128:131], v[40:43], a[12:15]
    buffer_load_dwordx4 v[116:119], v12, s[8:11], s22 offen offset:0
    v_mfma_f32_16x16x32_bf16 a[8:11], v[124:127], v[40:43], a[8:11]
    buffer_load_dwordx4 v[120:123], v12, s[8:11], s22 offen offset:1024
    v_mfma_f32_16x16x32_bf16 a[16:19], v[124:127], v[44:47], a[16:19]
    v_mfma_f32_16x16x32_bf16 a[20:23], v[128:131], v[44:47], a[20:23]
    ds_read_b128 v[68:71], v9 offset:38144
    v_mfma_f32_16x16x32_bf16 a[28:31], v[128:131], v[48:51], a[28:31]
    v_mfma_f32_16x16x32_bf16 a[24:27], v[124:127], v[48:51], a[24:27]
    v_mfma_f32_16x16x32_bf16 a[32:35], v[124:127], v[52:55], a[32:35]
    v_mfma_f32_16x16x32_bf16 a[36:39], v[128:131], v[52:55], a[36:39]
    v_mfma_f32_16x16x32_bf16 a[44:47], v[128:131], v[56:59], a[44:47]
    v_mfma_f32_16x16x32_bf16 a[40:43], v[124:127], v[56:59], a[40:43]
    v_mfma_f32_16x16x32_bf16 a[48:51], v[124:127], v[60:63], a[48:51]
    v_mfma_f32_16x16x32_bf16 a[52:55], v[128:131], v[60:63], a[52:55]
    s_waitcnt lgkmcnt(1)
    v_mfma_f32_16x16x32_bf16 a[60:63], v[128:131], v[64:67], a[60:63]
    v_mfma_f32_16x16x32_bf16 a[56:59], v[124:127], v[64:67], a[56:59]
    s_waitcnt vmcnt(21)
    v_mfma_f32_16x16x32_bf16 a[0:3], v[132:135], v[40:43], a[0:3]
    s_waitcnt vmcnt(8) lgkmcnt(0)
    s_barrier
    v_mfma_f32_16x16x32_bf16 a[4:7], v[136:139], v[40:43], a[4:7]
    ds_read_b128 v[40:43], v8 offset:0
    s_add_u32 s22, s21, 417792
    v_mfma_f32_16x16x32_bf16 a[12:15], v[136:139], v[44:47], a[12:15]
    buffer_load_dwordx4 v[124:127], v12, s[8:11], s22 offen offset:0
    v_mfma_f32_16x16x32_bf16 a[8:11], v[132:135], v[44:47], a[8:11]
    ds_read_b128 v[44:47], v8 offset:256
    buffer_load_dwordx4 v[128:131], v12, s[8:11], s22 offen offset:1024
    v_mfma_f32_16x16x32_bf16 a[16:19], v[132:135], v[48:51], a[16:19]
    s_mov_b32 s26, 768
    v_mfma_f32_16x16x32_bf16 a[20:23], v[136:139], v[48:51], a[20:23]
    ds_read_b128 v[48:51], v8 offset:512
    s_add_u32 m0, s24, 34816
    v_mfma_f32_16x16x32_bf16 a[28:31], v[136:139], v[52:55], a[28:31]
    buffer_load_dwordx4 v29, s[4:7], s26 offen lds
    v_mfma_f32_16x16x32_bf16 a[24:27], v[132:135], v[52:55], a[24:27]
    ds_read_b128 v[52:55], v8 offset:768
    s_add_u32 m0, s24, 38912
    v_mfma_f32_16x16x32_bf16 a[32:35], v[132:135], v[56:59], a[32:35]
    buffer_load_dwordx4 v30, s[4:7], s26 offen lds
    v_mfma_f32_16x16x32_bf16 a[36:39], v[136:139], v[56:59], a[36:39]
    ds_read_b128 v[56:59], v8 offset:1024
    s_add_u32 m0, s24, 43008
    v_mfma_f32_16x16x32_bf16 a[44:47], v[136:139], v[60:63], a[44:47]
    buffer_load_dwordx4 v31, s[4:7], s26 offen lds
    v_mfma_f32_16x16x32_bf16 a[40:43], v[132:135], v[60:63], a[40:43]
    ds_read_b128 v[60:63], v8 offset:1280
    v_mfma_f32_16x16x32_bf16 a[48:51], v[132:135], v[64:67], a[48:51]
    v_mfma_f32_16x16x32_bf16 a[52:55], v[136:139], v[64:67], a[52:55]
    ds_read_b128 v[64:67], v8 offset:1536
    v_mfma_f32_16x16x32_bf16 a[60:63], v[136:139], v[68:71], a[60:63]
    v_mfma_f32_16x16x32_bf16 a[56:59], v[132:135], v[68:71], a[56:59]
    ds_read_b128 v[68:71], v8 offset:1792
    s_waitcnt lgkmcnt(7)
    v_mfma_f32_16x16x32_bf16 a[0:3], v[140:143], v[40:43], a[0:3]
    v_mfma_f32_16x16x32_bf16 a[4:7], v[144:147], v[40:43], a[4:7]
    s_add_u32 s22, s21, 483328
    s_waitcnt lgkmcnt(6)
    v_mfma_f32_16x16x32_bf16 a[12:15], v[144:147], v[44:47], a[12:15]
    buffer_load_dwordx4 v[132:135], v12, s[8:11], s22 offen offset:0
    v_mfma_f32_16x16x32_bf16 a[8:11], v[140:143], v[44:47], a[8:11]
    buffer_load_dwordx4 v[136:139], v12, s[8:11], s22 offen offset:1024
    s_waitcnt lgkmcnt(5)
    v_mfma_f32_16x16x32_bf16 a[16:19], v[140:143], v[48:51], a[16:19]
    s_add_u32 m0, s24, 47104
    v_mfma_f32_16x16x32_bf16 a[20:23], v[144:147], v[48:51], a[20:23]
    ds_read_b128 v[72:75], v9 offset:2048
    buffer_load_dwordx4 v32, s[4:7], s26 offen lds
    s_waitcnt lgkmcnt(5)
    v_mfma_f32_16x16x32_bf16 a[28:31], v[144:147], v[52:55], a[28:31]
    s_add_u32 m0, s24, 51200
    v_mfma_f32_16x16x32_bf16 a[24:27], v[140:143], v[52:55], a[24:27]
    buffer_load_dwordx4 v33, s[4:7], s26 offen lds
    s_waitcnt lgkmcnt(4)
    v_mfma_f32_16x16x32_bf16 a[32:35], v[140:143], v[56:59], a[32:35]
    s_add_u32 m0, s24, 55296
    v_mfma_f32_16x16x32_bf16 a[36:39], v[144:147], v[56:59], a[36:39]
    buffer_load_dwordx4 v34, s[4:7], s26 offen lds
    s_waitcnt lgkmcnt(3)
    v_mfma_f32_16x16x32_bf16 a[44:47], v[144:147], v[60:63], a[44:47]
    v_mfma_f32_16x16x32_bf16 a[40:43], v[140:143], v[60:63], a[40:43]
    s_waitcnt lgkmcnt(2)
    v_mfma_f32_16x16x32_bf16 a[48:51], v[140:143], v[64:67], a[48:51]
    v_mfma_f32_16x16x32_bf16 a[52:55], v[144:147], v[64:67], a[52:55]
    s_waitcnt lgkmcnt(1)
    v_mfma_f32_16x16x32_bf16 a[60:63], v[144:147], v[68:71], a[60:63]
    v_mfma_f32_16x16x32_bf16 a[56:59], v[140:143], v[68:71], a[56:59]
    v_mfma_f32_16x16x32_bf16 a[0:3], v[148:151], v[44:47], a[0:3]
    v_mfma_f32_16x16x32_bf16 a[4:7], v[152:155], v[44:47], a[4:7]
    s_add_u32 s22, s21, 57344
    v_mfma_f32_16x16x32_bf16 a[12:15], v[152:155], v[48:51], a[12:15]
    buffer_load_dwordx4 v[140:143], v12, s[8:11], s22 offen offset:0
    v_mfma_f32_16x16x32_bf16 a[8:11], v[148:151], v[48:51], a[8:11]
    buffer_load_dwordx4 v[144:147], v12, s[8:11], s22 offen offset:1024
    v_mfma_f32_16x16x32_bf16 a[16:19], v[148:151], v[52:55], a[16:19]
    s_add_u32 m0, s24, 59392
    v_mfma_f32_16x16x32_bf16 a[20:23], v[152:155], v[52:55], a[20:23]
    ds_read_b128 v[76:79], v9 offset:2304
    buffer_load_dwordx4 v35, s[4:7], s26 offen lds
    v_mfma_f32_16x16x32_bf16 a[28:31], v[152:155], v[56:59], a[28:31]
    s_add_u32 m0, s24, 63488
    v_mfma_f32_16x16x32_bf16 a[24:27], v[148:151], v[56:59], a[24:27]
    buffer_load_dwordx4 v36, s[4:7], s26 offen lds
    v_mfma_f32_16x16x32_bf16 a[32:35], v[148:151], v[60:63], a[32:35]
    s_add_u32 m0, s25, 34816
    v_mfma_f32_16x16x32_bf16 a[36:39], v[152:155], v[60:63], a[36:39]
    buffer_load_dwordx4 v37, s[4:7], s26 offen lds
    v_mfma_f32_16x16x32_bf16 a[44:47], v[152:155], v[64:67], a[44:47]
    v_mfma_f32_16x16x32_bf16 a[40:43], v[148:151], v[64:67], a[40:43]
    v_mfma_f32_16x16x32_bf16 a[48:51], v[148:151], v[68:71], a[48:51]
    v_mfma_f32_16x16x32_bf16 a[52:55], v[152:155], v[68:71], a[52:55]
    s_waitcnt lgkmcnt(1)
    v_mfma_f32_16x16x32_bf16 a[60:63], v[152:155], v[72:75], a[60:63]
    v_mfma_f32_16x16x32_bf16 a[56:59], v[148:151], v[72:75], a[56:59]
    s_waitcnt vmcnt(21)
    v_mfma_f32_16x16x32_bf16 a[0:3], v[92:95], v[48:51], a[0:3]
    v_mfma_f32_16x16x32_bf16 a[4:7], v[96:99], v[48:51], a[4:7]
    s_add_u32 s22, s21, 122880
    v_mfma_f32_16x16x32_bf16 a[12:15], v[96:99], v[52:55], a[12:15]
    buffer_load_dwordx4 v[148:151], v12, s[8:11], s22 offen offset:0
    v_mfma_f32_16x16x32_bf16 a[8:11], v[92:95], v[52:55], a[8:11]
    buffer_load_dwordx4 v[152:155], v12, s[8:11], s22 offen offset:1024
    v_mfma_f32_16x16x32_bf16 a[16:19], v[92:95], v[56:59], a[16:19]
    v_mfma_f32_16x16x32_bf16 a[20:23], v[96:99], v[56:59], a[20:23]
    ds_read_b128 v[80:83], v9 offset:2560
    v_mfma_f32_16x16x32_bf16 a[28:31], v[96:99], v[60:63], a[28:31]
    v_mfma_f32_16x16x32_bf16 a[24:27], v[92:95], v[60:63], a[24:27]
    v_mfma_f32_16x16x32_bf16 a[32:35], v[92:95], v[64:67], a[32:35]
    v_mfma_f32_16x16x32_bf16 a[36:39], v[96:99], v[64:67], a[36:39]
    v_mfma_f32_16x16x32_bf16 a[44:47], v[96:99], v[68:71], a[44:47]
    v_mfma_f32_16x16x32_bf16 a[40:43], v[92:95], v[68:71], a[40:43]
    v_mfma_f32_16x16x32_bf16 a[48:51], v[92:95], v[72:75], a[48:51]
    v_mfma_f32_16x16x32_bf16 a[52:55], v[96:99], v[72:75], a[52:55]
    s_waitcnt lgkmcnt(1)
    v_mfma_f32_16x16x32_bf16 a[60:63], v[96:99], v[76:79], a[60:63]
    v_mfma_f32_16x16x32_bf16 a[56:59], v[92:95], v[76:79], a[56:59]
    s_waitcnt vmcnt(21)
    v_mfma_f32_16x16x32_bf16 a[0:3], v[100:103], v[52:55], a[0:3]
    v_mfma_f32_16x16x32_bf16 a[4:7], v[104:107], v[52:55], a[4:7]
    s_add_u32 s22, s21, 188416
    v_mfma_f32_16x16x32_bf16 a[12:15], v[104:107], v[56:59], a[12:15]
    buffer_load_dwordx4 v[92:95], v12, s[8:11], s22 offen offset:0
    v_mfma_f32_16x16x32_bf16 a[8:11], v[100:103], v[56:59], a[8:11]
    buffer_load_dwordx4 v[96:99], v12, s[8:11], s22 offen offset:1024
    v_mfma_f32_16x16x32_bf16 a[16:19], v[100:103], v[60:63], a[16:19]
    s_mov_b64 exec, s[56:57]
    buffer_load_dword v248, v247, s[92:95], 0 offen sc1
    s_mov_b64 exec, -1
    v_mfma_f32_16x16x32_bf16 a[20:23], v[104:107], v[60:63], a[20:23]
    ds_read_b128 v[84:87], v9 offset:2816
    v_mfma_f32_16x16x32_bf16 a[28:31], v[104:107], v[64:67], a[28:31]
    v_mfma_f32_16x16x32_bf16 a[24:27], v[100:103], v[64:67], a[24:27]
    v_mfma_f32_16x16x32_bf16 a[32:35], v[100:103], v[68:71], a[32:35]
    v_mfma_f32_16x16x32_bf16 a[36:39], v[104:107], v[68:71], a[36:39]
    v_mfma_f32_16x16x32_bf16 a[44:47], v[104:107], v[72:75], a[44:47]
    v_mfma_f32_16x16x32_bf16 a[40:43], v[100:103], v[72:75], a[40:43]
    v_mfma_f32_16x16x32_bf16 a[48:51], v[100:103], v[76:79], a[48:51]
    v_mfma_f32_16x16x32_bf16 a[52:55], v[104:107], v[76:79], a[52:55]
    s_waitcnt lgkmcnt(1)
    v_mfma_f32_16x16x32_bf16 a[60:63], v[104:107], v[80:83], a[60:63]
    v_mfma_f32_16x16x32_bf16 a[56:59], v[100:103], v[80:83], a[56:59]
    s_waitcnt vmcnt(22)
    v_mfma_f32_16x16x32_bf16 a[0:3], v[108:111], v[56:59], a[0:3]
    v_mfma_f32_16x16x32_bf16 a[4:7], v[112:115], v[56:59], a[4:7]
    s_add_u32 s22, s21, 253952
    v_mfma_f32_16x16x32_bf16 a[12:15], v[112:115], v[60:63], a[12:15]
    buffer_load_dwordx4 v[100:103], v12, s[8:11], s22 offen offset:0
    v_mfma_f32_16x16x32_bf16 a[8:11], v[108:111], v[60:63], a[8:11]
    buffer_load_dwordx4 v[104:107], v12, s[8:11], s22 offen offset:1024
    v_mfma_f32_16x16x32_bf16 a[16:19], v[108:111], v[64:67], a[16:19]
    v_mfma_f32_16x16x32_bf16 a[20:23], v[112:115], v[64:67], a[20:23]
    ds_read_b128 v[88:91], v9 offset:3072
    v_mfma_f32_16x16x32_bf16 a[28:31], v[112:115], v[68:71], a[28:31]
    v_mfma_f32_16x16x32_bf16 a[24:27], v[108:111], v[68:71], a[24:27]
    v_mfma_f32_16x16x32_bf16 a[32:35], v[108:111], v[72:75], a[32:35]
    v_mfma_f32_16x16x32_bf16 a[36:39], v[112:115], v[72:75], a[36:39]
    v_mfma_f32_16x16x32_bf16 a[44:47], v[112:115], v[76:79], a[44:47]
    v_mfma_f32_16x16x32_bf16 a[40:43], v[108:111], v[76:79], a[40:43]
    v_mfma_f32_16x16x32_bf16 a[48:51], v[108:111], v[80:83], a[48:51]
    v_mfma_f32_16x16x32_bf16 a[52:55], v[112:115], v[80:83], a[52:55]
    s_waitcnt lgkmcnt(1)
    v_mfma_f32_16x16x32_bf16 a[60:63], v[112:115], v[84:87], a[60:63]
    v_mfma_f32_16x16x32_bf16 a[56:59], v[108:111], v[84:87], a[56:59]
    s_waitcnt vmcnt(22)
    v_mfma_f32_16x16x32_bf16 a[0:3], v[116:119], v[60:63], a[0:3]
    v_mfma_f32_16x16x32_bf16 a[4:7], v[120:123], v[60:63], a[4:7]
    s_add_u32 s22, s21, 319488
    v_mfma_f32_16x16x32_bf16 a[12:15], v[120:123], v[64:67], a[12:15]
    buffer_load_dwordx4 v[108:111], v12, s[8:11], s22 offen offset:0
    v_mfma_f32_16x16x32_bf16 a[8:11], v[116:119], v[64:67], a[8:11]
    buffer_load_dwordx4 v[112:115], v12, s[8:11], s22 offen offset:1024
    v_mfma_f32_16x16x32_bf16 a[16:19], v[116:119], v[68:71], a[16:19]
    v_mfma_f32_16x16x32_bf16 a[20:23], v[120:123], v[68:71], a[20:23]
    ds_read_b128 v[40:43], v9 offset:3328
    v_mfma_f32_16x16x32_bf16 a[28:31], v[120:123], v[72:75], a[28:31]
    v_mfma_f32_16x16x32_bf16 a[24:27], v[116:119], v[72:75], a[24:27]
    v_mfma_f32_16x16x32_bf16 a[32:35], v[116:119], v[76:79], a[32:35]
    v_mfma_f32_16x16x32_bf16 a[36:39], v[120:123], v[76:79], a[36:39]
    v_mfma_f32_16x16x32_bf16 a[44:47], v[120:123], v[80:83], a[44:47]
    v_mfma_f32_16x16x32_bf16 a[40:43], v[116:119], v[80:83], a[40:43]
    v_mfma_f32_16x16x32_bf16 a[48:51], v[116:119], v[84:87], a[48:51]
    v_mfma_f32_16x16x32_bf16 a[52:55], v[120:123], v[84:87], a[52:55]
    s_waitcnt lgkmcnt(1)
    v_mfma_f32_16x16x32_bf16 a[60:63], v[120:123], v[88:91], a[60:63]
    v_mfma_f32_16x16x32_bf16 a[56:59], v[116:119], v[88:91], a[56:59]
    s_waitcnt vmcnt(22)
    v_mfma_f32_16x16x32_bf16 a[0:3], v[124:127], v[64:67], a[0:3]
    v_mfma_f32_16x16x32_bf16 a[4:7], v[128:131], v[64:67], a[4:7]
    s_add_u32 s22, s21, 385024
    v_mfma_f32_16x16x32_bf16 a[12:15], v[128:131], v[68:71], a[12:15]
    buffer_load_dwordx4 v[116:119], v12, s[8:11], s22 offen offset:0
    v_mfma_f32_16x16x32_bf16 a[8:11], v[124:127], v[68:71], a[8:11]
    buffer_load_dwordx4 v[120:123], v12, s[8:11], s22 offen offset:1024
    v_mfma_f32_16x16x32_bf16 a[16:19], v[124:127], v[72:75], a[16:19]
    v_mfma_f32_16x16x32_bf16 a[20:23], v[128:131], v[72:75], a[20:23]
    ds_read_b128 v[44:47], v9 offset:3584
    v_mfma_f32_16x16x32_bf16 a[28:31], v[128:131], v[76:79], a[28:31]
    v_mfma_f32_16x16x32_bf16 a[24:27], v[124:127], v[76:79], a[24:27]
    v_mfma_f32_16x16x32_bf16 a[32:35], v[124:127], v[80:83], a[32:35]
    v_mfma_f32_16x16x32_bf16 a[36:39], v[128:131], v[80:83], a[36:39]
    v_mfma_f32_16x16x32_bf16 a[44:47], v[128:131], v[84:87], a[44:47]
    v_mfma_f32_16x16x32_bf16 a[40:43], v[124:127], v[84:87], a[40:43]
    v_mfma_f32_16x16x32_bf16 a[48:51], v[124:127], v[88:91], a[48:51]
    v_mfma_f32_16x16x32_bf16 a[52:55], v[128:131], v[88:91], a[52:55]
    s_waitcnt lgkmcnt(1)
    v_mfma_f32_16x16x32_bf16 a[60:63], v[128:131], v[40:43], a[60:63]
    v_mfma_f32_16x16x32_bf16 a[56:59], v[124:127], v[40:43], a[56:59]
    s_waitcnt vmcnt(19)
    v_mfma_f32_16x16x32_bf16 a[0:3], v[132:135], v[68:71], a[0:3]
    s_waitcnt vmcnt(11) lgkmcnt(0)
    s_barrier
    v_mfma_f32_16x16x32_bf16 a[4:7], v[136:139], v[68:71], a[4:7]
    ds_read_b128 v[68:71], v8 offset:34816
    s_add_u32 s22, s21, 450560
    v_mfma_f32_16x16x32_bf16 a[12:15], v[136:139], v[72:75], a[12:15]
    buffer_load_dwordx4 v[124:127], v12, s[8:11], s22 offen offset:0
    v_mfma_f32_16x16x32_bf16 a[8:11], v[132:135], v[72:75], a[8:11]
    ds_read_b128 v[72:75], v8 offset:35072
    buffer_load_dwordx4 v[128:131], v12, s[8:11], s22 offen offset:1024
    v_mfma_f32_16x16x32_bf16 a[16:19], v[132:135], v[76:79], a[16:19]
    s_mov_b64 exec, s[56:57]
    s_waitcnt vmcnt(8)
    v_cmp_ne_u32 vcc, s100, v248
    s_nop 4
    s_cbranch_vccz p2_chk10
    s_mov_b32 s27, 0x20000
p2_poll11:
    buffer_load_dword v248, v247, s[92:95], 0 offen sc1
    s_waitcnt vmcnt(0)
    v_cmp_ne_u32 vcc, s100, v248
    s_sub_u32 s27, s27, 1
    s_cmp_eq_u32 s27, 0
    s_cbranch_scc1 p2_poll11_done
    s_cbranch_vccz p2_poll11_done
    s_sleep 4
    s_branch p2_poll11
p2_poll11_done:
p2_chk10:
    s_mov_b64 exec, -1
    v_mfma_f32_16x16x32_bf16 a[20:23], v[136:139], v[76:79], a[20:23]
    ds_read_b128 v[76:79], v8 offset:35328
    s_mov_b32 s26, 256
    v_mfma_f32_16x16x32_bf16 a[28:31], v[136:139], v[80:83], a[28:31]
    s_add_u32 m0, s24, 0
    v_mfma_f32_16x16x32_bf16 a[24:27], v[132:135], v[80:83], a[24:27]
    ds_read_b128 v[80:83], v8 offset:35584
    buffer_load_dwordx4 v20, s[4:7], s26 offen lds
    v_mfma_f32_16x16x32_bf16 a[32:35], v[132:135], v[84:87], a[32:35]
    s_add_u32 m0, s24, 4096
    v_mfma_f32_16x16x32_bf16 a[36:39], v[136:139], v[84:87], a[36:39]
    ds_read_b128 v[84:87], v8 offset:35840
    buffer_load_dwordx4 v21, s[4:7], s26 offen lds
    v_mfma_f32_16x16x32_bf16 a[44:47], v[136:139], v[88:91], a[44:47]
    s_add_u32 m0, s24, 8192
    v_mfma_f32_16x16x32_bf16 a[40:43], v[132:135], v[88:91], a[40:43]
    ds_read_b128 v[88:91], v8 offset:36096
    buffer_load_dwordx4 v22, s[4:7], s26 offen lds
    v_mfma_f32_16x16x32_bf16 a[48:51], v[132:135], v[40:43], a[48:51]
    v_mfma_f32_16x16x32_bf16 a[52:55], v[136:139], v[40:43], a[52:55]
    ds_read_b128 v[40:43], v8 offset:36352
    v_mfma_f32_16x16x32_bf16 a[60:63], v[136:139], v[44:47], a[60:63]
    v_mfma_f32_16x16x32_bf16 a[56:59], v[132:135], v[44:47], a[56:59]
    ds_read_b128 v[44:47], v8 offset:36608
    s_waitcnt lgkmcnt(7)
    v_mfma_f32_16x16x32_bf16 a[0:3], v[140:143], v[68:71], a[0:3]
    v_mfma_f32_16x16x32_bf16 a[4:7], v[144:147], v[68:71], a[4:7]
    s_add_u32 s22, s21, 8192
    s_waitcnt lgkmcnt(6)
    v_mfma_f32_16x16x32_bf16 a[12:15], v[144:147], v[72:75], a[12:15]
    buffer_load_dwordx4 v[132:135], v12, s[8:11], s22 offen offset:0
    v_mfma_f32_16x16x32_bf16 a[8:11], v[140:143], v[72:75], a[8:11]
    buffer_load_dwordx4 v[136:139], v12, s[8:11], s22 offen offset:1024
    s_waitcnt lgkmcnt(5)
    v_mfma_f32_16x16x32_bf16 a[16:19], v[140:143], v[76:79], a[16:19]
    s_add_u32 m0, s24, 12288
    v_mfma_f32_16x16x32_bf16 a[20:23], v[144:147], v[76:79], a[20:23]
    ds_read_b128 v[48:51], v9 offset:36864
    buffer_load_dwordx4 v23, s[4:7], s26 offen lds
    s_waitcnt lgkmcnt(5)
    v_mfma_f32_16x16x32_bf16 a[28:31], v[144:147], v[80:83], a[28:31]
    s_add_u32 m0, s24, 16384
    v_mfma_f32_16x16x32_bf16 a[24:27], v[140:143], v[80:83], a[24:27]
    buffer_load_dwordx4 v24, s[4:7], s26 offen lds
    s_waitcnt lgkmcnt(4)
    v_mfma_f32_16x16x32_bf16 a[32:35], v[140:143], v[84:87], a[32:35]
    s_add_u32 m0, s24, 20480
    v_mfma_f32_16x16x32_bf16 a[36:39], v[144:147], v[84:87], a[36:39]
    buffer_load_dwordx4 v25, s[4:7], s26 offen lds
    s_waitcnt lgkmcnt(3)
    v_mfma_f32_16x16x32_bf16 a[44:47], v[144:147], v[88:91], a[44:47]
    v_mfma_f32_16x16x32_bf16 a[40:43], v[140:143], v[88:91], a[40:43]
    s_waitcnt lgkmcnt(2)
    v_mfma_f32_16x16x32_bf16 a[48:51], v[140:143], v[40:43], a[48:51]
    v_mfma_f32_16x16x32_bf16 a[52:55], v[144:147], v[40:43], a[52:55]
    s_waitcnt lgkmcnt(1)
    v_mfma_f32_16x16x32_bf16 a[60:63], v[144:147], v[44:47], a[60:63]
    v_mfma_f32_16x16x32_bf16 a[56:59], v[140:143], v[44:47], a[56:59]
    v_mfma_f32_16x16x32_bf16 a[0:3], v[148:151], v[72:75], a[0:3]
    v_mfma_f32_16x16x32_bf16 a[4:7], v[152:155], v[72:75], a[4:7]
    s_add_u32 s22, s21, 73728
    v_mfma_f32_16x16x32_bf16 a[12:15], v[152:155], v[76:79], a[12:15]
    buffer_load_dwordx4 v[140:143], v12, s[8:11], s22 offen offset:0
    v_mfma_f32_16x16x32_bf16 a[8:11], v[148:151], v[76:79], a[8:11]
    buffer_load_dwordx4 v[144:147], v12, s[8:11], s22 offen offset:1024
    v_mfma_f32_16x16x32_bf16 a[16:19], v[148:151], v[80:83], a[16:19]
    s_add_u32 m0, s24, 24576
    v_mfma_f32_16x16x32_bf16 a[20:23], v[152:155], v[80:83], a[20:23]
    ds_read_b128 v[52:55], v9 offset:37120
    buffer_load_dwordx4 v26, s[4:7], s26 offen lds
    v_mfma_f32_16x16x32_bf16 a[28:31], v[152:155], v[84:87], a[28:31]
    s_add_u32 m0, s24, 28672
    v_mfma_f32_16x16x32_bf16 a[24:27], v[148:151], v[84:87], a[24:27]
    buffer_load_dwordx4 v27, s[4:7], s26 offen lds
    v_mfma_f32_16x16x32_bf16 a[32:35], v[148:151], v[88:91], a[32:35]
    s_add_u32 m0, s25, 0
    v_mfma_f32_16x16x32_bf16 a[36:39], v[152:155], v[88:91], a[36:39]
    buffer_load_dwordx4 v28, s[4:7], s26 offen lds
    v_mfma_f32_16x16x32_bf16 a[44:47], v[152:155], v[40:43], a[44:47]
    v_mfma_f32_16x16x32_bf16 a[40:43], v[148:151], v[40:43], a[40:43]
    v_mfma_f32_16x16x32_bf16 a[48:51], v[148:151], v[44:47], a[48:51]
    v_mfma_f32_16x16x32_bf16 a[52:55], v[152:155], v[44:47], a[52:55]
    s_waitcnt lgkmcnt(1)
    v_mfma_f32_16x16x32_bf16 a[60:63], v[152:155], v[48:51], a[60:63]
    v_mfma_f32_16x16x32_bf16 a[56:59], v[148:151], v[48:51], a[56:59]
    v_mfma_f32_16x16x32_bf16 a[0:3], v[92:95], v[76:79], a[0:3]
    v_mfma_f32_16x16x32_bf16 a[4:7], v[96:99], v[76:79], a[4:7]
    s_add_u32 s22, s21, 139264
    v_mfma_f32_16x16x32_bf16 a[12:15], v[96:99], v[80:83], a[12:15]
    buffer_load_dwordx4 v[148:151], v12, s[8:11], s22 offen offset:0
    v_mfma_f32_16x16x32_bf16 a[8:11], v[92:95], v[80:83], a[8:11]
    buffer_load_dwordx4 v[152:155], v12, s[8:11], s22 offen offset:1024
    v_mfma_f32_16x16x32_bf16 a[16:19], v[92:95], v[84:87], a[16:19]
    v_mfma_f32_16x16x32_bf16 a[20:23], v[96:99], v[84:87], a[20:23]
    ds_read_b128 v[56:59], v9 offset:37376
    v_mfma_f32_16x16x32_bf16 a[28:31], v[96:99], v[88:91], a[28:31]
    v_mfma_f32_16x16x32_bf16 a[24:27], v[92:95], v[88:91], a[24:27]
    v_mfma_f32_16x16x32_bf16 a[32:35], v[92:95], v[40:43], a[32:35]
    v_mfma_f32_16x16x32_bf16 a[36:39], v[96:99], v[40:43], a[36:39]
    v_mfma_f32_16x16x32_bf16 a[44:47], v[96:99], v[44:47], a[44:47]
    v_mfma_f32_16x16x32_bf16 a[40:43], v[92:95], v[44:47], a[40:43]
    v_mfma_f32_16x16x32_bf16 a[48:51], v[92:95], v[48:51], a[48:51]
    v_mfma_f32_16x16x32_bf16 a[52:55], v[96:99], v[48:51], a[52:55]
    s_waitcnt lgkmcnt(1)
    v_mfma_f32_16x16x32_bf16 a[60:63], v[96:99], v[52:55], a[60:63]
    v_mfma_f32_16x16x32_bf16 a[56:59], v[92:95], v[52:55], a[56:59]
    s_waitcnt vmcnt(21)
    v_mfma_f32_16x16x32_bf16 a[0:3], v[100:103], v[80:83], a[0:3]
    v_mfma_f32_16x16x32_bf16 a[4:7], v[104:107], v[80:83], a[4:7]
    s_add_u32 s22, s21, 204800
    v_mfma_f32_16x16x32_bf16 a[12:15], v[104:107], v[84:87], a[12:15]
    buffer_load_dwordx4 v[92:95], v12, s[8:11], s22 offen offset:0
    v_mfma_f32_16x16x32_bf16 a[8:11], v[100:103], v[84:87], a[8:11]
    buffer_load_dwordx4 v[96:99], v12, s[8:11], s22 offen offset:1024
    v_mfma_f32_16x16x32_bf16 a[16:19], v[100:103], v[88:91], a[16:19]
    v_mfma_f32_16x16x32_bf16 a[20:23], v[104:107], v[88:91], a[20:23]
    ds_read_b128 v[60:63], v9 offset:37632
    v_mfma_f32_16x16x32_bf16 a[28:31], v[104:107], v[40:43], a[28:31]
    v_mfma_f32_16x16x32_bf16 a[24:27], v[100:103], v[40:43], a[24:27]
    v_mfma_f32_16x16x32_bf16 a[32:35], v[100:103], v[44:47], a[32:35]
    v_mfma_f32_16x16x32_bf16 a[36:39], v[104:107], v[44:47], a[36:39]
    v_mfma_f32_16x16x32_bf16 a[44:47], v[104:107], v[48:51], a[44:47]
    v_mfma_f32_16x16x32_bf16 a[40:43], v[100:103], v[48:51], a[40:43]
    v_mfma_f32_16x16x32_bf16 a[48:51], v[100:103], v[52:55], a[48:51]
    v_mfma_f32_16x16x32_bf16 a[52:55], v[104:107], v[52:55], a[52:55]
    s_waitcnt lgkmcnt(1)
    v_mfma_f32_16x16x32_bf16 a[60:63], v[104:107], v[56:59], a[60:63]
    v_mfma_f32_16x16x32_bf16 a[56:59], v[100:103], v[56:59], a[56:59]
    s_waitcnt vmcnt(21)
    v_mfma_f32_16x16x32_bf16 a[0:3], v[108:111], v[84:87], a[0:3]
    v_mfma_f32_16x16x32_bf16 a[4:7], v[112:115], v[84:87], a[4:7]
    s_add_u32 s22, s21, 270336
    v_mfma_f32_16x16x32_bf16 a[12:15], v[112:115], v[88:91], a[12:15]
    buffer_load_dwordx4 v[100:103], v12, s[8:11], s22 offen offset:0
    v_mfma_f32_16x16x32_bf16 a[8:11], v[108:111], v[88:91], a[8:11]
    buffer_load_dwordx4 v[104:107], v12, s[8:11], s22 offen offset:1024
    v_mfma_f32_16x16x32_bf16 a[16:19], v[108:111], v[40:43], a[16:19]
    v_mfma_f32_16x16x32_bf16 a[20:23], v[112:115], v[40:43], a[20:23]
    ds_read_b128 v[64:67], v9 offset:37888
    v_mfma_f32_16x16x32_bf16 a[28:31], v[112:115], v[44:47], a[28:31]
    v_mfma_f32_16x16x32_bf16 a[24:27], v[108:111], v[44:47], a[24:27]
    v_mfma_f32_16x16x32_bf16 a[32:35], v[108:111], v[48:51], a[32:35]
    v_mfma_f32_16x16x32_bf16 a[36:39], v[112:115], v[48:51], a[36:39]
    v_mfma_f32_16x16x32_bf16 a[44:47], v[112:115], v[52:55], a[44:47]
    v_mfma_f32_16x16x32_bf16 a[40:43], v[108:111], v[52:55], a[40:43]
    v_mfma_f32_16x16x32_bf16 a[48:51], v[108:111], v[56:59], a[48:51]
    v_mfma_f32_16x16x32_bf16 a[52:55], v[112:115], v[56:59], a[52:55]
    s_waitcnt lgkmcnt(1)
    v_mfma_f32_16x16x32_bf16 a[60:63], v[112:115], v[60:63], a[60:63]
    v_mfma_f32_16x16x32_bf16 a[56:59], v[108:111], v[60:63], a[56:59]
    s_waitcnt vmcnt(21)
    v_mfma_f32_16x16x32_bf16 a[0:3], v[116:119], v[88:91], a[0:3]
    v_mfma_f32_16x16x32_bf16 a[4:7], v[120:123], v[88:91], a[4:7]
    s_add_u32 s22, s21, 335872
    v_mfma_f32_16x16x32_bf16 a[12:15], v[120:123], v[40:43], a[12:15]
    buffer_load_dwordx4 v[108:111], v12, s[8:11], s22 offen offset:0
    v_mfma_f32_16x16x32_bf16 a[8:11], v[116:119], v[40:43], a[8:11]
    buffer_load_dwordx4 v[112:115], v12, s[8:11], s22 offen offset:1024
    v_mfma_f32_16x16x32_bf16 a[16:19], v[116:119], v[44:47], a[16:19]
    v_mfma_f32_16x16x32_bf16 a[20:23], v[120:123], v[44:47], a[20:23]
    ds_read_b128 v[68:71], v9 offset:38144
    v_mfma_f32_16x16x32_bf16 a[28:31], v[120:123], v[48:51], a[28:31]
    v_mfma_f32_16x16x32_bf16 a[24:27], v[116:119], v[48:51], a[24:27]
    v_mfma_f32_16x16x32_bf16 a[32:35], v[116:119], v[52:55], a[32:35]
    v_mfma_f32_16x16x32_bf16 a[36:39], v[120:123], v[52:55], a[36:39]
    v_mfma_f32_16x16x32_bf16 a[44:47], v[120:123], v[56:59], a[44:47]
    v_mfma_f32_16x16x32_bf16 a[40:43], v[116:119], v[56:59], a[40:43]
    v_mfma_f32_16x16x32_bf16 a[48:51], v[116:119], v[60:63], a[48:51]
    v_mfma_f32_16x16x32_bf16 a[52:55], v[120:123], v[60:63], a[52:55]
    s_waitcnt lgkmcnt(1)
    v_mfma_f32_16x16x32_bf16 a[60:63], v[120:123], v[64:67], a[60:63]
    v_mfma_f32_16x16x32_bf16 a[56:59], v[116:119], v[64:67], a[56:59]
    s_waitcnt vmcnt(21)
    v_mfma_f32_16x16x32_bf16 a[0:3], v[124:127], v[40:43], a[0:3]
    s_waitcnt vmcnt(8) lgkmcnt(0)
    s_barrier
    v_mfma_f32_16x16x32_bf16 a[4:7], v[128:131], v[40:43], a[4:7]
    ds_read_b128 v[40:43], v8 offset:0
    s_add_u32 s22, s21, 401408
    v_mfma_f32_16x16x32_bf16 a[12:15], v[128:131], v[44:47], a[12:15]
    buffer_load_dwordx4 v[116:119], v12, s[8:11], s22 offen offset:0
    v_mfma_f32_16x16x32_bf16 a[8:11], v[124:127], v[44:47], a[8:11]
    ds_read_b128 v[44:47], v8 offset:256
    buffer_load_dwordx4 v[120:123], v12, s[8:11], s22 offen offset:1024
    v_mfma_f32_16x16x32_bf16 a[16:19], v[124:127], v[48:51], a[16:19]
    s_mov_b32 s26, 256
    v_mfma_f32_16x16x32_bf16 a[20:23], v[128:131], v[48:51], a[20:23]
    ds_read_b128 v[48:51], v8 offset:512
    s_add_u32 m0, s24, 34816
    v_mfma_f32_16x16x32_bf16 a[28:31], v[128:131], v[52:55], a[28:31]
    buffer_load_dwordx4 v29, s[4:7], s26 offen lds
    v_mfma_f32_16x16x32_bf16 a[24:27], v[124:127], v[52:55], a[24:27]
    ds_read_b128 v[52:55], v8 offset:768
    s_add_u32 m0, s24, 38912
    v_mfma_f32_16x16x32_bf16 a[32:35], v[124:127], v[56:59], a[32:35]
    buffer_load_dwordx4 v30, s[4:7], s26 offen lds
    v_mfma_f32_16x16x32_bf16 a[36:39], v[128:131], v[56:59], a[36:39]
    ds_read_b128 v[56:59], v8 offset:1024
    s_add_u32 m0, s24, 43008
    v_mfma_f32_16x16x32_bf16 a[44:47], v[128:131], v[60:63], a[44:47]
    buffer_load_dwordx4 v31, s[4:7], s26 offen lds
    v_mfma_f32_16x16x32_bf16 a[40:43], v[124:127], v[60:63], a[40:43]
    ds_read_b128 v[60:63], v8 offset:1280
    v_mfma_f32_16x16x32_bf16 a[48:51], v[124:127], v[64:67], a[48:51]
    v_mfma_f32_16x16x32_bf16 a[52:55], v[128:131], v[64:67], a[52:55]
    ds_read_b128 v[64:67], v8 offset:1536
    v_mfma_f32_16x16x32_bf16 a[60:63], v[128:131], v[68:71], a[60:63]
    v_mfma_f32_16x16x32_bf16 a[56:59], v[124:127], v[68:71], a[56:59]
    ds_read_b128 v[68:71], v8 offset:1792
    s_waitcnt lgkmcnt(7)
    v_mfma_f32_16x16x32_bf16 a[0:3], v[132:135], v[40:43], a[0:3]
    v_mfma_f32_16x16x32_bf16 a[4:7], v[136:139], v[40:43], a[4:7]
    s_add_u32 s22, s21, 466944
    s_waitcnt lgkmcnt(6)
    v_mfma_f32_16x16x32_bf16 a[12:15], v[136:139], v[44:47], a[12:15]
    buffer_load_dwordx4 v[124:127], v12, s[8:11], s22 offen offset:0
    v_mfma_f32_16x16x32_bf16 a[8:11], v[132:135], v[44:47], a[8:11]
    buffer_load_dwordx4 v[128:131], v12, s[8:11], s22 offen offset:1024
    s_waitcnt lgkmcnt(5)
    v_mfma_f32_16x16x32_bf16 a[16:19], v[132:135], v[48:51], a[16:19]
    s_add_u32 m0, s24, 47104
    v_mfma_f32_16x16x32_bf16 a[20:23], v[136:139], v[48:51], a[20:23]
    ds_read_b128 v[72:75], v9 offset:2048
    buffer_load_dwordx4 v32, s[4:7], s26 offen lds
    s_waitcnt lgkmcnt(5)
    v_mfma_f32_16x16x32_bf16 a[28:31], v[136:139], v[52:55], a[28:31]
    s_add_u32 m0, s24, 51200
    v_mfma_f32_16x16x32_bf16 a[24:27], v[132:135], v[52:55], a[24:27]
    buffer_load_dwordx4 v33, s[4:7], s26 offen lds
    s_waitcnt lgkmcnt(4)
    v_mfma_f32_16x16x32_bf16 a[32:35], v[132:135], v[56:59], a[32:35]
    s_add_u32 m0, s24, 55296
    v_mfma_f32_16x16x32_bf16 a[36:39], v[136:139], v[56:59], a[36:39]
    buffer_load_dwordx4 v34, s[4:7], s26 offen lds
    s_waitcnt lgkmcnt(3)
    v_mfma_f32_16x16x32_bf16 a[44:47], v[136:139], v[60:63], a[44:47]
    v_mfma_f32_16x16x32_bf16 a[40:43], v[132:135], v[60:63], a[40:43]
    s_waitcnt lgkmcnt(2)
    v_mfma_f32_16x16x32_bf16 a[48:51], v[132:135], v[64:67], a[48:51]
    v_mfma_f32_16x16x32_bf16 a[52:55], v[136:139], v[64:67], a[52:55]
    s_waitcnt lgkmcnt(1)
    v_mfma_f32_16x16x32_bf16 a[60:63], v[136:139], v[68:71], a[60:63]
    v_mfma_f32_16x16x32_bf16 a[56:59], v[132:135], v[68:71], a[56:59]
    v_mfma_f32_16x16x32_bf16 a[0:3], v[140:143], v[44:47], a[0:3]
    v_mfma_f32_16x16x32_bf16 a[4:7], v[144:147], v[44:47], a[4:7]
    s_add_u32 s22, s21, 40960
    v_mfma_f32_16x16x32_bf16 a[12:15], v[144:147], v[48:51], a[12:15]
    buffer_load_dwordx4 v[132:135], v12, s[8:11], s22 offen offset:0
    v_mfma_f32_16x16x32_bf16 a[8:11], v[140:143], v[48:51], a[8:11]
    buffer_load_dwordx4 v[136:139], v12, s[8:11], s22 offen offset:1024
    v_mfma_f32_16x16x32_bf16 a[16:19], v[140:143], v[52:55], a[16:19]
    s_add_u32 m0, s24, 59392
    v_mfma_f32_16x16x32_bf16 a[20:23], v[144:147], v[52:55], a[20:23]
    ds_read_b128 v[76:79], v9 offset:2304
    buffer_load_dwordx4 v35, s[4:7], s26 offen lds
    v_mfma_f32_16x16x32_bf16 a[28:31], v[144:147], v[56:59], a[28:31]
    s_add_u32 m0, s24, 63488
    v_mfma_f32_16x16x32_bf16 a[24:27], v[140:143], v[56:59], a[24:27]
    buffer_load_dwordx4 v36, s[4:7], s26 offen lds
    v_mfma_f32_16x16x32_bf16 a[32:35], v[140:143], v[60:63], a[32:35]
    s_add_u32 m0, s25, 34816
    v_mfma_f32_16x16x32_bf16 a[36:39], v[144:147], v[60:63], a[36:39]
    buffer_load_dwordx4 v37, s[4:7], s26 offen lds
    v_mfma_f32_16x16x32_bf16 a[44:47], v[144:147], v[64:67], a[44:47]
    v_mfma_f32_16x16x32_bf16 a[40:43], v[140:143], v[64:67], a[40:43]
    v_mfma_f32_16x16x32_bf16 a[48:51], v[140:143], v[68:71], a[48:51]
    v_mfma_f32_16x16x32_bf16 a[52:55], v[144:147], v[68:71], a[52:55]
    s_waitcnt lgkmcnt(1)
    v_mfma_f32_16x16x32_bf16 a[60:63], v[144:147], v[72:75], a[60:63]
    v_mfma_f32_16x16x32_bf16 a[56:59], v[140:143], v[72:75], a[56:59]
    s_waitcnt vmcnt(21)
    v_mfma_f32_16x16x32_bf16 a[0:3], v[148:151], v[48:51], a[0:3]
    v_mfma_f32_16x16x32_bf16 a[4:7], v[152:155], v[48:51], a[4:7]
    s_add_u32 s22, s21, 106496
    v_mfma_f32_16x16x32_bf16 a[12:15], v[152:155], v[52:55], a[12:15]
    buffer_load_dwordx4 v[140:143], v12, s[8:11], s22 offen offset:0
    v_mfma_f32_16x16x32_bf16 a[8:11], v[148:151], v[52:55], a[8:11]
    buffer_load_dwordx4 v[144:147], v12, s[8:11], s22 offen offset:1024
    v_mfma_f32_16x16x32_bf16 a[16:19], v[148:151], v[56:59], a[16:19]
    v_mfma_f32_16x16x32_bf16 a[20:23], v[152:155], v[56:59], a[20:23]
    ds_read_b128 v[80:83], v9 offset:2560
    v_mfma_f32_16x16x32_bf16 a[28:31], v[152:155], v[60:63], a[28:31]
    v_mfma_f32_16x16x32_bf16 a[24:27], v[148:151], v[60:63], a[24:27]
    v_mfma_f32_16x16x32_bf16 a[32:35], v[148:151], v[64:67], a[32:35]
    v_mfma_f32_16x16x32_bf16 a[36:39], v[152:155], v[64:67], a[36:39]
    v_mfma_f32_16x16x32_bf16 a[44:47], v[152:155], v[68:71], a[44:47]
    v_mfma_f32_16x16x32_bf16 a[40:43], v[148:151], v[68:71], a[40:43]
    v_mfma_f32_16x16x32_bf16 a[48:51], v[148:151], v[72:75], a[48:51]
    v_mfma_f32_16x16x32_bf16 a[52:55], v[152:155], v[72:75], a[52:55]
    s_waitcnt lgkmcnt(1)
    v_mfma_f32_16x16x32_bf16 a[60:63], v[152:155], v[76:79], a[60:63]
    v_mfma_f32_16x16x32_bf16 a[56:59], v[148:151], v[76:79], a[56:59]
    s_waitcnt vmcnt(21)
    v_mfma_f32_16x16x32_bf16 a[0:3], v[92:95], v[52:55], a[0:3]
    v_mfma_f32_16x16x32_bf16 a[4:7], v[96:99], v[52:55], a[4:7]
    s_add_u32 s22, s21, 172032
    v_mfma_f32_16x16x32_bf16 a[12:15], v[96:99], v[56:59], a[12:15]
    buffer_load_dwordx4 v[148:151], v12, s[8:11], s22 offen offset:0
    v_mfma_f32_16x16x32_bf16 a[8:11], v[92:95], v[56:59], a[8:11]
    buffer_load_dwordx4 v[152:155], v12, s[8:11], s22 offen offset:1024
    v_mfma_f32_16x16x32_bf16 a[16:19], v[92:95], v[60:63], a[16:19]
    v_mfma_f32_16x16x32_bf16 a[20:23], v[96:99], v[60:63], a[20:23]
    ds_read_b128 v[84:87], v9 offset:2816
    v_mfma_f32_16x16x32_bf16 a[28:31], v[96:99], v[64:67], a[28:31]
    v_mfma_f32_16x16x32_bf16 a[24:27], v[92:95], v[64:67], a[24:27]
    v_mfma_f32_16x16x32_bf16 a[32:35], v[92:95], v[68:71], a[32:35]
    v_mfma_f32_16x16x32_bf16 a[36:39], v[96:99], v[68:71], a[36:39]
    v_mfma_f32_16x16x32_bf16 a[44:47], v[96:99], v[72:75], a[44:47]
    v_mfma_f32_16x16x32_bf16 a[40:43], v[92:95], v[72:75], a[40:43]
    v_mfma_f32_16x16x32_bf16 a[48:51], v[92:95], v[76:79], a[48:51]
    v_mfma_f32_16x16x32_bf16 a[52:55], v[96:99], v[76:79], a[52:55]
    s_waitcnt lgkmcnt(1)
    v_mfma_f32_16x16x32_bf16 a[60:63], v[96:99], v[80:83], a[60:63]
    v_mfma_f32_16x16x32_bf16 a[56:59], v[92:95], v[80:83], a[56:59]
    s_waitcnt vmcnt(21)
    v_mfma_f32_16x16x32_bf16 a[0:3], v[100:103], v[56:59], a[0:3]
    v_mfma_f32_16x16x32_bf16 a[4:7], v[104:107], v[56:59], a[4:7]
    s_add_u32 s22, s21, 237568
    v_mfma_f32_16x16x32_bf16 a[12:15], v[104:107], v[60:63], a[12:15]
    buffer_load_dwordx4 v[92:95], v12, s[8:11], s22 offen offset:0
    v_mfma_f32_16x16x32_bf16 a[8:11], v[100:103], v[60:63], a[8:11]
    buffer_load_dwordx4 v[96:99], v12, s[8:11], s22 offen offset:1024
    v_mfma_f32_16x16x32_bf16 a[16:19], v[100:103], v[64:67], a[16:19]
    v_mfma_f32_16x16x32_bf16 a[20:23], v[104:107], v[64:67], a[20:23]
    ds_read_b128 v[88:91], v9 offset:3072
    v_mfma_f32_16x16x32_bf16 a[28:31], v[104:107], v[68:71], a[28:31]
    v_mfma_f32_16x16x32_bf16 a[24:27], v[100:103], v[68:71], a[24:27]
    v_mfma_f32_16x16x32_bf16 a[32:35], v[100:103], v[72:75], a[32:35]
    v_mfma_f32_16x16x32_bf16 a[36:39], v[104:107], v[72:75], a[36:39]
    v_mfma_f32_16x16x32_bf16 a[44:47], v[104:107], v[76:79], a[44:47]
    v_mfma_f32_16x16x32_bf16 a[40:43], v[100:103], v[76:79], a[40:43]
    v_mfma_f32_16x16x32_bf16 a[48:51], v[100:103], v[80:83], a[48:51]
    v_mfma_f32_16x16x32_bf16 a[52:55], v[104:107], v[80:83], a[52:55]
    s_waitcnt lgkmcnt(1)
    v_mfma_f32_16x16x32_bf16 a[60:63], v[104:107], v[84:87], a[60:63]
    v_mfma_f32_16x16x32_bf16 a[56:59], v[100:103], v[84:87], a[56:59]
    s_waitcnt vmcnt(21)
    v_mfma_f32_16x16x32_bf16 a[0:3], v[108:111], v[60:63], a[0:3]
    v_mfma_f32_16x16x32_bf16 a[4:7], v[112:115], v[60:63], a[4:7]
    s_add_u32 s22, s21, 303104
    v_mfma_f32_16x16x32_bf16 a[12:15], v[112:115], v[64:67], a[12:15]
    buffer_load_dwordx4 v[100:103], v12, s[8:11], s22 offen offset:0
    v_mfma_f32_16x16x32_bf16 a[8:11], v[108:111], v[64:67], a[8:11]
    buffer_load_dwordx4 v[104:107], v12, s[8:11], s22 offen offset:1024
    v_mfma_f32_16x16x32_bf16 a[16:19], v[108:111], v[68:71], a[16:19]
    v_mfma_f32_16x16x32_bf16 a[20:23], v[112:115], v[68:71], a[20:23]
    ds_read_b128 v[40:43], v9 offset:3328
    v_mfma_f32_16x16x32_bf16 a[28:31], v[112:115], v[72:75], a[28:31]
    v_mfma_f32_16x16x32_bf16 a[24:27], v[108:111], v[72:75], a[24:27]
    v_mfma_f32_16x16x32_bf16 a[32:35], v[108:111], v[76:79], a[32:35]
    v_mfma_f32_16x16x32_bf16 a[36:39], v[112:115], v[76:79], a[36:39]
    v_mfma_f32_16x16x32_bf16 a[44:47], v[112:115], v[80:83], a[44:47]
    v_mfma_f32_16x16x32_bf16 a[40:43], v[108:111], v[80:83], a[40:43]
    v_mfma_f32_16x16x32_bf16 a[48:51], v[108:111], v[84:87], a[48:51]
    v_mfma_f32_16x16x32_bf16 a[52:55], v[112:115], v[84:87], a[52:55]
    s_waitcnt lgkmcnt(1)
    v_mfma_f32_16x16x32_bf16 a[60:63], v[112:115], v[88:91], a[60:63]
    v_mfma_f32_16x16x32_bf16 a[56:59], v[108:111], v[88:91], a[56:59]
    s_waitcnt vmcnt(21)
    v_mfma_f32_16x16x32_bf16 a[0:3], v[116:119], v[64:67], a[0:3]
    v_mfma_f32_16x16x32_bf16 a[4:7], v[120:123], v[64:67], a[4:7]
    s_add_u32 s22, s21, 368640
    v_mfma_f32_16x16x32_bf16 a[12:15], v[120:123], v[68:71], a[12:15]
    buffer_load_dwordx4 v[108:111], v12, s[8:11], s22 offen offset:0
    v_mfma_f32_16x16x32_bf16 a[8:11], v[116:119], v[68:71], a[8:11]
    buffer_load_dwordx4 v[112:115], v12, s[8:11], s22 offen offset:1024
    v_mfma_f32_16x16x32_bf16 a[16:19], v[116:119], v[72:75], a[16:19]
    v_mfma_f32_16x16x32_bf16 a[20:23], v[120:123], v[72:75], a[20:23]
    ds_read_b128 v[44:47], v9 offset:3584
    v_mfma_f32_16x16x32_bf16 a[28:31], v[120:123], v[76:79], a[28:31]
    v_mfma_f32_16x16x32_bf16 a[24:27], v[116:119], v[76:79], a[24:27]
    v_mfma_f32_16x16x32_bf16 a[32:35], v[116:119], v[80:83], a[32:35]
    v_mfma_f32_16x16x32_bf16 a[36:39], v[120:123], v[80:83], a[36:39]
    v_mfma_f32_16x16x32_bf16 a[44:47], v[120:123], v[84:87], a[44:47]
    v_mfma_f32_16x16x32_bf16 a[40:43], v[116:119], v[84:87], a[40:43]
    v_mfma_f32_16x16x32_bf16 a[48:51], v[116:119], v[88:91], a[48:51]
    v_mfma_f32_16x16x32_bf16 a[52:55], v[120:123], v[88:91], a[52:55]
    s_waitcnt lgkmcnt(1)
    v_mfma_f32_16x16x32_bf16 a[60:63], v[120:123], v[40:43], a[60:63]
    v_mfma_f32_16x16x32_bf16 a[56:59], v[116:119], v[40:43], a[56:59]
    s_waitcnt vmcnt(18)
    v_mfma_f32_16x16x32_bf16 a[0:3], v[124:127], v[68:71], a[0:3]
    s_waitcnt vmcnt(10) lgkmcnt(0)
    s_barrier
    v_mfma_f32_16x16x32_bf16 a[4:7], v[128:131], v[68:71], a[4:7]
    ds_read_b128 v[68:71], v8 offset:34816
    s_add_u32 s22, s21, 434176
    v_mfma_f32_16x16x32_bf16 a[12:15], v[128:131], v[72:75], a[12:15]
    buffer_load_dwordx4 v[116:119], v12, s[8:11], s22 offen offset:0
    v_mfma_f32_16x16x32_bf16 a[8:11], v[124:127], v[72:75], a[8:11]
    ds_read_b128 v[72:75], v8 offset:35072
    buffer_load_dwordx4 v[120:123], v12, s[8:11], s22 offen offset:1024
    v_mfma_f32_16x16x32_bf16 a[16:19], v[124:127], v[76:79], a[16:19]
    s_lshr_b32 s86, s2, 3
    s_and_b32 s86, s86, 7
    s_lshl_b32 s86, s86, 12
    v_mfma_f32_16x16x32_bf16 a[20:23], v[128:131], v[76:79], a[20:23]
    ds_read_b128 v[76:79], v8 offset:35328
    v_mfma_f32_16x16x32_bf16 a[28:31], v[128:131], v[80:83], a[28:31]
    s_add_u32 s86, s86, 7864320
    s_lshl_b32 s87, s16, 10
    s_add_u32 s86, s86, s87
    v_mfma_f32_16x16x32_bf16 a[24:27], v[124:127], v[80:83], a[24:27]
    ds_read_b128 v[80:83], v8 offset:35584
    s_add_u32 s87, s87, 69632
    v_lshlrev_b32 v242, 4, v0
    v_mfma_f32_16x16x32_bf16 a[32:35], v[124:127], v[84:87], a[32:35]
    v_mfma_f32_16x16x32_bf16 a[36:39], v[128:131], v[84:87], a[36:39]
    ds_read_b128 v[84:87], v8 offset:35840
    v_mfma_f32_16x16x32_bf16 a[44:47], v[128:131], v[88:91], a[44:47]
    v_mfma_f32_16x16x32_bf16 a[40:43], v[124:127], v[88:91], a[40:43]
    ds_read_b128 v[88:91], v8 offset:36096
    v_mfma_f32_16x16x32_bf16 a[48:51], v[124:127], v[40:43], a[48:51]
    v_mfma_f32_16x16x32_bf16 a[52:55], v[128:131], v[40:43], a[52:55]
    ds_read_b128 v[40:43], v8 offset:36352
    v_mfma_f32_16x16x32_bf16 a[60:63], v[128:131], v[44:47], a[60:63]
    v_mfma_f32_16x16x32_bf16 a[56:59], v[124:127], v[44:47], a[56:59]
    ds_read_b128 v[44:47], v8 offset:36608
    s_waitcnt lgkmcnt(7)
    v_mfma_f32_16x16x32_bf16 a[0:3], v[132:135], v[68:71], a[0:3]
    v_mfma_f32_16x16x32_bf16 a[4:7], v[136:139], v[68:71], a[4:7]
    s_waitcnt lgkmcnt(6)
    v_mfma_f32_16x16x32_bf16 a[12:15], v[136:139], v[72:75], a[12:15]
    s_add_u32 m0, s87, 0
    s_add_u32 s31, s86, 0
    buffer_load_dwordx4 v242, s[8:11], s31 offen lds
    v_mfma_f32_16x16x32_bf16 a[8:11], v[132:135], v[72:75], a[8:11]
    s_add_u32 m0, s87, 4096
    s_add_u32 s31, s86, 32768
    buffer_load_dwordx4 v242, s[8:11], s31 offen lds
    s_waitcnt lgkmcnt(5)
    v_mfma_f32_16x16x32_bf16 a[16:19], v[132:135], v[76:79], a[16:19]
    s_add_u32 m0, s87, 8192
    s_add_u32 s31, s86, 65536
    buffer_load_dwordx4 v242, s[8:11], s31 offen lds
    v_mfma_f32_16x16x32_bf16 a[20:23], v[136:139], v[76:79], a[20:23]
    ds_read_b128 v[48:51], v9 offset:36864
    s_waitcnt lgkmcnt(5)
    v_mfma_f32_16x16x32_bf16 a[28:31], v[136:139], v[80:83], a[28:31]
    v_mfma_f32_16x16x32_bf16 a[24:27], v[132:135], v[80:83], a[24:27]
    s_waitcnt lgkmcnt(4)
    v_mfma_f32_16x16x32_bf16 a[32:35], v[132:135], v[84:87], a[32:35]
    v_mfma_f32_16x16x32_bf16 a[36:39], v[136:139], v[84:87], a[36:39]
    s_waitcnt lgkmcnt(3)
    v_mfma_f32_16x16x32_bf16 a[44:47], v[136:139], v[88:91], a[44:47]
    v_mfma_f32_16x16x32_bf16 a[40:43], v[132:135], v[88:91], a[40:43]
    s_waitcnt lgkmcnt(2)
    v_mfma_f32_16x16x32_bf16 a[48:51], v[132:135], v[40:43], a[48:51]
    v_mfma_f32_16x16x32_bf16 a[52:55], v[136:139], v[40:43], a[52:55]
    s_waitcnt lgkmcnt(1)
    v_mfma_f32_16x16x32_bf16 a[60:63], v[136:139], v[44:47], a[60:63]
    v_mfma_f32_16x16x32_bf16 a[56:59], v[132:135], v[44:47], a[56:59]
    s_waitcnt vmcnt(13)
    v_mfma_f32_16x16x32_bf16 a[0:3], v[140:143], v[72:75], a[0:3]
    v_mfma_f32_16x16x32_bf16 a[4:7], v[144:147], v[72:75], a[4:7]
    v_mfma_f32_16x16x32_bf16 a[12:15], v[144:147], v[76:79], a[12:15]
    s_add_u32 m0, s87, 12288
    s_add_u32 s31, s86, 98304
    buffer_load_dwordx4 v242, s[8:11], s31 offen lds
    v_mfma_f32_16x16x32_bf16 a[8:11], v[140:143], v[76:79], a[8:11]
    s_add_u32 m0, s87, 16384
    s_add_u32 s31, s86, 131072
    buffer_load_dwordx4 v242, s[8:11], s31 offen lds
    v_mfma_f32_16x16x32_bf16 a[16:19], v[140:143], v[80:83], a[16:19]
    s_add_u32 m0, s87, 20480
    s_add_u32 s31, s86, 163840
    buffer_load_dwordx4 v242, s[8:11], s31 offen lds
    v_mfma_f32_16x16x32_bf16 a[20:23], v[144:147], v[80:83], a[20:23]
    ds_read_b128 v[52:55], v9 offset:37120
    v_mfma_f32_16x16x32_bf16 a[28:31], v[144:147], v[84:87], a[28:31]
    v_mfma_f32_16x16x32_bf16 a[24:27], v[140:143], v[84:87], a[24:27]
    v_mfma_f32_16x16x32_bf16 a[32:35], v[140:143], v[88:91], a[32:35]
    v_mfma_f32_16x16x32_bf16 a[36:39], v[144:147], v[88:91], a[36:39]
    v_mfma_f32_16x16x32_bf16 a[44:47], v[144:147], v[40:43], a[44:47]
    v_mfma_f32_16x16x32_bf16 a[40:43], v[140:143], v[40:43], a[40:43]
    v_mfma_f32_16x16x32_bf16 a[48:51], v[140:143], v[44:47], a[48:51]
    v_mfma_f32_16x16x32_bf16 a[52:55], v[144:147], v[44:47], a[52:55]
    s_waitcnt lgkmcnt(1)
    v_mfma_f32_16x16x32_bf16 a[60:63], v[144:147], v[48:51], a[60:63]
    v_mfma_f32_16x16x32_bf16 a[56:59], v[140:143], v[48:51], a[56:59]
    s_waitcnt vmcnt(14)
    v_mfma_f32_16x16x32_bf16 a[0:3], v[148:151], v[76:79], a[0:3]
    v_mfma_f32_16x16x32_bf16 a[4:7], v[152:155], v[76:79], a[4:7]
    v_mfma_f32_16x16x32_bf16 a[12:15], v[152:155], v[80:83], a[12:15]
    s_add_u32 m0, s87, 24576
    s_add_u32 s31, s86, 196608
    buffer_load_dwordx4 v242, s[8:11], s31 offen lds
    v_mfma_f32_16x16x32_bf16 a[8:11], v[148:151], v[80:83], a[8:11]
    s_add_u32 m0, s87, 28672
    s_add_u32 s31, s86, 229376
    buffer_load_dwordx4 v242, s[8:11], s31 offen lds
    v_mfma_f32_16x16x32_bf16 a[16:19], v[148:151], v[84:87], a[16:19]
    s_add_u32 m0, s87, 32768
    s_add_u32 s31, s86, 262144
    buffer_load_dwordx4 v242, s[8:11], s31 offen lds
    v_mfma_f32_16x16x32_bf16 a[20:23], v[152:155], v[84:87], a[20:23]
    ds_read_b128 v[56:59], v9 offset:37376
    v_mfma_f32_16x16x32_bf16 a[28:31], v[152:155], v[88:91], a[28:31]
    v_mfma_f32_16x16x32_bf16 a[24:27], v[148:151], v[88:91], a[24:27]
    v_mfma_f32_16x16x32_bf16 a[32:35], v[148:151], v[40:43], a[32:35]
    v_mfma_f32_16x16x32_bf16 a[36:39], v[152:155], v[40:43], a[36:39]
    v_mfma_f32_16x16x32_bf16 a[44:47], v[152:155], v[44:47], a[44:47]
    v_mfma_f32_16x16x32_bf16 a[40:43], v[148:151], v[44:47], a[40:43]
    v_mfma_f32_16x16x32_bf16 a[48:51], v[148:151], v[48:51], a[48:51]
    v_mfma_f32_16x16x32_bf16 a[52:55], v[152:155], v[48:51], a[52:55]
    s_waitcnt lgkmcnt(1)
    v_mfma_f32_16x16x32_bf16 a[60:63], v[152:155], v[52:55], a[60:63]
    v_mfma_f32_16x16x32_bf16 a[56:59], v[148:151], v[52:55], a[56:59]
    s_waitcnt vmcnt(15)
    v_mfma_f32_16x16x32_bf16 a[0:3], v[92:95], v[80:83], a[0:3]
    v_mfma_f32_16x16x32_bf16 a[4:7], v[96:99], v[80:83], a[4:7]
    v_mfma_f32_16x16x32_bf16 a[12:15], v[96:99], v[84:87], a[12:15]
    s_add_u32 m0, s87, 36864
    s_add_u32 s31, s86, 294912
    buffer_load_dwordx4 v242, s[8:11], s31 offen lds
    v_mfma_f32_16x16x32_bf16 a[8:11], v[92:95], v[84:87], a[8:11]
    s_add_u32 m0, s87, 40960
    s_add_u32 s31, s86, 327680
    buffer_load_dwordx4 v242, s[8:11], s31 offen lds
    v_mfma_f32_16x16x32_bf16 a[16:19], v[92:95], v[88:91], a[16:19]
    s_add_u32 m0, s87, 45056
    s_add_u32 s31, s86, 360448
    buffer_load_dwordx4 v242, s[8:11], s31 offen lds
    v_mfma_f32_16x16x32_bf16 a[20:23], v[96:99], v[88:91], a[20:23]
    ds_read_b128 v[60:63], v9 offset:37632
    v_mfma_f32_16x16x32_bf16 a[28:31], v[96:99], v[40:43], a[28:31]
    v_mfma_f32_16x16x32_bf16 a[24:27], v[92:95], v[40:43], a[24:27]
    v_mfma_f32_16x16x32_bf16 a[32:35], v[92:95], v[44:47], a[32:35]
    v_mfma_f32_16x16x32_bf16 a[36:39], v[96:99], v[44:47], a[36:39]
    v_mfma_f32_16x16x32_bf16 a[44:47], v[96:99], v[48:51], a[44:47]
    v_mfma_f32_16x16x32_bf16 a[40:43], v[92:95], v[48:51], a[40:43]
    v_mfma_f32_16x16x32_bf16 a[48:51], v[92:95], v[52:55], a[48:51]
    v_mfma_f32_16x16x32_bf16 a[52:55], v[96:99], v[52:55], a[52:55]
    s_waitcnt lgkmcnt(1)
    v_mfma_f32_16x16x32_bf16 a[60:63], v[96:99], v[56:59], a[60:63]
    v_mfma_f32_16x16x32_bf16 a[56:59], v[92:95], v[56:59], a[56:59]
    s_waitcnt vmcnt(16)
    v_mfma_f32_16x16x32_bf16 a[0:3], v[100:103], v[84:87], a[0:3]
    v_mfma_f32_16x16x32_bf16 a[4:7], v[104:107], v[84:87], a[4:7]
    v_mfma_f32_16x16x32_bf16 a[12:15], v[104:107], v[88:91], a[12:15]
    s_add_u32 m0, s87, 49152
    s_add_u32 s31, s86, 393216
    buffer_load_dwordx4 v242, s[8:11], s31 offen lds
    v_mfma_f32_16x16x32_bf16 a[8:11], v[100:103], v[88:91], a[8:11]
    s_add_u32 m0, s87, 53248
    s_add_u32 s31, s86, 425984
    buffer_load_dwordx4 v242, s[8:11], s31 offen lds
    v_mfma_f32_16x16x32_bf16 a[16:19], v[100:103], v[40:43], a[16:19]
    s_add_u32 m0, s87, 57344
    s_add_u32 s31, s86, 458752
    buffer_load_dwordx4 v242, s[8:11], s31 offen lds
    v_mfma_f32_16x16x32_bf16 a[20:23], v[104:107], v[40:43], a[20:23]
    ds_read_b128 v[64:67], v9 offset:37888
    v_mfma_f32_16x16x32_bf16 a[28:31], v[104:107], v[44:47], a[28:31]
    v_mfma_f32_16x16x32_bf16 a[24:27], v[100:103], v[44:47], a[24:27]
    v_mfma_f32_16x16x32_bf16 a[32:35], v[100:103], v[48:51], a[32:35]
    v_mfma_f32_16x16x32_bf16 a[36:39], v[104:107], v[48:51], a[36:39]
    v_mfma_f32_16x16x32_bf16 a[44:47], v[104:107], v[52:55], a[44:47]
    v_mfma_f32_16x16x32_bf16 a[40:43], v[100:103], v[52:55], a[40:43]
    v_mfma_f32_16x16x32_bf16 a[48:51], v[100:103], v[56:59], a[48:51]
    v_mfma_f32_16x16x32_bf16 a[52:55], v[104:107], v[56:59], a[52:55]
    s_waitcnt lgkmcnt(1)
    v_mfma_f32_16x16x32_bf16 a[60:63], v[104:107], v[60:63], a[60:63]
    v_mfma_f32_16x16x32_bf16 a[56:59], v[100:103], v[60:63], a[56:59]
    s_waitcnt vmcnt(17)
    v_mfma_f32_16x16x32_bf16 a[0:3], v[108:111], v[88:91], a[0:3]
    v_mfma_f32_16x16x32_bf16 a[4:7], v[112:115], v[88:91], a[4:7]
    v_mfma_f32_16x16x32_bf16 a[12:15], v[112:115], v[40:43], a[12:15]
    s_add_u32 m0, s87, 61440
    s_add_u32 s31, s86, 491520
    buffer_load_dwordx4 v242, s[8:11], s31 offen lds
    v_mfma_f32_16x16x32_bf16 a[8:11], v[108:111], v[40:43], a[8:11]
    v_mfma_f32_16x16x32_bf16 a[16:19], v[108:111], v[44:47], a[16:19]
    v_mfma_f32_16x16x32_bf16 a[20:23], v[112:115], v[44:47], a[20:23]
    ds_read_b128 v[68:71], v9 offset:38144
    v_mfma_f32_16x16x32_bf16 a[28:31], v[112:115], v[48:51], a[28:31]
    v_mfma_f32_16x16x32_bf16 a[24:27], v[108:111], v[48:51], a[24:27]
    v_mfma_f32_16x16x32_bf16 a[32:35], v[108:111], v[52:55], a[32:35]
    v_mfma_f32_16x16x32_bf16 a[36:39], v[112:115], v[52:55], a[36:39]
    v_mfma_f32_16x16x32_bf16 a[44:47], v[112:115], v[56:59], a[44:47]
    v_mfma_f32_16x16x32_bf16 a[40:43], v[108:111], v[56:59], a[40:43]
    v_mfma_f32_16x16x32_bf16 a[48:51], v[108:111], v[60:63], a[48:51]
    v_mfma_f32_16x16x32_bf16 a[52:55], v[112:115], v[60:63], a[52:55]
    s_waitcnt lgkmcnt(1)
    v_mfma_f32_16x16x32_bf16 a[60:63], v[112:115], v[64:67], a[60:63]
    v_mfma_f32_16x16x32_bf16 a[56:59], v[108:111], v[64:67], a[56:59]
    s_waitcnt vmcnt(16)
    v_mfma_f32_16x16x32_bf16 a[0:3], v[116:119], v[40:43], a[0:3]
    v_mfma_f32_16x16x32_bf16 a[4:7], v[120:123], v[40:43], a[4:7]
    v_mfma_f32_16x16x32_bf16 a[12:15], v[120:123], v[44:47], a[12:15]
    v_and_b32 v240, 31, v0
    v_lshlrev_b32 v240, 2, v240
    v_mfma_f32_16x16x32_bf16 a[8:11], v[116:119], v[44:47], a[8:11]
    v_add_u32 v240, 20480, v240
    buffer_load_dword v241, v240, s[92:95], 0 offen sc1
    v_mfma_f32_16x16x32_bf16 a[16:19], v[116:119], v[48:51], a[16:19]
    v_mfma_f32_16x16x32_bf16 a[20:23], v[120:123], v[48:51], a[20:23]
    v_mfma_f32_16x16x32_bf16 a[28:31], v[120:123], v[52:55], a[28:31]
    v_mfma_f32_16x16x32_bf16 a[24:27], v[116:119], v[52:55], a[24:27]
    v_mfma_f32_16x16x32_bf16 a[32:35], v[116:119], v[56:59], a[32:35]
    v_mfma_f32_16x16x32_bf16 a[36:39], v[120:123], v[56:59], a[36:39]
    v_mfma_f32_16x16x32_bf16 a[44:47], v[120:123], v[60:63], a[44:47]
    v_mfma_f32_16x16x32_bf16 a[40:43], v[116:119], v[60:63], a[40:43]
    v_mfma_f32_16x16x32_bf16 a[48:51], v[116:119], v[64:67], a[48:51]
    v_mfma_f32_16x16x32_bf16 a[52:55], v[120:123], v[64:67], a[52:55]
    s_waitcnt lgkmcnt(0)
    v_mfma_f32_16x16x32_bf16 a[60:63], v[120:123], v[68:71], a[60:63]
    v_mfma_f32_16x16x32_bf16 a[56:59], v[116:119], v[68:71], a[56:59]
    v_mov_b32 v18, 0xc0135761
    v_mov_b32 v19, 0xc0135761
    s_mov_b32 s28, 0xbdd2d3e8
    s_mov_b32 s29, 0xbdd2d3e8
    v_lshlrev_b32 v4, 4, v0
    s_add_u32 s27, s16, 1
    s_and_b32 s27, s27, 3
    s_mul_i32 s30, s27, 12288
    v_add_u32 v9, s30, v4
    s_add_u32 s27, s16, 2
    s_and_b32 s27, s27, 3
    s_mul_i32 s30, s27, 12288
    v_add_u32 v10, s30, v4
    s_add_u32 s27, s16, 3
    s_and_b32 s27, s27, 3
    s_mul_i32 s30, s27, 12288
    v_add_u32 v11, s30, v4
    s_mul_i32 s30, s16, 12288
    v_add_u32 v8, s30, v4
    s_waitcnt lgkmcnt(0)
    s_barrier
    s_cmp_eq_u32 s16, 0
    s_cbranch_scc1 p2_w0
    s_cmp_eq_u32 s16, 1
    s_cbranch_scc1 p2_w1
    s_cmp_eq_u32 s16, 2
    s_cbranch_scc1 p2_w2
p2_w3:
    ds_write_b128 v9, a[0:3] offset:8192
    ds_write_b128 v9, a[4:7] offset:9216
    ds_write_b128 v9, a[8:11] offset:10240
    ds_write_b128 v9, a[12:15] offset:11264
    ds_write_b128 v10, a[16:19] offset:4096
    ds_write_b128 v10, a[20:23] offset:5120
    ds_write_b128 v10, a[24:27] offset:6144
    ds_write_b128 v10, a[28:31] offset:7168
    ds_write_b128 v11, a[32:35] offset:0
    ds_write_b128 v11, a[36:39] offset:1024
    ds_write_b128 v11, a[40:43] offset:2048
    ds_write_b128 v11, a[44:47] offset:3072
    v_accvgpr_read_b32 v20, a48
    v_accvgpr_read_b32 v21, a49
    v_accvgpr_read_b32 v22, a50
    v_accvgpr_read_b32 v23, a51
    v_accvgpr_read_b32 v24, a52
    v_accvgpr_read_b32 v25, a53
    v_accvgpr_read_b32 v26, a54
    v_accvgpr_read_b32 v27, a55
    v_accvgpr_read_b32 v28, a56
    v_accvgpr_read_b32 v29, a57
    v_accvgpr_read_b32 v30, a58
    v_accvgpr_read_b32 v31, a59
    v_accvgpr_read_b32 v32, a60
    v_accvgpr_read_b32 v33, a61
    v_accvgpr_read_b32 v34, a62
    v_accvgpr_read_b32 v35, a63
    s_branch p2_wj
p2_w0:
    ds_write_b128 v9, a[16:19] offset:8192
    ds_write_b128 v9, a[20:23] offset:9216
    ds_write_b128 v9, a[24:27] offset:10240
    ds_write_b128 v9, a[28:31] offset:11264
    ds_write_b128 v10, a[32:35] offset:4096
    ds_write_b128 v10, a[36:39] offset:5120
    ds_write_b128 v10, a[40:43] offset:6144
    ds_write_b128 v10, a[44:47] offset:7168
    ds_write_b128 v11, a[48:51] offset:0
    ds_write_b128 v11, a[52:55] offset:1024
    ds_write_b128 v11, a[56:59] offset:2048
    ds_write_b128 v11, a[60:63] offset:3072
    v_accvgpr_read_b32 v20, a0
    v_accvgpr_read_b32 v21, a1
    v_accvgpr_read_b32 v22, a2
    v_accvgpr_read_b32 v23, a3
    v_accvgpr_read_b32 v24, a4
    v_accvgpr_read_b32 v25, a5
    v_accvgpr_read_b32 v26, a6
    v_accvgpr_read_b32 v27, a7
    v_accvgpr_read_b32 v28, a8
    v_accvgpr_read_b32 v29, a9
    v_accvgpr_read_b32 v30, a10
    v_accvgpr_read_b32 v31, a11
    v_accvgpr_read_b32 v32, a12
    v_accvgpr_read_b32 v33, a13
    v_accvgpr_read_b32 v34, a14
    v_accvgpr_read_b32 v35, a15
    s_branch p2_wj
p2_w1:
    ds_write_b128 v9, a[32:35] offset:8192
    ds_write_b128 v9, a[36:39] offset:9216
    ds_write_b128 v9, a[40:43] offset:10240
    ds_write_b128 v9, a[44:47] offset:11264
    ds_write_b128 v10, a[48:51] offset:4096
    ds_write_b128 v10, a[52:55] offset:5120
    ds_write_b128 v10, a[56:59] offset:6144
    ds_write_b128 v10, a[60:63] offset:7168
    ds_write_b128 v11, a[0:3] offset:0
    ds_write_b128 v11, a[4:7] offset:1024
    ds_write_b128 v11, a[8:11] offset:2048
    ds_write_b128 v11, a[12:15] offset:3072
    v_accvgpr_read_b32 v20, a16
    v_accvgpr_read_b32 v21, a17
    v_accvgpr_read_b32 v22, a18
    v_accvgpr_read_b32 v23, a19
    v_accvgpr_read_b32 v24, a20
    v_accvgpr_read_b32 v25, a21
    v_accvgpr_read_b32 v26, a22
    v_accvgpr_read_b32 v27, a23
    v_accvgpr_read_b32 v28, a24
    v_accvgpr_read_b32 v29, a25
    v_accvgpr_read_b32 v30, a26
    v_accvgpr_read_b32 v31, a27
    v_accvgpr_read_b32 v32, a28
    v_accvgpr_read_b32 v33, a29
    v_accvgpr_read_b32 v34, a30
    v_accvgpr_read_b32 v35, a31
    s_branch p2_wj
p2_w2:
    ds_write_b128 v9, a[48:51] offset:8192
    ds_write_b128 v9, a[52:55] offset:9216
    ds_write_b128 v9, a[56:59] offset:10240
    ds_write_b128 v9, a[60:63] offset:11264
    ds_write_b128 v10, a[0:3] offset:4096
    ds_write_b128 v10, a[4:7] offset:5120
    ds_write_b128 v10, a[8:11] offset:6144
    ds_write_b128 v10, a[12:15] offset:7168
    ds_write_b128 v11, a[16:19] offset:0
    ds_write_b128 v11, a[20:23] offset:1024
    ds_write_b128 v11, a[24:27] offset:2048
    ds_write_b128 v11, a[28:31] offset:3072
    v_accvgpr_read_b32 v20, a32
    v_accvgpr_read_b32 v21, a33
    v_accvgpr_read_b32 v22, a34
    v_accvgpr_read_b32 v23, a35
    v_accvgpr_read_b32 v24, a36
    v_accvgpr_read_b32 v25, a37
    v_accvgpr_read_b32 v26, a38
    v_accvgpr_read_b32 v27, a39
    v_accvgpr_read_b32 v28, a40
    v_accvgpr_read_b32 v29, a41
    v_accvgpr_read_b32 v30, a42
    v_accvgpr_read_b32 v31, a43
    v_accvgpr_read_b32 v32, a44
    v_accvgpr_read_b32 v33, a45
    v_accvgpr_read_b32 v34, a46
    v_accvgpr_read_b32 v35, a47
p2_wj:
    s_waitcnt lgkmcnt(0)
    s_barrier
    ds_read_b128 v[36:39], v8 offset:0
    ds_read_b128 v[40:43], v8 offset:1024
    ds_read_b128 v[44:47], v8 offset:2048
    ds_read_b128 v[48:51], v8 offset:3072
    ds_read_b128 v[52:55], v8 offset:4096
    ds_read_b128 v[56:59], v8 offset:5120
    ds_read_b128 v[60:63], v8 offset:6144
    ds_read_b128 v[64:67], v8 offset:7168
    ds_read_b128 v[68:71], v8 offset:8192
    ds_read_b128 v[72:75], v8 offset:9216
    ds_read_b128 v[76:79], v8 offset:10240
    ds_read_b128 v[80:83], v8 offset:11264
    s_add_u32 s12, s12, 4194304
    s_addc_u32 s13, s13, 0
    s_mov_b32 s14, 2097152
    s_mov_b32 s15, 0x00020000
    s_lshl_b32 s27, s17, 3
    s_lshl_b32 s30, s16, 1
    s_add_u32 s27, s27, s30
    s_lshl_b32 s27, s27, 4
    s_add_u32 s27, s27, s18
    s_lshl_b32 s27, s27, 10
    s_waitcnt lgkmcnt(8)
    v_pk_add_f32 v[20:21], v[20:21], v[36:37]
    v_pk_add_f32 v[22:23], v[22:23], v[38:39]
    v_pk_add_f32 v[24:25], v[24:25], v[40:41]
    v_pk_add_f32 v[26:27], v[26:27], v[42:43]
    v_pk_add_f32 v[28:29], v[28:29], v[44:45]
    v_pk_add_f32 v[30:31], v[30:31], v[46:47]
    v_pk_add_f32 v[32:33], v[32:33], v[48:49]
    v_pk_add_f32 v[34:35], v[34:35], v[50:51]
    s_waitcnt lgkmcnt(4)
    v_pk_add_f32 v[20:21], v[20:21], v[52:53]
    v_pk_add_f32 v[22:23], v[22:23], v[54:55]
    v_pk_add_f32 v[24:25], v[24:25], v[56:57]
    v_pk_add_f32 v[26:27], v[26:27], v[58:59]
    v_pk_add_f32 v[28:29], v[28:29], v[60:61]
    v_pk_add_f32 v[30:31], v[30:31], v[62:63]
    v_pk_add_f32 v[32:33], v[32:33], v[64:65]
    v_pk_add_f32 v[34:35], v[34:35], v[66:67]
    s_waitcnt lgkmcnt(0)
    v_pk_add_f32 v[20:21], v[20:21], v[68:69]
    v_pk_add_f32 v[22:23], v[22:23], v[70:71]
    v_pk_add_f32 v[24:25], v[24:25], v[72:73]
    v_pk_add_f32 v[26:27], v[26:27], v[74:75]
    v_pk_add_f32 v[28:29], v[28:29], v[76:77]
    v_pk_add_f32 v[30:31], v[30:31], v[78:79]
    v_pk_add_f32 v[32:33], v[32:33], v[80:81]
    v_pk_add_f32 v[34:35], v[34:35], v[82:83]
    v_pk_mul_f32 v[36:37], v[20:21], v[20:21]
    v_pk_mul_f32 v[38:39], v[22:23], v[22:23]
    v_pk_mul_f32 v[40:41], v[24:25], v[24:25]
    v_pk_mul_f32 v[42:43], v[26:27], v[26:27]
    v_pk_mul_f32 v[44:45], v[28:29], v[28:29]
    v_pk_mul_f32 v[46:47], v[30:31], v[30:31]
    v_pk_mul_f32 v[48:49], v[32:33], v[32:33]
    v_pk_mul_f32 v[50:51], v[34:35], v[34:35]
    v_pk_fma_f32 v[36:37], v[36:37], s[28:29], v[18:19]
    v_pk_fma_f32 v[38:39], v[38:39], s[28:29], v[18:19]
    v_pk_fma_f32 v[40:41], v[40:41], s[28:29], v[18:19]
    v_pk_fma_f32 v[42:43], v[42:43], s[28:29], v[18:19]
    v_pk_fma_f32 v[44:45], v[44:45], s[28:29], v[18:19]
    v_pk_fma_f32 v[46:47], v[46:47], s[28:29], v[18:19]
    v_pk_fma_f32 v[48:49], v[48:49], s[28:29], v[18:19]
    v_pk_fma_f32 v[50:51], v[50:51], s[28:29], v[18:19]
    v_pk_mul_f32 v[36:37], v[36:37], v[20:21]
    v_pk_mul_f32 v[38:39], v[38:39], v[22:23]
    v_pk_mul_f32 v[40:41], v[40:41], v[24:25]
    v_pk_mul_f32 v[42:43], v[42:43], v[26:27]
    v_pk_mul_f32 v[44:45], v[44:45], v[28:29]
    v_pk_mul_f32 v[46:47], v[46:47], v[30:31]
    v_pk_mul_f32 v[48:49], v[48:49], v[32:33]
    v_pk_mul_f32 v[50:51], v[50:51], v[34:35]
    v_exp_f32 v36, v36
    v_exp_f32 v37, v37
    v_exp_f32 v38, v38
    v_exp_f32 v39, v39
    v_exp_f32 v40, v40
    v_exp_f32 v41, v41
    v_exp_f32 v42, v42
    v_exp_f32 v43, v43
    v_exp_f32 v44, v44
    v_exp_f32 v45, v45
    v_exp_f32 v46, v46
    v_exp_f32 v47, v47
    v_exp_f32 v48, v48
    v_exp_f32 v49, v49
    v_exp_f32 v50, v50
    v_exp_f32 v51, v51
    v_pk_add_f32 v[36:37], v[36:37], 1.0 op_sel_hi:[1,0]
    v_pk_add_f32 v[38:39], v[38:39], 1.0 op_sel_hi:[1,0]
    v_pk_add_f32 v[40:41], v[40:41], 1.0 op_sel_hi:[1,0]
    v_pk_add_f32 v[42:43], v[42:43], 1.0 op_sel_hi:[1,0]
    v_pk_add_f32 v[44:45], v[44:45], 1.0 op_sel_hi:[1,0]
    v_pk_add_f32 v[46:47], v[46:47], 1.0 op_sel_hi:[1,0]
    v_pk_add_f32 v[48:49], v[48:49], 1.0 op_sel_hi:[1,0]
    v_pk_add_f32 v[50:51], v[50:51], 1.0 op_sel_hi:[1,0]
    v_rcp_f32 v36, v36
    v_rcp_f32 v37, v37
    v_rcp_f32 v38, v38
    v_rcp_f32 v39, v39
    v_rcp_f32 v40, v40
    v_rcp_f32 v41, v41
    v_rcp_f32 v42, v42
    v_rcp_f32 v43, v43
    v_rcp_f32 v44, v44
    v_rcp_f32 v45, v45
    v_rcp_f32 v46, v46
    v_rcp_f32 v47, v47
    v_rcp_f32 v48, v48
    v_rcp_f32 v49, v49
    v_rcp_f32 v50, v50
    v_rcp_f32 v51, v51
    v_pk_mul_f32 v[36:37], v[36:37], v[20:21]
    v_pk_mul_f32 v[38:39], v[38:39], v[22:23]
    v_pk_mul_f32 v[40:41], v[40:41], v[24:25]
    v_pk_mul_f32 v[42:43], v[42:43], v[26:27]
    v_pk_mul_f32 v[44:45], v[44:45], v[28:29]
    v_pk_mul_f32 v[46:47], v[46:47], v[30:31]
    v_pk_mul_f32 v[48:49], v[48:49], v[32:33]
    v_pk_mul_f32 v[50:51], v[50:51], v[34:35]
    v_cvt_pk_bf16_f32 v52, v36, v40
    v_cvt_pk_bf16_f32 v53, v37, v41
    v_cvt_pk_bf16_f32 v54, v38, v42
    v_cvt_pk_bf16_f32 v55, v39, v43
    buffer_store_dwordx4 v[52:55], v4, s[12:15], s27 offen sc0 sc1
    s_add_u32 s27, s27, 16384
    v_cvt_pk_bf16_f32 v56, v44, v48
    v_cvt_pk_bf16_f32 v57, v45, v49
    v_cvt_pk_bf16_f32 v58, v46, v50
    v_cvt_pk_bf16_f32 v59, v47, v51
    buffer_store_dwordx4 v[56:59], v4, s[12:15], s27 offen sc0 sc1
    s_lshl_b32 s101, s17, 4
    s_add_u32 s101, s101, s18
    s_lshl_b32 s101, s101, 2
    s_add_u32 s101, s101, 12288
    s_load_dwordx2 s[4:5], s[0:1], 72
    v_lshlrev_b32 v3, 4, v0
    s_lshr_b32 s17, s2, 3
    s_and_b32 s18, s17, 15
    s_lshr_b32 s17, s17, 4
    s_and_b32 s19, s2, 7
    s_lshl_b32 s19, s19, 1
    s_add_u32 s17, s17, s19
    s_lshr_b32 s19, s18, 3
    s_and_b32 s18, s18, 7
    s_lshl_b32 s19, s19, 2
    s_add_u32 s19, s19, s16
    s_lshl_b32 s23, s17, 3
    s_add_u32 s23, s23, s19
    s_lshl_b32 s23, s23, 14
    s_add_u32 s23, s23, 4194304
    s_waitcnt lgkmcnt(0)
    s_mov_b32 s12, s4
    s_mov_b32 s13, s5
    s_mov_b32 s14, 10559488
    s_mov_b32 s15, 0x00020000
    s_add_u32 s92, s4, 11534336
    s_addc_u32 s93, s5, 0
    s_mov_b32 s94, 24576
    s_mov_b32 s95, 0x00020000
    s_waitcnt vmcnt(0)
    s_barrier
    s_cmp_lg_u32 s16, 0
    s_cbranch_scc1 p2_sig12
    v_mov_b32 v6, s100
    v_mov_b32 v7, 0
    s_mov_b64 exec, 1
    buffer_store_dword v6, v7, s[92:95], s101 offen sc0 sc1
    s_mov_b64 exec, -1
p2_sig12:
    s_add_u32 s8, s4, 25165824
    s_addc_u32 s9, s5, 0
    s_mov_b32 s10, 524288
    s_mov_b32 s11, 0x00020000
    s_lshl_b32 s24, s16, 13
    s_add_u32 s25, s24, 0
    s_add_u32 s31, s24, 4096
    buffer_load_dwordx4 a[0:3], v3, s[8:11], s25 offen offset:0
    buffer_load_dwordx4 a[4:7], v3, s[8:11], s25 offen offset:1024
    buffer_load_dwordx4 a[8:11], v3, s[8:11], s25 offen offset:2048
    buffer_load_dwordx4 a[12:15], v3, s[8:11], s25 offen offset:3072
    buffer_load_dwordx4 a[16:19], v3, s[8:11], s31 offen offset:0
    buffer_load_dwordx4 a[20:23], v3, s[8:11], s31 offen offset:1024
    buffer_load_dwordx4 a[24:27], v3, s[8:11], s31 offen offset:2048
    buffer_load_dwordx4 a[28:31], v3, s[8:11], s31 offen offset:3072
    s_add_u32 s25, s24, 32768
    s_add_u32 s31, s24, 36864
    buffer_load_dwordx4 a[32:35], v3, s[8:11], s25 offen offset:0
    buffer_load_dwordx4 a[36:39], v3, s[8:11], s25 offen offset:1024
    buffer_load_dwordx4 a[40:43], v3, s[8:11], s25 offen offset:2048
    buffer_load_dwordx4 a[44:47], v3, s[8:11], s25 offen offset:3072
    buffer_load_dwordx4 a[48:51], v3, s[8:11], s31 offen offset:0
    buffer_load_dwordx4 a[52:55], v3, s[8:11], s31 offen offset:1024
    buffer_load_dwordx4 a[56:59], v3, s[8:11], s31 offen offset:2048
    buffer_load_dwordx4 a[60:63], v3, s[8:11], s31 offen offset:3072
    v_cmp_ne_u32 vcc, s100, v241
    s_nop 4
    s_cbranch_vccz p4e_chk13
    s_mov_b32 s27, 0x20000
p4e_poll14:
    buffer_load_dword v241, v240, s[92:95], 0 offen sc1
    s_waitcnt vmcnt(0)
    v_cmp_ne_u32 vcc, s100, v241
    s_sub_u32 s27, s27, 1
    s_cmp_eq_u32 s27, 0
    s_cbranch_scc1 p4e_poll14_done
    s_cbranch_vccz p4e_poll14_done
    s_sleep 4
    s_branch p4e_poll14
p4e_poll14_done:
p4e_chk13:
    s_lshr_b32 s21, s17, 3
    s_lshl_b32 s21, s21, 14
    s_lshl_b32 s22, s16, 12
    s_add_u32 s21, s21, s22
    s_add_u32 s21, s21, 10518528
    s_add_u32 m0, s22, 135168
    s_nop 0
    buffer_load_dwordx4 v3, s[12:15], s21 offen offset:0 lds
    buffer_load_dwordx4 v3, s[12:15], s21 offen offset:1024 lds
    buffer_load_dwordx4 v3, s[12:15], s21 offen offset:2048 lds
    buffer_load_dwordx4 v3, s[12:15], s21 offen offset:3072 lds
    s_lshl_b32 s27, s17, 6
    s_add_u32 s27, s27, 12288
    v_lshlrev_b32 v5, 2, v0
    v_add_u32 v5, s27, v5
    s_mov_b64 exec, 0xffff
    s_mov_b32 s27, 0x20000
p3_poll15:
    buffer_load_dword v6, v5, s[92:95], 0 offen sc1
    s_waitcnt vmcnt(0)
    v_cmp_ne_u32 vcc, s100, v6
    s_sub_u32 s27, s27, 1
    s_cmp_eq_u32 s27, 0
    s_cbranch_scc1 p3_poll15_done
    s_cbranch_vccz p3_poll15_done
    s_sleep 4
    s_branch p3_poll15
p3_poll15_done:
    s_mov_b64 exec, -1
    buffer_load_dwordx4 v[16:19], v3, s[12:15], s23 offen offset:0
    buffer_load_dwordx4 v[20:23], v3, s[12:15], s23 offen offset:1024
    buffer_load_dwordx4 v[24:27], v3, s[12:15], s23 offen offset:2048
    buffer_load_dwordx4 v[28:31], v3, s[12:15], s23 offen offset:3072
    s_add_u32 s23, s23, 4096
    buffer_load_dwordx4 v[32:35], v3, s[12:15], s23 offen offset:0
    buffer_load_dwordx4 v[36:39], v3, s[12:15], s23 offen offset:1024
    buffer_load_dwordx4 v[40:43], v3, s[12:15], s23 offen offset:2048
    buffer_load_dwordx4 v[44:47], v3, s[12:15], s23 offen offset:3072
    s_add_u32 s23, s23, 4096
    buffer_load_dwordx4 v[48:51], v3, s[12:15], s23 offen offset:0
    buffer_load_dwordx4 v[52:55], v3, s[12:15], s23 offen offset:1024
    buffer_load_dwordx4 v[56:59], v3, s[12:15], s23 offen offset:2048
    buffer_load_dwordx4 v[60:63], v3, s[12:15], s23 offen offset:3072
    s_add_u32 s23, s23, 4096
    buffer_load_dwordx4 v[64:67], v3, s[12:15], s23 offen offset:0
    buffer_load_dwordx4 v[68:71], v3, s[12:15], s23 offen offset:1024
    buffer_load_dwordx4 v[72:75], v3, s[12:15], s23 offen offset:2048
    buffer_load_dwordx4 v[76:79], v3, s[12:15], s23 offen offset:3072
    s_barrier
    v_add_u32 v4, 69632, v3
    ds_read_b128 v[80:83], v4 offset:0
    ds_read_b128 v[84:87], v4 offset:1024
    ds_read_b128 v[88:91], v4 offset:2048
    ds_read_b128 v[92:95], v4 offset:3072
    ds_read_b128 v[96:99], v4 offset:4096
    ds_read_b128 v[100:103], v4 offset:5120
    ds_read_b128 v[104:107], v4 offset:6144
    ds_read_b128 v[108:111], v4 offset:7168
    s_waitcnt vmcnt(15) lgkmcnt(4)
    v_mfma_f32_16x16x32_bf16 v[112:115], v[80:83], v[16:19], 0
    v_mfma_f32_16x16x32_bf16 v[116:119], v[84:87], v[16:19], 0
    v_mfma_f32_16x16x32_bf16 v[120:123], v[88:91], v[16:19], 0
    v_mfma_f32_16x16x32_bf16 v[124:127], v[92:95], v[16:19], 0
    ds_read_b128 v[80:83], v4 offset:8192
    ds_read_b128 v[84:87], v4 offset:9216
    ds_read_b128 v[88:91], v4 offset:10240
    ds_read_b128 v[92:95], v4 offset:11264
    s_waitcnt vmcnt(14) lgkmcnt(4)
    v_mfma_f32_16x16x32_bf16 v[112:115], v[96:99], v[20:23], v[112:115]
    v_mfma_f32_16x16x32_bf16 v[116:119], v[100:103], v[20:23], v[116:119]
    v_mfma_f32_16x16x32_bf16 v[120:123], v[104:107], v[20:23], v[120:123]
    v_mfma_f32_16x16x32_bf16 v[124:127], v[108:111], v[20:23], v[124:127]
    ds_read_b128 v[96:99], v4 offset:12288
    ds_read_b128 v[100:103], v4 offset:13312
    ds_read_b128 v[104:107], v4 offset:14336
    ds_read_b128 v[108:111], v4 offset:15360
    s_waitcnt vmcnt(13) lgkmcnt(4)
    v_mfma_f32_16x16x32_bf16 v[112:115], v[80:83], v[24:27], v[112:115]
    v_mfma_f32_16x16x32_bf16 v[116:119], v[84:87], v[24:27], v[116:119]
    v_mfma_f32_16x16x32_bf16 v[120:123], v[88:91], v[24:27], v[120:123]
    v_mfma_f32_16x16x32_bf16 v[124:127], v[92:95], v[24:27], v[124:127]
    ds_read_b128 v[80:83], v4 offset:16384
    ds_read_b128 v[84:87], v4 offset:17408
    ds_read_b128 v[88:91], v4 offset:18432
    ds_read_b128 v[92:95], v4 offset:19456
    s_waitcnt vmcnt(12) lgkmcnt(4)
    v_mfma_f32_16x16x32_bf16 v[112:115], v[96:99], v[28:31], v[112:115]
    v_mfma_f32_16x16x32_bf16 v[116:119], v[100:103], v[28:31], v[116:119]
    v_mfma_f32_16x16x32_bf16 v[120:123], v[104:107], v[28:31], v[120:123]
    v_mfma_f32_16x16x32_bf16 v[124:127], v[108:111], v[28:31], v[124:127]
    ds_read_b128 v[96:99], v4 offset:20480
    ds_read_b128 v[100:103], v4 offset:21504
    ds_read_b128 v[104:107], v4 offset:22528
    ds_read_b128 v[108:111], v4 offset:23552
    s_waitcnt vmcnt(11) lgkmcnt(4)
    v_mfma_f32_16x16x32_bf16 v[112:115], v[80:83], v[32:35], v[112:115]
    v_mfma_f32_16x16x32_bf16 v[116:119], v[84:87], v[32:35], v[116:119]
    v_mfma_f32_16x16x32_bf16 v[120:123], v[88:91], v[32:35], v[120:123]
    v_mfma_f32_16x16x32_bf16 v[124:127], v[92:95], v[32:35], v[124:127]
    ds_read_b128 v[80:83], v4 offset:24576
    ds_read_b128 v[84:87], v4 offset:25600
    ds_read_b128 v[88:91], v4 offset:26624
    ds_read_b128 v[92:95], v4 offset:27648
    s_waitcnt vmcnt(10) lgkmcnt(4)
    v_mfma_f32_16x16x32_bf16 v[112:115], v[96:99], v[36:39], v[112:115]
    v_mfma_f32_16x16x32_bf16 v[116:119], v[100:103], v[36:39], v[116:119]
    v_mfma_f32_16x16x32_bf16 v[120:123], v[104:107], v[36:39], v[120:123]
    v_mfma_f32_16x16x32_bf16 v[124:127], v[108:111], v[36:39], v[124:127]
    ds_read_b128 v[96:99], v4 offset:28672
    ds_read_b128 v[100:103], v4 offset:29696
    ds_read_b128 v[104:107], v4 offset:30720
    ds_read_b128 v[108:111], v4 offset:31744
    s_waitcnt vmcnt(9) lgkmcnt(4)
    v_mfma_f32_16x16x32_bf16 v[112:115], v[80:83], v[40:43], v[112:115]
    v_mfma_f32_16x16x32_bf16 v[116:119], v[84:87], v[40:43], v[116:119]
    v_mfma_f32_16x16x32_bf16 v[120:123], v[88:91], v[40:43], v[120:123]
    v_mfma_f32_16x16x32_bf16 v[124:127], v[92:95], v[40:43], v[124:127]
    ds_read_b128 v[80:83], v4 offset:32768
    ds_read_b128 v[84:87], v4 offset:33792
    ds_read_b128 v[88:91], v4 offset:34816
    ds_read_b128 v[92:95], v4 offset:35840
    s_waitcnt vmcnt(8) lgkmcnt(4)
    v_mfma_f32_16x16x32_bf16 v[112:115], v[96:99], v[44:47], v[112:115]
    v_mfma_f32_16x16x32_bf16 v[116:119], v[100:103], v[44:47], v[116:119]
    v_mfma_f32_16x16x32_bf16 v[120:123], v[104:107], v[44:47], v[120:123]
    v_mfma_f32_16x16x32_bf16 v[124:127], v[108:111], v[44:47], v[124:127]
    ds_read_b128 v[96:99], v4 offset:36864
    ds_read_b128 v[100:103], v4 offset:37888
    ds_read_b128 v[104:107], v4 offset:38912
    ds_read_b128 v[108:111], v4 offset:39936
    s_waitcnt vmcnt(7) lgkmcnt(4)
    v_mfma_f32_16x16x32_bf16 v[112:115], v[80:83], v[48:51], v[112:115]
    v_mfma_f32_16x16x32_bf16 v[116:119], v[84:87], v[48:51], v[116:119]
    v_mfma_f32_16x16x32_bf16 v[120:123], v[88:91], v[48:51], v[120:123]
    v_mfma_f32_16x16x32_bf16 v[124:127], v[92:95], v[48:51], v[124:127]
    ds_read_b128 v[80:83], v4 offset:40960
    ds_read_b128 v[84:87], v4 offset:41984
    ds_read_b128 v[88:91], v4 offset:43008
    ds_read_b128 v[92:95], v4 offset:44032
    s_waitcnt vmcnt(6) lgkmcnt(4)
    v_mfma_f32_16x16x32_bf16 v[112:115], v[96:99], v[52:55], v[112:115]
    v_mfma_f32_16x16x32_bf16 v[116:119], v[100:103], v[52:55], v[116:119]
    v_mfma_f32_16x16x32_bf16 v[120:123], v[104:107], v[52:55], v[120:123]
    v_mfma_f32_16x16x32_bf16 v[124:127], v[108:111], v[52:55], v[124:127]
    ds_read_b128 v[96:99], v4 offset:45056
    ds_read_b128 v[100:103], v4 offset:46080
    ds_read_b128 v[104:107], v4 offset:47104
    ds_read_b128 v[108:111], v4 offset:48128
    s_waitcnt vmcnt(5) lgkmcnt(4)
    v_mfma_f32_16x16x32_bf16 v[112:115], v[80:83], v[56:59], v[112:115]
    v_mfma_f32_16x16x32_bf16 v[116:119], v[84:87], v[56:59], v[116:119]
    v_mfma_f32_16x16x32_bf16 v[120:123], v[88:91], v[56:59], v[120:123]
    v_mfma_f32_16x16x32_bf16 v[124:127], v[92:95], v[56:59], v[124:127]
    ds_read_b128 v[80:83], v4 offset:49152
    ds_read_b128 v[84:87], v4 offset:50176
    ds_read_b128 v[88:91], v4 offset:51200
    ds_read_b128 v[92:95], v4 offset:52224
    s_waitcnt vmcnt(4) lgkmcnt(4)
    v_mfma_f32_16x16x32_bf16 v[112:115], v[96:99], v[60:63], v[112:115]
    v_mfma_f32_16x16x32_bf16 v[116:119], v[100:103], v[60:63], v[116:119]
    v_mfma_f32_16x16x32_bf16 v[120:123], v[104:107], v[60:63], v[120:123]
    v_mfma_f32_16x16x32_bf16 v[124:127], v[108:111], v[60:63], v[124:127]
    ds_read_b128 v[96:99], v4 offset:53248
    ds_read_b128 v[100:103], v4 offset:54272
    ds_read_b128 v[104:107], v4 offset:55296
    ds_read_b128 v[108:111], v4 offset:56320
    s_waitcnt vmcnt(3) lgkmcnt(4)
    v_mfma_f32_16x16x32_bf16 v[112:115], v[80:83], v[64:67], v[112:115]
    v_mfma_f32_16x16x32_bf16 v[116:119], v[84:87], v[64:67], v[116:119]
    v_mfma_f32_16x16x32_bf16 v[120:123], v[88:91], v[64:67], v[120:123]
    v_mfma_f32_16x16x32_bf16 v[124:127], v[92:95], v[64:67], v[124:127]
    ds_read_b128 v[80:83], v4 offset:57344
    ds_read_b128 v[84:87], v4 offset:58368
    ds_read_b128 v[88:91], v4 offset:59392
    ds_read_b128 v[92:95], v4 offset:60416
    s_waitcnt vmcnt(2) lgkmcnt(4)
    v_mfma_f32_16x16x32_bf16 v[112:115], v[96:99], v[68:71], v[112:115]
    v_mfma_f32_16x16x32_bf16 v[116:119], v[100:103], v[68:71], v[116:119]
    v_mfma_f32_16x16x32_bf16 v[120:123], v[104:107], v[68:71], v[120:123]
    v_mfma_f32_16x16x32_bf16 v[124:127], v[108:111], v[68:71], v[124:127]
    ds_read_b128 v[96:99], v4 offset:61440
    ds_read_b128 v[100:103], v4 offset:62464
    ds_read_b128 v[104:107], v4 offset:63488
    ds_read_b128 v[108:111], v4 offset:64512
    s_waitcnt vmcnt(1) lgkmcnt(4)
    v_mfma_f32_16x16x32_bf16 v[112:115], v[80:83], v[72:75], v[112:115]
    v_mfma_f32_16x16x32_bf16 v[116:119], v[84:87], v[72:75], v[116:119]
    v_mfma_f32_16x16x32_bf16 v[120:123], v[88:91], v[72:75], v[120:123]
    v_mfma_f32_16x16x32_bf16 v[124:127], v[92:95], v[72:75], v[124:127]
    s_waitcnt vmcnt(0) lgkmcnt(0)
    v_mfma_f32_16x16x32_bf16 v[112:115], v[96:99], v[76:79], v[112:115]
    v_mfma_f32_16x16x32_bf16 v[116:119], v[100:103], v[76:79], v[116:119]
    v_mfma_f32_16x16x32_bf16 v[120:123], v[104:107], v[76:79], v[120:123]
    v_mfma_f32_16x16x32_bf16 v[124:127], v[108:111], v[76:79], v[124:127]
    s_lshl_b32 s23, s17, 3
    s_add_u32 s23, s23, s19
    s_lshl_b32 s23, s23, 3
    s_add_u32 s23, s23, s18
    s_lshl_b32 s25, s23, 2
    s_add_u32 s25, s25, 10551296
    s_lshl_b32 s23, s23, 12
    s_add_u32 s23, s23, 6291456
    s_mov_b32 s24, 0x4038aa3b
    s_nop 4
    v_mul_f32 v80, s24, v112
    v_mul_f32 v81, s24, v116
    v_mul_f32 v82, s24, v120
    v_mul_f32 v83, s24, v124
    buffer_store_dwordx4 v[80:83], v3, s[12:15], s23 offen offset:0 sc0 sc1
    v_mul_f32 v84, s24, v113
    v_mul_f32 v85, s24, v117
    v_mul_f32 v86, s24, v121
    v_mul_f32 v87, s24, v125
    buffer_store_dwordx4 v[84:87], v3, s[12:15], s23 offen offset:1024 sc0 sc1
    v_mul_f32 v88, s24, v114
    v_mul_f32 v89, s24, v118
    v_mul_f32 v90, s24, v122
    v_mul_f32 v91, s24, v126
    buffer_store_dwordx4 v[88:91], v3, s[12:15], s23 offen offset:2048 sc0 sc1
    v_mul_f32 v92, s24, v115
    v_mul_f32 v93, s24, v119
    v_mul_f32 v94, s24, v123
    v_mul_f32 v95, s24, v127
    buffer_store_dwordx4 v[92:95], v3, s[12:15], s23 offen offset:3072 sc0 sc1
    v_max3_f32 v4, |v80|, |v81|, |v82|
    v_max3_f32 v4, v4, |v83|, |v84|
    v_max3_f32 v4, v4, |v85|, |v86|
    v_max3_f32 v4, v4, |v87|, |v88|
    v_max3_f32 v4, v4, |v89|, |v90|
    v_max3_f32 v4, v4, |v91|, |v92|
    v_max3_f32 v4, v4, |v93|, |v94|
    v_max3_f32 v4, v4, |v95|, |v95|
    s_mov_b32 s26, 0x42fc0000
    v_cmp_le_f32 vcc, s26, v4
    s_nop 4
    s_cmp_lg_u64 vcc, 0
    s_cselect_b32 s26, 1, 0
    v_mov_b32 v5, s26
    v_mov_b32 v6, 0
    s_mov_b64 exec, 1
    buffer_store_dword v5, v6, s[12:15], s25 offen sc0 sc1
    s_mov_b64 exec, -1
    s_lshr_b32 s27, s19, 2
    s_lshl_b32 s27, s27, 3
    s_add_u32 s27, s27, s18
    s_lshl_b32 s28, s17, 4
    s_add_u32 s27, s27, s28
    s_lshl_b32 s101, s27, 2
    s_add_u32 s101, s101, 16384
    s_load_dwordx2 s[4:5], s[0:1], 72
    s_load_dwordx2 s[12:13], s[0:1], 56
    s_lshr_b32 s17, s2, 3
    v_and_b32 v1, 15, v0
    v_lshrrev_b32 v2, 4, v0
    v_lshlrev_b32 v12, 4, v0
    s_and_b32 s18, s17, 15
    s_lshr_b32 s17, s17, 4
    s_and_b32 s19, s2, 7
    s_lshl_b32 s19, s19, 1
    s_add_u32 s17, s17, s19
    s_lshr_b32 s19, s18, 1
    s_and_b32 s18, s18, 1
    s_lshr_b32 s20, s17, 3
    v_and_b32 v3, 7, v0
    v_bfe_u32 v4, v0, 3, 1
    v_lshlrev_b32 v4, 11, v4
    s_lshl_b32 s22, s18, 3
    v_lshl_add_u32 v5, v2, 4, v3
    v_add_u32 v5, s22, v5
    v_lshl_add_u32 v13, v5, 4, v4
    s_lshl_b32 s23, s17, 3
    s_add_u32 s23, s23, s19
    s_lshl_b32 s30, s23, 5
    s_lshl_b32 s23, s23, 3
    s_and_b32 s22, s16, 1
    s_add_u32 s23, s23, s22
    s_lshl_b32 s23, s23, 12
    s_add_u32 s23, s23, 6291456
    s_lshl_b32 s24, s16, 13
    s_lshl_b32 s21, s20, 14
    s_lshl_b32 s22, s16, 12
    s_add_u32 s21, s21, s22
    s_add_u32 s26, s21, 10518528
    s_add_u32 s21, s21, 10485760
    s_add_u32 m0, s22, 135168
    s_mov_b32 s6, 10559488
    s_mov_b32 s7, 0x00020000
    s_mov_b32 s10, 524288
    s_mov_b32 s11, 0x00020000
    s_waitcnt lgkmcnt(0)
    s_add_u32 s8, s4, 25165824
    s_addc_u32 s9, s5, 0
    s_mov_b32 s85, s21
    s_lshr_b32 s21, s16, 1
    s_lshl_b32 s27, s21, 13
    s_and_b32 s22, s16, 1
    s_lshl_b32 s22, s22, 3
    v_lshrrev_b32 v4, 3, v0
    v_add_u32 v4, s22, v4
    v_lshlrev_b32 v5, 5, v4
    s_add_u32 s27, s27, 135168
    v_add_u32 v14, s27, v5
    v_subrev_u32 v94, 53248, v14
    v_lshlrev_b32 v5, 1, v3
    v_xor_b32 v5, v5, v4
    v_lshlrev_b32 v5, 4, v5
    s_lshl_b32 s27, s21, 15
    v_lshl_add_u32 v5, v3, 10, v5
    v_add_u32 v15, s27, v5
    v_and_b32 v4, 7, v1
    v_lshlrev_b32 v6, 1, v4
    v_add_u32 v5, 0, v2
    v_xor_b32 v5, v5, v6
    v_lshlrev_b32 v5, 4, v5
    v_lshl_add_u32 v8, v1, 10, v5
    v_add_u32 v5, 4, v2
    v_xor_b32 v5, v5, v6
    v_lshlrev_b32 v5, 4, v5
    v_lshl_add_u32 v9, v1, 10, v5
    v_add_u32 v5, 8, v2
    v_xor_b32 v5, v5, v6
    v_lshlrev_b32 v5, 4, v5
    v_lshl_add_u32 v10, v1, 10, v5
    v_add_u32 v5, 12, v2
    v_xor_b32 v5, v5, v6
    v_lshlrev_b32 v5, 4, v5
    v_lshl_add_u32 v11, v1, 10, v5
    v_lshlrev_b32 v5, 1, v2
    s_lshl_b32 s22, s16, 4
    v_add_u32 v5, s22, v5
    v_xor_b32 v5, v5, v4
    v_lshlrev_b32 v5, 4, v5
    v_lshl_add_u32 v5, v1, 10, v5
    v_add_u32 v88, 65536, v5
    v_xor_b32 v89, 16, v88
    s_lshl_b32 s22, s16, 12
    s_add_u32 s22, s22, 65536
    s_and_b32 s27, s16, 1
    s_lshl_b32 s27, s27, 6
    v_xor_b32 v5, s27, v12
    v_xor_b32 v6, 0, v5
    v_add_u32 v90, s22, v6
    v_xor_b32 v6, 16, v5
    v_add_u32 v91, s22, v6
    v_xor_b32 v6, 32, v5
    v_add_u32 v92, s22, v6
    v_xor_b32 v6, 48, v5
    v_add_u32 v93, s22, v6
    s_and_b32 s21, s17, 7
    s_mul_i32 s21, s21, 126
    s_lshl_b32 s22, s18, 6
    s_add_u32 s22, s22, s19
    s_and_b32 s27, s16, 1
    s_lshl_b32 s27, s27, 5
    s_add_u32 s22, s22, s27
    s_lshr_b32 s26, s16, 1
    s_add_u32 s27, s22, 0
    s_add_u32 s28, s27, s21
    s_lshl_b32 s28, s28, 3
    s_add_u32 s28, s28, s26
    s_lshl_b32 s28, s28, 10
    s_cmp_lt_u32 s27, 126
    s_cselect_b32 s60, s28, 0x7ff00000
    s_add_u32 s27, s22, 8
    s_add_u32 s28, s27, s21
    s_lshl_b32 s28, s28, 3
    s_add_u32 s28, s28, s26
    s_lshl_b32 s28, s28, 10
    s_cmp_lt_u32 s27, 126
    s_cselect_b32 s61, s28, 0x7ff00000
    s_add_u32 s27, s22, 16
    s_add_u32 s28, s27, s21
    s_lshl_b32 s28, s28, 3
    s_add_u32 s28, s28, s26
    s_lshl_b32 s28, s28, 10
    s_cmp_lt_u32 s27, 126
    s_cselect_b32 s62, s28, 0x7ff00000
    s_add_u32 s27, s22, 24
    s_add_u32 s28, s27, s21
    s_lshl_b32 s28, s28, 3
    s_add_u32 s28, s28, s26
    s_lshl_b32 s28, s28, 10
    s_cmp_lt_u32 s27, 126
    s_cselect_b32 s63, s28, 0x7ff00000
    s_mul_i32 s21, s20, 8192000
    s_add_u32 s12, s12, s21
    s_addc_u32 s13, s13, 0
    s_mov_b32 s14, 8192000
    s_mov_b32 s15, 0x00020000
    s_waitcnt vmcnt(0)
    s_barrier
    s_cmp_lg_u32 s16, 0
    s_cbranch_scc1 p3_sig16
    v_mov_b32 v6, s100
    v_mov_b32 v7, 0
    s_mov_b64 exec, 1
    buffer_store_dword v6, v7, s[92:95], s101 offen sc0 sc1
    s_mov_b64 exec, -1
p3_sig16:
    s_lshr_b32 s27, s19, 2
    s_lshl_b32 s27, s27, 3
    s_lshl_b32 s28, s17, 4
    s_add_u32 s27, s27, s28
    s_lshl_b32 s27, s27, 2
    s_add_u32 s27, s27, 16384
    v_lshlrev_b32 v5, 2, v0
    v_add_u32 v5, s27, v5
    s_mov_b64 exec, 0xff
    s_mov_b32 s27, 0x20000
p4_poll17:
    buffer_load_dword v6, v5, s[92:95], 0 offen sc1
    s_waitcnt vmcnt(0)
    v_cmp_ne_u32 vcc, s100, v6
    s_sub_u32 s27, s27, 1
    s_cmp_eq_u32 s27, 0
    s_cbranch_scc1 p4_poll17_done
    s_cbranch_vccz p4_poll17_done
    s_sleep 4
    s_branch p4_poll17
p4_poll17_done:
    s_mov_b64 exec, -1
    buffer_load_dwordx4 v[16:19], v13, s[4:7], s23 offen offset:0
    buffer_load_dwordx4 v[20:23], v13, s[4:7], s23 offen offset:1024
    s_add_u32 s23, s23, 8192
    v_lshlrev_b32 v5, 2, v0
    v_add_u32 v6, 10555360, v5
    s_add_u32 s27, s30, 10551296
    v_add_u32 v5, s27, v5
    v_cmp_gt_u32 vcc, 8, v0
    s_nop 1
    v_cndmask_b32 v5, v6, v5, vcc
    buffer_load_dword v7, v5, s[4:7], 0 offen sc1
    buffer_load_dwordx4 v[24:27], v13, s[4:7], s23 offen offset:0
    buffer_load_dwordx4 v[28:31], v13, s[4:7], s23 offen offset:1024
    s_add_u32 s23, s23, 8192
    buffer_load_dwordx4 v[32:35], v13, s[4:7], s23 offen offset:0
    buffer_load_dwordx4 v[36:39], v13, s[4:7], s23 offen offset:1024
    s_add_u32 s23, s23, 8192
    buffer_load_dwordx4 v[40:43], v13, s[4:7], s23 offen offset:0
    buffer_load_dwordx4 v[44:47], v13, s[4:7], s23 offen offset:1024
    s_waitcnt vmcnt(6)
    v_cmp_ne_u32 vcc, 0, v7
    s_nop 4
    s_and_b32 s26, vcc_hi, 0xff
    s_or_b32 s84, s26, vcc_lo
    s_cmp_lg_u32 s84, 0
    s_cbranch_scc1 p4_slow
    ds_read_b128 v[48:51], v14 offset:0
    ds_read_b128 v[52:55], v14 offset:16
    v_exp_f32 v16, v16
    v_exp_f32 v17, v17
    v_exp_f32 v18, v18
    v_exp_f32 v19, v19
    v_exp_f32 v20, v20
    v_exp_f32 v21, v21
    v_exp_f32 v22, v22
    v_exp_f32 v23, v23
    ds_read_b128 v[56:59], v14 offset:2048
    ds_read_b128 v[60:63], v14 offset:2064
    s_waitcnt lgkmcnt(2)
    v_fma_f32 v64, v16, v48, 1.0
    v_fma_f32 v65, v17, v49, 1.0
    v_fma_f32 v66, v18, v50, 1.0
    v_fma_f32 v67, v19, v51, 1.0
    v_fma_f32 v68, v20, v52, 1.0
    v_fma_f32 v69, v21, v53, 1.0
    v_fma_f32 v70, v22, v54, 1.0
    v_fma_f32 v71, v23, v55, 1.0
    v_rcp_f32 v64, v64
    v_rcp_f32 v65, v65
    v_rcp_f32 v66, v66
    v_rcp_f32 v67, v67
    v_rcp_f32 v68, v68
    v_rcp_f32 v69, v69
    v_rcp_f32 v70, v70
    v_rcp_f32 v71, v71
    v_fma_f32 v64, v64, -2.0, 1.0
    v_fma_f32 v65, v65, -2.0, 1.0
    v_fma_f32 v66, v66, -2.0, 1.0
    v_fma_f32 v67, v67, -2.0, 1.0
    v_fma_f32 v68, v68, -2.0, 1.0
    v_fma_f32 v69, v69, -2.0, 1.0
    v_fma_f32 v70, v70, -2.0, 1.0
    v_fma_f32 v71, v71, -2.0, 1.0
    v_cvt_pk_bf16_f32 v80, v64, v65
    v_cvt_pk_bf16_f32 v81, v66, v67
    v_cvt_pk_bf16_f32 v82, v68, v69
    v_cvt_pk_bf16_f32 v83, v70, v71
    ds_write_b128 v15, v[80:83] offset:0
    ds_read_b128 v[48:51], v14 offset:4096
    ds_read_b128 v[52:55], v14 offset:4112
    s_waitcnt lgkmcnt(3)
    v_fma_f32 v72, v16, v56, 1.0
    v_fma_f32 v73, v17, v57, 1.0
    v_fma_f32 v74, v18, v58, 1.0
    v_fma_f32 v75, v19, v59, 1.0
    v_fma_f32 v76, v20, v60, 1.0
    v_fma_f32 v77, v21, v61, 1.0
    v_fma_f32 v78, v22, v62, 1.0
    v_fma_f32 v79, v23, v63, 1.0
    v_rcp_f32 v72, v72
    v_rcp_f32 v73, v73
    v_rcp_f32 v74, v74
    v_rcp_f32 v75, v75
    v_rcp_f32 v76, v76
    v_rcp_f32 v77, v77
    v_rcp_f32 v78, v78
    v_rcp_f32 v79, v79
    v_fma_f32 v72, v72, -2.0, 1.0
    v_fma_f32 v73, v73, -2.0, 1.0
    v_fma_f32 v74, v74, -2.0, 1.0
    v_fma_f32 v75, v75, -2.0, 1.0
    v_fma_f32 v76, v76, -2.0, 1.0
    v_fma_f32 v77, v77, -2.0, 1.0
    v_fma_f32 v78, v78, -2.0, 1.0
    v_fma_f32 v79, v79, -2.0, 1.0
    v_cvt_pk_bf16_f32 v84, v72, v73
    v_cvt_pk_bf16_f32 v85, v74, v75
    v_cvt_pk_bf16_f32 v86, v76, v77
    v_cvt_pk_bf16_f32 v87, v78, v79
    ds_write_b128 v15, v[84:87] offset:8192
    ds_read_b128 v[56:59], v14 offset:6144
    ds_read_b128 v[60:63], v14 offset:6160
    s_waitcnt lgkmcnt(3)
    v_fma_f32 v64, v16, v48, 1.0
    v_fma_f32 v65, v17, v49, 1.0
    v_fma_f32 v66, v18, v50, 1.0
    v_fma_f32 v67, v19, v51, 1.0
    v_fma_f32 v68, v20, v52, 1.0
    v_fma_f32 v69, v21, v53, 1.0
    v_fma_f32 v70, v22, v54, 1.0
    v_fma_f32 v71, v23, v55, 1.0
    v_rcp_f32 v64, v64
    v_rcp_f32 v65, v65
    v_rcp_f32 v66, v66
    v_rcp_f32 v67, v67
    v_rcp_f32 v68, v68
    v_rcp_f32 v69, v69
    v_rcp_f32 v70, v70
    v_rcp_f32 v71, v71
    v_fma_f32 v64, v64, -2.0, 1.0
    v_fma_f32 v65, v65, -2.0, 1.0
    v_fma_f32 v66, v66, -2.0, 1.0
    v_fma_f32 v67, v67, -2.0, 1.0
    v_fma_f32 v68, v68, -2.0, 1.0
    v_fma_f32 v69, v69, -2.0, 1.0
    v_fma_f32 v70, v70, -2.0, 1.0
    v_fma_f32 v71, v71, -2.0, 1.0
    v_cvt_pk_bf16_f32 v80, v64, v65
    v_cvt_pk_bf16_f32 v81, v66, v67
    v_cvt_pk_bf16_f32 v82, v68, v69
    v_cvt_pk_bf16_f32 v83, v70, v71
    ds_write_b128 v15, v[80:83] offset:16384
    s_waitcnt lgkmcnt(1)
    v_fma_f32 v72, v16, v56, 1.0
    v_fma_f32 v73, v17, v57, 1.0
    v_fma_f32 v74, v18, v58, 1.0
    v_fma_f32 v75, v19, v59, 1.0
    v_fma_f32 v76, v20, v60, 1.0
    v_fma_f32 v77, v21, v61, 1.0
    v_fma_f32 v78, v22, v62, 1.0
    v_fma_f32 v79, v23, v63, 1.0
    v_rcp_f32 v72, v72
    v_rcp_f32 v73, v73
    v_rcp_f32 v74, v74
    v_rcp_f32 v75, v75
    v_rcp_f32 v76, v76
    v_rcp_f32 v77, v77
    v_rcp_f32 v78, v78
    v_rcp_f32 v79, v79
    v_fma_f32 v72, v72, -2.0, 1.0
    v_fma_f32 v73, v73, -2.0, 1.0
    v_fma_f32 v74, v74, -2.0, 1.0
    v_fma_f32 v75, v75, -2.0, 1.0
    v_fma_f32 v76, v76, -2.0, 1.0
    v_fma_f32 v77, v77, -2.0, 1.0
    v_fma_f32 v78, v78, -2.0, 1.0
    v_fma_f32 v79, v79, -2.0, 1.0
    v_cvt_pk_bf16_f32 v84, v72, v73
    v_cvt_pk_bf16_f32 v85, v74, v75
    v_cvt_pk_bf16_f32 v86, v76, v77
    v_cvt_pk_bf16_f32 v87, v78, v79
    ds_write_b128 v15, v[84:87] offset:24576
    s_waitcnt lgkmcnt(0)
    s_barrier
    ds_read_b128 a[96:99], v8 offset:0
    ds_read_b128 a[100:103], v8 offset:16384
    ds_read_b128 a[104:107], v8 offset:32768
    ds_read_b128 a[108:111], v8 offset:49152
    s_waitcnt lgkmcnt(0)
    v_mfma_f32_16x16x32_bf16 v[128:131], a[0:3], a[96:99], 0
    s_add_u32 s25, s24, 65536
    s_add_u32 s31, s24, 69632
    ds_read_b128 v[48:51], v14 offset:512
    v_mfma_f32_16x16x32_bf16 v[132:135], a[4:7], a[96:99], 0
    buffer_load_dwordx4 a[64:67], v12, s[8:11], s25 offen offset:0
    ds_read_b128 v[52:55], v14 offset:528
    s_waitcnt vmcnt(5)
    v_mfma_f32_16x16x32_bf16 v[136:139], a[8:11], a[96:99], 0
    v_exp_f32 v24, v24
    v_mfma_f32_16x16x32_bf16 v[140:143], a[12:15], a[96:99], 0
    v_exp_f32 v25, v25
    v_mfma_f32_16x16x32_bf16 v[144:147], a[16:19], a[96:99], 0
    buffer_load_dwordx4 a[68:71], v12, s[8:11], s25 offen offset:1024
    v_exp_f32 v26, v26
    v_mfma_f32_16x16x32_bf16 v[148:151], a[20:23], a[96:99], 0
    ds_read_b128 a[112:115], v9 offset:0
    v_exp_f32 v27, v27
    v_mfma_f32_16x16x32_bf16 v[152:155], a[24:27], a[96:99], 0
    v_exp_f32 v28, v28
    v_mfma_f32_16x16x32_bf16 v[156:159], a[28:31], a[96:99], 0
    v_exp_f32 v29, v29
    v_mfma_f32_16x16x32_bf16 v[188:191], a[28:31], a[100:103], 0
    buffer_load_dwordx4 a[72:75], v12, s[8:11], s25 offen offset:2048
    v_exp_f32 v30, v30
    v_mfma_f32_16x16x32_bf16 v[184:187], a[24:27], a[100:103], 0
    v_exp_f32 v31, v31
    ds_read_b128 v[56:59], v14 offset:2560
    ds_read_b128 v[60:63], v14 offset:2576
    v_mfma_f32_16x16x32_bf16 v[180:183], a[20:23], a[100:103], 0
    s_waitcnt lgkmcnt(3)
    v_fma_f32 v64, v24, v48, 1.0
    v_fma_f32 v65, v25, v49, 1.0
    v_mfma_f32_16x16x32_bf16 v[176:179], a[16:19], a[100:103], 0
    v_fma_f32 v66, v26, v50, 1.0
    v_fma_f32 v67, v27, v51, 1.0
    v_mfma_f32_16x16x32_bf16 v[172:175], a[12:15], a[100:103], 0
    buffer_load_dwordx4 a[76:79], v12, s[8:11], s25 offen offset:3072
    v_fma_f32 v68, v28, v52, 1.0
    v_fma_f32 v69, v29, v53, 1.0
    v_mfma_f32_16x16x32_bf16 v[168:171], a[8:11], a[100:103], 0
    ds_read_b128 a[116:119], v9 offset:16384
    v_fma_f32 v70, v30, v54, 1.0
    v_fma_f32 v71, v31, v55, 1.0
    v_mfma_f32_16x16x32_bf16 v[164:167], a[4:7], a[100:103], 0
    v_rcp_f32 v64, v64
    v_mfma_f32_16x16x32_bf16 v[160:163], a[0:3], a[100:103], 0
    v_rcp_f32 v65, v65
    v_mfma_f32_16x16x32_bf16 v[192:195], a[0:3], a[104:107], 0
    buffer_load_dwordx4 a[80:83], v12, s[8:11], s31 offen offset:0
    v_rcp_f32 v66, v66
    v_mfma_f32_16x16x32_bf16 v[196:199], a[4:7], a[104:107], 0
    v_rcp_f32 v67, v67
    v_mfma_f32_16x16x32_bf16 v[200:203], a[8:11], a[104:107], 0
    v_rcp_f32 v68, v68
    v_mfma_f32_16x16x32_bf16 v[204:207], a[12:15], a[104:107], 0
    v_rcp_f32 v69, v69
    v_mfma_f32_16x16x32_bf16 v[208:211], a[16:19], a[104:107], 0
    buffer_load_dwordx4 a[84:87], v12, s[8:11], s31 offen offset:1024
    v_rcp_f32 v70, v70
    v_mfma_f32_16x16x32_bf16 v[212:215], a[20:23], a[104:107], 0
    ds_read_b128 a[120:123], v9 offset:32768
    v_rcp_f32 v71, v71
    v_mfma_f32_16x16x32_bf16 v[216:219], a[24:27], a[104:107], 0
    v_fma_f32 v64, v64, -2.0, 1.0
    v_fma_f32 v65, v65, -2.0, 1.0
    v_mfma_f32_16x16x32_bf16 v[220:223], a[28:31], a[104:107], 0
    v_fma_f32 v66, v66, -2.0, 1.0
    v_fma_f32 v67, v67, -2.0, 1.0
    v_mfma_f32_16x16x32_bf16 v[252:255], a[28:31], a[108:111], 0
    buffer_load_dwordx4 a[88:91], v12, s[8:11], s31 offen offset:2048
    v_fma_f32 v68, v68, -2.0, 1.0
    v_fma_f32 v69, v69, -2.0, 1.0
    v_mfma_f32_16x16x32_bf16 v[248:251], a[24:27], a[108:111], 0
    v_fma_f32 v70, v70, -2.0, 1.0
    v_fma_f32 v71, v71, -2.0, 1.0
    v_mfma_f32_16x16x32_bf16 v[244:247], a[20:23], a[108:111], 0
    v_cvt_pk_bf16_f32 v80, v64, v65
    v_cvt_pk_bf16_f32 v81, v66, v67
    v_mfma_f32_16x16x32_bf16 v[240:243], a[16:19], a[108:111], 0
    v_cvt_pk_bf16_f32 v82, v68, v69
    v_cvt_pk_bf16_f32 v83, v70, v71
    ds_write_b128 v15, v[80:83] offset:256
    v_mfma_f32_16x16x32_bf16 v[236:239], a[12:15], a[108:111], 0
    buffer_load_dwordx4 a[92:95], v12, s[8:11], s31 offen offset:3072
    ds_read_b128 v[48:51], v14 offset:4608
    ds_read_b128 v[52:55], v14 offset:4624
    v_mfma_f32_16x16x32_bf16 v[232:235], a[8:11], a[108:111], 0
    ds_read_b128 a[124:127], v9 offset:49152
    s_waitcnt lgkmcnt(6)
    v_fma_f32 v72, v24, v56, 1.0
    v_mfma_f32_16x16x32_bf16 v[228:231], a[4:7], a[108:111], 0
    v_fma_f32 v73, v25, v57, 1.0
    v_fma_f32 v74, v26, v58, 1.0
    v_mfma_f32_16x16x32_bf16 v[224:227], a[0:3], a[108:111], 0
    v_fma_f32 v75, v27, v59, 1.0
    v_fma_f32 v76, v28, v60, 1.0
    s_waitcnt lgkmcnt(0)
    v_mfma_f32_16x16x32_bf16 v[128:131], a[32:35], a[112:115], v[128:131]
    s_add_u32 s25, s24, 98304
    s_add_u32 s31, s24, 102400
    v_fma_f32 v77, v29, v61, 1.0
    v_mfma_f32_16x16x32_bf16 v[132:135], a[36:39], a[112:115], v[132:135]
    buffer_load_dwordx4 a[0:3], v12, s[8:11], s25 offen offset:0
    v_fma_f32 v78, v30, v62, 1.0
    v_fma_f32 v79, v31, v63, 1.0
    v_mfma_f32_16x16x32_bf16 v[136:139], a[40:43], a[112:115], v[136:139]
    v_rcp_f32 v72, v72
    v_mfma_f32_16x16x32_bf16 v[140:143], a[44:47], a[112:115], v[140:143]
    v_rcp_f32 v73, v73
    v_mfma_f32_16x16x32_bf16 v[144:147], a[48:51], a[112:115], v[144:147]
    buffer_load_dwordx4 a[4:7], v12, s[8:11], s25 offen offset:1024
    v_rcp_f32 v74, v74
    v_mfma_f32_16x16x32_bf16 v[148:151], a[52:55], a[112:115], v[148:151]
    ds_read_b128 a[96:99], v10 offset:0
    v_rcp_f32 v75, v75
    v_mfma_f32_16x16x32_bf16 v[152:155], a[56:59], a[112:115], v[152:155]
    v_rcp_f32 v76, v76
    v_mfma_f32_16x16x32_bf16 v[156:159], a[60:63], a[112:115], v[156:159]
    v_rcp_f32 v77, v77
    v_mfma_f32_16x16x32_bf16 v[188:191], a[60:63], a[116:119], v[188:191]
    buffer_load_dwordx4 a[8:11], v12, s[8:11], s25 offen offset:2048
    v_rcp_f32 v78, v78
    v_mfma_f32_16x16x32_bf16 v[184:187], a[56:59], a[116:119], v[184:187]
    v_rcp_f32 v79, v79
    v_mfma_f32_16x16x32_bf16 v[180:183], a[52:55], a[116:119], v[180:183]
    v_fma_f32 v72, v72, -2.0, 1.0
    v_fma_f32 v73, v73, -2.0, 1.0
    v_mfma_f32_16x16x32_bf16 v[176:179], a[48:51], a[116:119], v[176:179]
    v_fma_f32 v74, v74, -2.0, 1.0
    v_fma_f32 v75, v75, -2.0, 1.0
    v_mfma_f32_16x16x32_bf16 v[172:175], a[44:47], a[116:119], v[172:175]
    buffer_load_dwordx4 a[12:15], v12, s[8:11], s25 offen offset:3072
    v_fma_f32 v76, v76, -2.0, 1.0
    v_fma_f32 v77, v77, -2.0, 1.0
    v_mfma_f32_16x16x32_bf16 v[168:171], a[40:43], a[116:119], v[168:171]
    ds_read_b128 a[100:103], v10 offset:16384
    v_fma_f32 v78, v78, -2.0, 1.0
    v_fma_f32 v79, v79, -2.0, 1.0
    v_mfma_f32_16x16x32_bf16 v[164:167], a[36:39], a[116:119], v[164:167]
    v_cvt_pk_bf16_f32 v84, v72, v73
    v_cvt_pk_bf16_f32 v85, v74, v75
    v_mfma_f32_16x16x32_bf16 v[160:163], a[32:35], a[116:119], v[160:163]
    v_cvt_pk_bf16_f32 v86, v76, v77
    v_cvt_pk_bf16_f32 v87, v78, v79
    ds_write_b128 v15, v[84:87] offset:8448
    v_mfma_f32_16x16x32_bf16 v[192:195], a[32:35], a[120:123], v[192:195]
    buffer_load_dwordx4 a[16:19], v12, s[8:11], s31 offen offset:0
    ds_read_b128 v[56:59], v14 offset:6656
    ds_read_b128 v[60:63], v14 offset:6672
    v_mfma_f32_16x16x32_bf16 v[196:199], a[36:39], a[120:123], v[196:199]
    v_fma_f32 v64, v24, v48, 1.0
    v_fma_f32 v65, v25, v49, 1.0
    v_mfma_f32_16x16x32_bf16 v[200:203], a[40:43], a[120:123], v[200:203]
    v_fma_f32 v66, v26, v50, 1.0
    v_fma_f32 v67, v27, v51, 1.0
    v_mfma_f32_16x16x32_bf16 v[204:207], a[44:47], a[120:123], v[204:207]
    v_fma_f32 v68, v28, v52, 1.0
    v_fma_f32 v69, v29, v53, 1.0
    v_mfma_f32_16x16x32_bf16 v[208:211], a[48:51], a[120:123], v[208:211]
    buffer_load_dwordx4 a[20:23], v12, s[8:11], s31 offen offset:1024
    v_fma_f32 v70, v30, v54, 1.0
    v_fma_f32 v71, v31, v55, 1.0
    v_mfma_f32_16x16x32_bf16 v[212:215], a[52:55], a[120:123], v[212:215]
    ds_read_b128 a[104:107], v10 offset:32768
    v_rcp_f32 v64, v64
    v_mfma_f32_16x16x32_bf16 v[216:219], a[56:59], a[120:123], v[216:219]
    v_rcp_f32 v65, v65
    v_mfma_f32_16x16x32_bf16 v[220:223], a[60:63], a[120:123], v[220:223]
    v_rcp_f32 v66, v66
    v_mfma_f32_16x16x32_bf16 v[252:255], a[60:63], a[124:127], v[252:255]
    buffer_load_dwordx4 a[24:27], v12, s[8:11], s31 offen offset:2048
    v_rcp_f32 v67, v67
    v_mfma_f32_16x16x32_bf16 v[248:251], a[56:59], a[124:127], v[248:251]
    v_rcp_f32 v68, v68
    v_mfma_f32_16x16x32_bf16 v[244:247], a[52:55], a[124:127], v[244:247]
    v_rcp_f32 v69, v69
    v_mfma_f32_16x16x32_bf16 v[240:243], a[48:51], a[124:127], v[240:243]
    v_rcp_f32 v70, v70
    v_mfma_f32_16x16x32_bf16 v[236:239], a[44:47], a[124:127], v[236:239]
    buffer_load_dwordx4 a[28:31], v12, s[8:11], s31 offen offset:3072
    v_rcp_f32 v71, v71
    v_mfma_f32_16x16x32_bf16 v[232:235], a[40:43], a[124:127], v[232:235]
    ds_read_b128 a[108:111], v10 offset:49152
    v_fma_f32 v64, v64, -2.0, 1.0
    v_fma_f32 v65, v65, -2.0, 1.0
    v_mfma_f32_16x16x32_bf16 v[228:231], a[36:39], a[124:127], v[228:231]
    v_fma_f32 v66, v66, -2.0, 1.0
    v_fma_f32 v67, v67, -2.0, 1.0
    v_mfma_f32_16x16x32_bf16 v[224:227], a[32:35], a[124:127], v[224:227]
    v_fma_f32 v68, v68, -2.0, 1.0
    v_fma_f32 v69, v69, -2.0, 1.0
    s_waitcnt vmcnt(8) lgkmcnt(0)
    v_mfma_f32_16x16x32_bf16 v[128:131], a[64:67], a[96:99], v[128:131]
    s_add_u32 s25, s24, 131072
    s_add_u32 s31, s24, 135168
    v_fma_f32 v70, v70, -2.0, 1.0
    v_mfma_f32_16x16x32_bf16 v[132:135], a[68:71], a[96:99], v[132:135]
    buffer_load_dwordx4 a[32:35], v12, s[8:11], s25 offen offset:0
    v_fma_f32 v71, v71, -2.0, 1.0
    v_cvt_pk_bf16_f32 v80, v64, v65
    v_mfma_f32_16x16x32_bf16 v[136:139], a[72:75], a[96:99], v[136:139]
    v_cvt_pk_bf16_f32 v81, v66, v67
    v_cvt_pk_bf16_f32 v82, v68, v69
    v_mfma_f32_16x16x32_bf16 v[140:143], a[76:79], a[96:99], v[140:143]
    v_cvt_pk_bf16_f32 v83, v70, v71
    ds_write_b128 v15, v[80:83] offset:16640
    v_mfma_f32_16x16x32_bf16 v[144:147], a[80:83], a[96:99], v[144:147]
    buffer_load_dwordx4 a[36:39], v12, s[8:11], s25 offen offset:1024
    v_fma_f32 v72, v24, v56, 1.0
    v_fma_f32 v73, v25, v57, 1.0
    v_mfma_f32_16x16x32_bf16 v[148:151], a[84:87], a[96:99], v[148:151]
    ds_read_b128 a[112:115], v11 offset:0
    v_fma_f32 v74, v26, v58, 1.0
    v_fma_f32 v75, v27, v59, 1.0
    v_mfma_f32_16x16x32_bf16 v[152:155], a[88:91], a[96:99], v[152:155]
    v_fma_f32 v76, v28, v60, 1.0
    v_fma_f32 v77, v29, v61, 1.0
    v_mfma_f32_16x16x32_bf16 v[156:159], a[92:95], a[96:99], v[156:159]
    v_fma_f32 v78, v30, v62, 1.0
    v_fma_f32 v79, v31, v63, 1.0
    v_mfma_f32_16x16x32_bf16 v[188:191], a[92:95], a[100:103], v[188:191]
    buffer_load_dwordx4 a[40:43], v12, s[8:11], s25 offen offset:2048
    v_rcp_f32 v72, v72
    v_mfma_f32_16x16x32_bf16 v[184:187], a[88:91], a[100:103], v[184:187]
    v_rcp_f32 v73, v73
    v_mfma_f32_16x16x32_bf16 v[180:183], a[84:87], a[100:103], v[180:183]
    v_rcp_f32 v74, v74
    v_mfma_f32_16x16x32_bf16 v[176:179], a[80:83], a[100:103], v[176:179]
    v_rcp_f32 v75, v75
    v_mfma_f32_16x16x32_bf16 v[172:175], a[76:79], a[100:103], v[172:175]
    buffer_load_dwordx4 a[44:47], v12, s[8:11], s25 offen offset:3072
    v_rcp_f32 v76, v76
    v_mfma_f32_16x16x32_bf16 v[168:171], a[72:75], a[100:103], v[168:171]
    ds_read_b128 a[116:119], v11 offset:16384
    v_rcp_f32 v77, v77
    v_mfma_f32_16x16x32_bf16 v[164:167], a[68:71], a[100:103], v[164:167]
    v_rcp_f32 v78, v78
    v_mfma_f32_16x16x32_bf16 v[160:163], a[64:67], a[100:103], v[160:163]
    v_rcp_f32 v79, v79
    v_mfma_f32_16x16x32_bf16 v[192:195], a[64:67], a[104:107], v[192:195]
    buffer_load_dwordx4 a[48:51], v12, s[8:11], s31 offen offset:0
    v_fma_f32 v72, v72, -2.0, 1.0
    v_fma_f32 v73, v73, -2.0, 1.0
    v_mfma_f32_16x16x32_bf16 v[196:199], a[68:71], a[104:107], v[196:199]
    v_fma_f32 v74, v74, -2.0, 1.0
    v_fma_f32 v75, v75, -2.0, 1.0
    v_mfma_f32_16x16x32_bf16 v[200:203], a[72:75], a[104:107], v[200:203]
    v_fma_f32 v76, v76, -2.0, 1.0
    v_fma_f32 v77, v77, -2.0, 1.0
    v_mfma_f32_16x16x32_bf16 v[204:207], a[76:79], a[104:107], v[204:207]
    v_fma_f32 v78, v78, -2.0, 1.0
    v_fma_f32 v79, v79, -2.0, 1.0
    v_mfma_f32_16x16x32_bf16 v[208:211], a[80:83], a[104:107], v[208:211]
    buffer_load_dwordx4 a[52:55], v12, s[8:11], s31 offen offset:1024
    v_cvt_pk_bf16_f32 v84, v72, v73
    v_cvt_pk_bf16_f32 v85, v74, v75
    v_mfma_f32_16x16x32_bf16 v[212:215], a[84:87], a[104:107], v[212:215]
    ds_read_b128 a[120:123], v11 offset:32768
    v_cvt_pk_bf16_f32 v86, v76, v77
    v_cvt_pk_bf16_f32 v87, v78, v79
    v_mfma_f32_16x16x32_bf16 v[216:219], a[88:91], a[104:107], v[216:219]
    ds_write_b128 v15, v[84:87] offset:24832
    v_mfma_f32_16x16x32_bf16 v[220:223], a[92:95], a[104:107], v[220:223]
    v_mfma_f32_16x16x32_bf16 v[252:255], a[92:95], a[108:111], v[252:255]
    buffer_load_dwordx4 a[56:59], v12, s[8:11], s31 offen offset:2048
    v_mfma_f32_16x16x32_bf16 v[248:251], a[88:91], a[108:111], v[248:251]
    v_mfma_f32_16x16x32_bf16 v[244:247], a[84:87], a[108:111], v[244:247]
    v_mfma_f32_16x16x32_bf16 v[240:243], a[80:83], a[108:111], v[240:243]
    v_mfma_f32_16x16x32_bf16 v[236:239], a[76:79], a[108:111], v[236:239]
    buffer_load_dwordx4 a[60:63], v12, s[8:11], s31 offen offset:3072
    v_mfma_f32_16x16x32_bf16 v[232:235], a[72:75], a[108:111], v[232:235]
    ds_read_b128 a[124:127], v11 offset:49152
    v_mfma_f32_16x16x32_bf16 v[228:231], a[68:71], a[108:111], v[228:231]
    v_mfma_f32_16x16x32_bf16 v[224:227], a[64:67], a[108:111], v[224:227]
    s_waitcnt vmcnt(8) lgkmcnt(0)
    v_mfma_f32_16x16x32_bf16 v[128:131], a[0:3], a[112:115], v[128:131]
    s_add_u32 s25, s24, 163840
    s_add_u32 s31, s24, 167936
    v_mfma_f32_16x16x32_bf16 v[132:135], a[4:7], a[112:115], v[132:135]
    buffer_load_dwordx4 a[64:67], v12, s[8:11], s25 offen offset:0
    v_mfma_f32_16x16x32_bf16 v[136:139], a[8:11], a[112:115], v[136:139]
    v_mfma_f32_16x16x32_bf16 v[140:143], a[12:15], a[112:115], v[140:143]
    v_mfma_f32_16x16x32_bf16 v[144:147], a[16:19], a[112:115], v[144:147]
    buffer_load_dwordx4 a[68:71], v12, s[8:11], s25 offen offset:1024
    v_mfma_f32_16x16x32_bf16 v[148:151], a[20:23], a[112:115], v[148:151]
    v_mfma_f32_16x16x32_bf16 v[152:155], a[24:27], a[112:115], v[152:155]
    v_mfma_f32_16x16x32_bf16 v[156:159], a[28:31], a[112:115], v[156:159]
    v_mfma_f32_16x16x32_bf16 v[188:191], a[28:31], a[116:119], v[188:191]
    buffer_load_dwordx4 a[72:75], v12, s[8:11], s25 offen offset:2048
    v_mfma_f32_16x16x32_bf16 v[184:187], a[24:27], a[116:119], v[184:187]
    v_mfma_f32_16x16x32_bf16 v[180:183], a[20:23], a[116:119], v[180:183]
    v_mfma_f32_16x16x32_bf16 v[176:179], a[16:19], a[116:119], v[176:179]
    v_mfma_f32_16x16x32_bf16 v[172:175], a[12:15], a[116:119], v[172:175]
    buffer_load_dwordx4 a[76:79], v12, s[8:11], s25 offen offset:3072
    v_mfma_f32_16x16x32_bf16 v[168:171], a[8:11], a[116:119], v[168:171]
    v_mfma_f32_16x16x32_bf16 v[164:167], a[4:7], a[116:119], v[164:167]
    v_mfma_f32_16x16x32_bf16 v[160:163], a[0:3], a[116:119], v[160:163]
    v_mfma_f32_16x16x32_bf16 v[192:195], a[0:3], a[120:123], v[192:195]
    buffer_load_dwordx4 a[80:83], v12, s[8:11], s31 offen offset:0
    v_mfma_f32_16x16x32_bf16 v[196:199], a[4:7], a[120:123], v[196:199]
    v_mfma_f32_16x16x32_bf16 v[200:203], a[8:11], a[120:123], v[200:203]
    v_mfma_f32_16x16x32_bf16 v[204:207], a[12:15], a[120:123], v[204:207]
    v_mfma_f32_16x16x32_bf16 v[208:211], a[16:19], a[120:123], v[208:211]
    buffer_load_dwordx4 a[84:87], v12, s[8:11], s31 offen offset:1024
    v_mfma_f32_16x16x32_bf16 v[212:215], a[20:23], a[120:123], v[212:215]
    v_mfma_f32_16x16x32_bf16 v[216:219], a[24:27], a[120:123], v[216:219]
    s_barrier
    v_mfma_f32_16x16x32_bf16 v[220:223], a[28:31], a[120:123], v[220:223]
    ds_read_b128 a[96:99], v8 offset:256
    v_mfma_f32_16x16x32_bf16 v[252:255], a[28:31], a[124:127], v[252:255]
    buffer_load_dwordx4 a[88:91], v12, s[8:11], s31 offen offset:2048
    v_mfma_f32_16x16x32_bf16 v[248:251], a[24:27], a[124:127], v[248:251]
    ds_read_b128 a[100:103], v8 offset:16640
    v_mfma_f32_16x16x32_bf16 v[244:247], a[20:23], a[124:127], v[244:247]
    v_mfma_f32_16x16x32_bf16 v[240:243], a[16:19], a[124:127], v[240:243]
    ds_read_b128 a[104:107], v8 offset:33024
    v_mfma_f32_16x16x32_bf16 v[236:239], a[12:15], a[124:127], v[236:239]
    buffer_load_dwordx4 a[92:95], v12, s[8:11], s31 offen offset:3072
    v_mfma_f32_16x16x32_bf16 v[232:235], a[8:11], a[124:127], v[232:235]
    ds_read_b128 a[108:111], v8 offset:49408
    v_mfma_f32_16x16x32_bf16 v[228:231], a[4:7], a[124:127], v[228:231]
    v_mfma_f32_16x16x32_bf16 v[224:227], a[0:3], a[124:127], v[224:227]
    s_waitcnt vmcnt(8) lgkmcnt(0)
    v_mfma_f32_16x16x32_bf16 v[128:131], a[32:35], a[96:99], v[128:131]
    s_add_u32 s25, s24, 196608
    s_add_u32 s31, s24, 200704
    ds_read_b128 v[48:51], v14 offset:1024
    v_mfma_f32_16x16x32_bf16 v[132:135], a[36:39], a[96:99], v[132:135]
    buffer_load_dwordx4 a[0:3], v12, s[8:11], s25 offen offset:0
    ds_read_b128 v[52:55], v14 offset:1040
    v_mfma_f32_16x16x32_bf16 v[136:139], a[40:43], a[96:99], v[136:139]
    v_exp_f32 v32, v32
    v_mfma_f32_16x16x32_bf16 v[140:143], a[44:47], a[96:99], v[140:143]
    v_exp_f32 v33, v33
    v_mfma_f32_16x16x32_bf16 v[144:147], a[48:51], a[96:99], v[144:147]
    buffer_load_dwordx4 a[4:7], v12, s[8:11], s25 offen offset:1024
    v_exp_f32 v34, v34
    v_mfma_f32_16x16x32_bf16 v[148:151], a[52:55], a[96:99], v[148:151]
    ds_read_b128 a[112:115], v9 offset:256
    v_exp_f32 v35, v35
    v_mfma_f32_16x16x32_bf16 v[152:155], a[56:59], a[96:99], v[152:155]
    v_exp_f32 v36, v36
    v_mfma_f32_16x16x32_bf16 v[156:159], a[60:63], a[96:99], v[156:159]
    v_exp_f32 v37, v37
    v_mfma_f32_16x16x32_bf16 v[188:191], a[60:63], a[100:103], v[188:191]
    buffer_load_dwordx4 a[8:11], v12, s[8:11], s25 offen offset:2048
    v_exp_f32 v38, v38
    v_mfma_f32_16x16x32_bf16 v[184:187], a[56:59], a[100:103], v[184:187]
    v_exp_f32 v39, v39
    ds_read_b128 v[56:59], v14 offset:3072
    ds_read_b128 v[60:63], v14 offset:3088
    v_mfma_f32_16x16x32_bf16 v[180:183], a[52:55], a[100:103], v[180:183]
    s_waitcnt lgkmcnt(3)
    v_fma_f32 v64, v32, v48, 1.0
    v_fma_f32 v65, v33, v49, 1.0
    v_mfma_f32_16x16x32_bf16 v[176:179], a[48:51], a[100:103], v[176:179]
    v_fma_f32 v66, v34, v50, 1.0
    v_fma_f32 v67, v35, v51, 1.0
    v_mfma_f32_16x16x32_bf16 v[172:175], a[44:47], a[100:103], v[172:175]
    buffer_load_dwordx4 a[12:15], v12, s[8:11], s25 offen offset:3072
    v_fma_f32 v68, v36, v52, 1.0
    v_fma_f32 v69, v37, v53, 1.0
    v_mfma_f32_16x16x32_bf16 v[168:171], a[40:43], a[100:103], v[168:171]
    ds_read_b128 a[116:119], v9 offset:16640
    v_fma_f32 v70, v38, v54, 1.0
    v_fma_f32 v71, v39, v55, 1.0
    v_mfma_f32_16x16x32_bf16 v[164:167], a[36:39], a[100:103], v[164:167]
    v_rcp_f32 v64, v64
    v_mfma_f32_16x16x32_bf16 v[160:163], a[32:35], a[100:103], v[160:163]
    v_rcp_f32 v65, v65
    v_mfma_f32_16x16x32_bf16 v[192:195], a[32:35], a[104:107], v[192:195]
    buffer_load_dwordx4 a[16:19], v12, s[8:11], s31 offen offset:0
    v_rcp_f32 v66, v66
    v_mfma_f32_16x16x32_bf16 v[196:199], a[36:39], a[104:107], v[196:199]
    v_rcp_f32 v67, v67
    v_mfma_f32_16x16x32_bf16 v[200:203], a[40:43], a[104:107], v[200:203]
    v_rcp_f32 v68, v68
    v_mfma_f32_16x16x32_bf16 v[204:207], a[44:47], a[104:107], v[204:207]
    v_rcp_f32 v69, v69
    v_mfma_f32_16x16x32_bf16 v[208:211], a[48:51], a[104:107], v[208:211]
    buffer_load_dwordx4 a[20:23], v12, s[8:11], s31 offen offset:1024
    v_rcp_f32 v70, v70
    v_mfma_f32_16x16x32_bf16 v[212:215], a[52:55], a[104:107], v[212:215]
    ds_read_b128 a[120:123], v9 offset:33024
    v_rcp_f32 v71, v71
    v_mfma_f32_16x16x32_bf16 v[216:219], a[56:59], a[104:107], v[216:219]
    v_fma_f32 v64, v64, -2.0, 1.0
    v_fma_f32 v65, v65, -2.0, 1.0
    v_mfma_f32_16x16x32_bf16 v[220:223], a[60:63], a[104:107], v[220:223]
    v_fma_f32 v66, v66, -2.0, 1.0
    v_fma_f32 v67, v67, -2.0, 1.0
    v_mfma_f32_16x16x32_bf16 v[252:255], a[60:63], a[108:111], v[252:255]
    buffer_load_dwordx4 a[24:27], v12, s[8:11], s31 offen offset:2048
    v_fma_f32 v68, v68, -2.0, 1.0
    v_fma_f32 v69, v69, -2.0, 1.0
    v_mfma_f32_16x16x32_bf16 v[248:251], a[56:59], a[108:111], v[248:251]
    v_fma_f32 v70, v70, -2.0, 1.0
    v_fma_f32 v71, v71, -2.0, 1.0
    v_mfma_f32_16x16x32_bf16 v[244:247], a[52:55], a[108:111], v[244:247]
    v_cvt_pk_bf16_f32 v80, v64, v65
    v_cvt_pk_bf16_f32 v81, v66, v67
    v_mfma_f32_16x16x32_bf16 v[240:243], a[48:51], a[108:111], v[240:243]
    v_cvt_pk_bf16_f32 v82, v68, v69
    v_cvt_pk_bf16_f32 v83, v70, v71
    ds_write_b128 v15, v[80:83] offset:512
    v_mfma_f32_16x16x32_bf16 v[236:239], a[44:47], a[108:111], v[236:239]
    buffer_load_dwordx4 a[28:31], v12, s[8:11], s31 offen offset:3072
    ds_read_b128 v[48:51], v14 offset:5120
    ds_read_b128 v[52:55], v14 offset:5136
    v_mfma_f32_16x16x32_bf16 v[232:235], a[40:43], a[108:111], v[232:235]
    ds_read_b128 a[124:127], v9 offset:49408
    s_waitcnt lgkmcnt(6)
    v_fma_f32 v72, v32, v56, 1.0
    v_mfma_f32_16x16x32_bf16 v[228:231], a[36:39], a[108:111], v[228:231]
    v_fma_f32 v73, v33, v57, 1.0
    v_fma_f32 v74, v34, v58, 1.0
    v_mfma_f32_16x16x32_bf16 v[224:227], a[32:35], a[108:111], v[224:227]
    v_fma_f32 v75, v35, v59, 1.0
    v_fma_f32 v76, v36, v60, 1.0
    s_waitcnt vmcnt(8) lgkmcnt(0)
    v_mfma_f32_16x16x32_bf16 v[128:131], a[64:67], a[112:115], v[128:131]
    s_add_u32 s25, s24, 229376
    s_add_u32 s31, s24, 233472
    v_fma_f32 v77, v37, v61, 1.0
    v_mfma_f32_16x16x32_bf16 v[132:135], a[68:71], a[112:115], v[132:135]
    buffer_load_dwordx4 a[32:35], v12, s[8:11], s25 offen offset:0
    v_fma_f32 v78, v38, v62, 1.0
    v_fma_f32 v79, v39, v63, 1.0
    v_mfma_f32_16x16x32_bf16 v[136:139], a[72:75], a[112:115], v[136:139]
    v_rcp_f32 v72, v72
    v_mfma_f32_16x16x32_bf16 v[140:143], a[76:79], a[112:115], v[140:143]
    v_rcp_f32 v73, v73
    v_mfma_f32_16x16x32_bf16 v[144:147], a[80:83], a[112:115], v[144:147]
    buffer_load_dwordx4 a[36:39], v12, s[8:11], s25 offen offset:1024
    v_rcp_f32 v74, v74
    v_mfma_f32_16x16x32_bf16 v[148:151], a[84:87], a[112:115], v[148:151]
    ds_read_b128 a[96:99], v10 offset:256
    v_rcp_f32 v75, v75
    v_mfma_f32_16x16x32_bf16 v[152:155], a[88:91], a[112:115], v[152:155]
    v_rcp_f32 v76, v76
    v_mfma_f32_16x16x32_bf16 v[156:159], a[92:95], a[112:115], v[156:159]
    v_rcp_f32 v77, v77
    v_mfma_f32_16x16x32_bf16 v[188:191], a[92:95], a[116:119], v[188:191]
    buffer_load_dwordx4 a[40:43], v12, s[8:11], s25 offen offset:2048
    v_rcp_f32 v78, v78
    v_mfma_f32_16x16x32_bf16 v[184:187], a[88:91], a[116:119], v[184:187]
    v_rcp_f32 v79, v79
    v_mfma_f32_16x16x32_bf16 v[180:183], a[84:87], a[116:119], v[180:183]
    v_fma_f32 v72, v72, -2.0, 1.0
    v_fma_f32 v73, v73, -2.0, 1.0
    v_mfma_f32_16x16x32_bf16 v[176:179], a[80:83], a[116:119], v[176:179]
    v_fma_f32 v74, v74, -2.0, 1.0
    v_fma_f32 v75, v75, -2.0, 1.0
    v_mfma_f32_16x16x32_bf16 v[172:175], a[76:79], a[116:119], v[172:175]
    buffer_load_dwordx4 a[44:47], v12, s[8:11], s25 offen offset:3072
    v_fma_f32 v76, v76, -2.0, 1.0
    v_fma_f32 v77, v77, -2.0, 1.0
    v_mfma_f32_16x16x32_bf16 v[168:171], a[72:75], a[116:119], v[168:171]
    ds_read_b128 a[100:103], v10 offset:16640
    v_fma_f32 v78, v78, -2.0, 1.0
    v_fma_f32 v79, v79, -2.0, 1.0
    v_mfma_f32_16x16x32_bf16 v[164:167], a[68:71], a[116:119], v[164:167]
    v_cvt_pk_bf16_f32 v84, v72, v73
    v_cvt_pk_bf16_f32 v85, v74, v75
    v_mfma_f32_16x16x32_bf16 v[160:163], a[64:67], a[116:119], v[160:163]
    v_cvt_pk_bf16_f32 v86, v76, v77
    v_cvt_pk_bf16_f32 v87, v78, v79
    ds_write_b128 v15, v[84:87] offset:8704
    v_mfma_f32_16x16x32_bf16 v[192:195], a[64:67], a[120:123], v[192:195]
    buffer_load_dwordx4 a[48:51], v12, s[8:11], s31 offen offset:0
    ds_read_b128 v[56:59], v14 offset:7168
    ds_read_b128 v[60:63], v14 offset:7184
    v_mfma_f32_16x16x32_bf16 v[196:199], a[68:71], a[120:123], v[196:199]
    v_fma_f32 v64, v32, v48, 1.0
    v_fma_f32 v65, v33, v49, 1.0
    v_mfma_f32_16x16x32_bf16 v[200:203], a[72:75], a[120:123], v[200:203]
    v_fma_f32 v66, v34, v50, 1.0
    v_fma_f32 v67, v35, v51, 1.0
    v_mfma_f32_16x16x32_bf16 v[204:207], a[76:79], a[120:123], v[204:207]
    v_fma_f32 v68, v36, v52, 1.0
    v_fma_f32 v69, v37, v53, 1.0
    v_mfma_f32_16x16x32_bf16 v[208:211], a[80:83], a[120:123], v[208:211]
    buffer_load_dwordx4 a[52:55], v12, s[8:11], s31 offen offset:1024
    v_fma_f32 v70, v38, v54, 1.0
    v_fma_f32 v71, v39, v55, 1.0
    v_mfma_f32_16x16x32_bf16 v[212:215], a[84:87], a[120:123], v[212:215]
    ds_read_b128 a[104:107], v10 offset:33024
    v_rcp_f32 v64, v64
    v_mfma_f32_16x16x32_bf16 v[216:219], a[88:91], a[120:123], v[216:219]
    v_rcp_f32 v65, v65
    v_mfma_f32_16x16x32_bf16 v[220:223], a[92:95], a[120:123], v[220:223]
    v_rcp_f32 v66, v66
    v_mfma_f32_16x16x32_bf16 v[252:255], a[92:95], a[124:127], v[252:255]
    buffer_load_dwordx4 a[56:59], v12, s[8:11], s31 offen offset:2048
    v_rcp_f32 v67, v67
    v_mfma_f32_16x16x32_bf16 v[248:251], a[88:91], a[124:127], v[248:251]
    v_rcp_f32 v68, v68
    v_mfma_f32_16x16x32_bf16 v[244:247], a[84:87], a[124:127], v[244:247]
    v_rcp_f32 v69, v69
    v_mfma_f32_16x16x32_bf16 v[240:243], a[80:83], a[124:127], v[240:243]
    v_rcp_f32 v70, v70
    v_mfma_f32_16x16x32_bf16 v[236:239], a[76:79], a[124:127], v[236:239]
    buffer_load_dwordx4 a[60:63], v12, s[8:11], s31 offen offset:3072
    v_rcp_f32 v71, v71
    v_mfma_f32_16x16x32_bf16 v[232:235], a[72:75], a[124:127], v[232:235]
    ds_read_b128 a[108:111], v10 offset:49408
    v_fma_f32 v64, v64, -2.0, 1.0
    v_fma_f32 v65, v65, -2.0, 1.0
    v_mfma_f32_16x16x32_bf16 v[228:231], a[68:71], a[124:127], v[228:231]
    v_fma_f32 v66, v66, -2.0, 1.0
    v_fma_f32 v67, v67, -2.0, 1.0
    v_mfma_f32_16x16x32_bf16 v[224:227], a[64:67], a[124:127], v[224:227]
    v_fma_f32 v68, v68, -2.0, 1.0
    v_fma_f32 v69, v69, -2.0, 1.0
    s_waitcnt vmcnt(8) lgkmcnt(0)
    v_mfma_f32_16x16x32_bf16 v[128:131], a[0:3], a[96:99], v[128:131]
    s_add_u32 s25, s24, 262144
    s_add_u32 s31, s24, 266240
    v_fma_f32 v70, v70, -2.0, 1.0
    v_mfma_f32_16x16x32_bf16 v[132:135], a[4:7], a[96:99], v[132:135]
    buffer_load_dwordx4 a[64:67], v12, s[8:11], s25 offen offset:0
    v_fma_f32 v71, v71, -2.0, 1.0
    v_cvt_pk_bf16_f32 v80, v64, v65
    v_mfma_f32_16x16x32_bf16 v[136:139], a[8:11], a[96:99], v[136:139]
    v_cvt_pk_bf16_f32 v81, v66, v67
    v_cvt_pk_bf16_f32 v82, v68, v69
    v_mfma_f32_16x16x32_bf16 v[140:143], a[12:15], a[96:99], v[140:143]
    v_cvt_pk_bf16_f32 v83, v70, v71
    ds_write_b128 v15, v[80:83] offset:16896
    v_mfma_f32_16x16x32_bf16 v[144:147], a[16:19], a[96:99], v[144:147]
    buffer_load_dwordx4 a[68:71], v12, s[8:11], s25 offen offset:1024
    v_fma_f32 v72, v32, v56, 1.0
    v_fma_f32 v73, v33, v57, 1.0
    v_mfma_f32_16x16x32_bf16 v[148:151], a[20:23], a[96:99], v[148:151]
    ds_read_b128 a[112:115], v11 offset:256
    v_fma_f32 v74, v34, v58, 1.0
    v_fma_f32 v75, v35, v59, 1.0
    v_mfma_f32_16x16x32_bf16 v[152:155], a[24:27], a[96:99], v[152:155]
    v_fma_f32 v76, v36, v60, 1.0
    v_fma_f32 v77, v37, v61, 1.0
    v_mfma_f32_16x16x32_bf16 v[156:159], a[28:31], a[96:99], v[156:159]
    v_fma_f32 v78, v38, v62, 1.0
    v_fma_f32 v79, v39, v63, 1.0
    v_mfma_f32_16x16x32_bf16 v[188:191], a[28:31], a[100:103], v[188:191]
    buffer_load_dwordx4 a[72:75], v12, s[8:11], s25 offen offset:2048
    v_rcp_f32 v72, v72
    v_mfma_f32_16x16x32_bf16 v[184:187], a[24:27], a[100:103], v[184:187]
    v_rcp_f32 v73, v73
    v_mfma_f32_16x16x32_bf16 v[180:183], a[20:23], a[100:103], v[180:183]
    v_rcp_f32 v74, v74
    v_mfma_f32_16x16x32_bf16 v[176:179], a[16:19], a[100:103], v[176:179]
    v_rcp_f32 v75, v75
    v_mfma_f32_16x16x32_bf16 v[172:175], a[12:15], a[100:103], v[172:175]
    buffer_load_dwordx4 a[76:79], v12, s[8:11], s25 offen offset:3072
    v_rcp_f32 v76, v76
    v_mfma_f32_16x16x32_bf16 v[168:171], a[8:11], a[100:103], v[168:171]
    ds_read_b128 a[116:119], v11 offset:16640
    v_rcp_f32 v77, v77
    v_mfma_f32_16x16x32_bf16 v[164:167], a[4:7], a[100:103], v[164:167]
    v_rcp_f32 v78, v78
    v_mfma_f32_16x16x32_bf16 v[160:163], a[0:3], a[100:103], v[160:163]
    v_rcp_f32 v79, v79
    v_mfma_f32_16x16x32_bf16 v[192:195], a[0:3], a[104:107], v[192:195]
    buffer_load_dwordx4 a[80:83], v12, s[8:11], s31 offen offset:0
    v_fma_f32 v72, v72, -2.0, 1.0
    v_fma_f32 v73, v73, -2.0, 1.0
    v_mfma_f32_16x16x32_bf16 v[196:199], a[4:7], a[104:107], v[196:199]
    v_fma_f32 v74, v74, -2.0, 1.0
    v_fma_f32 v75, v75, -2.0, 1.0
    v_mfma_f32_16x16x32_bf16 v[200:203], a[8:11], a[104:107], v[200:203]
    v_fma_f32 v76, v76, -2.0, 1.0
    v_fma_f32 v77, v77, -2.0, 1.0
    v_mfma_f32_16x16x32_bf16 v[204:207], a[12:15], a[104:107], v[204:207]
    v_fma_f32 v78, v78, -2.0, 1.0
    v_fma_f32 v79, v79, -2.0, 1.0
    v_mfma_f32_16x16x32_bf16 v[208:211], a[16:19], a[104:107], v[208:211]
    buffer_load_dwordx4 a[84:87], v12, s[8:11], s31 offen offset:1024
    v_cvt_pk_bf16_f32 v84, v72, v73
    v_cvt_pk_bf16_f32 v85, v74, v75
    v_mfma_f32_16x16x32_bf16 v[212:215], a[20:23], a[104:107], v[212:215]
    ds_read_b128 a[120:123], v11 offset:33024
    v_cvt_pk_bf16_f32 v86, v76, v77
    v_cvt_pk_bf16_f32 v87, v78, v79
    v_mfma_f32_16x16x32_bf16 v[216:219], a[24:27], a[104:107], v[216:219]
    ds_write_b128 v15, v[84:87] offset:25088
    v_mfma_f32_16x16x32_bf16 v[220:223], a[28:31], a[104:107], v[220:223]
    v_mfma_f32_16x16x32_bf16 v[252:255], a[28:31], a[108:111], v[252:255]
    buffer_load_dwordx4 a[88:91], v12, s[8:11], s31 offen offset:2048
    v_mfma_f32_16x16x32_bf16 v[248:251], a[24:27], a[108:111], v[248:251]
    v_mfma_f32_16x16x32_bf16 v[244:247], a[20:23], a[108:111], v[244:247]
    v_mfma_f32_16x16x32_bf16 v[240:243], a[16:19], a[108:111], v[240:243]
    v_mfma_f32_16x16x32_bf16 v[236:239], a[12:15], a[108:111], v[236:239]
    buffer_load_dwordx4 a[92:95], v12, s[8:11], s31 offen offset:3072
    v_mfma_f32_16x16x32_bf16 v[232:235], a[8:11], a[108:111], v[232:235]
    ds_read_b128 a[124:127], v11 offset:49408
    v_mfma_f32_16x16x32_bf16 v[228:231], a[4:7], a[108:111], v[228:231]
    v_mfma_f32_16x16x32_bf16 v[224:227], a[0:3], a[108:111], v[224:227]
    s_waitcnt vmcnt(8) lgkmcnt(0)
    v_mfma_f32_16x16x32_bf16 v[128:131], a[32:35], a[112:115], v[128:131]
    s_add_u32 s25, s24, 294912
    s_add_u32 s31, s24, 299008
    v_mfma_f32_16x16x32_bf16 v[132:135], a[36:39], a[112:115], v[132:135]
    buffer_load_dwordx4 a[0:3], v12, s[8:11], s25 offen offset:0
    v_mfma_f32_16x16x32_bf16 v[136:139], a[40:43], a[112:115], v[136:139]
    v_mfma_f32_16x16x32_bf16 v[140:143], a[44:47], a[112:115], v[140:143]
    v_mfma_f32_16x16x32_bf16 v[144:147], a[48:51], a[112:115], v[144:147]
    buffer_load_dwordx4 a[4:7], v12, s[8:11], s25 offen offset:1024
    v_mfma_f32_16x16x32_bf16 v[148:151], a[52:55], a[112:115], v[148:151]
    v_mfma_f32_16x16x32_bf16 v[152:155], a[56:59], a[112:115], v[152:155]
    v_mfma_f32_16x16x32_bf16 v[156:159], a[60:63], a[112:115], v[156:159]
    v_mfma_f32_16x16x32_bf16 v[188:191], a[60:63], a[116:119], v[188:191]
    buffer_load_dwordx4 a[8:11], v12, s[8:11], s25 offen offset:2048
    v_mfma_f32_16x16x32_bf16 v[184:187], a[56:59], a[116:119], v[184:187]
    v_mfma_f32_16x16x32_bf16 v[180:183], a[52:55], a[116:119], v[180:183]
    v_mfma_f32_16x16x32_bf16 v[176:179], a[48:51], a[116:119], v[176:179]
    v_mfma_f32_16x16x32_bf16 v[172:175], a[44:47], a[116:119], v[172:175]
    buffer_load_dwordx4 a[12:15], v12, s[8:11], s25 offen offset:3072
    v_mfma_f32_16x16x32_bf16 v[168:171], a[40:43], a[116:119], v[168:171]
    v_mfma_f32_16x16x32_bf16 v[164:167], a[36:39], a[116:119], v[164:167]
    v_mfma_f32_16x16x32_bf16 v[160:163], a[32:35], a[116:119], v[160:163]
    v_mfma_f32_16x16x32_bf16 v[192:195], a[32:35], a[120:123], v[192:195]
    buffer_load_dwordx4 a[16:19], v12, s[8:11], s31 offen offset:0
    v_mfma_f32_16x16x32_bf16 v[196:199], a[36:39], a[120:123], v[196:199]
    v_mfma_f32_16x16x32_bf16 v[200:203], a[40:43], a[120:123], v[200:203]
    v_mfma_f32_16x16x32_bf16 v[204:207], a[44:47], a[120:123], v[204:207]
    v_mfma_f32_16x16x32_bf16 v[208:211], a[48:51], a[120:123], v[208:211]
    buffer_load_dwordx4 a[20:23], v12, s[8:11], s31 offen offset:1024
    v_mfma_f32_16x16x32_bf16 v[212:215], a[52:55], a[120:123], v[212:215]
    v_mfma_f32_16x16x32_bf16 v[216:219], a[56:59], a[120:123], v[216:219]
    s_barrier
    v_mfma_f32_16x16x32_bf16 v[220:223], a[60:63], a[120:123], v[220:223]
    ds_read_b128 a[96:99], v8 offset:512
    v_mfma_f32_16x16x32_bf16 v[252:255], a[60:63], a[124:127], v[252:255]
    buffer_load_dwordx4 a[24:27], v12, s[8:11], s31 offen offset:2048
    v_mfma_f32_16x16x32_bf16 v[248:251], a[56:59], a[124:127], v[248:251]
    ds_read_b128 a[100:103], v8 offset:16896
    v_mfma_f32_16x16x32_bf16 v[244:247], a[52:55], a[124:127], v[244:247]
    v_mfma_f32_16x16x32_bf16 v[240:243], a[48:51], a[124:127], v[240:243]
    ds_read_b128 a[104:107], v8 offset:33280
    v_mfma_f32_16x16x32_bf16 v[236:239], a[44:47], a[124:127], v[236:239]
    buffer_load_dwordx4 a[28:31], v12, s[8:11], s31 offen offset:3072
    v_mfma_f32_16x16x32_bf16 v[232:235], a[40:43], a[124:127], v[232:235]
    ds_read_b128 a[108:111], v8 offset:49664
    v_mfma_f32_16x16x32_bf16 v[228:231], a[36:39], a[124:127], v[228:231]
    v_mfma_f32_16x16x32_bf16 v[224:227], a[32:35], a[124:127], v[224:227]
    s_waitcnt vmcnt(8) lgkmcnt(0)
    v_mfma_f32_16x16x32_bf16 v[128:131], a[64:67], a[96:99], v[128:131]
    s_add_u32 s25, s24, 327680
    s_add_u32 s31, s24, 331776
    ds_read_b128 v[48:51], v14 offset:1536
    v_mfma_f32_16x16x32_bf16 v[132:135], a[68:71], a[96:99], v[132:135]
    buffer_load_dwordx4 a[32:35], v12, s[8:11], s25 offen offset:0
    ds_read_b128 v[52:55], v14 offset:1552
    v_mfma_f32_16x16x32_bf16 v[136:139], a[72:75], a[96:99], v[136:139]
    v_exp_f32 v40, v40
    v_mfma_f32_16x16x32_bf16 v[140:143], a[76:79], a[96:99], v[140:143]
    v_exp_f32 v41, v41
    v_mfma_f32_16x16x32_bf16 v[144:147], a[80:83], a[96:99], v[144:147]
    buffer_load_dwordx4 a[36:39], v12, s[8:11], s25 offen offset:1024
    v_exp_f32 v42, v42
    v_mfma_f32_16x16x32_bf16 v[148:151], a[84:87], a[96:99], v[148:151]
    ds_read_b128 a[112:115], v9 offset:512
    v_exp_f32 v43, v43
    v_mfma_f32_16x16x32_bf16 v[152:155], a[88:91], a[96:99], v[152:155]
    v_exp_f32 v44, v44
    v_mfma_f32_16x16x32_bf16 v[156:159], a[92:95], a[96:99], v[156:159]
    v_exp_f32 v45, v45
    v_mfma_f32_16x16x32_bf16 v[188:191], a[92:95], a[100:103], v[188:191]
    buffer_load_dwordx4 a[40:43], v12, s[8:11], s25 offen offset:2048
    v_exp_f32 v46, v46
    v_mfma_f32_16x16x32_bf16 v[184:187], a[88:91], a[100:103], v[184:187]
    v_exp_f32 v47, v47
    ds_read_b128 v[56:59], v14 offset:3584
    ds_read_b128 v[60:63], v14 offset:3600
    v_mfma_f32_16x16x32_bf16 v[180:183], a[84:87], a[100:103], v[180:183]
    s_waitcnt lgkmcnt(3)
    v_fma_f32 v64, v40, v48, 1.0
    v_fma_f32 v65, v41, v49, 1.0
    v_mfma_f32_16x16x32_bf16 v[176:179], a[80:83], a[100:103], v[176:179]
    v_fma_f32 v66, v42, v50, 1.0
    v_fma_f32 v67, v43, v51, 1.0
    v_mfma_f32_16x16x32_bf16 v[172:175], a[76:79], a[100:103], v[172:175]
    buffer_load_dwordx4 a[44:47], v12, s[8:11], s25 offen offset:3072
    v_fma_f32 v68, v44, v52, 1.0
    v_fma_f32 v69, v45, v53, 1.0
    v_mfma_f32_16x16x32_bf16 v[168:171], a[72:75], a[100:103], v[168:171]
    ds_read_b128 a[116:119], v9 offset:16896
    v_fma_f32 v70, v46, v54, 1.0
    v_fma_f32 v71, v47, v55, 1.0
    v_mfma_f32_16x16x32_bf16 v[164:167], a[68:71], a[100:103], v[164:167]
    v_rcp_f32 v64, v64
    v_mfma_f32_16x16x32_bf16 v[160:163], a[64:67], a[100:103], v[160:163]
    v_rcp_f32 v65, v65
    v_mfma_f32_16x16x32_bf16 v[192:195], a[64:67], a[104:107], v[192:195]
    buffer_load_dwordx4 a[48:51], v12, s[8:11], s31 offen offset:0
    v_rcp_f32 v66, v66
    v_mfma_f32_16x16x32_bf16 v[196:199], a[68:71], a[104:107], v[196:199]
    v_rcp_f32 v67, v67
    v_mfma_f32_16x16x32_bf16 v[200:203], a[72:75], a[104:107], v[200:203]
    v_rcp_f32 v68, v68
    v_mfma_f32_16x16x32_bf16 v[204:207], a[76:79], a[104:107], v[204:207]
    v_rcp_f32 v69, v69
    v_mfma_f32_16x16x32_bf16 v[208:211], a[80:83], a[104:107], v[208:211]
    buffer_load_dwordx4 a[52:55], v12, s[8:11], s31 offen offset:1024
    v_rcp_f32 v70, v70
    v_mfma_f32_16x16x32_bf16 v[212:215], a[84:87], a[104:107], v[212:215]
    ds_read_b128 a[120:123], v9 offset:33280
    v_rcp_f32 v71, v71
    v_mfma_f32_16x16x32_bf16 v[216:219], a[88:91], a[104:107], v[216:219]
    v_fma_f32 v64, v64, -2.0, 1.0
    v_fma_f32 v65, v65, -2.0, 1.0
    v_mfma_f32_16x16x32_bf16 v[220:223], a[92:95], a[104:107], v[220:223]
    v_fma_f32 v66, v66, -2.0, 1.0
    v_fma_f32 v67, v67, -2.0, 1.0
    v_mfma_f32_16x16x32_bf16 v[252:255], a[92:95], a[108:111], v[252:255]
    buffer_load_dwordx4 a[56:59], v12, s[8:11], s31 offen offset:2048
    v_fma_f32 v68, v68, -2.0, 1.0
    v_fma_f32 v69, v69, -2.0, 1.0
    v_mfma_f32_16x16x32_bf16 v[248:251], a[88:91], a[108:111], v[248:251]
    v_fma_f32 v70, v70, -2.0, 1.0
    v_fma_f32 v71, v71, -2.0, 1.0
    v_mfma_f32_16x16x32_bf16 v[244:247], a[84:87], a[108:111], v[244:247]
    v_cvt_pk_bf16_f32 v80, v64, v65
    v_cvt_pk_bf16_f32 v81, v66, v67
    v_mfma_f32_16x16x32_bf16 v[240:243], a[80:83], a[108:111], v[240:243]
    v_cvt_pk_bf16_f32 v82, v68, v69
    v_cvt_pk_bf16_f32 v83, v70, v71
    ds_write_b128 v15, v[80:83] offset:768
    v_mfma_f32_16x16x32_bf16 v[236:239], a[76:79], a[108:111], v[236:239]
    buffer_load_dwordx4 a[60:63], v12, s[8:11], s31 offen offset:3072
    ds_read_b128 v[48:51], v14 offset:5632
    ds_read_b128 v[52:55], v14 offset:5648
    v_mfma_f32_16x16x32_bf16 v[232:235], a[72:75], a[108:111], v[232:235]
    ds_read_b128 a[124:127], v9 offset:49664
    s_waitcnt lgkmcnt(6)
    v_fma_f32 v72, v40, v56, 1.0
    v_mfma_f32_16x16x32_bf16 v[228:231], a[68:71], a[108:111], v[228:231]
    v_fma_f32 v73, v41, v57, 1.0
    v_fma_f32 v74, v42, v58, 1.0
    v_mfma_f32_16x16x32_bf16 v[224:227], a[64:67], a[108:111], v[224:227]
    v_fma_f32 v75, v43, v59, 1.0
    v_fma_f32 v76, v44, v60, 1.0
    s_waitcnt vmcnt(8) lgkmcnt(0)
    v_mfma_f32_16x16x32_bf16 v[128:131], a[0:3], a[112:115], v[128:131]
    s_add_u32 s25, s24, 360448
    s_add_u32 s31, s24, 364544
    v_fma_f32 v77, v45, v61, 1.0
    v_mfma_f32_16x16x32_bf16 v[132:135], a[4:7], a[112:115], v[132:135]
    buffer_load_dwordx4 a[64:67], v12, s[8:11], s25 offen offset:0
    v_fma_f32 v78, v46, v62, 1.0
    v_fma_f32 v79, v47, v63, 1.0
    v_mfma_f32_16x16x32_bf16 v[136:139], a[8:11], a[112:115], v[136:139]
    v_rcp_f32 v72, v72
    v_mfma_f32_16x16x32_bf16 v[140:143], a[12:15], a[112:115], v[140:143]
    v_rcp_f32 v73, v73
    v_mfma_f32_16x16x32_bf16 v[144:147], a[16:19], a[112:115], v[144:147]
    buffer_load_dwordx4 a[68:71], v12, s[8:11], s25 offen offset:1024
    v_rcp_f32 v74, v74
    v_mfma_f32_16x16x32_bf16 v[148:151], a[20:23], a[112:115], v[148:151]
    ds_read_b128 a[96:99], v10 offset:512
    v_rcp_f32 v75, v75
    v_mfma_f32_16x16x32_bf16 v[152:155], a[24:27], a[112:115], v[152:155]
    v_rcp_f32 v76, v76
    v_mfma_f32_16x16x32_bf16 v[156:159], a[28:31], a[112:115], v[156:159]
    v_rcp_f32 v77, v77
    v_mfma_f32_16x16x32_bf16 v[188:191], a[28:31], a[116:119], v[188:191]
    buffer_load_dwordx4 a[72:75], v12, s[8:11], s25 offen offset:2048
    v_rcp_f32 v78, v78
    v_mfma_f32_16x16x32_bf16 v[184:187], a[24:27], a[116:119], v[184:187]
    v_rcp_f32 v79, v79
    v_mfma_f32_16x16x32_bf16 v[180:183], a[20:23], a[116:119], v[180:183]
    v_fma_f32 v72, v72, -2.0, 1.0
    v_fma_f32 v73, v73, -2.0, 1.0
    v_mfma_f32_16x16x32_bf16 v[176:179], a[16:19], a[116:119], v[176:179]
    v_fma_f32 v74, v74, -2.0, 1.0
    v_fma_f32 v75, v75, -2.0, 1.0
    v_mfma_f32_16x16x32_bf16 v[172:175], a[12:15], a[116:119], v[172:175]
    buffer_load_dwordx4 a[76:79], v12, s[8:11], s25 offen offset:3072
    v_fma_f32 v76, v76, -2.0, 1.0
    v_fma_f32 v77, v77, -2.0, 1.0
    v_mfma_f32_16x16x32_bf16 v[168:171], a[8:11], a[116:119], v[168:171]
    ds_read_b128 a[100:103], v10 offset:16896
    v_fma_f32 v78, v78, -2.0, 1.0
    v_fma_f32 v79, v79, -2.0, 1.0
    v_mfma_f32_16x16x32_bf16 v[164:167], a[4:7], a[116:119], v[164:167]
    v_cvt_pk_bf16_f32 v84, v72, v73
    v_cvt_pk_bf16_f32 v85, v74, v75
    v_mfma_f32_16x16x32_bf16 v[160:163], a[0:3], a[116:119], v[160:163]
    v_cvt_pk_bf16_f32 v86, v76, v77
    v_cvt_pk_bf16_f32 v87, v78, v79
    ds_write_b128 v15, v[84:87] offset:8960
    v_mfma_f32_16x16x32_bf16 v[192:195], a[0:3], a[120:123], v[192:195]
    buffer_load_dwordx4 a[80:83], v12, s[8:11], s31 offen offset:0
    ds_read_b128 v[56:59], v14 offset:7680
    ds_read_b128 v[60:63], v14 offset:7696
    v_mfma_f32_16x16x32_bf16 v[196:199], a[4:7], a[120:123], v[196:199]
    v_fma_f32 v64, v40, v48, 1.0
    v_fma_f32 v65, v41, v49, 1.0
    v_mfma_f32_16x16x32_bf16 v[200:203], a[8:11], a[120:123], v[200:203]
    v_fma_f32 v66, v42, v50, 1.0
    v_fma_f32 v67, v43, v51, 1.0
    v_mfma_f32_16x16x32_bf16 v[204:207], a[12:15], a[120:123], v[204:207]
    v_fma_f32 v68, v44, v52, 1.0
    v_fma_f32 v69, v45, v53, 1.0
    v_mfma_f32_16x16x32_bf16 v[208:211], a[16:19], a[120:123], v[208:211]
    buffer_load_dwordx4 a[84:87], v12, s[8:11], s31 offen offset:1024
    v_fma_f32 v70, v46, v54, 1.0
    v_fma_f32 v71, v47, v55, 1.0
    v_mfma_f32_16x16x32_bf16 v[212:215], a[20:23], a[120:123], v[212:215]
    ds_read_b128 a[104:107], v10 offset:33280
    v_rcp_f32 v64, v64
    v_mfma_f32_16x16x32_bf16 v[216:219], a[24:27], a[120:123], v[216:219]
    v_rcp_f32 v65, v65
    v_mfma_f32_16x16x32_bf16 v[220:223], a[28:31], a[120:123], v[220:223]
    v_rcp_f32 v66, v66
    v_mfma_f32_16x16x32_bf16 v[252:255], a[28:31], a[124:127], v[252:255]
    buffer_load_dwordx4 a[88:91], v12, s[8:11], s31 offen offset:2048
    v_rcp_f32 v67, v67
    v_mfma_f32_16x16x32_bf16 v[248:251], a[24:27], a[124:127], v[248:251]
    v_rcp_f32 v68, v68
    v_mfma_f32_16x16x32_bf16 v[244:247], a[20:23], a[124:127], v[244:247]
    v_rcp_f32 v69, v69
    v_mfma_f32_16x16x32_bf16 v[240:243], a[16:19], a[124:127], v[240:243]
    v_rcp_f32 v70, v70
    v_mfma_f32_16x16x32_bf16 v[236:239], a[12:15], a[124:127], v[236:239]
    buffer_load_dwordx4 a[92:95], v12, s[8:11], s31 offen offset:3072
    v_rcp_f32 v71, v71
    v_mfma_f32_16x16x32_bf16 v[232:235], a[8:11], a[124:127], v[232:235]
    ds_read_b128 a[108:111], v10 offset:49664
    v_fma_f32 v64, v64, -2.0, 1.0
    v_fma_f32 v65, v65, -2.0, 1.0
    v_mfma_f32_16x16x32_bf16 v[228:231], a[4:7], a[124:127], v[228:231]
    v_fma_f32 v66, v66, -2.0, 1.0
    v_fma_f32 v67, v67, -2.0, 1.0
    v_mfma_f32_16x16x32_bf16 v[224:227], a[0:3], a[124:127], v[224:227]
    v_fma_f32 v68, v68, -2.0, 1.0
    v_fma_f32 v69, v69, -2.0, 1.0
    s_waitcnt vmcnt(8) lgkmcnt(0)
    v_mfma_f32_16x16x32_bf16 v[128:131], a[32:35], a[96:99], v[128:131]
    s_add_u32 s25, s24, 393216
    s_add_u32 s31, s24, 397312
    v_fma_f32 v70, v70, -2.0, 1.0
    v_mfma_f32_16x16x32_bf16 v[132:135], a[36:39], a[96:99], v[132:135]
    buffer_load_dwordx4 a[0:3], v12, s[8:11], s25 offen offset:0
    v_fma_f32 v71, v71, -2.0, 1.0
    v_cvt_pk_bf16_f32 v80, v64, v65
    v_mfma_f32_16x16x32_bf16 v[136:139], a[40:43], a[96:99], v[136:139]
    v_cvt_pk_bf16_f32 v81, v66, v67
    v_cvt_pk_bf16_f32 v82, v68, v69
    v_mfma_f32_16x16x32_bf16 v[140:143], a[44:47], a[96:99], v[140:143]
    v_cvt_pk_bf16_f32 v83, v70, v71
    ds_write_b128 v15, v[80:83] offset:17152
    v_mfma_f32_16x16x32_bf16 v[144:147], a[48:51], a[96:99], v[144:147]
    buffer_load_dwordx4 a[4:7], v12, s[8:11], s25 offen offset:1024
    v_fma_f32 v72, v40, v56, 1.0
    v_fma_f32 v73, v41, v57, 1.0
    v_mfma_f32_16x16x32_bf16 v[148:151], a[52:55], a[96:99], v[148:151]
    ds_read_b128 a[112:115], v11 offset:512
    v_fma_f32 v74, v42, v58, 1.0
    v_fma_f32 v75, v43, v59, 1.0
    v_mfma_f32_16x16x32_bf16 v[152:155], a[56:59], a[96:99], v[152:155]
    v_fma_f32 v76, v44, v60, 1.0
    v_fma_f32 v77, v45, v61, 1.0
    v_mfma_f32_16x16x32_bf16 v[156:159], a[60:63], a[96:99], v[156:159]
    v_fma_f32 v78, v46, v62, 1.0
    v_fma_f32 v79, v47, v63, 1.0
    v_mfma_f32_16x16x32_bf16 v[188:191], a[60:63], a[100:103], v[188:191]
    buffer_load_dwordx4 a[8:11], v12, s[8:11], s25 offen offset:2048
    v_rcp_f32 v72, v72
    v_mfma_f32_16x16x32_bf16 v[184:187], a[56:59], a[100:103], v[184:187]
    v_rcp_f32 v73, v73
    v_mfma_f32_16x16x32_bf16 v[180:183], a[52:55], a[100:103], v[180:183]
    v_rcp_f32 v74, v74
    v_mfma_f32_16x16x32_bf16 v[176:179], a[48:51], a[100:103], v[176:179]
    v_rcp_f32 v75, v75
    v_mfma_f32_16x16x32_bf16 v[172:175], a[44:47], a[100:103], v[172:175]
    buffer_load_dwordx4 a[12:15], v12, s[8:11], s25 offen offset:3072
    v_rcp_f32 v76, v76
    v_mfma_f32_16x16x32_bf16 v[168:171], a[40:43], a[100:103], v[168:171]
    ds_read_b128 a[116:119], v11 offset:16896
    v_rcp_f32 v77, v77
    v_mfma_f32_16x16x32_bf16 v[164:167], a[36:39], a[100:103], v[164:167]
    v_rcp_f32 v78, v78
    v_mfma_f32_16x16x32_bf16 v[160:163], a[32:35], a[100:103], v[160:163]
    v_rcp_f32 v79, v79
    v_mfma_f32_16x16x32_bf16 v[192:195], a[32:35], a[104:107], v[192:195]
    buffer_load_dwordx4 a[16:19], v12, s[8:11], s31 offen offset:0
    v_fma_f32 v72, v72, -2.0, 1.0
    v_fma_f32 v73, v73, -2.0, 1.0
    v_mfma_f32_16x16x32_bf16 v[196:199], a[36:39], a[104:107], v[196:199]
    v_fma_f32 v74, v74, -2.0, 1.0
    v_fma_f32 v75, v75, -2.0, 1.0
    v_mfma_f32_16x16x32_bf16 v[200:203], a[40:43], a[104:107], v[200:203]
    v_fma_f32 v76, v76, -2.0, 1.0
    v_fma_f32 v77, v77, -2.0, 1.0
    v_mfma_f32_16x16x32_bf16 v[204:207], a[44:47], a[104:107], v[204:207]
    v_fma_f32 v78, v78, -2.0, 1.0
    v_fma_f32 v79, v79, -2.0, 1.0
    v_mfma_f32_16x16x32_bf16 v[208:211], a[48:51], a[104:107], v[208:211]
    buffer_load_dwordx4 a[20:23], v12, s[8:11], s31 offen offset:1024
    v_cvt_pk_bf16_f32 v84, v72, v73
    v_cvt_pk_bf16_f32 v85, v74, v75
    v_mfma_f32_16x16x32_bf16 v[212:215], a[52:55], a[104:107], v[212:215]
    ds_read_b128 a[120:123], v11 offset:33280
    v_cvt_pk_bf16_f32 v86, v76, v77
    v_cvt_pk_bf16_f32 v87, v78, v79
    v_mfma_f32_16x16x32_bf16 v[216:219], a[56:59], a[104:107], v[216:219]
    ds_write_b128 v15, v[84:87] offset:25344
    v_mfma_f32_16x16x32_bf16 v[220:223], a[60:63], a[104:107], v[220:223]
    v_mfma_f32_16x16x32_bf16 v[252:255], a[60:63], a[108:111], v[252:255]
    buffer_load_dwordx4 a[24:27], v12, s[8:11], s31 offen offset:2048
    v_mfma_f32_16x16x32_bf16 v[248:251], a[56:59], a[108:111], v[248:251]
    v_mfma_f32_16x16x32_bf16 v[244:247], a[52:55], a[108:111], v[244:247]
    v_mfma_f32_16x16x32_bf16 v[240:243], a[48:51], a[108:111], v[240:243]
    v_mfma_f32_16x16x32_bf16 v[236:239], a[44:47], a[108:111], v[236:239]
    buffer_load_dwordx4 a[28:31], v12, s[8:11], s31 offen offset:3072
    v_mfma_f32_16x16x32_bf16 v[232:235], a[40:43], a[108:111], v[232:235]
    ds_read_b128 a[124:127], v11 offset:49664
    v_mfma_f32_16x16x32_bf16 v[228:231], a[36:39], a[108:111], v[228:231]
    v_mfma_f32_16x16x32_bf16 v[224:227], a[32:35], a[108:111], v[224:227]
    s_waitcnt vmcnt(8) lgkmcnt(0)
    v_mfma_f32_16x16x32_bf16 v[128:131], a[64:67], a[112:115], v[128:131]
    s_add_u32 s25, s24, 425984
    s_add_u32 s31, s24, 430080
    v_mfma_f32_16x16x32_bf16 v[132:135], a[68:71], a[112:115], v[132:135]
    buffer_load_dwordx4 a[32:35], v12, s[8:11], s25 offen offset:0
    v_mfma_f32_16x16x32_bf16 v[136:139], a[72:75], a[112:115], v[136:139]
    v_mfma_f32_16x16x32_bf16 v[140:143], a[76:79], a[112:115], v[140:143]
    v_mfma_f32_16x16x32_bf16 v[144:147], a[80:83], a[112:115], v[144:147]
    buffer_load_dwordx4 a[36:39], v12, s[8:11], s25 offen offset:1024
    v_mfma_f32_16x16x32_bf16 v[148:151], a[84:87], a[112:115], v[148:151]
    v_mfma_f32_16x16x32_bf16 v[152:155], a[88:91], a[112:115], v[152:155]
    v_mfma_f32_16x16x32_bf16 v[156:159], a[92:95], a[112:115], v[156:159]
    v_mfma_f32_16x16x32_bf16 v[188:191], a[92:95], a[116:119], v[188:191]
    buffer_load_dwordx4 a[40:43], v12, s[8:11], s25 offen offset:2048
    v_mfma_f32_16x16x32_bf16 v[184:187], a[88:91], a[116:119], v[184:187]
    v_mfma_f32_16x16x32_bf16 v[180:183], a[84:87], a[116:119], v[180:183]
    v_mfma_f32_16x16x32_bf16 v[176:179], a[80:83], a[116:119], v[176:179]
    v_mfma_f32_16x16x32_bf16 v[172:175], a[76:79], a[116:119], v[172:175]
    buffer_load_dwordx4 a[44:47], v12, s[8:11], s25 offen offset:3072
    v_mfma_f32_16x16x32_bf16 v[168:171], a[72:75], a[116:119], v[168:171]
    v_mfma_f32_16x16x32_bf16 v[164:167], a[68:71], a[116:119], v[164:167]
    v_mfma_f32_16x16x32_bf16 v[160:163], a[64:67], a[116:119], v[160:163]
    v_mfma_f32_16x16x32_bf16 v[192:195], a[64:67], a[120:123], v[192:195]
    buffer_load_dwordx4 a[48:51], v12, s[8:11], s31 offen offset:0
    v_mfma_f32_16x16x32_bf16 v[196:199], a[68:71], a[120:123], v[196:199]
    v_mfma_f32_16x16x32_bf16 v[200:203], a[72:75], a[120:123], v[200:203]
    v_mfma_f32_16x16x32_bf16 v[204:207], a[76:79], a[120:123], v[204:207]
    v_mfma_f32_16x16x32_bf16 v[208:211], a[80:83], a[120:123], v[208:211]
    buffer_load_dwordx4 a[52:55], v12, s[8:11], s31 offen offset:1024
    v_mfma_f32_16x16x32_bf16 v[212:215], a[84:87], a[120:123], v[212:215]
    v_mfma_f32_16x16x32_bf16 v[216:219], a[88:91], a[120:123], v[216:219]
    s_barrier
    v_mfma_f32_16x16x32_bf16 v[220:223], a[92:95], a[120:123], v[220:223]
    ds_read_b128 a[96:99], v8 offset:768
    v_mfma_f32_16x16x32_bf16 v[252:255], a[92:95], a[124:127], v[252:255]
    buffer_load_dwordx4 a[56:59], v12, s[8:11], s31 offen offset:2048
    v_mfma_f32_16x16x32_bf16 v[248:251], a[88:91], a[124:127], v[248:251]
    ds_read_b128 a[100:103], v8 offset:17152
    v_mfma_f32_16x16x32_bf16 v[244:247], a[84:87], a[124:127], v[244:247]
    v_mfma_f32_16x16x32_bf16 v[240:243], a[80:83], a[124:127], v[240:243]
    ds_read_b128 a[104:107], v8 offset:33536
    v_mfma_f32_16x16x32_bf16 v[236:239], a[76:79], a[124:127], v[236:239]
    buffer_load_dwordx4 a[60:63], v12, s[8:11], s31 offen offset:3072
    v_mfma_f32_16x16x32_bf16 v[232:235], a[72:75], a[124:127], v[232:235]
    ds_read_b128 a[108:111], v8 offset:49920
    v_mfma_f32_16x16x32_bf16 v[228:231], a[68:71], a[124:127], v[228:231]
    v_mfma_f32_16x16x32_bf16 v[224:227], a[64:67], a[124:127], v[224:227]
    s_waitcnt vmcnt(8) lgkmcnt(0)
    v_mfma_f32_16x16x32_bf16 v[128:131], a[0:3], a[96:99], v[128:131]
    s_add_u32 s25, s24, 458752
    s_add_u32 s31, s24, 462848
    v_mfma_f32_16x16x32_bf16 v[132:135], a[4:7], a[96:99], v[132:135]
    buffer_load_dwordx4 a[64:67], v12, s[8:11], s25 offen offset:0
    v_mfma_f32_16x16x32_bf16 v[136:139], a[8:11], a[96:99], v[136:139]
    v_mfma_f32_16x16x32_bf16 v[140:143], a[12:15], a[96:99], v[140:143]
    v_mfma_f32_16x16x32_bf16 v[144:147], a[16:19], a[96:99], v[144:147]
    buffer_load_dwordx4 a[68:71], v12, s[8:11], s25 offen offset:1024
    v_mfma_f32_16x16x32_bf16 v[148:151], a[20:23], a[96:99], v[148:151]
    ds_read_b128 a[112:115], v9 offset:768
    v_mfma_f32_16x16x32_bf16 v[152:155], a[24:27], a[96:99], v[152:155]
    v_mfma_f32_16x16x32_bf16 v[156:159], a[28:31], a[96:99], v[156:159]
    v_mfma_f32_16x16x32_bf16 v[188:191], a[28:31], a[100:103], v[188:191]
    buffer_load_dwordx4 a[72:75], v12, s[8:11], s25 offen offset:2048
    v_mfma_f32_16x16x32_bf16 v[184:187], a[24:27], a[100:103], v[184:187]
    v_mfma_f32_16x16x32_bf16 v[180:183], a[20:23], a[100:103], v[180:183]
    v_mfma_f32_16x16x32_bf16 v[176:179], a[16:19], a[100:103], v[176:179]
    v_mfma_f32_16x16x32_bf16 v[172:175], a[12:15], a[100:103], v[172:175]
    buffer_load_dwordx4 a[76:79], v12, s[8:11], s25 offen offset:3072
    v_mfma_f32_16x16x32_bf16 v[168:171], a[8:11], a[100:103], v[168:171]
    ds_read_b128 a[116:119], v9 offset:17152
    v_mfma_f32_16x16x32_bf16 v[164:167], a[4:7], a[100:103], v[164:167]
    v_mfma_f32_16x16x32_bf16 v[160:163], a[0:3], a[100:103], v[160:163]
    v_mfma_f32_16x16x32_bf16 v[192:195], a[0:3], a[104:107], v[192:195]
    buffer_load_dwordx4 a[80:83], v12, s[8:11], s31 offen offset:0
    v_mfma_f32_16x16x32_bf16 v[196:199], a[4:7], a[104:107], v[196:199]
    v_mfma_f32_16x16x32_bf16 v[200:203], a[8:11], a[104:107], v[200:203]
    v_mfma_f32_16x16x32_bf16 v[204:207], a[12:15], a[104:107], v[204:207]
    v_mfma_f32_16x16x32_bf16 v[208:211], a[16:19], a[104:107], v[208:211]
    buffer_load_dwordx4 a[84:87], v12, s[8:11], s31 offen offset:1024
    v_mfma_f32_16x16x32_bf16 v[212:215], a[20:23], a[104:107], v[212:215]
    ds_read_b128 a[120:123], v9 offset:33536
    v_mfma_f32_16x16x32_bf16 v[216:219], a[24:27], a[104:107], v[216:219]
    v_mfma_f32_16x16x32_bf16 v[220:223], a[28:31], a[104:107], v[220:223]
    v_mfma_f32_16x16x32_bf16 v[252:255], a[28:31], a[108:111], v[252:255]
    buffer_load_dwordx4 a[88:91], v12, s[8:11], s31 offen offset:2048
    v_mfma_f32_16x16x32_bf16 v[248:251], a[24:27], a[108:111], v[248:251]
    v_mfma_f32_16x16x32_bf16 v[244:247], a[20:23], a[108:111], v[244:247]
    v_mfma_f32_16x16x32_bf16 v[240:243], a[16:19], a[108:111], v[240:243]
    v_mfma_f32_16x16x32_bf16 v[236:239], a[12:15], a[108:111], v[236:239]
    buffer_load_dwordx4 a[92:95], v12, s[8:11], s31 offen offset:3072
    v_mfma_f32_16x16x32_bf16 v[232:235], a[8:11], a[108:111], v[232:235]
    ds_read_b128 a[124:127], v9 offset:49920
    v_mfma_f32_16x16x32_bf16 v[228:231], a[4:7], a[108:111], v[228:231]
    v_mfma_f32_16x16x32_bf16 v[224:227], a[0:3], a[108:111], v[224:227]
    s_waitcnt vmcnt(8) lgkmcnt(0)
    v_mfma_f32_16x16x32_bf16 v[128:131], a[32:35], a[112:115], v[128:131]
    s_add_u32 s25, s24, 491520
    s_add_u32 s31, s24, 495616
    v_mfma_f32_16x16x32_bf16 v[132:135], a[36:39], a[112:115], v[132:135]
    buffer_load_dwordx4 a[0:3], v12, s[8:11], s25 offen offset:0
    v_mfma_f32_16x16x32_bf16 v[136:139], a[40:43], a[112:115], v[136:139]
    v_mfma_f32_16x16x32_bf16 v[140:143], a[44:47], a[112:115], v[140:143]
    v_mfma_f32_16x16x32_bf16 v[144:147], a[48:51], a[112:115], v[144:147]
    buffer_load_dwordx4 a[4:7], v12, s[8:11], s25 offen offset:1024
    v_mfma_f32_16x16x32_bf16 v[148:151], a[52:55], a[112:115], v[148:151]
    ds_read_b128 a[96:99], v10 offset:768
    v_mfma_f32_16x16x32_bf16 v[152:155], a[56:59], a[112:115], v[152:155]
    v_mfma_f32_16x16x32_bf16 v[156:159], a[60:63], a[112:115], v[156:159]
    v_mfma_f32_16x16x32_bf16 v[188:191], a[60:63], a[116:119], v[188:191]
    buffer_load_dwordx4 a[8:11], v12, s[8:11], s25 offen offset:2048
    v_mfma_f32_16x16x32_bf16 v[184:187], a[56:59], a[116:119], v[184:187]
    v_mfma_f32_16x16x32_bf16 v[180:183], a[52:55], a[116:119], v[180:183]
    v_mfma_f32_16x16x32_bf16 v[176:179], a[48:51], a[116:119], v[176:179]
    v_mfma_f32_16x16x32_bf16 v[172:175], a[44:47], a[116:119], v[172:175]
    buffer_load_dwordx4 a[12:15], v12, s[8:11], s25 offen offset:3072
    v_mfma_f32_16x16x32_bf16 v[168:171], a[40:43], a[116:119], v[168:171]
    ds_read_b128 a[100:103], v10 offset:17152
    v_mfma_f32_16x16x32_bf16 v[164:167], a[36:39], a[116:119], v[164:167]
    v_mfma_f32_16x16x32_bf16 v[160:163], a[32:35], a[116:119], v[160:163]
    v_mfma_f32_16x16x32_bf16 v[192:195], a[32:35], a[120:123], v[192:195]
    buffer_load_dwordx4 a[16:19], v12, s[8:11], s31 offen offset:0
    v_mfma_f32_16x16x32_bf16 v[196:199], a[36:39], a[120:123], v[196:199]
    v_mfma_f32_16x16x32_bf16 v[200:203], a[40:43], a[120:123], v[200:203]
    v_mfma_f32_16x16x32_bf16 v[204:207], a[44:47], a[120:123], v[204:207]
    v_mfma_f32_16x16x32_bf16 v[208:211], a[48:51], a[120:123], v[208:211]
    buffer_load_dwordx4 a[20:23], v12, s[8:11], s31 offen offset:1024
    v_mfma_f32_16x16x32_bf16 v[212:215], a[52:55], a[120:123], v[212:215]
    ds_read_b128 a[104:107], v10 offset:33536
    v_mfma_f32_16x16x32_bf16 v[216:219], a[56:59], a[120:123], v[216:219]
    v_mfma_f32_16x16x32_bf16 v[220:223], a[60:63], a[120:123], v[220:223]
    v_mfma_f32_16x16x32_bf16 v[252:255], a[60:63], a[124:127], v[252:255]
    buffer_load_dwordx4 a[24:27], v12, s[8:11], s31 offen offset:2048
    v_mfma_f32_16x16x32_bf16 v[248:251], a[56:59], a[124:127], v[248:251]
    v_mfma_f32_16x16x32_bf16 v[244:247], a[52:55], a[124:127], v[244:247]
    v_mfma_f32_16x16x32_bf16 v[240:243], a[48:51], a[124:127], v[240:243]
    v_mfma_f32_16x16x32_bf16 v[236:239], a[44:47], a[124:127], v[236:239]
    buffer_load_dwordx4 a[28:31], v12, s[8:11], s31 offen offset:3072
    v_mfma_f32_16x16x32_bf16 v[232:235], a[40:43], a[124:127], v[232:235]
    ds_read_b128 a[108:111], v10 offset:49920
    v_mfma_f32_16x16x32_bf16 v[228:231], a[36:39], a[124:127], v[228:231]
    v_mfma_f32_16x16x32_bf16 v[224:227], a[32:35], a[124:127], v[224:227]
    s_waitcnt vmcnt(8) lgkmcnt(0)
    v_mfma_f32_16x16x32_bf16 v[128:131], a[64:67], a[96:99], v[128:131]
    v_mfma_f32_16x16x32_bf16 v[132:135], a[68:71], a[96:99], v[132:135]
    v_mfma_f32_16x16x32_bf16 v[136:139], a[72:75], a[96:99], v[136:139]
    v_mfma_f32_16x16x32_bf16 v[140:143], a[76:79], a[96:99], v[140:143]
    v_mfma_f32_16x16x32_bf16 v[144:147], a[80:83], a[96:99], v[144:147]
    v_mfma_f32_16x16x32_bf16 v[148:151], a[84:87], a[96:99], v[148:151]
    ds_read_b128 a[112:115], v11 offset:768
    v_mfma_f32_16x16x32_bf16 v[152:155], a[88:91], a[96:99], v[152:155]
    v_mfma_f32_16x16x32_bf16 v[156:159], a[92:95], a[96:99], v[156:159]
    v_mfma_f32_16x16x32_bf16 v[188:191], a[92:95], a[100:103], v[188:191]
    v_mfma_f32_16x16x32_bf16 v[184:187], a[88:91], a[100:103], v[184:187]
    v_mfma_f32_16x16x32_bf16 v[180:183], a[84:87], a[100:103], v[180:183]
    v_mfma_f32_16x16x32_bf16 v[176:179], a[80:83], a[100:103], v[176:179]
    v_mfma_f32_16x16x32_bf16 v[172:175], a[76:79], a[100:103], v[172:175]
    v_mfma_f32_16x16x32_bf16 v[168:171], a[72:75], a[100:103], v[168:171]
    ds_read_b128 a[116:119], v11 offset:17152
    v_mfma_f32_16x16x32_bf16 v[164:167], a[68:71], a[100:103], v[164:167]
    v_mfma_f32_16x16x32_bf16 v[160:163], a[64:67], a[100:103], v[160:163]
    v_mfma_f32_16x16x32_bf16 v[192:195], a[64:67], a[104:107], v[192:195]
    v_mfma_f32_16x16x32_bf16 v[196:199], a[68:71], a[104:107], v[196:199]
    v_mfma_f32_16x16x32_bf16 v[200:203], a[72:75], a[104:107], v[200:203]
    v_mfma_f32_16x16x32_bf16 v[204:207], a[76:79], a[104:107], v[204:207]
    v_mfma_f32_16x16x32_bf16 v[208:211], a[80:83], a[104:107], v[208:211]
    v_mfma_f32_16x16x32_bf16 v[212:215], a[84:87], a[104:107], v[212:215]
    ds_read_b128 a[120:123], v11 offset:33536
    v_mfma_f32_16x16x32_bf16 v[216:219], a[88:91], a[104:107], v[216:219]
    v_mfma_f32_16x16x32_bf16 v[220:223], a[92:95], a[104:107], v[220:223]
    v_mfma_f32_16x16x32_bf16 v[252:255], a[92:95], a[108:111], v[252:255]
    v_mfma_f32_16x16x32_bf16 v[248:251], a[88:91], a[108:111], v[248:251]
    v_mfma_f32_16x16x32_bf16 v[244:247], a[84:87], a[108:111], v[244:247]
    v_mfma_f32_16x16x32_bf16 v[240:243], a[80:83], a[108:111], v[240:243]
    v_mfma_f32_16x16x32_bf16 v[236:239], a[76:79], a[108:111], v[236:239]
    v_mfma_f32_16x16x32_bf16 v[232:235], a[72:75], a[108:111], v[232:235]
    ds_read_b128 a[124:127], v11 offset:49920
    v_mfma_f32_16x16x32_bf16 v[228:231], a[68:71], a[108:111], v[228:231]
    v_mfma_f32_16x16x32_bf16 v[224:227], a[64:67], a[108:111], v[224:227]
    s_waitcnt vmcnt(0) lgkmcnt(0)
    v_mfma_f32_16x16x32_bf16 v[128:131], a[0:3], a[112:115], v[128:131]
    v_mfma_f32_16x16x32_bf16 v[132:135], a[4:7], a[112:115], v[132:135]
    v_mfma_f32_16x16x32_bf16 v[136:139], a[8:11], a[112:115], v[136:139]
    v_mfma_f32_16x16x32_bf16 v[140:143], a[12:15], a[112:115], v[140:143]
    v_mfma_f32_16x16x32_bf16 v[144:147], a[16:19], a[112:115], v[144:147]
    v_mfma_f32_16x16x32_bf16 v[148:151], a[20:23], a[112:115], v[148:151]
    v_mfma_f32_16x16x32_bf16 v[152:155], a[24:27], a[112:115], v[152:155]
    v_mfma_f32_16x16x32_bf16 v[156:159], a[28:31], a[112:115], v[156:159]
    v_mfma_f32_16x16x32_bf16 v[188:191], a[28:31], a[116:119], v[188:191]
    v_mfma_f32_16x16x32_bf16 v[184:187], a[24:27], a[116:119], v[184:187]
    v_mfma_f32_16x16x32_bf16 v[180:183], a[20:23], a[116:119], v[180:183]
    v_mfma_f32_16x16x32_bf16 v[176:179], a[16:19], a[116:119], v[176:179]
    v_cvt_pk_bf16_f32 v96, v128, v132
    v_cvt_pk_bf16_f32 v97, v136, v140
    v_mfma_f32_16x16x32_bf16 v[172:175], a[12:15], a[116:119], v[172:175]
    v_cvt_pk_bf16_f32 v98, v129, v133
    v_cvt_pk_bf16_f32 v99, v137, v141
    v_mfma_f32_16x16x32_bf16 v[168:171], a[8:11], a[116:119], v[168:171]
    v_cvt_pk_bf16_f32 v100, v130, v134
    v_cvt_pk_bf16_f32 v101, v138, v142
    v_mfma_f32_16x16x32_bf16 v[164:167], a[4:7], a[116:119], v[164:167]
    v_cvt_pk_bf16_f32 v102, v131, v135
    v_cvt_pk_bf16_f32 v103, v139, v143
    ds_write_b128 v88, v[96:99] offset:0
    v_mfma_f32_16x16x32_bf16 v[160:163], a[0:3], a[116:119], v[160:163]
    ds_write_b128 v89, v[100:103] offset:0
    v_cvt_pk_bf16_f32 v104, v144, v148
    v_cvt_pk_bf16_f32 v105, v152, v156
    v_mfma_f32_16x16x32_bf16 v[192:195], a[0:3], a[120:123], v[192:195]
    v_cvt_pk_bf16_f32 v106, v145, v149
    v_cvt_pk_bf16_f32 v107, v153, v157
    v_mfma_f32_16x16x32_bf16 v[196:199], a[4:7], a[120:123], v[196:199]
    v_cvt_pk_bf16_f32 v108, v146, v150
    v_cvt_pk_bf16_f32 v109, v154, v158
    v_mfma_f32_16x16x32_bf16 v[200:203], a[8:11], a[120:123], v[200:203]
    v_cvt_pk_bf16_f32 v110, v147, v151
    v_cvt_pk_bf16_f32 v111, v155, v159
    ds_write_b128 v88, v[104:107] offset:128
    v_mfma_f32_16x16x32_bf16 v[204:207], a[12:15], a[120:123], v[204:207]
    ds_write_b128 v89, v[108:111] offset:128
    v_cvt_pk_bf16_f32 v120, v176, v180
    v_cvt_pk_bf16_f32 v121, v184, v188
    v_mfma_f32_16x16x32_bf16 v[208:211], a[16:19], a[120:123], v[208:211]
    v_cvt_pk_bf16_f32 v122, v177, v181
    v_cvt_pk_bf16_f32 v123, v185, v189
    v_mfma_f32_16x16x32_bf16 v[212:215], a[20:23], a[120:123], v[212:215]
    v_cvt_pk_bf16_f32 v124, v178, v182
    v_cvt_pk_bf16_f32 v125, v186, v190
    v_mfma_f32_16x16x32_bf16 v[216:219], a[24:27], a[120:123], v[216:219]
    v_cvt_pk_bf16_f32 v126, v179, v183
    v_cvt_pk_bf16_f32 v127, v187, v191
    ds_write_b128 v88, v[120:123] offset:16512
    v_mfma_f32_16x16x32_bf16 v[220:223], a[28:31], a[120:123], v[220:223]
    ds_write_b128 v89, v[124:127] offset:16512
    v_cvt_pk_bf16_f32 v112, v160, v164
    v_cvt_pk_bf16_f32 v113, v168, v172
    v_mfma_f32_16x16x32_bf16 v[252:255], a[28:31], a[124:127], v[252:255]
    v_cvt_pk_bf16_f32 v114, v161, v165
    v_cvt_pk_bf16_f32 v115, v169, v173
    v_mfma_f32_16x16x32_bf16 v[248:251], a[24:27], a[124:127], v[248:251]
    v_cvt_pk_bf16_f32 v116, v162, v166
    v_cvt_pk_bf16_f32 v117, v170, v174
    v_mfma_f32_16x16x32_bf16 v[244:247], a[20:23], a[124:127], v[244:247]
    v_cvt_pk_bf16_f32 v118, v163, v167
    v_cvt_pk_bf16_f32 v119, v171, v175
    ds_write_b128 v88, v[112:115] offset:16384
    v_mfma_f32_16x16x32_bf16 v[240:243], a[16:19], a[124:127], v[240:243]
    ds_write_b128 v89, v[116:119] offset:16384
    v_cvt_pk_bf16_f32 v96, v192, v196
    v_cvt_pk_bf16_f32 v97, v200, v204
    v_mfma_f32_16x16x32_bf16 v[236:239], a[12:15], a[124:127], v[236:239]
    v_cvt_pk_bf16_f32 v98, v193, v197
    v_cvt_pk_bf16_f32 v99, v201, v205
    v_mfma_f32_16x16x32_bf16 v[232:235], a[8:11], a[124:127], v[232:235]
    v_cvt_pk_bf16_f32 v100, v194, v198
    v_cvt_pk_bf16_f32 v101, v202, v206
    v_mfma_f32_16x16x32_bf16 v[228:231], a[4:7], a[124:127], v[228:231]
    v_cvt_pk_bf16_f32 v102, v195, v199
    v_cvt_pk_bf16_f32 v103, v203, v207
    ds_write_b128 v88, v[96:99] offset:32768
    v_mfma_f32_16x16x32_bf16 v[224:227], a[0:3], a[124:127], v[224:227]
    ds_write_b128 v89, v[100:103] offset:32768
    v_cvt_pk_bf16_f32 v104, v208, v212
    v_cvt_pk_bf16_f32 v105, v216, v220
    v_cvt_pk_bf16_f32 v106, v209, v213
    v_cvt_pk_bf16_f32 v107, v217, v221
    v_cvt_pk_bf16_f32 v108, v210, v214
    v_cvt_pk_bf16_f32 v109, v218, v222
    v_cvt_pk_bf16_f32 v110, v211, v215
    v_cvt_pk_bf16_f32 v111, v219, v223
    ds_write_b128 v88, v[104:107] offset:32896
    ds_write_b128 v89, v[108:111] offset:32896
    s_waitcnt lgkmcnt(4)
    s_barrier
    ds_read_b128 v[16:19], v90 offset:0
    ds_read_b128 v[20:23], v91 offset:1024
    ds_read_b128 v[24:27], v92 offset:2048
    ds_read_b128 v[28:31], v93 offset:3072
    ds_read_b128 v[32:35], v90 offset:16384
    ds_read_b128 v[36:39], v91 offset:17408
    ds_read_b128 v[40:43], v92 offset:18432
    ds_read_b128 v[44:47], v93 offset:19456
    s_nop 3
    v_cvt_pk_bf16_f32 v120, v240, v244
    v_cvt_pk_bf16_f32 v121, v248, v252
    v_cvt_pk_bf16_f32 v122, v241, v245
    v_cvt_pk_bf16_f32 v123, v249, v253
    v_cvt_pk_bf16_f32 v124, v242, v246
    v_cvt_pk_bf16_f32 v125, v250, v254
    v_cvt_pk_bf16_f32 v126, v243, v247
    v_cvt_pk_bf16_f32 v127, v251, v255
    ds_write_b128 v88, v[120:123] offset:49280
    ds_write_b128 v89, v[124:127] offset:49280
    v_cvt_pk_bf16_f32 v112, v224, v228
    v_cvt_pk_bf16_f32 v113, v232, v236
    v_cvt_pk_bf16_f32 v114, v225, v229
    v_cvt_pk_bf16_f32 v115, v233, v237
    v_cvt_pk_bf16_f32 v116, v226, v230
    v_cvt_pk_bf16_f32 v117, v234, v238
    v_cvt_pk_bf16_f32 v118, v227, v231
    v_cvt_pk_bf16_f32 v119, v235, v239
    ds_write_b128 v88, v[112:115] offset:49152
    ds_write_b128 v89, v[116:119] offset:49152
    s_waitcnt lgkmcnt(11)
    s_add_u32 s27, s60, 0
    buffer_store_dwordx4 v[16:19], v12, s[12:15], s27 offen sc0 sc1
    s_waitcnt lgkmcnt(10)
    s_add_u32 s27, s61, 0
    buffer_store_dwordx4 v[20:23], v12, s[12:15], s27 offen sc0 sc1
    s_waitcnt lgkmcnt(9)
    s_add_u32 s27, s62, 0
    buffer_store_dwordx4 v[24:27], v12, s[12:15], s27 offen sc0 sc1
    s_waitcnt lgkmcnt(8)
    s_add_u32 s27, s63, 0
    buffer_store_dwordx4 v[28:31], v12, s[12:15], s27 offen sc0 sc1
    s_waitcnt lgkmcnt(7)
    s_add_u32 s27, s60, 2048
    buffer_store_dwordx4 v[32:35], v12, s[12:15], s27 offen sc0 sc1
    s_waitcnt lgkmcnt(6)
    s_add_u32 s27, s61, 2048
    buffer_store_dwordx4 v[36:39], v12, s[12:15], s27 offen sc0 sc1
    s_waitcnt lgkmcnt(5)
    s_add_u32 s27, s62, 2048
    buffer_store_dwordx4 v[40:43], v12, s[12:15], s27 offen sc0 sc1
    s_waitcnt lgkmcnt(4)
    s_add_u32 s27, s63, 2048
    buffer_store_dwordx4 v[44:47], v12, s[12:15], s27 offen sc0 sc1
    s_waitcnt lgkmcnt(0)
    s_barrier
    ds_read_b128 v[128:131], v90 offset:32768
    ds_read_b128 v[132:135], v91 offset:33792
    ds_read_b128 v[136:139], v92 offset:34816
    ds_read_b128 v[140:143], v93 offset:35840
    ds_read_b128 v[144:147], v90 offset:49152
    ds_read_b128 v[148:151], v91 offset:50176
    ds_read_b128 v[152:155], v92 offset:51200
    ds_read_b128 v[156:159], v93 offset:52224
    s_waitcnt lgkmcnt(7)
    s_add_u32 s27, s60, 4096
    buffer_store_dwordx4 v[128:131], v12, s[12:15], s27 offen sc0 sc1
    s_waitcnt lgkmcnt(6)
    s_add_u32 s27, s61, 4096
    buffer_store_dwordx4 v[132:135], v12, s[12:15], s27 offen sc0 sc1
    s_waitcnt lgkmcnt(5)
    s_add_u32 s27, s62, 4096
    buffer_store_dwordx4 v[136:139], v12, s[12:15], s27 offen sc0 sc1
    s_waitcnt lgkmcnt(4)
    s_add_u32 s27, s63, 4096
    buffer_store_dwordx4 v[140:143], v12, s[12:15], s27 offen sc0 sc1
    s_waitcnt lgkmcnt(3)
    s_add_u32 s27, s60, 6144
    buffer_store_dwordx4 v[144:147], v12, s[12:15], s27 offen sc0 sc1
    s_waitcnt lgkmcnt(2)
    s_add_u32 s27, s61, 6144
    buffer_store_dwordx4 v[148:151], v12, s[12:15], s27 offen sc0 sc1
    s_waitcnt lgkmcnt(1)
    s_add_u32 s27, s62, 6144
    buffer_store_dwordx4 v[152:155], v12, s[12:15], s27 offen sc0 sc1
    s_waitcnt lgkmcnt(0)
    s_add_u32 s27, s63, 6144
    buffer_store_dwordx4 v[156:159], v12, s[12:15], s27 offen sc0 sc1
    s_cmp_lg_u32 s2, 0
    s_cbranch_scc1 p4_fin0
    s_mov_b32 s27, 0
    s_cmp_lg_u32 s16, 0
    s_cbranch_scc1 p4_sig18
    v_mov_b32 v6, s100
    v_mov_b32 v7, 0
    s_mov_b64 exec, 1
    buffer_store_dword v6, v7, s[92:95], s27 offen sc0 sc1
    s_mov_b64 exec, -1
p4_sig18:
p4_fin0:
    s_endpgm
p4_slow:
    s_lshl_b32 s22, s16, 12
    s_add_u32 m0, s22, 81920
    s_nop 0
    buffer_load_dwordx4 v12, s[4:7], s85 offen offset:0 lds
    buffer_load_dwordx4 v12, s[4:7], s85 offen offset:1024 lds
    buffer_load_dwordx4 v12, s[4:7], s85 offen offset:2048 lds
    buffer_load_dwordx4 v12, s[4:7], s85 offen offset:3072 lds
    s_waitcnt vmcnt(0)
    s_barrier
    ds_read_b128 v[48:51], v94 offset:0
    ds_read_b128 v[52:55], v94 offset:16
    ds_read_b128 v[56:59], v94 offset:2048
    ds_read_b128 v[60:63], v94 offset:2064
    s_waitcnt lgkmcnt(2)
    v_add_f32 v64, v16, v48
    v_add_f32 v65, v17, v49
    v_add_f32 v66, v18, v50
    v_add_f32 v67, v19, v51
    v_add_f32 v68, v20, v52
    v_add_f32 v69, v21, v53
    v_add_f32 v70, v22, v54
    v_add_f32 v71, v23, v55
    v_exp_f32 v64, v64
    v_exp_f32 v65, v65
    v_exp_f32 v66, v66
    v_exp_f32 v67, v67
    v_exp_f32 v68, v68
    v_exp_f32 v69, v69
    v_exp_f32 v70, v70
    v_exp_f32 v71, v71
    v_add_f32 v64, 1.0, v64
    v_add_f32 v65, 1.0, v65
    v_add_f32 v66, 1.0, v66
    v_add_f32 v67, 1.0, v67
    v_add_f32 v68, 1.0, v68
    v_add_f32 v69, 1.0, v69
    v_add_f32 v70, 1.0, v70
    v_add_f32 v71, 1.0, v71
    v_rcp_f32 v64, v64
    v_rcp_f32 v65, v65
    v_rcp_f32 v66, v66
    v_rcp_f32 v67, v67
    v_rcp_f32 v68, v68
    v_rcp_f32 v69, v69
    v_rcp_f32 v70, v70
    v_rcp_f32 v71, v71
    v_fma_f32 v64, v64, -2.0, 1.0
    v_fma_f32 v65, v65, -2.0, 1.0
    v_fma_f32 v66, v66, -2.0, 1.0
    v_fma_f32 v67, v67, -2.0, 1.0
    v_fma_f32 v68, v68, -2.0, 1.0
    v_fma_f32 v69, v69, -2.0, 1.0
    v_fma_f32 v70, v70, -2.0, 1.0
    v_fma_f32 v71, v71, -2.0, 1.0
    v_cvt_pk_bf16_f32 v80, v64, v65
    v_cvt_pk_bf16_f32 v81, v66, v67
    v_cvt_pk_bf16_f32 v82, v68, v69
    v_cvt_pk_bf16_f32 v83, v70, v71
    ds_write_b128 v15, v[80:83] offset:0
    ds_read_b128 v[48:51], v94 offset:4096
    ds_read_b128 v[52:55], v94 offset:4112
    s_waitcnt lgkmcnt(3)
    v_add_f32 v72, v16, v56
    v_add_f32 v73, v17, v57
    v_add_f32 v74, v18, v58
    v_add_f32 v75, v19, v59
    v_add_f32 v76, v20, v60
    v_add_f32 v77, v21, v61
    v_add_f32 v78, v22, v62
    v_add_f32 v79, v23, v63
    v_exp_f32 v72, v72
    v_exp_f32 v73, v73
    v_exp_f32 v74, v74
    v_exp_f32 v75, v75
    v_exp_f32 v76, v76
    v_exp_f32 v77, v77
    v_exp_f32 v78, v78
    v_exp_f32 v79, v79
    v_add_f32 v72, 1.0, v72
    v_add_f32 v73, 1.0, v73
    v_add_f32 v74, 1.0, v74
    v_add_f32 v75, 1.0, v75
    v_add_f32 v76, 1.0, v76
    v_add_f32 v77, 1.0, v77
    v_add_f32 v78, 1.0, v78
    v_add_f32 v79, 1.0, v79
    v_rcp_f32 v72, v72
    v_rcp_f32 v73, v73
    v_rcp_f32 v74, v74
    v_rcp_f32 v75, v75
    v_rcp_f32 v76, v76
    v_rcp_f32 v77, v77
    v_rcp_f32 v78, v78
    v_rcp_f32 v79, v79
    v_fma_f32 v72, v72, -2.0, 1.0
    v_fma_f32 v73, v73, -2.0, 1.0
    v_fma_f32 v74, v74, -2.0, 1.0
    v_fma_f32 v75, v75, -2.0, 1.0
    v_fma_f32 v76, v76, -2.0, 1.0
    v_fma_f32 v77, v77, -2.0, 1.0
    v_fma_f32 v78, v78, -2.0, 1.0
    v_fma_f32 v79, v79, -2.0, 1.0
    v_cvt_pk_bf16_f32 v84, v72, v73
    v_cvt_pk_bf16_f32 v85, v74, v75
    v_cvt_pk_bf16_f32 v86, v76, v77
    v_cvt_pk_bf16_f32 v87, v78, v79
    ds_write_b128 v15, v[84:87] offset:8192
    ds_read_b128 v[56:59], v94 offset:6144
    ds_read_b128 v[60:63], v94 offset:6160
    s_waitcnt lgkmcnt(3)
    v_add_f32 v64, v16, v48
    v_add_f32 v65, v17, v49
    v_add_f32 v66, v18, v50
    v_add_f32 v67, v19, v51
    v_add_f32 v68, v20, v52
    v_add_f32 v69, v21, v53
    v_add_f32 v70, v22, v54
    v_add_f32 v71, v23, v55
    v_exp_f32 v64, v64
    v_exp_f32 v65, v65
    v_exp_f32 v66, v66
    v_exp_f32 v67, v67
    v_exp_f32 v68, v68
    v_exp_f32 v69, v69
    v_exp_f32 v70, v70
    v_exp_f32 v71, v71
    v_add_f32 v64, 1.0, v64
    v_add_f32 v65, 1.0, v65
    v_add_f32 v66, 1.0, v66
    v_add_f32 v67, 1.0, v67
    v_add_f32 v68, 1.0, v68
    v_add_f32 v69, 1.0, v69
    v_add_f32 v70, 1.0, v70
    v_add_f32 v71, 1.0, v71
    v_rcp_f32 v64, v64
    v_rcp_f32 v65, v65
    v_rcp_f32 v66, v66
    v_rcp_f32 v67, v67
    v_rcp_f32 v68, v68
    v_rcp_f32 v69, v69
    v_rcp_f32 v70, v70
    v_rcp_f32 v71, v71
    v_fma_f32 v64, v64, -2.0, 1.0
    v_fma_f32 v65, v65, -2.0, 1.0
    v_fma_f32 v66, v66, -2.0, 1.0
    v_fma_f32 v67, v67, -2.0, 1.0
    v_fma_f32 v68, v68, -2.0, 1.0
    v_fma_f32 v69, v69, -2.0, 1.0
    v_fma_f32 v70, v70, -2.0, 1.0
    v_fma_f32 v71, v71, -2.0, 1.0
    v_cvt_pk_bf16_f32 v80, v64, v65
    v_cvt_pk_bf16_f32 v81, v66, v67
    v_cvt_pk_bf16_f32 v82, v68, v69
    v_cvt_pk_bf16_f32 v83, v70, v71
    ds_write_b128 v15, v[80:83] offset:16384
    s_waitcnt lgkmcnt(1)
    v_add_f32 v72, v16, v56
    v_add_f32 v73, v17, v57
    v_add_f32 v74, v18, v58
    v_add_f32 v75, v19, v59
    v_add_f32 v76, v20, v60
    v_add_f32 v77, v21, v61
    v_add_f32 v78, v22, v62
    v_add_f32 v79, v23, v63
    v_exp_f32 v72, v72
    v_exp_f32 v73, v73
    v_exp_f32 v74, v74
    v_exp_f32 v75, v75
    v_exp_f32 v76, v76
    v_exp_f32 v77, v77
    v_exp_f32 v78, v78
    v_exp_f32 v79, v79
    v_add_f32 v72, 1.0, v72
    v_add_f32 v73, 1.0, v73
    v_add_f32 v74, 1.0, v74
    v_add_f32 v75, 1.0, v75
    v_add_f32 v76, 1.0, v76
    v_add_f32 v77, 1.0, v77
    v_add_f32 v78, 1.0, v78
    v_add_f32 v79, 1.0, v79
    v_rcp_f32 v72, v72
    v_rcp_f32 v73, v73
    v_rcp_f32 v74, v74
    v_rcp_f32 v75, v75
    v_rcp_f32 v76, v76
    v_rcp_f32 v77, v77
    v_rcp_f32 v78, v78
    v_rcp_f32 v79, v79
    v_fma_f32 v72, v72, -2.0, 1.0
    v_fma_f32 v73, v73, -2.0, 1.0
    v_fma_f32 v74, v74, -2.0, 1.0
    v_fma_f32 v75, v75, -2.0, 1.0
    v_fma_f32 v76, v76, -2.0, 1.0
    v_fma_f32 v77, v77, -2.0, 1.0
    v_fma_f32 v78, v78, -2.0, 1.0
    v_fma_f32 v79, v79, -2.0, 1.0
    v_cvt_pk_bf16_f32 v84, v72, v73
    v_cvt_pk_bf16_f32 v85, v74, v75
    v_cvt_pk_bf16_f32 v86, v76, v77
    v_cvt_pk_bf16_f32 v87, v78, v79
    ds_write_b128 v15, v[84:87] offset:24576
    ds_read_b128 v[48:51], v94 offset:512
    ds_read_b128 v[52:55], v94 offset:528
    ds_read_b128 v[56:59], v94 offset:2560
    ds_read_b128 v[60:63], v94 offset:2576
    s_waitcnt lgkmcnt(2)
    v_add_f32 v64, v24, v48
    v_add_f32 v65, v25, v49
    v_add_f32 v66, v26, v50
    v_add_f32 v67, v27, v51
    v_add_f32 v68, v28, v52
    v_add_f32 v69, v29, v53
    v_add_f32 v70, v30, v54
    v_add_f32 v71, v31, v55
    v_exp_f32 v64, v64
    v_exp_f32 v65, v65
    v_exp_f32 v66, v66
    v_exp_f32 v67, v67
    v_exp_f32 v68, v68
    v_exp_f32 v69, v69
    v_exp_f32 v70, v70
    v_exp_f32 v71, v71
    v_add_f32 v64, 1.0, v64
    v_add_f32 v65, 1.0, v65
    v_add_f32 v66, 1.0, v66
    v_add_f32 v67, 1.0, v67
    v_add_f32 v68, 1.0, v68
    v_add_f32 v69, 1.0, v69
    v_add_f32 v70, 1.0, v70
    v_add_f32 v71, 1.0, v71
    v_rcp_f32 v64, v64
    v_rcp_f32 v65, v65
    v_rcp_f32 v66, v66
    v_rcp_f32 v67, v67
    v_rcp_f32 v68, v68
    v_rcp_f32 v69, v69
    v_rcp_f32 v70, v70
    v_rcp_f32 v71, v71
    v_fma_f32 v64, v64, -2.0, 1.0
    v_fma_f32 v65, v65, -2.0, 1.0
    v_fma_f32 v66, v66, -2.0, 1.0
    v_fma_f32 v67, v67, -2.0, 1.0
    v_fma_f32 v68, v68, -2.0, 1.0
    v_fma_f32 v69, v69, -2.0, 1.0
    v_fma_f32 v70, v70, -2.0, 1.0
    v_fma_f32 v71, v71, -2.0, 1.0
    v_cvt_pk_bf16_f32 v80, v64, v65
    v_cvt_pk_bf16_f32 v81, v66, v67
    v_cvt_pk_bf16_f32 v82, v68, v69
    v_cvt_pk_bf16_f32 v83, v70, v71
    ds_write_b128 v15, v[80:83] offset:256
    ds_read_b128 v[48:51], v94 offset:4608
    ds_read_b128 v[52:55], v94 offset:4624
    s_waitcnt lgkmcnt(3)
    v_add_f32 v72, v24, v56
    v_add_f32 v73, v25, v57
    v_add_f32 v74, v26, v58
    v_add_f32 v75, v27, v59
    v_add_f32 v76, v28, v60
    v_add_f32 v77, v29, v61
    v_add_f32 v78, v30, v62
    v_add_f32 v79, v31, v63
    v_exp_f32 v72, v72
    v_exp_f32 v73, v73
    v_exp_f32 v74, v74
    v_exp_f32 v75, v75
    v_exp_f32 v76, v76
    v_exp_f32 v77, v77
    v_exp_f32 v78, v78
    v_exp_f32 v79, v79
    v_add_f32 v72, 1.0, v72
    v_add_f32 v73, 1.0, v73
    v_add_f32 v74, 1.0, v74
    v_add_f32 v75, 1.0, v75
    v_add_f32 v76, 1.0, v76
    v_add_f32 v77, 1.0, v77
    v_add_f32 v78, 1.0, v78
    v_add_f32 v79, 1.0, v79
    v_rcp_f32 v72, v72
    v_rcp_f32 v73, v73
    v_rcp_f32 v74, v74
    v_rcp_f32 v75, v75
    v_rcp_f32 v76, v76
    v_rcp_f32 v77, v77
    v_rcp_f32 v78, v78
    v_rcp_f32 v79, v79
    v_fma_f32 v72, v72, -2.0, 1.0
    v_fma_f32 v73, v73, -2.0, 1.0
    v_fma_f32 v74, v74, -2.0, 1.0
    v_fma_f32 v75, v75, -2.0, 1.0
    v_fma_f32 v76, v76, -2.0, 1.0
    v_fma_f32 v77, v77, -2.0, 1.0
    v_fma_f32 v78, v78, -2.0, 1.0
    v_fma_f32 v79, v79, -2.0, 1.0
    v_cvt_pk_bf16_f32 v84, v72, v73
    v_cvt_pk_bf16_f32 v85, v74, v75
    v_cvt_pk_bf16_f32 v86, v76, v77
    v_cvt_pk_bf16_f32 v87, v78, v79
    ds_write_b128 v15, v[84:87] offset:8448
    ds_read_b128 v[56:59], v94 offset:6656
    ds_read_b128 v[60:63], v94 offset:6672
    s_waitcnt lgkmcnt(3)
    v_add_f32 v64, v24, v48
    v_add_f32 v65, v25, v49
    v_add_f32 v66, v26, v50
    v_add_f32 v67, v27, v51
    v_add_f32 v68, v28, v52
    v_add_f32 v69, v29, v53
    v_add_f32 v70, v30, v54
    v_add_f32 v71, v31, v55
    v_exp_f32 v64, v64
    v_exp_f32 v65, v65
    v_exp_f32 v66, v66
    v_exp_f32 v67, v67
    v_exp_f32 v68, v68
    v_exp_f32 v69, v69
    v_exp_f32 v70, v70
    v_exp_f32 v71, v71
    v_add_f32 v64, 1.0, v64
    v_add_f32 v65, 1.0, v65
    v_add_f32 v66, 1.0, v66
    v_add_f32 v67, 1.0, v67
    v_add_f32 v68, 1.0, v68
    v_add_f32 v69, 1.0, v69
    v_add_f32 v70, 1.0, v70
    v_add_f32 v71, 1.0, v71
    v_rcp_f32 v64, v64
    v_rcp_f32 v65, v65
    v_rcp_f32 v66, v66
    v_rcp_f32 v67, v67
    v_rcp_f32 v68, v68
    v_rcp_f32 v69, v69
    v_rcp_f32 v70, v70
    v_rcp_f32 v71, v71
    v_fma_f32 v64, v64, -2.0, 1.0
    v_fma_f32 v65, v65, -2.0, 1.0
    v_fma_f32 v66, v66, -2.0, 1.0
    v_fma_f32 v67, v67, -2.0, 1.0
    v_fma_f32 v68, v68, -2.0, 1.0
    v_fma_f32 v69, v69, -2.0, 1.0
    v_fma_f32 v70, v70, -2.0, 1.0
    v_fma_f32 v71, v71, -2.0, 1.0
    v_cvt_pk_bf16_f32 v80, v64, v65
    v_cvt_pk_bf16_f32 v81, v66, v67
    v_cvt_pk_bf16_f32 v82, v68, v69
    v_cvt_pk_bf16_f32 v83, v70, v71
    ds_write_b128 v15, v[80:83] offset:16640
    s_waitcnt lgkmcnt(1)
    v_add_f32 v72, v24, v56
    v_add_f32 v73, v25, v57
    v_add_f32 v74, v26, v58
    v_add_f32 v75, v27, v59
    v_add_f32 v76, v28, v60
    v_add_f32 v77, v29, v61
    v_add_f32 v78, v30, v62
    v_add_f32 v79, v31, v63
    v_exp_f32 v72, v72
    v_exp_f32 v73, v73
    v_exp_f32 v74, v74
    v_exp_f32 v75, v75
    v_exp_f32 v76, v76
    v_exp_f32 v77, v77
    v_exp_f32 v78, v78
    v_exp_f32 v79, v79
    v_add_f32 v72, 1.0, v72
    v_add_f32 v73, 1.0, v73
    v_add_f32 v74, 1.0, v74
    v_add_f32 v75, 1.0, v75
    v_add_f32 v76, 1.0, v76
    v_add_f32 v77, 1.0, v77
    v_add_f32 v78, 1.0, v78
    v_add_f32 v79, 1.0, v79
    v_rcp_f32 v72, v72
    v_rcp_f32 v73, v73
    v_rcp_f32 v74, v74
    v_rcp_f32 v75, v75
    v_rcp_f32 v76, v76
    v_rcp_f32 v77, v77
    v_rcp_f32 v78, v78
    v_rcp_f32 v79, v79
    v_fma_f32 v72, v72, -2.0, 1.0
    v_fma_f32 v73, v73, -2.0, 1.0
    v_fma_f32 v74, v74, -2.0, 1.0
    v_fma_f32 v75, v75, -2.0, 1.0
    v_fma_f32 v76, v76, -2.0, 1.0
    v_fma_f32 v77, v77, -2.0, 1.0
    v_fma_f32 v78, v78, -2.0, 1.0
    v_fma_f32 v79, v79, -2.0, 1.0
    v_cvt_pk_bf16_f32 v84, v72, v73
    v_cvt_pk_bf16_f32 v85, v74, v75
    v_cvt_pk_bf16_f32 v86, v76, v77
    v_cvt_pk_bf16_f32 v87, v78, v79
    ds_write_b128 v15, v[84:87] offset:24832
    ds_read_b128 v[48:51], v94 offset:1024
    ds_read_b128 v[52:55], v94 offset:1040
    ds_read_b128 v[56:59], v94 offset:3072
    ds_read_b128 v[60:63], v94 offset:3088
    s_waitcnt lgkmcnt(2)
    v_add_f32 v64, v32, v48
    v_add_f32 v65, v33, v49
    v_add_f32 v66, v34, v50
    v_add_f32 v67, v35, v51
    v_add_f32 v68, v36, v52
    v_add_f32 v69, v37, v53
    v_add_f32 v70, v38, v54
    v_add_f32 v71, v39, v55
    v_exp_f32 v64, v64
    v_exp_f32 v65, v65
    v_exp_f32 v66, v66
    v_exp_f32 v67, v67
    v_exp_f32 v68, v68
    v_exp_f32 v69, v69
    v_exp_f32 v70, v70
    v_exp_f32 v71, v71
    v_add_f32 v64, 1.0, v64
    v_add_f32 v65, 1.0, v65
    v_add_f32 v66, 1.0, v66
    v_add_f32 v67, 1.0, v67
    v_add_f32 v68, 1.0, v68
    v_add_f32 v69, 1.0, v69
    v_add_f32 v70, 1.0, v70
    v_add_f32 v71, 1.0, v71
    v_rcp_f32 v64, v64
    v_rcp_f32 v65, v65
    v_rcp_f32 v66, v66
    v_rcp_f32 v67, v67
    v_rcp_f32 v68, v68
    v_rcp_f32 v69, v69
    v_rcp_f32 v70, v70
    v_rcp_f32 v71, v71
    v_fma_f32 v64, v64, -2.0, 1.0
    v_fma_f32 v65, v65, -2.0, 1.0
    v_fma_f32 v66, v66, -2.0, 1.0
    v_fma_f32 v67, v67, -2.0, 1.0
    v_fma_f32 v68, v68, -2.0, 1.0
    v_fma_f32 v69, v69, -2.0, 1.0
    v_fma_f32 v70, v70, -2.0, 1.0
    v_fma_f32 v71, v71, -2.0, 1.0
    v_cvt_pk_bf16_f32 v80, v64, v65
    v_cvt_pk_bf16_f32 v81, v66, v67
    v_cvt_pk_bf16_f32 v82, v68, v69
    v_cvt_pk_bf16_f32 v83, v70, v71
    ds_write_b128 v15, v[80:83] offset:512
    ds_read_b128 v[48:51], v94 offset:5120
    ds_read_b128 v[52:55], v94 offset:5136
    s_waitcnt lgkmcnt(3)
    v_add_f32 v72, v32, v56
    v_add_f32 v73, v33, v57
    v_add_f32 v74, v34, v58
    v_add_f32 v75, v35, v59
    v_add_f32 v76, v36, v60
    v_add_f32 v77, v37, v61
    v_add_f32 v78, v38, v62
    v_add_f32 v79, v39, v63
    v_exp_f32 v72, v72
    v_exp_f32 v73, v73
    v_exp_f32 v74, v74
    v_exp_f32 v75, v75
    v_exp_f32 v76, v76
    v_exp_f32 v77, v77
    v_exp_f32 v78, v78
    v_exp_f32 v79, v79
    v_add_f32 v72, 1.0, v72
    v_add_f32 v73, 1.0, v73
    v_add_f32 v74, 1.0, v74
    v_add_f32 v75, 1.0, v75
    v_add_f32 v76, 1.0, v76
    v_add_f32 v77, 1.0, v77
    v_add_f32 v78, 1.0, v78
    v_add_f32 v79, 1.0, v79
    v_rcp_f32 v72, v72
    v_rcp_f32 v73, v73
    v_rcp_f32 v74, v74
    v_rcp_f32 v75, v75
    v_rcp_f32 v76, v76
    v_rcp_f32 v77, v77
    v_rcp_f32 v78, v78
    v_rcp_f32 v79, v79
    v_fma_f32 v72, v72, -2.0, 1.0
    v_fma_f32 v73, v73, -2.0, 1.0
    v_fma_f32 v74, v74, -2.0, 1.0
    v_fma_f32 v75, v75, -2.0, 1.0
    v_fma_f32 v76, v76, -2.0, 1.0
    v_fma_f32 v77, v77, -2.0, 1.0
    v_fma_f32 v78, v78, -2.0, 1.0
    v_fma_f32 v79, v79, -2.0, 1.0
    v_cvt_pk_bf16_f32 v84, v72, v73
    v_cvt_pk_bf16_f32 v85, v74, v75
    v_cvt_pk_bf16_f32 v86, v76, v77
    v_cvt_pk_bf16_f32 v87, v78, v79
    ds_write_b128 v15, v[84:87] offset:8704
    ds_read_b128 v[56:59], v94 offset:7168
    ds_read_b128 v[60:63], v94 offset:7184
    s_waitcnt lgkmcnt(3)
    v_add_f32 v64, v32, v48
    v_add_f32 v65, v33, v49
    v_add_f32 v66, v34, v50
    v_add_f32 v67, v35, v51
    v_add_f32 v68, v36, v52
    v_add_f32 v69, v37, v53
    v_add_f32 v70, v38, v54
    v_add_f32 v71, v39, v55
    v_exp_f32 v64, v64
    v_exp_f32 v65, v65
    v_exp_f32 v66, v66
    v_exp_f32 v67, v67
    v_exp_f32 v68, v68
    v_exp_f32 v69, v69
    v_exp_f32 v70, v70
    v_exp_f32 v71, v71
    v_add_f32 v64, 1.0, v64
    v_add_f32 v65, 1.0, v65
    v_add_f32 v66, 1.0, v66
    v_add_f32 v67, 1.0, v67
    v_add_f32 v68, 1.0, v68
    v_add_f32 v69, 1.0, v69
    v_add_f32 v70, 1.0, v70
    v_add_f32 v71, 1.0, v71
    v_rcp_f32 v64, v64
    v_rcp_f32 v65, v65
    v_rcp_f32 v66, v66
    v_rcp_f32 v67, v67
    v_rcp_f32 v68, v68
    v_rcp_f32 v69, v69
    v_rcp_f32 v70, v70
    v_rcp_f32 v71, v71
    v_fma_f32 v64, v64, -2.0, 1.0
    v_fma_f32 v65, v65, -2.0, 1.0
    v_fma_f32 v66, v66, -2.0, 1.0
    v_fma_f32 v67, v67, -2.0, 1.0
    v_fma_f32 v68, v68, -2.0, 1.0
    v_fma_f32 v69, v69, -2.0, 1.0
    v_fma_f32 v70, v70, -2.0, 1.0
    v_fma_f32 v71, v71, -2.0, 1.0
    v_cvt_pk_bf16_f32 v80, v64, v65
    v_cvt_pk_bf16_f32 v81, v66, v67
    v_cvt_pk_bf16_f32 v82, v68, v69
    v_cvt_pk_bf16_f32 v83, v70, v71
    ds_write_b128 v15, v[80:83] offset:16896
    s_waitcnt lgkmcnt(1)
    v_add_f32 v72, v32, v56
    v_add_f32 v73, v33, v57
    v_add_f32 v74, v34, v58
    v_add_f32 v75, v35, v59
    v_add_f32 v76, v36, v60
    v_add_f32 v77, v37, v61
    v_add_f32 v78, v38, v62
    v_add_f32 v79, v39, v63
    v_exp_f32 v72, v72
    v_exp_f32 v73, v73
    v_exp_f32 v74, v74
    v_exp_f32 v75, v75
    v_exp_f32 v76, v76
    v_exp_f32 v77, v77
    v_exp_f32 v78, v78
    v_exp_f32 v79, v79
    v_add_f32 v72, 1.0, v72
    v_add_f32 v73, 1.0, v73
    v_add_f32 v74, 1.0, v74
    v_add_f32 v75, 1.0, v75
    v_add_f32 v76, 1.0, v76
    v_add_f32 v77, 1.0, v77
    v_add_f32 v78, 1.0, v78
    v_add_f32 v79, 1.0, v79
    v_rcp_f32 v72, v72
    v_rcp_f32 v73, v73
    v_rcp_f32 v74, v74
    v_rcp_f32 v75, v75
    v_rcp_f32 v76, v76
    v_rcp_f32 v77, v77
    v_rcp_f32 v78, v78
    v_rcp_f32 v79, v79
    v_fma_f32 v72, v72, -2.0, 1.0
    v_fma_f32 v73, v73, -2.0, 1.0
    v_fma_f32 v74, v74, -2.0, 1.0
    v_fma_f32 v75, v75, -2.0, 1.0
    v_fma_f32 v76, v76, -2.0, 1.0
    v_fma_f32 v77, v77, -2.0, 1.0
    v_fma_f32 v78, v78, -2.0, 1.0
    v_fma_f32 v79, v79, -2.0, 1.0
    v_cvt_pk_bf16_f32 v84, v72, v73
    v_cvt_pk_bf16_f32 v85, v74, v75
    v_cvt_pk_bf16_f32 v86, v76, v77
    v_cvt_pk_bf16_f32 v87, v78, v79
    ds_write_b128 v15, v[84:87] offset:25088
    ds_read_b128 v[48:51], v94 offset:1536
    ds_read_b128 v[52:55], v94 offset:1552
    ds_read_b128 v[56:59], v94 offset:3584
    ds_read_b128 v[60:63], v94 offset:3600
    s_waitcnt lgkmcnt(2)
    v_add_f32 v64, v40, v48
    v_add_f32 v65, v41, v49
    v_add_f32 v66, v42, v50
    v_add_f32 v67, v43, v51
    v_add_f32 v68, v44, v52
    v_add_f32 v69, v45, v53
    v_add_f32 v70, v46, v54
    v_add_f32 v71, v47, v55
    v_exp_f32 v64, v64
    v_exp_f32 v65, v65
    v_exp_f32 v66, v66
    v_exp_f32 v67, v67
    v_exp_f32 v68, v68
    v_exp_f32 v69, v69
    v_exp_f32 v70, v70
    v_exp_f32 v71, v71
    v_add_f32 v64, 1.0, v64
    v_add_f32 v65, 1.0, v65
    v_add_f32 v66, 1.0, v66
    v_add_f32 v67, 1.0, v67
    v_add_f32 v68, 1.0, v68
    v_add_f32 v69, 1.0, v69
    v_add_f32 v70, 1.0, v70
    v_add_f32 v71, 1.0, v71
    v_rcp_f32 v64, v64
    v_rcp_f32 v65, v65
    v_rcp_f32 v66, v66
    v_rcp_f32 v67, v67
    v_rcp_f32 v68, v68
    v_rcp_f32 v69, v69
    v_rcp_f32 v70, v70
    v_rcp_f32 v71, v71
    v_fma_f32 v64, v64, -2.0, 1.0
    v_fma_f32 v65, v65, -2.0, 1.0
    v_fma_f32 v66, v66, -2.0, 1.0
    v_fma_f32 v67, v67, -2.0, 1.0
    v_fma_f32 v68, v68, -2.0, 1.0
    v_fma_f32 v69, v69, -2.0, 1.0
    v_fma_f32 v70, v70, -2.0, 1.0
    v_fma_f32 v71, v71, -2.0, 1.0
    v_cvt_pk_bf16_f32 v80, v64, v65
    v_cvt_pk_bf16_f32 v81, v66, v67
    v_cvt_pk_bf16_f32 v82, v68, v69
    v_cvt_pk_bf16_f32 v83, v70, v71
    ds_write_b128 v15, v[80:83] offset:768
    ds_read_b128 v[48:51], v94 offset:5632
    ds_read_b128 v[52:55], v94 offset:5648
    s_waitcnt lgkmcnt(3)
    v_add_f32 v72, v40, v56
    v_add_f32 v73, v41, v57
    v_add_f32 v74, v42, v58
    v_add_f32 v75, v43, v59
    v_add_f32 v76, v44, v60
    v_add_f32 v77, v45, v61
    v_add_f32 v78, v46, v62
    v_add_f32 v79, v47, v63
    v_exp_f32 v72, v72
    v_exp_f32 v73, v73
    v_exp_f32 v74, v74
    v_exp_f32 v75, v75
    v_exp_f32 v76, v76
    v_exp_f32 v77, v77
    v_exp_f32 v78, v78
    v_exp_f32 v79, v79
    v_add_f32 v72, 1.0, v72
    v_add_f32 v73, 1.0, v73
    v_add_f32 v74, 1.0, v74
    v_add_f32 v75, 1.0, v75
    v_add_f32 v76, 1.0, v76
    v_add_f32 v77, 1.0, v77
    v_add_f32 v78, 1.0, v78
    v_add_f32 v79, 1.0, v79
    v_rcp_f32 v72, v72
    v_rcp_f32 v73, v73
    v_rcp_f32 v74, v74
    v_rcp_f32 v75, v75
    v_rcp_f32 v76, v76
    v_rcp_f32 v77, v77
    v_rcp_f32 v78, v78
    v_rcp_f32 v79, v79
    v_fma_f32 v72, v72, -2.0, 1.0
    v_fma_f32 v73, v73, -2.0, 1.0
    v_fma_f32 v74, v74, -2.0, 1.0
    v_fma_f32 v75, v75, -2.0, 1.0
    v_fma_f32 v76, v76, -2.0, 1.0
    v_fma_f32 v77, v77, -2.0, 1.0
    v_fma_f32 v78, v78, -2.0, 1.0
    v_fma_f32 v79, v79, -2.0, 1.0
    v_cvt_pk_bf16_f32 v84, v72, v73
    v_cvt_pk_bf16_f32 v85, v74, v75
    v_cvt_pk_bf16_f32 v86, v76, v77
    v_cvt_pk_bf16_f32 v87, v78, v79
    ds_write_b128 v15, v[84:87] offset:8960
    ds_read_b128 v[56:59], v94 offset:7680
    ds_read_b128 v[60:63], v94 offset:7696
    s_waitcnt lgkmcnt(3)
    v_add_f32 v64, v40, v48
    v_add_f32 v65, v41, v49
    v_add_f32 v66, v42, v50
    v_add_f32 v67, v43, v51
    v_add_f32 v68, v44, v52
    v_add_f32 v69, v45, v53
    v_add_f32 v70, v46, v54
    v_add_f32 v71, v47, v55
    v_exp_f32 v64, v64
    v_exp_f32 v65, v65
    v_exp_f32 v66, v66
    v_exp_f32 v67, v67
    v_exp_f32 v68, v68
    v_exp_f32 v69, v69
    v_exp_f32 v70, v70
    v_exp_f32 v71, v71
    v_add_f32 v64, 1.0, v64
    v_add_f32 v65, 1.0, v65
    v_add_f32 v66, 1.0, v66
    v_add_f32 v67, 1.0, v67
    v_add_f32 v68, 1.0, v68
    v_add_f32 v69, 1.0, v69
    v_add_f32 v70, 1.0, v70
    v_add_f32 v71, 1.0, v71
    v_rcp_f32 v64, v64
    v_rcp_f32 v65, v65
    v_rcp_f32 v66, v66
    v_rcp_f32 v67, v67
    v_rcp_f32 v68, v68
    v_rcp_f32 v69, v69
    v_rcp_f32 v70, v70
    v_rcp_f32 v71, v71
    v_fma_f32 v64, v64, -2.0, 1.0
    v_fma_f32 v65, v65, -2.0, 1.0
    v_fma_f32 v66, v66, -2.0, 1.0
    v_fma_f32 v67, v67, -2.0, 1.0
    v_fma_f32 v68, v68, -2.0, 1.0
    v_fma_f32 v69, v69, -2.0, 1.0
    v_fma_f32 v70, v70, -2.0, 1.0
    v_fma_f32 v71, v71, -2.0, 1.0
    v_cvt_pk_bf16_f32 v80, v64, v65
    v_cvt_pk_bf16_f32 v81, v66, v67
    v_cvt_pk_bf16_f32 v82, v68, v69
    v_cvt_pk_bf16_f32 v83, v70, v71
    ds_write_b128 v15, v[80:83] offset:17152
    s_waitcnt lgkmcnt(1)
    v_add_f32 v72, v40, v56
    v_add_f32 v73, v41, v57
    v_add_f32 v74, v42, v58
    v_add_f32 v75, v43, v59
    v_add_f32 v76, v44, v60
    v_add_f32 v77, v45, v61
    v_add_f32 v78, v46, v62
    v_add_f32 v79, v47, v63
    v_exp_f32 v72, v72
    v_exp_f32 v73, v73
    v_exp_f32 v74, v74
    v_exp_f32 v75, v75
    v_exp_f32 v76, v76
    v_exp_f32 v77, v77
    v_exp_f32 v78, v78
    v_exp_f32 v79, v79
    v_add_f32 v72, 1.0, v72
    v_add_f32 v73, 1.0, v73
    v_add_f32 v74, 1.0, v74
    v_add_f32 v75, 1.0, v75
    v_add_f32 v76, 1.0, v76
    v_add_f32 v77, 1.0, v77
    v_add_f32 v78, 1.0, v78
    v_add_f32 v79, 1.0, v79
    v_rcp_f32 v72, v72
    v_rcp_f32 v73, v73
    v_rcp_f32 v74, v74
    v_rcp_f32 v75, v75
    v_rcp_f32 v76, v76
    v_rcp_f32 v77, v77
    v_rcp_f32 v78, v78
    v_rcp_f32 v79, v79
    v_fma_f32 v72, v72, -2.0, 1.0
    v_fma_f32 v73, v73, -2.0, 1.0
    v_fma_f32 v74, v74, -2.0, 1.0
    v_fma_f32 v75, v75, -2.0, 1.0
    v_fma_f32 v76, v76, -2.0, 1.0
    v_fma_f32 v77, v77, -2.0, 1.0
    v_fma_f32 v78, v78, -2.0, 1.0
    v_fma_f32 v79, v79, -2.0, 1.0
    v_cvt_pk_bf16_f32 v84, v72, v73
    v_cvt_pk_bf16_f32 v85, v74, v75
    v_cvt_pk_bf16_f32 v86, v76, v77
    v_cvt_pk_bf16_f32 v87, v78, v79
    ds_write_b128 v15, v[84:87] offset:25344
    s_waitcnt lgkmcnt(0)
    s_barrier
    ds_read_b128 a[96:99], v8 offset:0
    ds_read_b128 a[100:103], v8 offset:16384
    ds_read_b128 a[104:107], v8 offset:32768
    ds_read_b128 a[108:111], v8 offset:49152
    s_waitcnt lgkmcnt(0)
    v_mfma_f32_16x16x32_bf16 v[128:131], a[0:3], a[96:99], 0
    s_add_u32 s25, s24, 65536
    s_add_u32 s31, s24, 69632
    v_mfma_f32_16x16x32_bf16 v[132:135], a[4:7], a[96:99], 0
    buffer_load_dwordx4 a[64:67], v12, s[8:11], s25 offen offset:0
    v_mfma_f32_16x16x32_bf16 v[136:139], a[8:11], a[96:99], 0
    v_mfma_f32_16x16x32_bf16 v[140:143], a[12:15], a[96:99], 0
    v_mfma_f32_16x16x32_bf16 v[144:147], a[16:19], a[96:99], 0
    buffer_load_dwordx4 a[68:71], v12, s[8:11], s25 offen offset:1024
    v_mfma_f32_16x16x32_bf16 v[148:151], a[20:23], a[96:99], 0
    ds_read_b128 a[112:115], v9 offset:0
    v_mfma_f32_16x16x32_bf16 v[152:155], a[24:27], a[96:99], 0
    v_mfma_f32_16x16x32_bf16 v[156:159], a[28:31], a[96:99], 0
    v_mfma_f32_16x16x32_bf16 v[188:191], a[28:31], a[100:103], 0
    buffer_load_dwordx4 a[72:75], v12, s[8:11], s25 offen offset:2048
    v_mfma_f32_16x16x32_bf16 v[184:187], a[24:27], a[100:103], 0
    v_mfma_f32_16x16x32_bf16 v[180:183], a[20:23], a[100:103], 0
    v_mfma_f32_16x16x32_bf16 v[176:179], a[16:19], a[100:103], 0
    v_mfma_f32_16x16x32_bf16 v[172:175], a[12:15], a[100:103], 0
    buffer_load_dwordx4 a[76:79], v12, s[8:11], s25 offen offset:3072
    v_mfma_f32_16x16x32_bf16 v[168:171], a[8:11], a[100:103], 0
    ds_read_b128 a[116:119], v9 offset:16384
    v_mfma_f32_16x16x32_bf16 v[164:167], a[4:7], a[100:103], 0
    v_mfma_f32_16x16x32_bf16 v[160:163], a[0:3], a[100:103], 0
    v_mfma_f32_16x16x32_bf16 v[192:195], a[0:3], a[104:107], 0
    buffer_load_dwordx4 a[80:83], v12, s[8:11], s31 offen offset:0
    v_mfma_f32_16x16x32_bf16 v[196:199], a[4:7], a[104:107], 0
    v_mfma_f32_16x16x32_bf16 v[200:203], a[8:11], a[104:107], 0
    v_mfma_f32_16x16x32_bf16 v[204:207], a[12:15], a[104:107], 0
    v_mfma_f32_16x16x32_bf16 v[208:211], a[16:19], a[104:107], 0
    buffer_load_dwordx4 a[84:87], v12, s[8:11], s31 offen offset:1024
    v_mfma_f32_16x16x32_bf16 v[212:215], a[20:23], a[104:107], 0
    ds_read_b128 a[120:123], v9 offset:32768
    v_mfma_f32_16x16x32_bf16 v[216:219], a[24:27], a[104:107], 0
    v_mfma_f32_16x16x32_bf16 v[220:223], a[28:31], a[104:107], 0
    v_mfma_f32_16x16x32_bf16 v[252:255], a[28:31], a[108:111], 0
    buffer_load_dwordx4 a[88:91], v12, s[8:11], s31 offen offset:2048
    v_mfma_f32_16x16x32_bf16 v[248:251], a[24:27], a[108:111], 0
    v_mfma_f32_16x16x32_bf16 v[244:247], a[20:23], a[108:111], 0
    v_mfma_f32_16x16x32_bf16 v[240:243], a[16:19], a[108:111], 0
    v_mfma_f32_16x16x32_bf16 v[236:239], a[12:15], a[108:111], 0
    buffer_load_dwordx4 a[92:95], v12, s[8:11], s31 offen offset:3072
    v_mfma_f32_16x16x32_bf16 v[232:235], a[8:11], a[108:111], 0
    ds_read_b128 a[124:127], v9 offset:49152
    v_mfma_f32_16x16x32_bf16 v[228:231], a[4:7], a[108:111], 0
    v_mfma_f32_16x16x32_bf16 v[224:227], a[0:3], a[108:111], 0
    s_waitcnt lgkmcnt(0)
    v_mfma_f32_16x16x32_bf16 v[128:131], a[32:35], a[112:115], v[128:131]
    s_add_u32 s25, s24, 98304
    s_add_u32 s31, s24, 102400
    v_mfma_f32_16x16x32_bf16 v[132:135], a[36:39], a[112:115], v[132:135]
    buffer_load_dwordx4 a[0:3], v12, s[8:11], s25 offen offset:0
    v_mfma_f32_16x16x32_bf16 v[136:139], a[40:43], a[112:115], v[136:139]
    v_mfma_f32_16x16x32_bf16 v[140:143], a[44:47], a[112:115], v[140:143]
    v_mfma_f32_16x16x32_bf16 v[144:147], a[48:51], a[112:115], v[144:147]
    buffer_load_dwordx4 a[4:7], v12, s[8:11], s25 offen offset:1024
    v_mfma_f32_16x16x32_bf16 v[148:151], a[52:55], a[112:115], v[148:151]
    ds_read_b128 a[96:99], v10 offset:0
    v_mfma_f32_16x16x32_bf16 v[152:155], a[56:59], a[112:115], v[152:155]
    v_mfma_f32_16x16x32_bf16 v[156:159], a[60:63], a[112:115], v[156:159]
    v_mfma_f32_16x16x32_bf16 v[188:191], a[60:63], a[116:119], v[188:191]
    buffer_load_dwordx4 a[8:11], v12, s[8:11], s25 offen offset:2048
    v_mfma_f32_16x16x32_bf16 v[184:187], a[56:59], a[116:119], v[184:187]
    v_mfma_f32_16x16x32_bf16 v[180:183], a[52:55], a[116:119], v[180:183]
    v_mfma_f32_16x16x32_bf16 v[176:179], a[48:51], a[116:119], v[176:179]
    v_mfma_f32_16x16x32_bf16 v[172:175], a[44:47], a[116:119], v[172:175]
    buffer_load_dwordx4 a[12:15], v12, s[8:11], s25 offen offset:3072
    v_mfma_f32_16x16x32_bf16 v[168:171], a[40:43], a[116:119], v[168:171]
    ds_read_b128 a[100:103], v10 offset:16384
    v_mfma_f32_16x16x32_bf16 v[164:167], a[36:39], a[116:119], v[164:167]
    v_mfma_f32_16x16x32_bf16 v[160:163], a[32:35], a[116:119], v[160:163]
    v_mfma_f32_16x16x32_bf16 v[192:195], a[32:35], a[120:123], v[192:195]
    buffer_load_dwordx4 a[16:19], v12, s[8:11], s31 offen offset:0
    v_mfma_f32_16x16x32_bf16 v[196:199], a[36:39], a[120:123], v[196:199]
    v_mfma_f32_16x16x32_bf16 v[200:203], a[40:43], a[120:123], v[200:203]
    v_mfma_f32_16x16x32_bf16 v[204:207], a[44:47], a[120:123], v[204:207]
    v_mfma_f32_16x16x32_bf16 v[208:211], a[48:51], a[120:123], v[208:211]
    buffer_load_dwordx4 a[20:23], v12, s[8:11], s31 offen offset:1024
    v_mfma_f32_16x16x32_bf16 v[212:215], a[52:55], a[120:123], v[212:215]
    ds_read_b128 a[104:107], v10 offset:32768
    v_mfma_f32_16x16x32_bf16 v[216:219], a[56:59], a[120:123], v[216:219]
    v_mfma_f32_16x16x32_bf16 v[220:223], a[60:63], a[120:123], v[220:223]
    v_mfma_f32_16x16x32_bf16 v[252:255], a[60:63], a[124:127], v[252:255]
    buffer_load_dwordx4 a[24:27], v12, s[8:11], s31 offen offset:2048
    v_mfma_f32_16x16x32_bf16 v[248:251], a[56:59], a[124:127], v[248:251]
    v_mfma_f32_16x16x32_bf16 v[244:247], a[52:55], a[124:127], v[244:247]
    v_mfma_f32_16x16x32_bf16 v[240:243], a[48:51], a[124:127], v[240:243]
    v_mfma_f32_16x16x32_bf16 v[236:239], a[44:47], a[124:127], v[236:239]
    buffer_load_dwordx4 a[28:31], v12, s[8:11], s31 offen offset:3072
    v_mfma_f32_16x16x32_bf16 v[232:235], a[40:43], a[124:127], v[232:235]
    ds_read_b128 a[108:111], v10 offset:49152
    v_mfma_f32_16x16x32_bf16 v[228:231], a[36:39], a[124:127], v[228:231]
    v_mfma_f32_16x16x32_bf16 v[224:227], a[32:35], a[124:127], v[224:227]
    s_waitcnt vmcnt(8) lgkmcnt(0)
    v_mfma_f32_16x16x32_bf16 v[128:131], a[64:67], a[96:99], v[128:131]
    s_add_u32 s25, s24, 131072
    s_add_u32 s31, s24, 135168
    v_mfma_f32_16x16x32_bf16 v[132:135], a[68:71], a[96:99], v[132:135]
    buffer_load_dwordx4 a[32:35], v12, s[8:11], s25 offen offset:0
    v_mfma_f32_16x16x32_bf16 v[136:139], a[72:75], a[96:99], v[136:139]
    v_mfma_f32_16x16x32_bf16 v[140:143], a[76:79], a[96:99], v[140:143]
    v_mfma_f32_16x16x32_bf16 v[144:147], a[80:83], a[96:99], v[144:147]
    buffer_load_dwordx4 a[36:39], v12, s[8:11], s25 offen offset:1024
    v_mfma_f32_16x16x32_bf16 v[148:151], a[84:87], a[96:99], v[148:151]
    ds_read_b128 a[112:115], v11 offset:0
    v_mfma_f32_16x16x32_bf16 v[152:155], a[88:91], a[96:99], v[152:155]
    v_mfma_f32_16x16x32_bf16 v[156:159], a[92:95], a[96:99], v[156:159]
    v_mfma_f32_16x16x32_bf16 v[188:191], a[92:95], a[100:103], v[188:191]
    buffer_load_dwordx4 a[40:43], v12, s[8:11], s25 offen offset:2048
    v_mfma_f32_16x16x32_bf16 v[184:187], a[88:91], a[100:103], v[184:187]
    v_mfma_f32_16x16x32_bf16 v[180:183], a[84:87], a[100:103], v[180:183]
    v_mfma_f32_16x16x32_bf16 v[176:179], a[80:83], a[100:103], v[176:179]
    v_mfma_f32_16x16x32_bf16 v[172:175], a[76:79], a[100:103], v[172:175]
    buffer_load_dwordx4 a[44:47], v12, s[8:11], s25 offen offset:3072
    v_mfma_f32_16x16x32_bf16 v[168:171], a[72:75], a[100:103], v[168:171]
    ds_read_b128 a[116:119], v11 offset:16384
    v_mfma_f32_16x16x32_bf16 v[164:167], a[68:71], a[100:103], v[164:167]
    v_mfma_f32_16x16x32_bf16 v[160:163], a[64:67], a[100:103], v[160:163]
    v_mfma_f32_16x16x32_bf16 v[192:195], a[64:67], a[104:107], v[192:195]
    buffer_load_dwordx4 a[48:51], v12, s[8:11], s31 offen offset:0
    v_mfma_f32_16x16x32_bf16 v[196:199], a[68:71], a[104:107], v[196:199]
    v_mfma_f32_16x16x32_bf16 v[200:203], a[72:75], a[104:107], v[200:203]
    v_mfma_f32_16x16x32_bf16 v[204:207], a[76:79], a[104:107], v[204:207]
    v_mfma_f32_16x16x32_bf16 v[208:211], a[80:83], a[104:107], v[208:211]
    buffer_load_dwordx4 a[52:55], v12, s[8:11], s31 offen offset:1024
    v_mfma_f32_16x16x32_bf16 v[212:215], a[84:87], a[104:107], v[212:215]
    ds_read_b128 a[120:123], v11 offset:32768
    v_mfma_f32_16x16x32_bf16 v[216:219], a[88:91], a[104:107], v[216:219]
    v_mfma_f32_16x16x32_bf16 v[220:223], a[92:95], a[104:107], v[220:223]
    v_mfma_f32_16x16x32_bf16 v[252:255], a[92:95], a[108:111], v[252:255]
    buffer_load_dwordx4 a[56:59], v12, s[8:11], s31 offen offset:2048
    v_mfma_f32_16x16x32_bf16 v[248:251], a[88:91], a[108:111], v[248:251]
    v_mfma_f32_16x16x32_bf16 v[244:247], a[84:87], a[108:111], v[244:247]
    v_mfma_f32_16x16x32_bf16 v[240:243], a[80:83], a[108:111], v[240:243]
    v_mfma_f32_16x16x32_bf16 v[236:239], a[76:79], a[108:111], v[236:239]
    buffer_load_dwordx4 a[60:63], v12, s[8:11], s31 offen offset:3072
    v_mfma_f32_16x16x32_bf16 v[232:235], a[72:75], a[108:111], v[232:235]
    ds_read_b128 a[124:127], v11 offset:49152
    v_mfma_f32_16x16x32_bf16 v[228:231], a[68:71], a[108:111], v[228:231]
    v_mfma_f32_16x16x32_bf16 v[224:227], a[64:67], a[108:111], v[224:227]
    s_waitcnt vmcnt(8) lgkmcnt(0)
    v_mfma_f32_16x16x32_bf16 v[128:131], a[0:3], a[112:115], v[128:131]
    s_add_u32 s25, s24, 163840
    s_add_u32 s31, s24, 167936
    v_mfma_f32_16x16x32_bf16 v[132:135], a[4:7], a[112:115], v[132:135]
    buffer_load_dwordx4 a[64:67], v12, s[8:11], s25 offen offset:0
    v_mfma_f32_16x16x32_bf16 v[136:139], a[8:11], a[112:115], v[136:139]
    v_mfma_f32_16x16x32_bf16 v[140:143], a[12:15], a[112:115], v[140:143]
    v_mfma_f32_16x16x32_bf16 v[144:147], a[16:19], a[112:115], v[144:147]
    buffer_load_dwordx4 a[68:71], v12, s[8:11], s25 offen offset:1024
    v_mfma_f32_16x16x32_bf16 v[148:151], a[20:23], a[112:115], v[148:151]
    ds_read_b128 a[96:99], v8 offset:256
    v_mfma_f32_16x16x32_bf16 v[152:155], a[24:27], a[112:115], v[152:155]
    v_mfma_f32_16x16x32_bf16 v[156:159], a[28:31], a[112:115], v[156:159]
    v_mfma_f32_16x16x32_bf16 v[188:191], a[28:31], a[116:119], v[188:191]
    buffer_load_dwordx4 a[72:75], v12, s[8:11], s25 offen offset:2048
    v_mfma_f32_16x16x32_bf16 v[184:187], a[24:27], a[116:119], v[184:187]
    v_mfma_f32_16x16x32_bf16 v[180:183], a[20:23], a[116:119], v[180:183]
    v_mfma_f32_16x16x32_bf16 v[176:179], a[16:19], a[116:119], v[176:179]
    v_mfma_f32_16x16x32_bf16 v[172:175], a[12:15], a[116:119], v[172:175]
    buffer_load_dwordx4 a[76:79], v12, s[8:11], s25 offen offset:3072
    v_mfma_f32_16x16x32_bf16 v[168:171], a[8:11], a[116:119], v[168:171]
    ds_read_b128 a[100:103], v8 offset:16640
    v_mfma_f32_16x16x32_bf16 v[164:167], a[4:7], a[116:119], v[164:167]
    v_mfma_f32_16x16x32_bf16 v[160:163], a[0:3], a[116:119], v[160:163]
    v_mfma_f32_16x16x32_bf16 v[192:195], a[0:3], a[120:123], v[192:195]
    buffer_load_dwordx4 a[80:83], v12, s[8:11], s31 offen offset:0
    v_mfma_f32_16x16x32_bf16 v[196:199], a[4:7], a[120:123], v[196:199]
    v_mfma_f32_16x16x32_bf16 v[200:203], a[8:11], a[120:123], v[200:203]
    v_mfma_f32_16x16x32_bf16 v[204:207], a[12:15], a[120:123], v[204:207]
    v_mfma_f32_16x16x32_bf16 v[208:211], a[16:19], a[120:123], v[208:211]
    buffer_load_dwordx4 a[84:87], v12, s[8:11], s31 offen offset:1024
    v_mfma_f32_16x16x32_bf16 v[212:215], a[20:23], a[120:123], v[212:215]
    ds_read_b128 a[104:107], v8 offset:33024
    v_mfma_f32_16x16x32_bf16 v[216:219], a[24:27], a[120:123], v[216:219]
    v_mfma_f32_16x16x32_bf16 v[220:223], a[28:31], a[120:123], v[220:223]
    v_mfma_f32_16x16x32_bf16 v[252:255], a[28:31], a[124:127], v[252:255]
    buffer_load_dwordx4 a[88:91], v12, s[8:11], s31 offen offset:2048
    v_mfma_f32_16x16x32_bf16 v[248:251], a[24:27], a[124:127], v[248:251]
    v_mfma_f32_16x16x32_bf16 v[244:247], a[20:23], a[124:127], v[244:247]
    v_mfma_f32_16x16x32_bf16 v[240:243], a[16:19], a[124:127], v[240:243]
    v_mfma_f32_16x16x32_bf16 v[236:239], a[12:15], a[124:127], v[236:239]
    buffer_load_dwordx4 a[92:95], v12, s[8:11], s31 offen offset:3072
    v_mfma_f32_16x16x32_bf16 v[232:235], a[8:11], a[124:127], v[232:235]
    ds_read_b128 a[108:111], v8 offset:49408
    v_mfma_f32_16x16x32_bf16 v[228:231], a[4:7], a[124:127], v[228:231]
    v_mfma_f32_16x16x32_bf16 v[224:227], a[0:3], a[124:127], v[224:227]
    s_waitcnt vmcnt(8) lgkmcnt(0)
    v_mfma_f32_16x16x32_bf16 v[128:131], a[32:35], a[96:99], v[128:131]
    s_add_u32 s25, s24, 196608
    s_add_u32 s31, s24, 200704
    v_mfma_f32_16x16x32_bf16 v[132:135], a[36:39], a[96:99], v[132:135]
    buffer_load_dwordx4 a[0:3], v12, s[8:11], s25 offen offset:0
    v_mfma_f32_16x16x32_bf16 v[136:139], a[40:43], a[96:99], v[136:139]
    v_mfma_f32_16x16x32_bf16 v[140:143], a[44:47], a[96:99], v[140:143]
    v_mfma_f32_16x16x32_bf16 v[144:147], a[48:51], a[96:99], v[144:147]
    buffer_load_dwordx4 a[4:7], v12, s[8:11], s25 offen offset:1024
    v_mfma_f32_16x16x32_bf16 v[148:151], a[52:55], a[96:99], v[148:151]
    ds_read_b128 a[112:115], v9 offset:256
    v_mfma_f32_16x16x32_bf16 v[152:155], a[56:59], a[96:99], v[152:155]
    v_mfma_f32_16x16x32_bf16 v[156:159], a[60:63], a[96:99], v[156:159]
    v_mfma_f32_16x16x32_bf16 v[188:191], a[60:63], a[100:103], v[188:191]
    buffer_load_dwordx4 a[8:11], v12, s[8:11], s25 offen offset:2048
    v_mfma_f32_16x16x32_bf16 v[184:187], a[56:59], a[100:103], v[184:187]
    v_mfma_f32_16x16x32_bf16 v[180:183], a[52:55], a[100:103], v[180:183]
    v_mfma_f32_16x16x32_bf16 v[176:179], a[48:51], a[100:103], v[176:179]
    v_mfma_f32_16x16x32_bf16 v[172:175], a[44:47], a[100:103], v[172:175]
    buffer_load_dwordx4 a[12:15], v12, s[8:11], s25 offen offset:3072
    v_mfma_f32_16x16x32_bf16 v[168:171], a[40:43], a[100:103], v[168:171]
    ds_read_b128 a[116:119], v9 offset:16640
    v_mfma_f32_16x16x32_bf16 v[164:167], a[36:39], a[100:103], v[164:167]
    v_mfma_f32_16x16x32_bf16 v[160:163], a[32:35], a[100:103], v[160:163]
    v_mfma_f32_16x16x32_bf16 v[192:195], a[32:35], a[104:107], v[192:195]
    buffer_load_dwordx4 a[16:19], v12, s[8:11], s31 offen offset:0
    v_mfma_f32_16x16x32_bf16 v[196:199], a[36:39], a[104:107], v[196:199]
    v_mfma_f32_16x16x32_bf16 v[200:203], a[40:43], a[104:107], v[200:203]
    v_mfma_f32_16x16x32_bf16 v[204:207], a[44:47], a[104:107], v[204:207]
    v_mfma_f32_16x16x32_bf16 v[208:211], a[48:51], a[104:107], v[208:211]
    buffer_load_dwordx4 a[20:23], v12, s[8:11], s31 offen offset:1024
    v_mfma_f32_16x16x32_bf16 v[212:215], a[52:55], a[104:107], v[212:215]
    ds_read_b128 a[120:123], v9 offset:33024
    v_mfma_f32_16x16x32_bf16 v[216:219], a[56:59], a[104:107], v[216:219]
    v_mfma_f32_16x16x32_bf16 v[220:223], a[60:63], a[104:107], v[220:223]
    v_mfma_f32_16x16x32_bf16 v[252:255], a[60:63], a[108:111], v[252:255]
    buffer_load_dwordx4 a[24:27], v12, s[8:11], s31 offen offset:2048
    v_mfma_f32_16x16x32_bf16 v[248:251], a[56:59], a[108:111], v[248:251]
    v_mfma_f32_16x16x32_bf16 v[244:247], a[52:55], a[108:111], v[244:247]
    v_mfma_f32_16x16x32_bf16 v[240:243], a[48:51], a[108:111], v[240:243]
    v_mfma_f32_16x16x32_bf16 v[236:239], a[44:47], a[108:111], v[236:239]
    buffer_load_dwordx4 a[28:31], v12, s[8:11], s31 offen offset:3072
    v_mfma_f32_16x16x32_bf16 v[232:235], a[40:43], a[108:111], v[232:235]
    ds_read_b128 a[124:127], v9 offset:49408
    v_mfma_f32_16x16x32_bf16 v[228:231], a[36:39], a[108:111], v[228:231]
    v_mfma_f32_16x16x32_bf16 v[224:227], a[32:35], a[108:111], v[224:227]
    s_waitcnt vmcnt(8) lgkmcnt(0)
    v_mfma_f32_16x16x32_bf16 v[128:131], a[64:67], a[112:115], v[128:131]
    s_add_u32 s25, s24, 229376
    s_add_u32 s31, s24, 233472
    v_mfma_f32_16x16x32_bf16 v[132:135], a[68:71], a[112:115], v[132:135]
    buffer_load_dwordx4 a[32:35], v12, s[8:11], s25 offen offset:0
    v_mfma_f32_16x16x32_bf16 v[136:139], a[72:75], a[112:115], v[136:139]
    v_mfma_f32_16x16x32_bf16 v[140:143], a[76:79], a[112:115], v[140:143]
    v_mfma_f32_16x16x32_bf16 v[144:147], a[80:83], a[112:115], v[144:147]
    buffer_load_dwordx4 a[36:39], v12, s[8:11], s25 offen offset:1024
    v_mfma_f32_16x16x32_bf16 v[148:151], a[84:87], a[112:115], v[148:151]
    ds_read_b128 a[96:99], v10 offset:256
    v_mfma_f32_16x16x32_bf16 v[152:155], a[88:91], a[112:115], v[152:155]
    v_mfma_f32_16x16x32_bf16 v[156:159], a[92:95], a[112:115], v[156:159]
    v_mfma_f32_16x16x32_bf16 v[188:191], a[92:95], a[116:119], v[188:191]
    buffer_load_dwordx4 a[40:43], v12, s[8:11], s25 offen offset:2048
    v_mfma_f32_16x16x32_bf16 v[184:187], a[88:91], a[116:119], v[184:187]
    v_mfma_f32_16x16x32_bf16 v[180:183], a[84:87], a[116:119], v[180:183]
    v_mfma_f32_16x16x32_bf16 v[176:179], a[80:83], a[116:119], v[176:179]
    v_mfma_f32_16x16x32_bf16 v[172:175], a[76:79], a[116:119], v[172:175]
    buffer_load_dwordx4 a[44:47], v12, s[8:11], s25 offen offset:3072
    v_mfma_f32_16x16x32_bf16 v[168:171], a[72:75], a[116:119], v[168:171]
    ds_read_b128 a[100:103], v10 offset:16640
    v_mfma_f32_16x16x32_bf16 v[164:167], a[68:71], a[116:119], v[164:167]
    v_mfma_f32_16x16x32_bf16 v[160:163], a[64:67], a[116:119], v[160:163]
    v_mfma_f32_16x16x32_bf16 v[192:195], a[64:67], a[120:123], v[192:195]
    buffer_load_dwordx4 a[48:51], v12, s[8:11], s31 offen offset:0
    v_mfma_f32_16x16x32_bf16 v[196:199], a[68:71], a[120:123], v[196:199]
    v_mfma_f32_16x16x32_bf16 v[200:203], a[72:75], a[120:123], v[200:203]
    v_mfma_f32_16x16x32_bf16 v[204:207], a[76:79], a[120:123], v[204:207]
    v_mfma_f32_16x16x32_bf16 v[208:211], a[80:83], a[120:123], v[208:211]
    buffer_load_dwordx4 a[52:55], v12, s[8:11], s31 offen offset:1024
    v_mfma_f32_16x16x32_bf16 v[212:215], a[84:87], a[120:123], v[212:215]
    ds_read_b128 a[104:107], v10 offset:33024
    v_mfma_f32_16x16x32_bf16 v[216:219], a[88:91], a[120:123], v[216:219]
    v_mfma_f32_16x16x32_bf16 v[220:223], a[92:95], a[120:123], v[220:223]
    v_mfma_f32_16x16x32_bf16 v[252:255], a[92:95], a[124:127], v[252:255]
    buffer_load_dwordx4 a[56:59], v12, s[8:11], s31 offen offset:2048
    v_mfma_f32_16x16x32_bf16 v[248:251], a[88:91], a[124:127], v[248:251]
    v_mfma_f32_16x16x32_bf16 v[244:247], a[84:87], a[124:127], v[244:247]
    v_mfma_f32_16x16x32_bf16 v[240:243], a[80:83], a[124:127], v[240:243]
    v_mfma_f32_16x16x32_bf16 v[236:239], a[76:79], a[124:127], v[236:239]
    buffer_load_dwordx4 a[60:63], v12, s[8:11], s31 offen offset:3072
    v_mfma_f32_16x16x32_bf16 v[232:235], a[72:75], a[124:127], v[232:235]
    ds_read_b128 a[108:111], v10 offset:49408
    v_mfma_f32_16x16x32_bf16 v[228:231], a[68:71], a[124:127], v[228:231]
    v_mfma_f32_16x16x32_bf16 v[224:227], a[64:67], a[124:127], v[224:227]
    s_waitcnt vmcnt(8) lgkmcnt(0)
    v_mfma_f32_16x16x32_bf16 v[128:131], a[0:3], a[96:99], v[128:131]
    s_add_u32 s25, s24, 262144
    s_add_u32 s31, s24, 266240
    v_mfma_f32_16x16x32_bf16 v[132:135], a[4:7], a[96:99], v[132:135]
    buffer_load_dwordx4 a[64:67], v12, s[8:11], s25 offen offset:0
    v_mfma_f32_16x16x32_bf16 v[136:139], a[8:11], a[96:99], v[136:139]
    v_mfma_f32_16x16x32_bf16 v[140:143], a[12:15], a[96:99], v[140:143]
    v_mfma_f32_16x16x32_bf16 v[144:147], a[16:19], a[96:99], v[144:147]
    buffer_load_dwordx4 a[68:71], v12, s[8:11], s25 offen offset:1024
    v_mfma_f32_16x16x32_bf16 v[148:151], a[20:23], a[96:99], v[148:151]
    ds_read_b128 a[112:115], v11 offset:256
    v_mfma_f32_16x16x32_bf16 v[152:155], a[24:27], a[96:99], v[152:155]
    v_mfma_f32_16x16x32_bf16 v[156:159], a[28:31], a[96:99], v[156:159]
    v_mfma_f32_16x16x32_bf16 v[188:191], a[28:31], a[100:103], v[188:191]
    buffer_load_dwordx4 a[72:75], v12, s[8:11], s25 offen offset:2048
    v_mfma_f32_16x16x32_bf16 v[184:187], a[24:27], a[100:103], v[184:187]
    v_mfma_f32_16x16x32_bf16 v[180:183], a[20:23], a[100:103], v[180:183]
    v_mfma_f32_16x16x32_bf16 v[176:179], a[16:19], a[100:103], v[176:179]
    v_mfma_f32_16x16x32_bf16 v[172:175], a[12:15], a[100:103], v[172:175]
    buffer_load_dwordx4 a[76:79], v12, s[8:11], s25 offen offset:3072
    v_mfma_f32_16x16x32_bf16 v[168:171], a[8:11], a[100:103], v[168:171]
    ds_read_b128 a[116:119], v11 offset:16640
    v_mfma_f32_16x16x32_bf16 v[164:167], a[4:7], a[100:103], v[164:167]
    v_mfma_f32_16x16x32_bf16 v[160:163], a[0:3], a[100:103], v[160:163]
    v_mfma_f32_16x16x32_bf16 v[192:195], a[0:3], a[104:107], v[192:195]
    buffer_load_dwordx4 a[80:83], v12, s[8:11], s31 offen offset:0
    v_mfma_f32_16x16x32_bf16 v[196:199], a[4:7], a[104:107], v[196:199]
    v_mfma_f32_16x16x32_bf16 v[200:203], a[8:11], a[104:107], v[200:203]
    v_mfma_f32_16x16x32_bf16 v[204:207], a[12:15], a[104:107], v[204:207]
    v_mfma_f32_16x16x32_bf16 v[208:211], a[16:19], a[104:107], v[208:211]
    buffer_load_dwordx4 a[84:87], v12, s[8:11], s31 offen offset:1024
    v_mfma_f32_16x16x32_bf16 v[212:215], a[20:23], a[104:107], v[212:215]
    ds_read_b128 a[120:123], v11 offset:33024
    v_mfma_f32_16x16x32_bf16 v[216:219], a[24:27], a[104:107], v[216:219]
    v_mfma_f32_16x16x32_bf16 v[220:223], a[28:31], a[104:107], v[220:223]
    v_mfma_f32_16x16x32_bf16 v[252:255], a[28:31], a[108:111], v[252:255]
    buffer_load_dwordx4 a[88:91], v12, s[8:11], s31 offen offset:2048
    v_mfma_f32_16x16x32_bf16 v[248:251], a[24:27], a[108:111], v[248:251]
    v_mfma_f32_16x16x32_bf16 v[244:247], a[20:23], a[108:111], v[244:247]
    v_mfma_f32_16x16x32_bf16 v[240:243], a[16:19], a[108:111], v[240:243]
    v_mfma_f32_16x16x32_bf16 v[236:239], a[12:15], a[108:111], v[236:239]
    buffer_load_dwordx4 a[92:95], v12, s[8:11], s31 offen offset:3072
    v_mfma_f32_16x16x32_bf16 v[232:235], a[8:11], a[108:111], v[232:235]
    ds_read_b128 a[124:127], v11 offset:49408
    v_mfma_f32_16x16x32_bf16 v[228:231], a[4:7], a[108:111], v[228:231]
    v_mfma_f32_16x16x32_bf16 v[224:227], a[0:3], a[108:111], v[224:227]
    s_waitcnt vmcnt(8) lgkmcnt(0)
    v_mfma_f32_16x16x32_bf16 v[128:131], a[32:35], a[112:115], v[128:131]
    s_add_u32 s25, s24, 294912
    s_add_u32 s31, s24, 299008
    v_mfma_f32_16x16x32_bf16 v[132:135], a[36:39], a[112:115], v[132:135]
    buffer_load_dwordx4 a[0:3], v12, s[8:11], s25 offen offset:0
    v_mfma_f32_16x16x32_bf16 v[136:139], a[40:43], a[112:115], v[136:139]
    v_mfma_f32_16x16x32_bf16 v[140:143], a[44:47], a[112:115], v[140:143]
    v_mfma_f32_16x16x32_bf16 v[144:147], a[48:51], a[112:115], v[144:147]
    buffer_load_dwordx4 a[4:7], v12, s[8:11], s25 offen offset:1024
    v_mfma_f32_16x16x32_bf16 v[148:151], a[52:55], a[112:115], v[148:151]
    ds_read_b128 a[96:99], v8 offset:512
    v_mfma_f32_16x16x32_bf16 v[152:155], a[56:59], a[112:115], v[152:155]
    v_mfma_f32_16x16x32_bf16 v[156:159], a[60:63], a[112:115], v[156:159]
    v_mfma_f32_16x16x32_bf16 v[188:191], a[60:63], a[116:119], v[188:191]
    buffer_load_dwordx4 a[8:11], v12, s[8:11], s25 offen offset:2048
    v_mfma_f32_16x16x32_bf16 v[184:187], a[56:59], a[116:119], v[184:187]
    v_mfma_f32_16x16x32_bf16 v[180:183], a[52:55], a[116:119], v[180:183]
    v_mfma_f32_16x16x32_bf16 v[176:179], a[48:51], a[116:119], v[176:179]
    v_mfma_f32_16x16x32_bf16 v[172:175], a[44:47], a[116:119], v[172:175]
    buffer_load_dwordx4 a[12:15], v12, s[8:11], s25 offen offset:3072
    v_mfma_f32_16x16x32_bf16 v[168:171], a[40:43], a[116:119], v[168:171]
    ds_read_b128 a[100:103], v8 offset:16896
    v_mfma_f32_16x16x32_bf16 v[164:167], a[36:39], a[116:119], v[164:167]
    v_mfma_f32_16x16x32_bf16 v[160:163], a[32:35], a[116:119], v[160:163]
    v_mfma_f32_16x16x32_bf16 v[192:195], a[32:35], a[120:123], v[192:195]
    buffer_load_dwordx4 a[16:19], v12, s[8:11], s31 offen offset:0
    v_mfma_f32_16x16x32_bf16 v[196:199], a[36:39], a[120:123], v[196:199]
    v_mfma_f32_16x16x32_bf16 v[200:203], a[40:43], a[120:123], v[200:203]
    v_mfma_f32_16x16x32_bf16 v[204:207], a[44:47], a[120:123], v[204:207]
    v_mfma_f32_16x16x32_bf16 v[208:211], a[48:51], a[120:123], v[208:211]
    buffer_load_dwordx4 a[20:23], v12, s[8:11], s31 offen offset:1024
    v_mfma_f32_16x16x32_bf16 v[212:215], a[52:55], a[120:123], v[212:215]
    ds_read_b128 a[104:107], v8 offset:33280
    v_mfma_f32_16x16x32_bf16 v[216:219], a[56:59], a[120:123], v[216:219]
    v_mfma_f32_16x16x32_bf16 v[220:223], a[60:63], a[120:123], v[220:223]
    v_mfma_f32_16x16x32_bf16 v[252:255], a[60:63], a[124:127], v[252:255]
    buffer_load_dwordx4 a[24:27], v12, s[8:11], s31 offen offset:2048
    v_mfma_f32_16x16x32_bf16 v[248:251], a[56:59], a[124:127], v[248:251]
    v_mfma_f32_16x16x32_bf16 v[244:247], a[52:55], a[124:127], v[244:247]
    v_mfma_f32_16x16x32_bf16 v[240:243], a[48:51], a[124:127], v[240:243]
    v_mfma_f32_16x16x32_bf16 v[236:239], a[44:47], a[124:127], v[236:239]
    buffer_load_dwordx4 a[28:31], v12, s[8:11], s31 offen offset:3072
    v_mfma_f32_16x16x32_bf16 v[232:235], a[40:43], a[124:127], v[232:235]
    ds_read_b128 a[108:111], v8 offset:49664
    v_mfma_f32_16x16x32_bf16 v[228:231], a[36:39], a[124:127], v[228:231]
    v_mfma_f32_16x16x32_bf16 v[224:227], a[32:35], a[124:127], v[224:227]
    s_waitcnt vmcnt(8) lgkmcnt(0)
    v_mfma_f32_16x16x32_bf16 v[128:131], a[64:67], a[96:99], v[128:131]
    s_add_u32 s25, s24, 327680
    s_add_u32 s31, s24, 331776
    v_mfma_f32_16x16x32_bf16 v[132:135], a[68:71], a[96:99], v[132:135]
    buffer_load_dwordx4 a[32:35], v12, s[8:11], s25 offen offset:0
    v_mfma_f32_16x16x32_bf16 v[136:139], a[72:75], a[96:99], v[136:139]
    v_mfma_f32_16x16x32_bf16 v[140:143], a[76:79], a[96:99], v[140:143]
    v_mfma_f32_16x16x32_bf16 v[144:147], a[80:83], a[96:99], v[144:147]
    buffer_load_dwordx4 a[36:39], v12, s[8:11], s25 offen offset:1024
    v_mfma_f32_16x16x32_bf16 v[148:151], a[84:87], a[96:99], v[148:151]
    ds_read_b128 a[112:115], v9 offset:512
    v_mfma_f32_16x16x32_bf16 v[152:155], a[88:91], a[96:99], v[152:155]
    v_mfma_f32_16x16x32_bf16 v[156:159], a[92:95], a[96:99], v[156:159]
    v_mfma_f32_16x16x32_bf16 v[188:191], a[92:95], a[100:103], v[188:191]
    buffer_load_dwordx4 a[40:43], v12, s[8:11], s25 offen offset:2048
    v_mfma_f32_16x16x32_bf16 v[184:187], a[88:91], a[100:103], v[184:187]
    v_mfma_f32_16x16x32_bf16 v[180:183], a[84:87], a[100:103], v[180:183]
    v_mfma_f32_16x16x32_bf16 v[176:179], a[80:83], a[100:103], v[176:179]
    v_mfma_f32_16x16x32_bf16 v[172:175], a[76:79], a[100:103], v[172:175]
    buffer_load_dwordx4 a[44:47], v12, s[8:11], s25 offen offset:3072
    v_mfma_f32_16x16x32_bf16 v[168:171], a[72:75], a[100:103], v[168:171]
    ds_read_b128 a[116:119], v9 offset:16896
    v_mfma_f32_16x16x32_bf16 v[164:167], a[68:71], a[100:103], v[164:167]
    v_mfma_f32_16x16x32_bf16 v[160:163], a[64:67], a[100:103], v[160:163]
    v_mfma_f32_16x16x32_bf16 v[192:195], a[64:67], a[104:107], v[192:195]
    buffer_load_dwordx4 a[48:51], v12, s[8:11], s31 offen offset:0
    v_mfma_f32_16x16x32_bf16 v[196:199], a[68:71], a[104:107], v[196:199]
    v_mfma_f32_16x16x32_bf16 v[200:203], a[72:75], a[104:107], v[200:203]
    v_mfma_f32_16x16x32_bf16 v[204:207], a[76:79], a[104:107], v[204:207]
    v_mfma_f32_16x16x32_bf16 v[208:211], a[80:83], a[104:107], v[208:211]
    buffer_load_dwordx4 a[52:55], v12, s[8:11], s31 offen offset:1024
    v_mfma_f32_16x16x32_bf16 v[212:215], a[84:87], a[104:107], v[212:215]
    ds_read_b128 a[120:123], v9 offset:33280
    v_mfma_f32_16x16x32_bf16 v[216:219], a[88:91], a[104:107], v[216:219]
    v_mfma_f32_16x16x32_bf16 v[220:223], a[92:95], a[104:107], v[220:223]
    v_mfma_f32_16x16x32_bf16 v[252:255], a[92:95], a[108:111], v[252:255]
    buffer_load_dwordx4 a[56:59], v12, s[8:11], s31 offen offset:2048
    v_mfma_f32_16x16x32_bf16 v[248:251], a[88:91], a[108:111], v[248:251]
    v_mfma_f32_16x16x32_bf16 v[244:247], a[84:87], a[108:111], v[244:247]
    v_mfma_f32_16x16x32_bf16 v[240:243], a[80:83], a[108:111], v[240:243]
    v_mfma_f32_16x16x32_bf16 v[236:239], a[76:79], a[108:111], v[236:239]
    buffer_load_dwordx4 a[60:63], v12, s[8:11], s31 offen offset:3072
    v_mfma_f32_16x16x32_bf16 v[232:235], a[72:75], a[108:111], v[232:235]
    ds_read_b128 a[124:127], v9 offset:49664
    v_mfma_f32_16x16x32_bf16 v[228:231], a[68:71], a[108:111], v[228:231]
    v_mfma_f32_16x16x32_bf16 v[224:227], a[64:67], a[108:111], v[224:227]
    s_waitcnt vmcnt(8) lgkmcnt(0)
    v_mfma_f32_16x16x32_bf16 v[128:131], a[0:3], a[112:115], v[128:131]
    s_add_u32 s25, s24, 360448
    s_add_u32 s31, s24, 364544
    v_mfma_f32_16x16x32_bf16 v[132:135], a[4:7], a[112:115], v[132:135]
    buffer_load_dwordx4 a[64:67], v12, s[8:11], s25 offen offset:0
    v_mfma_f32_16x16x32_bf16 v[136:139], a[8:11], a[112:115], v[136:139]
    v_mfma_f32_16x16x32_bf16 v[140:143], a[12:15], a[112:115], v[140:143]
    v_mfma_f32_16x16x32_bf16 v[144:147], a[16:19], a[112:115], v[144:147]
    buffer_load_dwordx4 a[68:71], v12, s[8:11], s25 offen offset:1024
    v_mfma_f32_16x16x32_bf16 v[148:151], a[20:23], a[112:115], v[148:151]
    ds_read_b128 a[96:99], v10 offset:512
    v_mfma_f32_16x16x32_bf16 v[152:155], a[24:27], a[112:115], v[152:155]
    v_mfma_f32_16x16x32_bf16 v[156:159], a[28:31], a[112:115], v[156:159]
    v_mfma_f32_16x16x32_bf16 v[188:191], a[28:31], a[116:119], v[188:191]
    buffer_load_dwordx4 a[72:75], v12, s[8:11], s25 offen offset:2048
    v_mfma_f32_16x16x32_bf16 v[184:187], a[24:27], a[116:119], v[184:187]
    v_mfma_f32_16x16x32_bf16 v[180:183], a[20:23], a[116:119], v[180:183]
    v_mfma_f32_16x16x32_bf16 v[176:179], a[16:19], a[116:119], v[176:179]
    v_mfma_f32_16x16x32_bf16 v[172:175], a[12:15], a[116:119], v[172:175]
    buffer_load_dwordx4 a[76:79], v12, s[8:11], s25 offen offset:3072
    v_mfma_f32_16x16x32_bf16 v[168:171], a[8:11], a[116:119], v[168:171]
    ds_read_b128 a[100:103], v10 offset:16896
    v_mfma_f32_16x16x32_bf16 v[164:167], a[4:7], a[116:119], v[164:167]
    v_mfma_f32_16x16x32_bf16 v[160:163], a[0:3], a[116:119], v[160:163]
    v_mfma_f32_16x16x32_bf16 v[192:195], a[0:3], a[120:123], v[192:195]
    buffer_load_dwordx4 a[80:83], v12, s[8:11], s31 offen offset:0
    v_mfma_f32_16x16x32_bf16 v[196:199], a[4:7], a[120:123], v[196:199]
    v_mfma_f32_16x16x32_bf16 v[200:203], a[8:11], a[120:123], v[200:203]
    v_mfma_f32_16x16x32_bf16 v[204:207], a[12:15], a[120:123], v[204:207]
    v_mfma_f32_16x16x32_bf16 v[208:211], a[16:19], a[120:123], v[208:211]
    buffer_load_dwordx4 a[84:87], v12, s[8:11], s31 offen offset:1024
    v_mfma_f32_16x16x32_bf16 v[212:215], a[20:23], a[120:123], v[212:215]
    ds_read_b128 a[104:107], v10 offset:33280
    v_mfma_f32_16x16x32_bf16 v[216:219], a[24:27], a[120:123], v[216:219]
    v_mfma_f32_16x16x32_bf16 v[220:223], a[28:31], a[120:123], v[220:223]
    v_mfma_f32_16x16x32_bf16 v[252:255], a[28:31], a[124:127], v[252:255]
    buffer_load_dwordx4 a[88:91], v12, s[8:11], s31 offen offset:2048
    v_mfma_f32_16x16x32_bf16 v[248:251], a[24:27], a[124:127], v[248:251]
    v_mfma_f32_16x16x32_bf16 v[244:247], a[20:23], a[124:127], v[244:247]
    v_mfma_f32_16x16x32_bf16 v[240:243], a[16:19], a[124:127], v[240:243]
    v_mfma_f32_16x16x32_bf16 v[236:239], a[12:15], a[124:127], v[236:239]
    buffer_load_dwordx4 a[92:95], v12, s[8:11], s31 offen offset:3072
    v_mfma_f32_16x16x32_bf16 v[232:235], a[8:11], a[124:127], v[232:235]
    ds_read_b128 a[108:111], v10 offset:49664
    v_mfma_f32_16x16x32_bf16 v[228:231], a[4:7], a[124:127], v[228:231]
    v_mfma_f32_16x16x32_bf16 v[224:227], a[0:3], a[124:127], v[224:227]
    s_waitcnt vmcnt(8) lgkmcnt(0)
    v_mfma_f32_16x16x32_bf16 v[128:131], a[32:35], a[96:99], v[128:131]
    s_add_u32 s25, s24, 393216
    s_add_u32 s31, s24, 397312
    v_mfma_f32_16x16x32_bf16 v[132:135], a[36:39], a[96:99], v[132:135]
    buffer_load_dwordx4 a[0:3], v12, s[8:11], s25 offen offset:0
    v_mfma_f32_16x16x32_bf16 v[136:139], a[40:43], a[96:99], v[136:139]
    v_mfma_f32_16x16x32_bf16 v[140:143], a[44:47], a[96:99], v[140:143]
    v_mfma_f32_16x16x32_bf16 v[144:147], a[48:51], a[96:99], v[144:147]
    buffer_load_dwordx4 a[4:7], v12, s[8:11], s25 offen offset:1024
    v_mfma_f32_16x16x32_bf16 v[148:151], a[52:55], a[96:99], v[148:151]
    ds_read_b128 a[112:115], v11 offset:512
    v_mfma_f32_16x16x32_bf16 v[152:155], a[56:59], a[96:99], v[152:155]
    v_mfma_f32_16x16x32_bf16 v[156:159], a[60:63], a[96:99], v[156:159]
    v_mfma_f32_16x16x32_bf16 v[188:191], a[60:63], a[100:103], v[188:191]
    buffer_load_dwordx4 a[8:11], v12, s[8:11], s25 offen offset:2048
    v_mfma_f32_16x16x32_bf16 v[184:187], a[56:59], a[100:103], v[184:187]
    v_mfma_f32_16x16x32_bf16 v[180:183], a[52:55], a[100:103], v[180:183]
    v_mfma_f32_16x16x32_bf16 v[176:179], a[48:51], a[100:103], v[176:179]
    v_mfma_f32_16x16x32_bf16 v[172:175], a[44:47], a[100:103], v[172:175]
    buffer_load_dwordx4 a[12:15], v12, s[8:11], s25 offen offset:3072
    v_mfma_f32_16x16x32_bf16 v[168:171], a[40:43], a[100:103], v[168:171]
    ds_read_b128 a[116:119], v11 offset:16896
    v_mfma_f32_16x16x32_bf16 v[164:167], a[36:39], a[100:103], v[164:167]
    v_mfma_f32_16x16x32_bf16 v[160:163], a[32:35], a[100:103], v[160:163]
    v_mfma_f32_16x16x32_bf16 v[192:195], a[32:35], a[104:107], v[192:195]
    buffer_load_dwordx4 a[16:19], v12, s[8:11], s31 offen offset:0
    v_mfma_f32_16x16x32_bf16 v[196:199], a[36:39], a[104:107], v[196:199]
    v_mfma_f32_16x16x32_bf16 v[200:203], a[40:43], a[104:107], v[200:203]
    v_mfma_f32_16x16x32_bf16 v[204:207], a[44:47], a[104:107], v[204:207]
    v_mfma_f32_16x16x32_bf16 v[208:211], a[48:51], a[104:107], v[208:211]
    buffer_load_dwordx4 a[20:23], v12, s[8:11], s31 offen offset:1024
    v_mfma_f32_16x16x32_bf16 v[212:215], a[52:55], a[104:107], v[212:215]
    ds_read_b128 a[120:123], v11 offset:33280
    v_mfma_f32_16x16x32_bf16 v[216:219], a[56:59], a[104:107], v[216:219]
    v_mfma_f32_16x16x32_bf16 v[220:223], a[60:63], a[104:107], v[220:223]
    v_mfma_f32_16x16x32_bf16 v[252:255], a[60:63], a[108:111], v[252:255]
    buffer_load_dwordx4 a[24:27], v12, s[8:11], s31 offen offset:2048
    v_mfma_f32_16x16x32_bf16 v[248:251], a[56:59], a[108:111], v[248:251]
    v_mfma_f32_16x16x32_bf16 v[244:247], a[52:55], a[108:111], v[244:247]
    v_mfma_f32_16x16x32_bf16 v[240:243], a[48:51], a[108:111], v[240:243]
    v_mfma_f32_16x16x32_bf16 v[236:239], a[44:47], a[108:111], v[236:239]
    buffer_load_dwordx4 a[28:31], v12, s[8:11], s31 offen offset:3072
    v_mfma_f32_16x16x32_bf16 v[232:235], a[40:43], a[108:111], v[232:235]
    ds_read_b128 a[124:127], v11 offset:49664
    v_mfma_f32_16x16x32_bf16 v[228:231], a[36:39], a[108:111], v[228:231]
    v_mfma_f32_16x16x32_bf16 v[224:227], a[32:35], a[108:111], v[224:227]
    s_waitcnt vmcnt(8) lgkmcnt(0)
    v_mfma_f32_16x16x32_bf16 v[128:131], a[64:67], a[112:115], v[128:131]
    s_add_u32 s25, s24, 425984
    s_add_u32 s31, s24, 430080
    v_mfma_f32_16x16x32_bf16 v[132:135], a[68:71], a[112:115], v[132:135]
    buffer_load_dwordx4 a[32:35], v12, s[8:11], s25 offen offset:0
    v_mfma_f32_16x16x32_bf16 v[136:139], a[72:75], a[112:115], v[136:139]
    v_mfma_f32_16x16x32_bf16 v[140:143], a[76:79], a[112:115], v[140:143]
    v_mfma_f32_16x16x32_bf16 v[144:147], a[80:83], a[112:115], v[144:147]
    buffer_load_dwordx4 a[36:39], v12, s[8:11], s25 offen offset:1024
    v_mfma_f32_16x16x32_bf16 v[148:151], a[84:87], a[112:115], v[148:151]
    ds_read_b128 a[96:99], v8 offset:768
    v_mfma_f32_16x16x32_bf16 v[152:155], a[88:91], a[112:115], v[152:155]
    v_mfma_f32_16x16x32_bf16 v[156:159], a[92:95], a[112:115], v[156:159]
    v_mfma_f32_16x16x32_bf16 v[188:191], a[92:95], a[116:119], v[188:191]
    buffer_load_dwordx4 a[40:43], v12, s[8:11], s25 offen offset:2048
    v_mfma_f32_16x16x32_bf16 v[184:187], a[88:91], a[116:119], v[184:187]
    v_mfma_f32_16x16x32_bf16 v[180:183], a[84:87], a[116:119], v[180:183]
    v_mfma_f32_16x16x32_bf16 v[176:179], a[80:83], a[116:119], v[176:179]
    v_mfma_f32_16x16x32_bf16 v[172:175], a[76:79], a[116:119], v[172:175]
    buffer_load_dwordx4 a[44:47], v12, s[8:11], s25 offen offset:3072
    v_mfma_f32_16x16x32_bf16 v[168:171], a[72:75], a[116:119], v[168:171]
    ds_read_b128 a[100:103], v8 offset:17152
    v_mfma_f32_16x16x32_bf16 v[164:167], a[68:71], a[116:119], v[164:167]
    v_mfma_f32_16x16x32_bf16 v[160:163], a[64:67], a[116:119], v[160:163]
    v_mfma_f32_16x16x32_bf16 v[192:195], a[64:67], a[120:123], v[192:195]
    buffer_load_dwordx4 a[48:51], v12, s[8:11], s31 offen offset:0
    v_mfma_f32_16x16x32_bf16 v[196:199], a[68:71], a[120:123], v[196:199]
    v_mfma_f32_16x16x32_bf16 v[200:203], a[72:75], a[120:123], v[200:203]
    v_mfma_f32_16x16x32_bf16 v[204:207], a[76:79], a[120:123], v[204:207]
    v_mfma_f32_16x16x32_bf16 v[208:211], a[80:83], a[120:123], v[208:211]
    buffer_load_dwordx4 a[52:55], v12, s[8:11], s31 offen offset:1024
    v_mfma_f32_16x16x32_bf16 v[212:215], a[84:87], a[120:123], v[212:215]
    ds_read_b128 a[104:107], v8 offset:33536
    v_mfma_f32_16x16x32_bf16 v[216:219], a[88:91], a[120:123], v[216:219]
    v_mfma_f32_16x16x32_bf16 v[220:223], a[92:95], a[120:123], v[220:223]
    v_mfma_f32_16x16x32_bf16 v[252:255], a[92:95], a[124:127], v[252:255]
    buffer_load_dwordx4 a[56:59], v12, s[8:11], s31 offen offset:2048
    v_mfma_f32_16x16x32_bf16 v[248:251], a[88:91], a[124:127], v[248:251]
    v_mfma_f32_16x16x32_bf16 v[244:247], a[84:87], a[124:127], v[244:247]
    v_mfma_f32_16x16x32_bf16 v[240:243], a[80:83], a[124:127], v[240:243]
    v_mfma_f32_16x16x32_bf16 v[236:239], a[76:79], a[124:127], v[236:239]
    buffer_load_dwordx4 a[60:63], v12, s[8:11], s31 offen offset:3072
    v_mfma_f32_16x16x32_bf16 v[232:235], a[72:75], a[124:127], v[232:235]
    ds_read_b128 a[108:111], v8 offset:49920
    v_mfma_f32_16x16x32_bf16 v[228:231], a[68:71], a[124:127], v[228:231]
    v_mfma_f32_16x16x32_bf16 v[224:227], a[64:67], a[124:127], v[224:227]
    s_waitcnt vmcnt(8) lgkmcnt(0)
    v_mfma_f32_16x16x32_bf16 v[128:131], a[0:3], a[96:99], v[128:131]
    s_add_u32 s25, s24, 458752
    s_add_u32 s31, s24, 462848
    v_mfma_f32_16x16x32_bf16 v[132:135], a[4:7], a[96:99], v[132:135]
    buffer_load_dwordx4 a[64:67], v12, s[8:11], s25 offen offset:0
    v_mfma_f32_16x16x32_bf16 v[136:139], a[8:11], a[96:99], v[136:139]
    v_mfma_f32_16x16x32_bf16 v[140:143], a[12:15], a[96:99], v[140:143]
    v_mfma_f32_16x16x32_bf16 v[144:147], a[16:19], a[96:99], v[144:147]
    buffer_load_dwordx4 a[68:71], v12, s[8:11], s25 offen offset:1024
    v_mfma_f32_16x16x32_bf16 v[148:151], a[20:23], a[96:99], v[148:151]
    ds_read_b128 a[112:115], v9 offset:768
    v_mfma_f32_16x16x32_bf16 v[152:155], a[24:27], a[96:99], v[152:155]
    v_mfma_f32_16x16x32_bf16 v[156:159], a[28:31], a[96:99], v[156:159]
    v_mfma_f32_16x16x32_bf16 v[188:191], a[28:31], a[100:103], v[188:191]
    buffer_load_dwordx4 a[72:75], v12, s[8:11], s25 offen offset:2048
    v_mfma_f32_16x16x32_bf16 v[184:187], a[24:27], a[100:103], v[184:187]
    v_mfma_f32_16x16x32_bf16 v[180:183], a[20:23], a[100:103], v[180:183]
    v_mfma_f32_16x16x32_bf16 v[176:179], a[16:19], a[100:103], v[176:179]
    v_mfma_f32_16x16x32_bf16 v[172:175], a[12:15], a[100:103], v[172:175]
    buffer_load_dwordx4 a[76:79], v12, s[8:11], s25 offen offset:3072
    v_mfma_f32_16x16x32_bf16 v[168:171], a[8:11], a[100:103], v[168:171]
    ds_read_b128 a[116:119], v9 offset:17152
    v_mfma_f32_16x16x32_bf16 v[164:167], a[4:7], a[100:103], v[164:167]
    v_mfma_f32_16x16x32_bf16 v[160:163], a[0:3], a[100:103], v[160:163]
    v_mfma_f32_16x16x32_bf16 v[192:195], a[0:3], a[104:107], v[192:195]
    buffer_load_dwordx4 a[80:83], v12, s[8:11], s31 offen offset:0
    v_mfma_f32_16x16x32_bf16 v[196:199], a[4:7], a[104:107], v[196:199]
    v_mfma_f32_16x16x32_bf16 v[200:203], a[8:11], a[104:107], v[200:203]
    v_mfma_f32_16x16x32_bf16 v[204:207], a[12:15], a[104:107], v[204:207]
    v_mfma_f32_16x16x32_bf16 v[208:211], a[16:19], a[104:107], v[208:211]
    buffer_load_dwordx4 a[84:87], v12, s[8:11], s31 offen offset:1024
    v_mfma_f32_16x16x32_bf16 v[212:215], a[20:23], a[104:107], v[212:215]
    ds_read_b128 a[120:123], v9 offset:33536
    v_mfma_f32_16x16x32_bf16 v[216:219], a[24:27], a[104:107], v[216:219]
    v_mfma_f32_16x16x32_bf16 v[220:223], a[28:31], a[104:107], v[220:223]
    v_mfma_f32_16x16x32_bf16 v[252:255], a[28:31], a[108:111], v[252:255]
    buffer_load_dwordx4 a[88:91], v12, s[8:11], s31 offen offset:2048
    v_mfma_f32_16x16x32_bf16 v[248:251], a[24:27], a[108:111], v[248:251]
    v_mfma_f32_16x16x32_bf16 v[244:247], a[20:23], a[108:111], v[244:247]
    v_mfma_f32_16x16x32_bf16 v[240:243], a[16:19], a[108:111], v[240:243]
    v_mfma_f32_16x16x32_bf16 v[236:239], a[12:15], a[108:111], v[236:239]
    buffer_load_dwordx4 a[92:95], v12, s[8:11], s31 offen offset:3072
    v_mfma_f32_16x16x32_bf16 v[232:235], a[8:11], a[108:111], v[232:235]
    ds_read_b128 a[124:127], v9 offset:49920
    v_mfma_f32_16x16x32_bf16 v[228:231], a[4:7], a[108:111], v[228:231]
    v_mfma_f32_16x16x32_bf16 v[224:227], a[0:3], a[108:111], v[224:227]
    s_waitcnt vmcnt(8) lgkmcnt(0)
    v_mfma_f32_16x16x32_bf16 v[128:131], a[32:35], a[112:115], v[128:131]
    s_add_u32 s25, s24, 491520
    s_add_u32 s31, s24, 495616
    v_mfma_f32_16x16x32_bf16 v[132:135], a[36:39], a[112:115], v[132:135]
    buffer_load_dwordx4 a[0:3], v12, s[8:11], s25 offen offset:0
    v_mfma_f32_16x16x32_bf16 v[136:139], a[40:43], a[112:115], v[136:139]
    v_mfma_f32_16x16x32_bf16 v[140:143], a[44:47], a[112:115], v[140:143]
    v_mfma_f32_16x16x32_bf16 v[144:147], a[48:51], a[112:115], v[144:147]
    buffer_load_dwordx4 a[4:7], v12, s[8:11], s25 offen offset:1024
    v_mfma_f32_16x16x32_bf16 v[148:151], a[52:55], a[112:115], v[148:151]
    ds_read_b128 a[96:99], v10 offset:768
    v_mfma_f32_16x16x32_bf16 v[152:155], a[56:59], a[112:115], v[152:155]
    v_mfma_f32_16x16x32_bf16 v[156:159], a[60:63], a[112:115], v[156:159]
    v_mfma_f32_16x16x32_bf16 v[188:191], a[60:63], a[116:119], v[188:191]
    buffer_load_dwordx4 a[8:11], v12, s[8:11], s25 offen offset:2048
    v_mfma_f32_16x16x32_bf16 v[184:187], a[56:59], a[116:119], v[184:187]
    v_mfma_f32_16x16x32_bf16 v[180:183], a[52:55], a[116:119], v[180:183]
    v_mfma_f32_16x16x32_bf16 v[176:179], a[48:51], a[116:119], v[176:179]
    v_mfma_f32_16x16x32_bf16 v[172:175], a[44:47], a[116:119], v[172:175]
    buffer_load_dwordx4 a[12:15], v12, s[8:11], s25 offen offset:3072
    v_mfma_f32_16x16x32_bf16 v[168:171], a[40:43], a[116:119], v[168:171]
    ds_read_b128 a[100:103], v10 offset:17152
    v_mfma_f32_16x16x32_bf16 v[164:167], a[36:39], a[116:119], v[164:167]
    v_mfma_f32_16x16x32_bf16 v[160:163], a[32:35], a[116:119], v[160:163]
    v_mfma_f32_16x16x32_bf16 v[192:195], a[32:35], a[120:123], v[192:195]
    buffer_load_dwordx4 a[16:19], v12, s[8:11], s31 offen offset:0
    v_mfma_f32_16x16x32_bf16 v[196:199], a[36:39], a[120:123], v[196:199]
    v_mfma_f32_16x16x32_bf16 v[200:203], a[40:43], a[120:123], v[200:203]
    v_mfma_f32_16x16x32_bf16 v[204:207], a[44:47], a[120:123], v[204:207]
    v_mfma_f32_16x16x32_bf16 v[208:211], a[48:51], a[120:123], v[208:211]
    buffer_load_dwordx4 a[20:23], v12, s[8:11], s31 offen offset:1024
    v_mfma_f32_16x16x32_bf16 v[212:215], a[52:55], a[120:123], v[212:215]
    ds_read_b128 a[104:107], v10 offset:33536
    v_mfma_f32_16x16x32_bf16 v[216:219], a[56:59], a[120:123], v[216:219]
    v_mfma_f32_16x16x32_bf16 v[220:223], a[60:63], a[120:123], v[220:223]
    v_mfma_f32_16x16x32_bf16 v[252:255], a[60:63], a[124:127], v[252:255]
    buffer_load_dwordx4 a[24:27], v12, s[8:11], s31 offen offset:2048
    v_mfma_f32_16x16x32_bf16 v[248:251], a[56:59], a[124:127], v[248:251]
    v_mfma_f32_16x16x32_bf16 v[244:247], a[52:55], a[124:127], v[244:247]
    v_mfma_f32_16x16x32_bf16 v[240:243], a[48:51], a[124:127], v[240:243]
    v_mfma_f32_16x16x32_bf16 v[236:239], a[44:47], a[124:127], v[236:239]
    buffer_load_dwordx4 a[28:31], v12, s[8:11], s31 offen offset:3072
    v_mfma_f32_16x16x32_bf16 v[232:235], a[40:43], a[124:127], v[232:235]
    ds_read_b128 a[108:111], v10 offset:49920
    v_mfma_f32_16x16x32_bf16 v[228:231], a[36:39], a[124:127], v[228:231]
    v_mfma_f32_16x16x32_bf16 v[224:227], a[32:35], a[124:127], v[224:227]
    s_waitcnt vmcnt(8) lgkmcnt(0)
    v_mfma_f32_16x16x32_bf16 v[128:131], a[64:67], a[96:99], v[128:131]
    v_mfma_f32_16x16x32_bf16 v[132:135], a[68:71], a[96:99], v[132:135]
    v_mfma_f32_16x16x32_bf16 v[136:139], a[72:75], a[96:99], v[136:139]
    v_mfma_f32_16x16x32_bf16 v[140:143], a[76:79], a[96:99], v[140:143]
    v_mfma_f32_16x16x32_bf16 v[144:147], a[80:83], a[96:99], v[144:147]
    v_mfma_f32_16x16x32_bf16 v[148:151], a[84:87], a[96:99], v[148:151]
    ds_read_b128 a[112:115], v11 offset:768
    v_mfma_f32_16x16x32_bf16 v[152:155], a[88:91], a[96:99], v[152:155]
    v_mfma_f32_16x16x32_bf16 v[156:159], a[92:95], a[96:99], v[156:159]
    v_mfma_f32_16x16x32_bf16 v[188:191], a[92:95], a[100:103], v[188:191]
    v_mfma_f32_16x16x32_bf16 v[184:187], a[88:91], a[100:103], v[184:187]
    v_mfma_f32_16x16x32_bf16 v[180:183], a[84:87], a[100:103], v[180:183]
    v_mfma_f32_16x16x32_bf16 v[176:179], a[80:83], a[100:103], v[176:179]
    v_mfma_f32_16x16x32_bf16 v[172:175], a[76:79], a[100:103], v[172:175]
    v_mfma_f32_16x16x32_bf16 v[168:171], a[72:75], a[100:103], v[168:171]
    ds_read_b128 a[116:119], v11 offset:17152
    v_mfma_f32_16x16x32_bf16 v[164:167], a[68:71], a[100:103], v[164:167]
    v_mfma_f32_16x16x32_bf16 v[160:163], a[64:67], a[100:103], v[160:163]
    v_mfma_f32_16x16x32_bf16 v[192:195], a[64:67], a[104:107], v[192:195]
    v_mfma_f32_16x16x32_bf16 v[196:199], a[68:71], a[104:107], v[196:199]
    v_mfma_f32_16x16x32_bf16 v[200:203], a[72:75], a[104:107], v[200:203]
    v_mfma_f32_16x16x32_bf16 v[204:207], a[76:79], a[104:107], v[204:207]
    v_mfma_f32_16x16x32_bf16 v[208:211], a[80:83], a[104:107], v[208:211]
    v_mfma_f32_16x16x32_bf16 v[212:215], a[84:87], a[104:107], v[212:215]
    ds_read_b128 a[120:123], v11 offset:33536
    v_mfma_f32_16x16x32_bf16 v[216:219], a[88:91], a[104:107], v[216:219]
    v_mfma_f32_16x16x32_bf16 v[220:223], a[92:95], a[104:107], v[220:223]
    v_mfma_f32_16x16x32_bf16 v[252:255], a[92:95], a[108:111], v[252:255]
    v_mfma_f32_16x16x32_bf16 v[248:251], a[88:91], a[108:111], v[248:251]
    v_mfma_f32_16x16x32_bf16 v[244:247], a[84:87], a[108:111], v[244:247]
    v_mfma_f32_16x16x32_bf16 v[240:243], a[80:83], a[108:111], v[240:243]
    v_mfma_f32_16x16x32_bf16 v[236:239], a[76:79], a[108:111], v[236:239]
    v_mfma_f32_16x16x32_bf16 v[232:235], a[72:75], a[108:111], v[232:235]
    ds_read_b128 a[124:127], v11 offset:49920
    v_mfma_f32_16x16x32_bf16 v[228:231], a[68:71], a[108:111], v[228:231]
    v_mfma_f32_16x16x32_bf16 v[224:227], a[64:67], a[108:111], v[224:227]
    s_waitcnt vmcnt(0) lgkmcnt(0)
    v_mfma_f32_16x16x32_bf16 v[128:131], a[0:3], a[112:115], v[128:131]
    v_mfma_f32_16x16x32_bf16 v[132:135], a[4:7], a[112:115], v[132:135]
    v_mfma_f32_16x16x32_bf16 v[136:139], a[8:11], a[112:115], v[136:139]
    v_mfma_f32_16x16x32_bf16 v[140:143], a[12:15], a[112:115], v[140:143]
    v_mfma_f32_16x16x32_bf16 v[144:147], a[16:19], a[112:115], v[144:147]
    v_mfma_f32_16x16x32_bf16 v[148:151], a[20:23], a[112:115], v[148:151]
    v_mfma_f32_16x16x32_bf16 v[152:155], a[24:27], a[112:115], v[152:155]
    v_mfma_f32_16x16x32_bf16 v[156:159], a[28:31], a[112:115], v[156:159]
    v_mfma_f32_16x16x32_bf16 v[188:191], a[28:31], a[116:119], v[188:191]
    v_mfma_f32_16x16x32_bf16 v[184:187], a[24:27], a[116:119], v[184:187]
    v_mfma_f32_16x16x32_bf16 v[180:183], a[20:23], a[116:119], v[180:183]
    v_mfma_f32_16x16x32_bf16 v[176:179], a[16:19], a[116:119], v[176:179]
    v_cvt_pk_bf16_f32 v96, v128, v132
    v_cvt_pk_bf16_f32 v97, v136, v140
    v_mfma_f32_16x16x32_bf16 v[172:175], a[12:15], a[116:119], v[172:175]
    v_cvt_pk_bf16_f32 v98, v129, v133
    v_cvt_pk_bf16_f32 v99, v137, v141
    v_mfma_f32_16x16x32_bf16 v[168:171], a[8:11], a[116:119], v[168:171]
    v_cvt_pk_bf16_f32 v100, v130, v134
    v_cvt_pk_bf16_f32 v101, v138, v142
    v_mfma_f32_16x16x32_bf16 v[164:167], a[4:7], a[116:119], v[164:167]
    v_cvt_pk_bf16_f32 v102, v131, v135
    v_cvt_pk_bf16_f32 v103, v139, v143
    ds_write_b128 v88, v[96:99] offset:0
    v_mfma_f32_16x16x32_bf16 v[160:163], a[0:3], a[116:119], v[160:163]
    ds_write_b128 v89, v[100:103] offset:0
    v_cvt_pk_bf16_f32 v104, v144, v148
    v_cvt_pk_bf16_f32 v105, v152, v156
    v_mfma_f32_16x16x32_bf16 v[192:195], a[0:3], a[120:123], v[192:195]
    v_cvt_pk_bf16_f32 v106, v145, v149
    v_cvt_pk_bf16_f32 v107, v153, v157
    v_mfma_f32_16x16x32_bf16 v[196:199], a[4:7], a[120:123], v[196:199]
    v_cvt_pk_bf16_f32 v108, v146, v150
    v_cvt_pk_bf16_f32 v109, v154, v158
    v_mfma_f32_16x16x32_bf16 v[200:203], a[8:11], a[120:123], v[200:203]
    v_cvt_pk_bf16_f32 v110, v147, v151
    v_cvt_pk_bf16_f32 v111, v155, v159
    ds_write_b128 v88, v[104:107] offset:128
    v_mfma_f32_16x16x32_bf16 v[204:207], a[12:15], a[120:123], v[204:207]
    ds_write_b128 v89, v[108:111] offset:128
    v_cvt_pk_bf16_f32 v120, v176, v180
    v_cvt_pk_bf16_f32 v121, v184, v188
    v_mfma_f32_16x16x32_bf16 v[208:211], a[16:19], a[120:123], v[208:211]
    v_cvt_pk_bf16_f32 v122, v177, v181
    v_cvt_pk_bf16_f32 v123, v185, v189
    v_mfma_f32_16x16x32_bf16 v[212:215], a[20:23], a[120:123], v[212:215]
    v_cvt_pk_bf16_f32 v124, v178, v182
    v_cvt_pk_bf16_f32 v125, v186, v190
    v_mfma_f32_16x16x32_bf16 v[216:219], a[24:27], a[120:123], v[216:219]
    v_cvt_pk_bf16_f32 v126, v179, v183
    v_cvt_pk_bf16_f32 v127, v187, v191
    ds_write_b128 v88, v[120:123] offset:16512
    v_mfma_f32_16x16x32_bf16 v[220:223], a[28:31], a[120:123], v[220:223]
    ds_write_b128 v89, v[124:127] offset:16512
    v_cvt_pk_bf16_f32 v112, v160, v164
    v_cvt_pk_bf16_f32 v113, v168, v172
    v_mfma_f32_16x16x32_bf16 v[252:255], a[28:31], a[124:127], v[252:255]
    v_cvt_pk_bf16_f32 v114, v161, v165
    v_cvt_pk_bf16_f32 v115, v169, v173
    v_mfma_f32_16x16x32_bf16 v[248:251], a[24:27], a[124:127], v[248:251]
    v_cvt_pk_bf16_f32 v116, v162, v166
    v_cvt_pk_bf16_f32 v117, v170, v174
    v_mfma_f32_16x16x32_bf16 v[244:247], a[20:23], a[124:127], v[244:247]
    v_cvt_pk_bf16_f32 v118, v163, v167
    v_cvt_pk_bf16_f32 v119, v171, v175
    ds_write_b128 v88, v[112:115] offset:16384
    v_mfma_f32_16x16x32_bf16 v[240:243], a[16:19], a[124:127], v[240:243]
    ds_write_b128 v89, v[116:119] offset:16384
    v_cvt_pk_bf16_f32 v96, v192, v196
    v_cvt_pk_bf16_f32 v97, v200, v204
    v_mfma_f32_16x16x32_bf16 v[236:239], a[12:15], a[124:127], v[236:239]
    v_cvt_pk_bf16_f32 v98, v193, v197
    v_cvt_pk_bf16_f32 v99, v201, v205
    v_mfma_f32_16x16x32_bf16 v[232:235], a[8:11], a[124:127], v[232:235]
    v_cvt_pk_bf16_f32 v100, v194, v198
    v_cvt_pk_bf16_f32 v101, v202, v206
    v_mfma_f32_16x16x32_bf16 v[228:231], a[4:7], a[124:127], v[228:231]
    v_cvt_pk_bf16_f32 v102, v195, v199
    v_cvt_pk_bf16_f32 v103, v203, v207
    ds_write_b128 v88, v[96:99] offset:32768
    v_mfma_f32_16x16x32_bf16 v[224:227], a[0:3], a[124:127], v[224:227]
    ds_write_b128 v89, v[100:103] offset:32768
    v_cvt_pk_bf16_f32 v104, v208, v212
    v_cvt_pk_bf16_f32 v105, v216, v220
    v_cvt_pk_bf16_f32 v106, v209, v213
    v_cvt_pk_bf16_f32 v107, v217, v221
    v_cvt_pk_bf16_f32 v108, v210, v214
    v_cvt_pk_bf16_f32 v109, v218, v222
    v_cvt_pk_bf16_f32 v110, v211, v215
    v_cvt_pk_bf16_f32 v111, v219, v223
    ds_write_b128 v88, v[104:107] offset:32896
    ds_write_b128 v89, v[108:111] offset:32896
    s_waitcnt lgkmcnt(4)
    s_barrier
    ds_read_b128 v[16:19], v90 offset:0
    ds_read_b128 v[20:23], v91 offset:1024
    ds_read_b128 v[24:27], v92 offset:2048
    ds_read_b128 v[28:31], v93 offset:3072
    ds_read_b128 v[32:35], v90 offset:16384
    ds_read_b128 v[36:39], v91 offset:17408
    ds_read_b128 v[40:43], v92 offset:18432
    ds_read_b128 v[44:47], v93 offset:19456
    s_nop 3
    v_cvt_pk_bf16_f32 v120, v240, v244
    v_cvt_pk_bf16_f32 v121, v248, v252
    v_cvt_pk_bf16_f32 v122, v241, v245
    v_cvt_pk_bf16_f32 v123, v249, v253
    v_cvt_pk_bf16_f32 v124, v242, v246
    v_cvt_pk_bf16_f32 v125, v250, v254
    v_cvt_pk_bf16_f32 v126, v243, v247
    v_cvt_pk_bf16_f32 v127, v251, v255
    ds_write_b128 v88, v[120:123] offset:49280
    ds_write_b128 v89, v[124:127] offset:49280
    v_cvt_pk_bf16_f32 v112, v224, v228
    v_cvt_pk_bf16_f32 v113, v232, v236
    v_cvt_pk_bf16_f32 v114, v225, v229
    v_cvt_pk_bf16_f32 v115, v233, v237
    v_cvt_pk_bf16_f32 v116, v226, v230
    v_cvt_pk_bf16_f32 v117, v234, v238
    v_cvt_pk_bf16_f32 v118, v227, v231
    v_cvt_pk_bf16_f32 v119, v235, v239
    ds_write_b128 v88, v[112:115] offset:49152
    ds_write_b128 v89, v[116:119] offset:49152
    s_waitcnt lgkmcnt(11)
    s_add_u32 s27, s60, 0
    buffer_store_dwordx4 v[16:19], v12, s[12:15], s27 offen sc0 sc1
    s_waitcnt lgkmcnt(10)
    s_add_u32 s27, s61, 0
    buffer_store_dwordx4 v[20:23], v12, s[12:15], s27 offen sc0 sc1
    s_waitcnt lgkmcnt(9)
    s_add_u32 s27, s62, 0
    buffer_store_dwordx4 v[24:27], v12, s[12:15], s27 offen sc0 sc1
    s_waitcnt lgkmcnt(8)
    s_add_u32 s27, s63, 0
    buffer_store_dwordx4 v[28:31], v12, s[12:15], s27 offen sc0 sc1
    s_waitcnt lgkmcnt(7)
    s_add_u32 s27, s60, 2048
    buffer_store_dwordx4 v[32:35], v12, s[12:15], s27 offen sc0 sc1
    s_waitcnt lgkmcnt(6)
    s_add_u32 s27, s61, 2048
    buffer_store_dwordx4 v[36:39], v12, s[12:15], s27 offen sc0 sc1
    s_waitcnt lgkmcnt(5)
    s_add_u32 s27, s62, 2048
    buffer_store_dwordx4 v[40:43], v12, s[12:15], s27 offen sc0 sc1
    s_waitcnt lgkmcnt(4)
    s_add_u32 s27, s63, 2048
    buffer_store_dwordx4 v[44:47], v12, s[12:15], s27 offen sc0 sc1
    s_waitcnt lgkmcnt(0)
    s_barrier
    ds_read_b128 v[128:131], v90 offset:32768
    ds_read_b128 v[132:135], v91 offset:33792
    ds_read_b128 v[136:139], v92 offset:34816
    ds_read_b128 v[140:143], v93 offset:35840
    ds_read_b128 v[144:147], v90 offset:49152
    ds_read_b128 v[148:151], v91 offset:50176
    ds_read_b128 v[152:155], v92 offset:51200
    ds_read_b128 v[156:159], v93 offset:52224
    s_waitcnt lgkmcnt(7)
    s_add_u32 s27, s60, 4096
    buffer_store_dwordx4 v[128:131], v12, s[12:15], s27 offen sc0 sc1
    s_waitcnt lgkmcnt(6)
    s_add_u32 s27, s61, 4096
    buffer_store_dwordx4 v[132:135], v12, s[12:15], s27 offen sc0 sc1
    s_waitcnt lgkmcnt(5)
    s_add_u32 s27, s62, 4096
    buffer_store_dwordx4 v[136:139], v12, s[12:15], s27 offen sc0 sc1
    s_waitcnt lgkmcnt(4)
    s_add_u32 s27, s63, 4096
    buffer_store_dwordx4 v[140:143], v12, s[12:15], s27 offen sc0 sc1
    s_waitcnt lgkmcnt(3)
    s_add_u32 s27, s60, 6144
    buffer_store_dwordx4 v[144:147], v12, s[12:15], s27 offen sc0 sc1
    s_waitcnt lgkmcnt(2)
    s_add_u32 s27, s61, 6144
    buffer_store_dwordx4 v[148:151], v12, s[12:15], s27 offen sc0 sc1
    s_waitcnt lgkmcnt(1)
    s_add_u32 s27, s62, 6144
    buffer_store_dwordx4 v[152:155], v12, s[12:15], s27 offen sc0 sc1
    s_waitcnt lgkmcnt(0)
    s_add_u32 s27, s63, 6144
    buffer_store_dwordx4 v[156:159], v12, s[12:15], s27 offen sc0 sc1
    s_cmp_lg_u32 s2, 0
    s_cbranch_scc1 p4_fin1
    s_mov_b32 s27, 0
    s_cmp_lg_u32 s16, 0
    s_cbranch_scc1 p4_sig19
    v_mov_b32 v6, s100
    v_mov_b32 v7, 0
    s_mov_b64 exec, 1
    buffer_store_dword v6, v7, s[92:95], s27 offen sc0 sc1
    s_mov_b64 exec, -1
p4_sig19:
p4_fin1:
    s_endpgm
standalone__seq2seq_rnn_t_joint__speech_kernel_end:
    s_endpgm
.section .rodata,"a"
.p2align 6
.amdhsa_kernel standalone__seq2seq_rnn_t_joint__speech_kernel
  .amdhsa_next_free_vgpr 384
  .amdhsa_next_free_sgpr 102
  .amdhsa_accum_offset 256
  .amdhsa_group_segment_fixed_size 0
  .amdhsa_kernarg_size 80
  .amdhsa_user_sgpr_count 2
  .amdhsa_user_sgpr_kernarg_segment_ptr 1
  .amdhsa_system_sgpr_workgroup_id_x 1
  .amdhsa_float_denorm_mode_32 3
.end_amdhsa_kernel
```
